```python
import torch

def _softmax(x, axis=-1):
    return torch.softmax(x, dim=axis)

def _gelu(x):
    return torch.nn.functional.gelu(x, approximate='tanh')

def _silu(x):
    return torch.nn.functional.silu(x)

def _sigmoid(x):
    return torch.sigmoid(x)

def _layernorm(x, axis=-1, eps=1e-05):
    m = x.mean(dim=axis, keepdim=True)
    v = x.var(dim=axis, keepdim=True, unbiased=False)
    return (x - m) / torch.sqrt(v + eps)

def _scatter_add(tgt, idx, src, axis=0):
    return tgt.clone().index_add_(axis, idx, src)

def _segment_sum(src, seg, n):
    out = torch.zeros((n,) + src.shape[1:], dtype=src.dtype)
    return out.index_add_(0, seg, src)

def _pad(x, pw):
    flat = tuple((v for pair in reversed(pw) for v in pair))
    return torch.nn.functional.pad(x, flat)
kernel_name = 'parallel_sum__memory_aug_recurrent_mem_tr__mixer_token_mlp__prompt'

def setup_inputs():

    _w = lambda a: (lambda t: t.to(torch.bfloat16) if t.is_floating_point() else t)(torch.as_tensor(a))

    def _A_setup():
        B, S, Dm = (1, 2048, 576)
        H, Dh = (32, 128)
        M, seg = (8, 32)
        seg = min(seg, S)
        S = S // seg * seg
        return {'x': _w((lambda *s: torch.randn(*s, dtype=torch.bfloat16) * 0.05)(B, S, Dm)), 'mem0': _w((lambda *s: torch.randn(*s, dtype=torch.bfloat16) * 0.2)(B, M, Dm)), 'Wq': _w((lambda *s: torch.randn(*s, dtype=torch.bfloat16) * 1.6)(Dm, H, Dh) * Dm ** (-0.5)), 'Wk': _w((lambda *s: torch.randn(*s, dtype=torch.bfloat16) * 1.6)(Dm, H, Dh) * Dm ** (-0.5)), 'Wv': _w((lambda *s: torch.randn(*s, dtype=torch.bfloat16) * 0.2)(Dm, H, Dh) * Dm ** (-0.5)), 'Wo': _w((lambda *s: torch.randn(*s, dtype=torch.bfloat16) * 0.2)(H, Dh, Dm) * (H * Dh) ** (-0.5)), 'seg_len': seg}
    _A_in = _A_setup()

    def _B_setup():
        B, S, D, F = (1, 2048, 576, 4608)
        return {'x': _w((lambda *s: torch.randn(*s, dtype=torch.bfloat16) * 0.05)(B, S, D)), 'w1': _w((lambda *s: torch.randn(*s, dtype=torch.bfloat16) * 0.4)(S, F) * S ** (-0.5)), 'b1': _w((lambda *s: torch.randn(*s, dtype=torch.bfloat16) * 3.2)(F) * 0.02), 'w2': _w((lambda *s: torch.randn(*s, dtype=torch.bfloat16) * 0.2)(F, S) * F ** (-0.5)), 'b2': _w((lambda *s: torch.randn(*s, dtype=torch.bfloat16) * 0.4)(S) * 0.02)}
    _B_in = _B_setup()
    return {'A_x': _A_in['x'], 'A_mem0': _A_in['mem0'], 'A_Wq': _A_in['Wq'], 'A_Wk': _A_in['Wk'], 'A_Wv': _A_in['Wv'], 'A_Wo': _A_in['Wo'], 'A_seg_len': _A_in['seg_len'], 'B_x': _B_in['x'], 'B_w1': _B_in['w1'], 'B_b1': _B_in['b1'], 'B_w2': _B_in['w2'], 'B_b2': _B_in['b2']}

def reference(A_x, A_mem0, A_Wq, A_Wk, A_Wv, A_Wo, A_seg_len, B_x, B_w1, B_b1, B_w2, B_b2):

    def _A_ref(x, mem0, Wq, Wk, Wv, Wo, seg_len):
        B, S, Dm = x.shape
        H, Dh = (Wq.shape[1], Wq.shape[2])
        M = mem0.shape[1]
        scale = Dh ** (-0.5)
        n_seg = S // seg_len
        L = M + seg_len
        idx = torch.arange(L)
        mask = (idx[:, None] < M) | (idx[:, None] >= idx[None, :])
        mem = mem0
        outs = []
        for s in range(n_seg):
            xs = x[:, s * seg_len:(s + 1) * seg_len, :].clone()
            h = torch.concatenate([mem, xs], axis=1)
            q = torch.einsum('btd,dhe->bhte', h, Wq)
            k = torch.einsum('btd,dhe->bhte', h, Wk)
            v = torch.einsum('btd,dhe->bhte', h, Wv)
            scores = torch.einsum('bhqe,bhke->bhqk', q, k) * scale
            scores = torch.where(mask[None, None], scores, -1000000000.0)
            p = _softmax(scores, axis=-1)
            o = torch.einsum('bhqk,bhke->bhqe', p, v)
            o = torch.einsum('bhte,hed->btd', o, Wo)
            mem = o[:, :M, :].clone()
            outs.append(o[:, M:, :])
        return torch.concatenate(outs, axis=1)

    def _B_ref(x, w1, b1, w2, b2):
        B, S, D = x.shape
        h = _layernorm(x, axis=-1)
        u = torch.einsum('bsd,sf->bdf', h, w1) + b1
        u = _gelu(u)
        y = torch.einsum('bdf,fs->bds', u, w2) + b2
        return (lambda x, *d: x.permute(*d))(y, 0, 2, 1)
    x = A_x
    xn = _layernorm(x, axis=-1)
    return x + _A_ref(xn, A_mem0, A_Wq, A_Wk, A_Wv, A_Wo, A_seg_len) + _B_ref(xn, B_w1, B_b1, B_w2, B_b2)
```

```asm
; @launch kernel=parallel_sum__memory_aug_recurrent_mem_tr__mixer_token_mlp__prompt_kernel grid=(256,1,1) block=(256,1,1) lds=163840
.amdgcn_target "amdgcn-amd-amdhsa--gfx950"
.text
.globl parallel_sum__memory_aug_recurrent_mem_tr__mixer_token_mlp__prompt_kernel
.p2align 8
.type parallel_sum__memory_aug_recurrent_mem_tr__mixer_token_mlp__prompt_kernel,@function
parallel_sum__memory_aug_recurrent_mem_tr__mixer_token_mlp__prompt_kernel:
s_cmp_ge_u32 s2, 256
s_cbranch_scc1 L_exit
s_load_dwordx2 s[6:7], s[0:1], 104
s_getreg_b32 s4, hwreg(HW_REG_XCC_ID, 0, 4)
s_and_b32 s4, s4, 7
v_lshrrev_b32 v1, 6, v0
s_nop 0
v_readfirstlane_b32 s8, v1
s_nop 0
s_cmp_eq_u32 s8, 0
s_cbranch_scc0 L_tk_wait
s_lshl_b32 s9, s4, 2
v_mov_b32 v2, s9
v_mov_b32 v3, 1
s_waitcnt lgkmcnt(0)
s_mov_b64 exec, 1
global_atomic_add v4, v2, v3, s[6:7] sc0
s_waitcnt vmcnt(0)
v_mov_b32 v5, 0
ds_write_b32 v5, v4
s_waitcnt lgkmcnt(0)
s_mov_b64 exec, -1
L_tk_wait:
s_barrier
v_mov_b32 v5, 0
ds_read_b32 v4, v5
s_waitcnt lgkmcnt(0)
v_readfirstlane_b32 s5, v4
s_barrier
s_cmp_ge_u32 s5, 32
s_cbranch_scc1 L_exit
s_cmp_eq_u32 s4, 0
s_cbranch_scc0 L_work
s_mov_b32 s10, s5
s_mov_b32 s42, s0
s_mov_b32 s43, s1
s_load_dwordx2 s[40:41], s[0:1], 104
s_load_dwordx2 s[12:13], s[0:1], 112
v_lshrrev_b32 v72, 6, v0
v_and_b32 v0, 63, v0
v_readfirstlane_b32 s11, v72
s_mov_b32 s14, 268435456
s_mov_b32 s15, 0x20000
s_mov_b32 s19, 0x20000
s_mov_b32 s28, 75497472
s_mov_b32 s29, 76021760
s_mov_b32 s48, 0x00ff00ff
s_mov_b32 s49, 0x00ff00ff
s_mov_b32 s50, 0x00ff00ff
s_mov_b32 s51, 0
s_mov_b32 s52, -1
s_mov_b32 s53, 0
s_mov_b32 s44, 0
s_mov_b32 s45, 0
s_mov_b32 s46, 0xfffefffe
s_mov_b32 s47, 0x3e0293ee
s_cmp_eq_u32 s10, 0
s_cbranch_scc0 L_noclr
s_waitcnt lgkmcnt(0)
v_lshlrev_b32 v56, 4, v0
v_mov_b32 v60, 0
v_mov_b32 v61, 0
v_mov_b32 v62, 0
v_mov_b32 v63, 0
s_mul_i32 s33, s11, 6144
s_add_u32 s33, s33, 77594624
buffer_store_dwordx4 v[60:63], v56, s[12:15], s33 offen sc1
s_add_u32 s33, s33, 1024
buffer_store_dwordx4 v[60:63], v56, s[12:15], s33 offen sc1
s_add_u32 s33, s33, 1024
buffer_store_dwordx4 v[60:63], v56, s[12:15], s33 offen sc1
s_add_u32 s33, s33, 1024
buffer_store_dwordx4 v[60:63], v56, s[12:15], s33 offen sc1
s_add_u32 s33, s33, 1024
buffer_store_dwordx4 v[60:63], v56, s[12:15], s33 offen sc1
s_add_u32 s33, s33, 1024
buffer_store_dwordx4 v[60:63], v56, s[12:15], s33 offen sc1
s_add_u32 s33, s33, 1024
s_waitcnt vmcnt(0)
s_barrier
s_cmp_eq_u32 s11, 0
s_cbranch_scc0 L_noclr
v_mov_b32 v56, 72
v_mov_b32 v57, 1
s_mov_b64 exec, 1
global_store_dword v56, v57, s[40:41] sc1
s_mov_b64 exec, -1
L_noclr:
v_lshlrev_b32 v1, 4, v0
v_add_u32 v1, 147456, v1
v_lshrrev_b32 v72, 4, v0
v_lshlrev_b32 v72, 7, v72
v_bfe_u32 v73, v0, 2, 2
v_lshl_add_u32 v72, v73, 4, v72
v_and_b32 v73, 1, v0
v_lshl_add_u32 v72, v73, 3, v72
v_add_u32 v2, 147456, v72
v_and_b32 v72, 8, v0
v_cmp_ne_u32 vcc, 0, v72
v_mov_b32 v72, 0x4444
v_mov_b32 v73, 0xeeee
v_cndmask_b32 v3, v72, v73, vcc
v_lshlrev_b32 v4, 4, v0
v_add_u32 v5, 49152, v4
v_add_u32 v6, 98304, v4
v_bfe_u32 v72, v0, 5, 1
v_lshlrev_b32 v72, 1, v72
v_bfe_u32 v73, v0, 3, 1
v_add_u32 v72, v72, v73
v_lshlrev_b32 v72, 12, v72
v_and_b32 v73, 7, v0
v_lshl_add_u32 v72, v73, 4, v72
v_bfe_u32 v73, v0, 4, 1
v_lshl_add_u32 v72, v73, 3, v72
s_lshl_b32 s34, s10, 7
v_add_u32 v7, s34, v72
s_and_b32 s33, s10, 1
s_sub_u32 s34, s11, 2
s_lshl_b32 s34, s34, 1
s_add_u32 s33, s33, s34
s_lshl_b32 s33, s33, 4
s_lshr_b32 s34, s10, 1
s_add_u32 s30, s33, s34
s_mov_b32 s31, 1
s_cmp_ge_u32 s11, 2
s_cbranch_scc1 L_task_done
s_lshr_b32 s30, s10, 2
s_add_u32 s30, s30, 64
s_and_b32 s33, s10, 3
s_cmp_eq_u32 s33, 0
s_cselect_b32 s31, 1, 0
s_cmp_eq_u32 s11, 1
s_cselect_b32 s31, s31, 0
s_cmp_eq_u32 s31, 1
s_cselect_b32 s30, s30, 0
L_task_done:
s_lshl_b32 s33, s30, 12
v_lshlrev_b32 v72, 4, v0
v_add_u32 v8, s33, v72
s_lshl_b32 s33, s30, 7
v_and_b32 v72, 7, v0
v_lshlrev_b32 v72, 4, v72
v_lshrrev_b32 v73, 4, v0
v_lshl_add_u32 v72, v73, 3, v72
v_add_u32 v9, s33, v72
v_and_b32 v72, 15, v0
s_add_u32 s33, s11, 3
s_and_b32 s33, s33, 1
s_lshl_b32 s33, s33, 4
v_add_u32 v72, s33, v72
v_lshlrev_b32 v72, 4, v72
v_lshrrev_b32 v73, 4, v0
v_lshl_add_u32 v72, v73, 9, v72
s_lshl_b32 s33, s10, 13
v_add_u32 v10, s33, v72
v_and_b32 v72, 15, v0
v_lshlrev_b32 v72, 4, v72
v_lshl_add_u32 v72, v73, 11, v72
s_lshl_b32 s33, s10, 13
s_lshl_b32 s34, s11, 9
s_add_u32 s33, s33, s34
v_add_u32 v11, s33, v72
v_and_b32 v72, 7, v0
v_lshlrev_b32 v72, 8, v72
v_lshl_add_u32 v12, v73, 4, v72
v_and_b32 v72, 15, v0
v_bfe_u32 v73, v0, 5, 1
v_lshl_add_u32 v72, v73, 4, v72
s_lshl_b32 s33, s11, 5
v_add_u32 v72, s33, v72
v_lshlrev_b32 v72, 4, v72
v_bfe_u32 v73, v0, 4, 1
v_lshl_add_u32 v13, v73, 3, v72
v_add_u32 v14, 156672, v13
v_and_b32 v72, 7, v0
v_mov_b32 v16, 0
v_cmp_eq_u32 vcc, 0, v72
v_mov_b32 v73, 0x3f80
s_nop 0
v_cndmask_b32 v16, v16, v73, vcc
v_cmp_eq_u32 vcc, 1, v72
v_mov_b32 v73, 0x3f800000
s_nop 0
v_cndmask_b32 v16, v16, v73, vcc
v_mov_b32 v17, 0
v_cmp_eq_u32 vcc, 2, v72
v_mov_b32 v73, 0x3f80
s_nop 0
v_cndmask_b32 v17, v17, v73, vcc
v_cmp_eq_u32 vcc, 3, v72
v_mov_b32 v73, 0x3f800000
s_nop 0
v_cndmask_b32 v17, v17, v73, vcc
v_mov_b32 v18, 0
v_cmp_eq_u32 vcc, 4, v72
v_mov_b32 v73, 0x3f80
s_nop 0
v_cndmask_b32 v18, v18, v73, vcc
v_cmp_eq_u32 vcc, 5, v72
v_mov_b32 v73, 0x3f800000
s_nop 0
v_cndmask_b32 v18, v18, v73, vcc
v_mov_b32 v19, 0
v_cmp_eq_u32 vcc, 6, v72
v_mov_b32 v73, 0x3f80
s_nop 0
v_cndmask_b32 v19, v19, v73, vcc
v_cmp_eq_u32 vcc, 7, v72
v_mov_b32 v73, 0x3f800000
s_nop 0
v_cndmask_b32 v19, v19, v73, vcc
s_waitcnt lgkmcnt(0)
v_lshrrev_b32 v72, 4, v0
v_and_b32 v73, 1, v72
v_lshlrev_b32 v73, 2, v73
v_and_b32 v74, 15, v0
v_xor_b32 v74, v74, v73
v_lshlrev_b32 v72, 13, v72
s_lshl_b32 s33, s10, 8
s_lshl_b32 s34, s11, 17
s_add_u32 s33, s33, s34
v_add_u32 v72, s33, v72
v_lshl_add_u32 v60, v74, 4, v72
v_xor_b32 v74, 8, v74
v_lshl_add_u32 v61, v74, 4, v72
v_lshrrev_b32 v72, 4, v0
v_bfe_u32 v73, v0, 2, 1
v_lshl_add_u32 v74, v72, 2, v73
v_lshlrev_b32 v74, 8, v74
v_and_b32 v72, 1, v72
v_lshl_add_u32 v72, v72, 1, v73
v_lshlrev_b32 v72, 2, v72
v_bfe_u32 v73, v0, 3, 1
v_lshlrev_b32 v73, 1, v73
v_bfe_u32 v75, v0, 1, 1
v_add_u32 v73, v73, v75
s_lshl_b32 s33, s11, 2
v_add_u32 v73, s33, v73
v_xor_b32 v73, v73, v72
v_lshl_add_u32 v74, v73, 4, v74
v_and_b32 v75, 1, v0
v_lshl_add_u32 v63, v75, 3, v74
v_add_u32 v64, 65536, v63
v_add_u32 v65, 131072, v63
s_load_dwordx2 s[60:61], s[42:43], 8
s_mov_b32 s62, 9216
s_mov_b32 s63, 0x20000
v_lshrrev_b32 v56, 4, v0
v_and_b32 v56, 1, v56
v_mul_u32_u24 v56, 4608, v56
v_and_b32 v57, 7, v0
v_lshl_add_u32 v56, v57, 1, v56
s_lshl_b32 s33, s30, 4
s_waitcnt lgkmcnt(0)
buffer_load_ushort v20, v56, s[60:63], s33 offen offset:0
buffer_load_ushort v21, v56, s[60:63], s33 offen offset:1152
buffer_load_ushort v22, v56, s[60:63], s33 offen offset:2304
buffer_load_ushort v23, v56, s[60:63], s33 offen offset:3456
v_mov_b32 v76, 0
v_mov_b32 v77, 0
v_mov_b32 v78, -1
v_mov_b32 v79, -1
s_lshl_b32 s35, s11, 14
s_add_u32 s35, s35, s28
s_add_u32 s33, s35, 0
buffer_store_dwordx2 v[76:77], v7, s[12:15], s33 offen
s_add_u32 s33, s35, 65536
buffer_store_dwordx2 v[76:77], v7, s[12:15], s33 offen
s_add_u32 s33, s35, 131072
buffer_store_dwordx2 v[76:77], v7, s[12:15], s33 offen
s_add_u32 s33, s35, 196608
buffer_store_dwordx2 v[76:77], v7, s[12:15], s33 offen
s_cmp_lt_u32 s11, 2
s_cbranch_scc0 L_clr1_skip
s_add_u32 s33, s35, 262144
buffer_store_dwordx2 v[76:77], v7, s[12:15], s33 offen
L_clr1_skip:
s_cmp_eq_u32 s31, 1
s_cbranch_scc0 L_clr2_skip
s_mov_b64 exec, s[50:51]
s_add_u32 s33, s29, 16384
buffer_store_dwordx2 v[78:79], v9, s[12:15], s33 offen
s_add_u32 s33, s29, 32768
buffer_store_dwordx2 v[78:79], v9, s[12:15], s33 offen
s_add_u32 s33, s29, 49152
buffer_store_dwordx2 v[78:79], v9, s[12:15], s33 offen
s_waitcnt vmcnt(0)
v_lshl_or_b32 v20, v21, 16, v20
v_lshl_or_b32 v21, v23, 16, v22
v_min_u32 v20, -2, v20
buffer_store_dwordx2 v[20:21], v9, s[12:15], s29 offen
s_mov_b64 exec, -1
L_clr2_skip:
s_load_dwordx2 s[16:17], s[42:43], 16
s_mov_b32 s18, 4718592
s_waitcnt lgkmcnt(0)
s_lshl_b32 s33, s11, 12
s_add_u32 m0, s33, 0
s_mov_b32 s34, 0
buffer_load_dwordx4 v60, s[16:19], s34 offen lds
s_lshl_b32 s33, s11, 12
s_add_u32 m0, s33, 1024
s_mov_b32 s34, 32768
buffer_load_dwordx4 v61, s[16:19], s34 offen lds
s_lshl_b32 s33, s11, 12
s_add_u32 m0, s33, 2048
s_mov_b32 s34, 65536
buffer_load_dwordx4 v60, s[16:19], s34 offen lds
s_lshl_b32 s33, s11, 12
s_add_u32 m0, s33, 3072
s_mov_b32 s34, 98304
buffer_load_dwordx4 v61, s[16:19], s34 offen lds
s_lshl_b32 s33, s11, 12
s_add_u32 m0, s33, 16384
s_mov_b32 s34, 524288
buffer_load_dwordx4 v60, s[16:19], s34 offen lds
s_lshl_b32 s33, s11, 12
s_add_u32 m0, s33, 17408
s_mov_b32 s34, 557056
buffer_load_dwordx4 v61, s[16:19], s34 offen lds
s_lshl_b32 s33, s11, 12
s_add_u32 m0, s33, 18432
s_mov_b32 s34, 589824
buffer_load_dwordx4 v60, s[16:19], s34 offen lds
s_lshl_b32 s33, s11, 12
s_add_u32 m0, s33, 19456
s_mov_b32 s34, 622592
buffer_load_dwordx4 v61, s[16:19], s34 offen lds
s_lshl_b32 s33, s11, 12
s_add_u32 m0, s33, 32768
s_mov_b32 s34, 1048576
buffer_load_dwordx4 v60, s[16:19], s34 offen lds
s_lshl_b32 s33, s11, 12
s_add_u32 m0, s33, 33792
s_mov_b32 s34, 1081344
buffer_load_dwordx4 v61, s[16:19], s34 offen lds
s_lshl_b32 s33, s11, 12
s_add_u32 m0, s33, 34816
s_mov_b32 s34, 1114112
buffer_load_dwordx4 v60, s[16:19], s34 offen lds
s_lshl_b32 s33, s11, 12
s_add_u32 m0, s33, 35840
s_mov_b32 s34, 1146880
buffer_load_dwordx4 v61, s[16:19], s34 offen lds
s_lshl_b32 s33, s11, 12
s_add_u32 m0, s33, 49152
s_mov_b32 s34, 1572864
buffer_load_dwordx4 v60, s[16:19], s34 offen lds
s_lshl_b32 s33, s11, 12
s_add_u32 m0, s33, 50176
s_mov_b32 s34, 1605632
buffer_load_dwordx4 v61, s[16:19], s34 offen lds
s_lshl_b32 s33, s11, 12
s_add_u32 m0, s33, 51200
s_mov_b32 s34, 1638400
buffer_load_dwordx4 v60, s[16:19], s34 offen lds
s_lshl_b32 s33, s11, 12
s_add_u32 m0, s33, 52224
s_mov_b32 s34, 1671168
buffer_load_dwordx4 v61, s[16:19], s34 offen lds
s_lshl_b32 s33, s11, 12
s_add_u32 m0, s33, 65536
s_mov_b32 s34, 2097152
buffer_load_dwordx4 v60, s[16:19], s34 offen lds
s_lshl_b32 s33, s11, 12
s_add_u32 m0, s33, 66560
s_mov_b32 s34, 2129920
buffer_load_dwordx4 v61, s[16:19], s34 offen lds
s_lshl_b32 s33, s11, 12
s_add_u32 m0, s33, 67584
s_mov_b32 s34, 2162688
buffer_load_dwordx4 v60, s[16:19], s34 offen lds
s_lshl_b32 s33, s11, 12
s_add_u32 m0, s33, 68608
s_mov_b32 s34, 2195456
buffer_load_dwordx4 v61, s[16:19], s34 offen lds
s_lshl_b32 s33, s11, 12
s_add_u32 m0, s33, 81920
s_mov_b32 s34, 2621440
buffer_load_dwordx4 v60, s[16:19], s34 offen lds
s_lshl_b32 s33, s11, 12
s_add_u32 m0, s33, 82944
s_mov_b32 s34, 2654208
buffer_load_dwordx4 v61, s[16:19], s34 offen lds
s_lshl_b32 s33, s11, 12
s_add_u32 m0, s33, 83968
s_mov_b32 s34, 2686976
buffer_load_dwordx4 v60, s[16:19], s34 offen lds
s_lshl_b32 s33, s11, 12
s_add_u32 m0, s33, 84992
s_mov_b32 s34, 2719744
buffer_load_dwordx4 v61, s[16:19], s34 offen lds
s_lshl_b32 s33, s11, 12
s_add_u32 m0, s33, 98304
s_mov_b32 s34, 3145728
buffer_load_dwordx4 v60, s[16:19], s34 offen lds
s_lshl_b32 s33, s11, 12
s_add_u32 m0, s33, 99328
s_mov_b32 s34, 3178496
buffer_load_dwordx4 v61, s[16:19], s34 offen lds
s_lshl_b32 s33, s11, 12
s_add_u32 m0, s33, 100352
s_mov_b32 s34, 3211264
buffer_load_dwordx4 v60, s[16:19], s34 offen lds
s_lshl_b32 s33, s11, 12
s_add_u32 m0, s33, 101376
s_mov_b32 s34, 3244032
buffer_load_dwordx4 v61, s[16:19], s34 offen lds
s_lshl_b32 s33, s11, 12
s_add_u32 m0, s33, 114688
s_mov_b32 s34, 3670016
buffer_load_dwordx4 v60, s[16:19], s34 offen lds
s_lshl_b32 s33, s11, 12
s_add_u32 m0, s33, 115712
s_mov_b32 s34, 3702784
buffer_load_dwordx4 v61, s[16:19], s34 offen lds
s_lshl_b32 s33, s11, 12
s_add_u32 m0, s33, 116736
s_mov_b32 s34, 3735552
buffer_load_dwordx4 v60, s[16:19], s34 offen lds
s_lshl_b32 s33, s11, 12
s_add_u32 m0, s33, 117760
s_mov_b32 s34, 3768320
buffer_load_dwordx4 v61, s[16:19], s34 offen lds
s_waitcnt vmcnt(32)
s_waitcnt lgkmcnt(0)
s_barrier
s_cmp_eq_u32 s11, 0
s_cbranch_scc0 L_cb_skip
v_mov_b32 v72, 64
v_mov_b32 v73, 1
s_mov_b64 exec, 1
global_atomic_add v72, v73, s[40:41]
s_mov_b64 exec, -1
L_cb_skip:
s_waitcnt vmcnt(28)
s_barrier
s_lshl_b32 s33, s11, 12
s_add_u32 m0, s33, 131072
s_mov_b32 s34, 4194304
buffer_load_dwordx4 v60, s[16:19], s34 offen lds
s_lshl_b32 s33, s11, 12
s_add_u32 m0, s33, 132096
s_mov_b32 s34, 4227072
buffer_load_dwordx4 v61, s[16:19], s34 offen lds
s_lshl_b32 s33, s11, 12
s_add_u32 m0, s33, 133120
s_mov_b32 s34, 4259840
buffer_load_dwordx4 v60, s[16:19], s34 offen lds
s_lshl_b32 s33, s11, 12
s_add_u32 m0, s33, 134144
s_mov_b32 s34, 4292608
buffer_load_dwordx4 v61, s[16:19], s34 offen lds
ds_read_b64_tr_b16 a[0:1], v63 offset:0
ds_read_b64_tr_b16 a[2:3], v63 offset:512
ds_read_b64_tr_b16 a[4:5], v63 offset:4096
ds_read_b64_tr_b16 a[6:7], v63 offset:4608
ds_read_b64_tr_b16 a[8:9], v63 offset:8192
ds_read_b64_tr_b16 a[10:11], v63 offset:8704
ds_read_b64_tr_b16 a[12:13], v63 offset:12288
ds_read_b64_tr_b16 a[14:15], v63 offset:12800
s_waitcnt lgkmcnt(0)
s_barrier
s_waitcnt vmcnt(28)
s_barrier
s_load_dwordx2 s[16:17], s[42:43], 24
s_mov_b32 s18, 4718592
s_waitcnt lgkmcnt(0)
s_lshl_b32 s33, s11, 12
s_add_u32 m0, s33, 0
s_mov_b32 s34, 0
buffer_load_dwordx4 v60, s[16:19], s34 offen lds
s_lshl_b32 s33, s11, 12
s_add_u32 m0, s33, 1024
s_mov_b32 s34, 32768
buffer_load_dwordx4 v61, s[16:19], s34 offen lds
s_lshl_b32 s33, s11, 12
s_add_u32 m0, s33, 2048
s_mov_b32 s34, 65536
buffer_load_dwordx4 v60, s[16:19], s34 offen lds
s_lshl_b32 s33, s11, 12
s_add_u32 m0, s33, 3072
s_mov_b32 s34, 98304
buffer_load_dwordx4 v61, s[16:19], s34 offen lds
ds_read_b64_tr_b16 a[16:17], v63 offset:16384
ds_read_b64_tr_b16 a[18:19], v63 offset:16896
ds_read_b64_tr_b16 a[20:21], v63 offset:20480
ds_read_b64_tr_b16 a[22:23], v63 offset:20992
ds_read_b64_tr_b16 a[24:25], v63 offset:24576
ds_read_b64_tr_b16 a[26:27], v63 offset:25088
ds_read_b64_tr_b16 a[28:29], v63 offset:28672
ds_read_b64_tr_b16 a[30:31], v63 offset:29184
s_waitcnt lgkmcnt(0)
s_barrier
s_waitcnt vmcnt(28)
s_barrier
s_lshl_b32 s33, s11, 12
s_add_u32 m0, s33, 16384
s_mov_b32 s34, 524288
buffer_load_dwordx4 v60, s[16:19], s34 offen lds
s_lshl_b32 s33, s11, 12
s_add_u32 m0, s33, 17408
s_mov_b32 s34, 557056
buffer_load_dwordx4 v61, s[16:19], s34 offen lds
s_lshl_b32 s33, s11, 12
s_add_u32 m0, s33, 18432
s_mov_b32 s34, 589824
buffer_load_dwordx4 v60, s[16:19], s34 offen lds
s_lshl_b32 s33, s11, 12
s_add_u32 m0, s33, 19456
s_mov_b32 s34, 622592
buffer_load_dwordx4 v61, s[16:19], s34 offen lds
ds_read_b64_tr_b16 a[32:33], v63 offset:32768
ds_read_b64_tr_b16 a[34:35], v63 offset:33280
ds_read_b64_tr_b16 a[36:37], v63 offset:36864
ds_read_b64_tr_b16 a[38:39], v63 offset:37376
ds_read_b64_tr_b16 a[40:41], v63 offset:40960
ds_read_b64_tr_b16 a[42:43], v63 offset:41472
ds_read_b64_tr_b16 a[44:45], v63 offset:45056
ds_read_b64_tr_b16 a[46:47], v63 offset:45568
s_waitcnt lgkmcnt(0)
s_barrier
s_waitcnt vmcnt(28)
s_barrier
s_lshl_b32 s33, s11, 12
s_add_u32 m0, s33, 32768
s_mov_b32 s34, 1048576
buffer_load_dwordx4 v60, s[16:19], s34 offen lds
s_lshl_b32 s33, s11, 12
s_add_u32 m0, s33, 33792
s_mov_b32 s34, 1081344
buffer_load_dwordx4 v61, s[16:19], s34 offen lds
s_lshl_b32 s33, s11, 12
s_add_u32 m0, s33, 34816
s_mov_b32 s34, 1114112
buffer_load_dwordx4 v60, s[16:19], s34 offen lds
s_lshl_b32 s33, s11, 12
s_add_u32 m0, s33, 35840
s_mov_b32 s34, 1146880
buffer_load_dwordx4 v61, s[16:19], s34 offen lds
ds_read_b64_tr_b16 a[48:49], v63 offset:49152
ds_read_b64_tr_b16 a[50:51], v63 offset:49664
ds_read_b64_tr_b16 a[52:53], v63 offset:53248
ds_read_b64_tr_b16 a[54:55], v63 offset:53760
ds_read_b64_tr_b16 a[56:57], v63 offset:57344
ds_read_b64_tr_b16 a[58:59], v63 offset:57856
ds_read_b64_tr_b16 a[60:61], v63 offset:61440
ds_read_b64_tr_b16 a[62:63], v63 offset:61952
s_waitcnt lgkmcnt(0)
s_barrier
s_waitcnt vmcnt(28)
s_barrier
s_lshl_b32 s33, s11, 12
s_add_u32 m0, s33, 49152
s_mov_b32 s34, 1572864
buffer_load_dwordx4 v60, s[16:19], s34 offen lds
s_lshl_b32 s33, s11, 12
s_add_u32 m0, s33, 50176
s_mov_b32 s34, 1605632
buffer_load_dwordx4 v61, s[16:19], s34 offen lds
s_lshl_b32 s33, s11, 12
s_add_u32 m0, s33, 51200
s_mov_b32 s34, 1638400
buffer_load_dwordx4 v60, s[16:19], s34 offen lds
s_lshl_b32 s33, s11, 12
s_add_u32 m0, s33, 52224
s_mov_b32 s34, 1671168
buffer_load_dwordx4 v61, s[16:19], s34 offen lds
ds_read_b64_tr_b16 a[64:65], v64 offset:0
ds_read_b64_tr_b16 a[66:67], v64 offset:512
ds_read_b64_tr_b16 a[68:69], v64 offset:4096
ds_read_b64_tr_b16 a[70:71], v64 offset:4608
ds_read_b64_tr_b16 a[72:73], v64 offset:8192
ds_read_b64_tr_b16 a[74:75], v64 offset:8704
ds_read_b64_tr_b16 a[76:77], v64 offset:12288
ds_read_b64_tr_b16 a[78:79], v64 offset:12800
s_waitcnt lgkmcnt(0)
s_barrier
s_waitcnt vmcnt(28)
s_barrier
s_lshl_b32 s33, s11, 12
s_add_u32 m0, s33, 65536
s_mov_b32 s34, 2097152
buffer_load_dwordx4 v60, s[16:19], s34 offen lds
s_lshl_b32 s33, s11, 12
s_add_u32 m0, s33, 66560
s_mov_b32 s34, 2129920
buffer_load_dwordx4 v61, s[16:19], s34 offen lds
s_lshl_b32 s33, s11, 12
s_add_u32 m0, s33, 67584
s_mov_b32 s34, 2162688
buffer_load_dwordx4 v60, s[16:19], s34 offen lds
s_lshl_b32 s33, s11, 12
s_add_u32 m0, s33, 68608
s_mov_b32 s34, 2195456
buffer_load_dwordx4 v61, s[16:19], s34 offen lds
ds_read_b64_tr_b16 a[80:81], v64 offset:16384
ds_read_b64_tr_b16 a[82:83], v64 offset:16896
ds_read_b64_tr_b16 a[84:85], v64 offset:20480
ds_read_b64_tr_b16 a[86:87], v64 offset:20992
ds_read_b64_tr_b16 a[88:89], v64 offset:24576
ds_read_b64_tr_b16 a[90:91], v64 offset:25088
ds_read_b64_tr_b16 a[92:93], v64 offset:28672
ds_read_b64_tr_b16 a[94:95], v64 offset:29184
s_waitcnt lgkmcnt(0)
s_barrier
s_waitcnt vmcnt(28)
s_barrier
s_lshl_b32 s33, s11, 12
s_add_u32 m0, s33, 81920
s_mov_b32 s34, 2621440
buffer_load_dwordx4 v60, s[16:19], s34 offen lds
s_lshl_b32 s33, s11, 12
s_add_u32 m0, s33, 82944
s_mov_b32 s34, 2654208
buffer_load_dwordx4 v61, s[16:19], s34 offen lds
s_lshl_b32 s33, s11, 12
s_add_u32 m0, s33, 83968
s_mov_b32 s34, 2686976
buffer_load_dwordx4 v60, s[16:19], s34 offen lds
s_lshl_b32 s33, s11, 12
s_add_u32 m0, s33, 84992
s_mov_b32 s34, 2719744
buffer_load_dwordx4 v61, s[16:19], s34 offen lds
ds_read_b64_tr_b16 a[96:97], v64 offset:32768
ds_read_b64_tr_b16 a[98:99], v64 offset:33280
ds_read_b64_tr_b16 a[100:101], v64 offset:36864
ds_read_b64_tr_b16 a[102:103], v64 offset:37376
ds_read_b64_tr_b16 a[104:105], v64 offset:40960
ds_read_b64_tr_b16 a[106:107], v64 offset:41472
ds_read_b64_tr_b16 a[108:109], v64 offset:45056
ds_read_b64_tr_b16 a[110:111], v64 offset:45568
s_waitcnt lgkmcnt(0)
s_barrier
s_waitcnt vmcnt(28)
s_barrier
s_lshl_b32 s33, s11, 12
s_add_u32 m0, s33, 98304
s_mov_b32 s34, 3145728
buffer_load_dwordx4 v60, s[16:19], s34 offen lds
s_lshl_b32 s33, s11, 12
s_add_u32 m0, s33, 99328
s_mov_b32 s34, 3178496
buffer_load_dwordx4 v61, s[16:19], s34 offen lds
s_lshl_b32 s33, s11, 12
s_add_u32 m0, s33, 100352
s_mov_b32 s34, 3211264
buffer_load_dwordx4 v60, s[16:19], s34 offen lds
s_lshl_b32 s33, s11, 12
s_add_u32 m0, s33, 101376
s_mov_b32 s34, 3244032
buffer_load_dwordx4 v61, s[16:19], s34 offen lds
ds_read_b64_tr_b16 a[112:113], v64 offset:49152
ds_read_b64_tr_b16 a[114:115], v64 offset:49664
ds_read_b64_tr_b16 a[116:117], v64 offset:53248
ds_read_b64_tr_b16 a[118:119], v64 offset:53760
ds_read_b64_tr_b16 a[120:121], v64 offset:57344
ds_read_b64_tr_b16 a[122:123], v64 offset:57856
ds_read_b64_tr_b16 a[124:125], v64 offset:61440
ds_read_b64_tr_b16 a[126:127], v64 offset:61952
s_waitcnt lgkmcnt(0)
s_barrier
s_waitcnt vmcnt(28)
s_barrier
s_lshl_b32 s33, s11, 12
s_add_u32 m0, s33, 114688
s_mov_b32 s34, 3670016
buffer_load_dwordx4 v60, s[16:19], s34 offen lds
s_lshl_b32 s33, s11, 12
s_add_u32 m0, s33, 115712
s_mov_b32 s34, 3702784
buffer_load_dwordx4 v61, s[16:19], s34 offen lds
s_lshl_b32 s33, s11, 12
s_add_u32 m0, s33, 116736
s_mov_b32 s34, 3735552
buffer_load_dwordx4 v60, s[16:19], s34 offen lds
s_lshl_b32 s33, s11, 12
s_add_u32 m0, s33, 117760
s_mov_b32 s34, 3768320
buffer_load_dwordx4 v61, s[16:19], s34 offen lds
ds_read_b64_tr_b16 a[128:129], v65 offset:0
ds_read_b64_tr_b16 a[130:131], v65 offset:512
ds_read_b64_tr_b16 a[132:133], v65 offset:4096
ds_read_b64_tr_b16 a[134:135], v65 offset:4608
ds_read_b64_tr_b16 a[136:137], v65 offset:8192
ds_read_b64_tr_b16 a[138:139], v65 offset:8704
ds_read_b64_tr_b16 a[140:141], v65 offset:12288
ds_read_b64_tr_b16 a[142:143], v65 offset:12800
s_waitcnt lgkmcnt(0)
s_barrier
s_waitcnt vmcnt(28)
s_barrier
s_lshl_b32 s33, s11, 12
s_add_u32 m0, s33, 131072
s_mov_b32 s34, 4194304
buffer_load_dwordx4 v60, s[16:19], s34 offen lds
s_lshl_b32 s33, s11, 12
s_add_u32 m0, s33, 132096
s_mov_b32 s34, 4227072
buffer_load_dwordx4 v61, s[16:19], s34 offen lds
s_lshl_b32 s33, s11, 12
s_add_u32 m0, s33, 133120
s_mov_b32 s34, 4259840
buffer_load_dwordx4 v60, s[16:19], s34 offen lds
s_lshl_b32 s33, s11, 12
s_add_u32 m0, s33, 134144
s_mov_b32 s34, 4292608
buffer_load_dwordx4 v61, s[16:19], s34 offen lds
ds_read_b64_tr_b16 a[144:145], v63 offset:0
ds_read_b64_tr_b16 a[146:147], v63 offset:512
ds_read_b64_tr_b16 a[148:149], v63 offset:4096
ds_read_b64_tr_b16 a[150:151], v63 offset:4608
ds_read_b64_tr_b16 a[152:153], v63 offset:8192
ds_read_b64_tr_b16 a[154:155], v63 offset:8704
ds_read_b64_tr_b16 a[156:157], v63 offset:12288
ds_read_b64_tr_b16 a[158:159], v63 offset:12800
s_waitcnt lgkmcnt(0)
s_barrier
s_waitcnt vmcnt(28)
s_barrier
s_load_dwordx2 s[16:17], s[42:43], 32
s_mov_b32 s18, 4718592
s_waitcnt lgkmcnt(0)
s_lshl_b32 s33, s11, 12
s_add_u32 m0, s33, 0
s_mov_b32 s34, 0
buffer_load_dwordx4 v60, s[16:19], s34 offen lds
s_lshl_b32 s33, s11, 12
s_add_u32 m0, s33, 1024
s_mov_b32 s34, 32768
buffer_load_dwordx4 v61, s[16:19], s34 offen lds
s_lshl_b32 s33, s11, 12
s_add_u32 m0, s33, 2048
s_mov_b32 s34, 65536
buffer_load_dwordx4 v60, s[16:19], s34 offen lds
s_lshl_b32 s33, s11, 12
s_add_u32 m0, s33, 3072
s_mov_b32 s34, 98304
buffer_load_dwordx4 v61, s[16:19], s34 offen lds
ds_read_b64_tr_b16 a[160:161], v63 offset:16384
ds_read_b64_tr_b16 a[162:163], v63 offset:16896
ds_read_b64_tr_b16 a[164:165], v63 offset:20480
ds_read_b64_tr_b16 a[166:167], v63 offset:20992
ds_read_b64_tr_b16 a[168:169], v63 offset:24576
ds_read_b64_tr_b16 a[170:171], v63 offset:25088
ds_read_b64_tr_b16 a[172:173], v63 offset:28672
ds_read_b64_tr_b16 a[174:175], v63 offset:29184
s_waitcnt lgkmcnt(0)
s_barrier
s_waitcnt vmcnt(28)
s_barrier
s_lshl_b32 s33, s11, 12
s_add_u32 m0, s33, 16384
s_mov_b32 s34, 524288
buffer_load_dwordx4 v60, s[16:19], s34 offen lds
s_lshl_b32 s33, s11, 12
s_add_u32 m0, s33, 17408
s_mov_b32 s34, 557056
buffer_load_dwordx4 v61, s[16:19], s34 offen lds
s_lshl_b32 s33, s11, 12
s_add_u32 m0, s33, 18432
s_mov_b32 s34, 589824
buffer_load_dwordx4 v60, s[16:19], s34 offen lds
s_lshl_b32 s33, s11, 12
s_add_u32 m0, s33, 19456
s_mov_b32 s34, 622592
buffer_load_dwordx4 v61, s[16:19], s34 offen lds
ds_read_b64_tr_b16 a[176:177], v63 offset:32768
ds_read_b64_tr_b16 a[178:179], v63 offset:33280
ds_read_b64_tr_b16 a[180:181], v63 offset:36864
ds_read_b64_tr_b16 a[182:183], v63 offset:37376
ds_read_b64_tr_b16 a[184:185], v63 offset:40960
ds_read_b64_tr_b16 a[186:187], v63 offset:41472
ds_read_b64_tr_b16 a[188:189], v63 offset:45056
ds_read_b64_tr_b16 a[190:191], v63 offset:45568
s_waitcnt lgkmcnt(0)
s_barrier
s_waitcnt vmcnt(28)
s_barrier
s_lshl_b32 s33, s11, 12
s_add_u32 m0, s33, 32768
s_mov_b32 s34, 1048576
buffer_load_dwordx4 v60, s[16:19], s34 offen lds
s_lshl_b32 s33, s11, 12
s_add_u32 m0, s33, 33792
s_mov_b32 s34, 1081344
buffer_load_dwordx4 v61, s[16:19], s34 offen lds
s_lshl_b32 s33, s11, 12
s_add_u32 m0, s33, 34816
s_mov_b32 s34, 1114112
buffer_load_dwordx4 v60, s[16:19], s34 offen lds
s_lshl_b32 s33, s11, 12
s_add_u32 m0, s33, 35840
s_mov_b32 s34, 1146880
buffer_load_dwordx4 v61, s[16:19], s34 offen lds
ds_read_b64_tr_b16 a[192:193], v63 offset:49152
ds_read_b64_tr_b16 a[194:195], v63 offset:49664
ds_read_b64_tr_b16 a[196:197], v63 offset:53248
ds_read_b64_tr_b16 a[198:199], v63 offset:53760
ds_read_b64_tr_b16 a[200:201], v63 offset:57344
ds_read_b64_tr_b16 a[202:203], v63 offset:57856
ds_read_b64_tr_b16 a[204:205], v63 offset:61440
ds_read_b64_tr_b16 a[206:207], v63 offset:61952
s_waitcnt lgkmcnt(0)
s_barrier
s_waitcnt vmcnt(28)
s_barrier
s_lshl_b32 s33, s11, 12
s_add_u32 m0, s33, 49152
s_mov_b32 s34, 1572864
buffer_load_dwordx4 v60, s[16:19], s34 offen lds
s_lshl_b32 s33, s11, 12
s_add_u32 m0, s33, 50176
s_mov_b32 s34, 1605632
buffer_load_dwordx4 v61, s[16:19], s34 offen lds
s_lshl_b32 s33, s11, 12
s_add_u32 m0, s33, 51200
s_mov_b32 s34, 1638400
buffer_load_dwordx4 v60, s[16:19], s34 offen lds
s_lshl_b32 s33, s11, 12
s_add_u32 m0, s33, 52224
s_mov_b32 s34, 1671168
buffer_load_dwordx4 v61, s[16:19], s34 offen lds
ds_read_b64_tr_b16 a[208:209], v64 offset:0
ds_read_b64_tr_b16 a[210:211], v64 offset:512
ds_read_b64_tr_b16 a[212:213], v64 offset:4096
ds_read_b64_tr_b16 a[214:215], v64 offset:4608
ds_read_b64_tr_b16 a[216:217], v64 offset:8192
ds_read_b64_tr_b16 a[218:219], v64 offset:8704
ds_read_b64_tr_b16 a[220:221], v64 offset:12288
ds_read_b64_tr_b16 a[222:223], v64 offset:12800
s_waitcnt lgkmcnt(0)
s_barrier
s_waitcnt vmcnt(28)
s_barrier
s_lshl_b32 s33, s11, 12
s_add_u32 m0, s33, 65536
s_mov_b32 s34, 2097152
buffer_load_dwordx4 v60, s[16:19], s34 offen lds
s_lshl_b32 s33, s11, 12
s_add_u32 m0, s33, 66560
s_mov_b32 s34, 2129920
buffer_load_dwordx4 v61, s[16:19], s34 offen lds
s_lshl_b32 s33, s11, 12
s_add_u32 m0, s33, 67584
s_mov_b32 s34, 2162688
buffer_load_dwordx4 v60, s[16:19], s34 offen lds
s_lshl_b32 s33, s11, 12
s_add_u32 m0, s33, 68608
s_mov_b32 s34, 2195456
buffer_load_dwordx4 v61, s[16:19], s34 offen lds
ds_read_b64_tr_b16 a[224:225], v64 offset:16384
ds_read_b64_tr_b16 a[226:227], v64 offset:16896
ds_read_b64_tr_b16 a[228:229], v64 offset:20480
ds_read_b64_tr_b16 a[230:231], v64 offset:20992
ds_read_b64_tr_b16 a[232:233], v64 offset:24576
ds_read_b64_tr_b16 a[234:235], v64 offset:25088
ds_read_b64_tr_b16 a[236:237], v64 offset:28672
ds_read_b64_tr_b16 a[238:239], v64 offset:29184
s_waitcnt lgkmcnt(0)
s_barrier
s_waitcnt vmcnt(28)
s_barrier
s_lshl_b32 s33, s11, 12
s_add_u32 m0, s33, 81920
s_mov_b32 s34, 2621440
buffer_load_dwordx4 v60, s[16:19], s34 offen lds
s_lshl_b32 s33, s11, 12
s_add_u32 m0, s33, 82944
s_mov_b32 s34, 2654208
buffer_load_dwordx4 v61, s[16:19], s34 offen lds
s_lshl_b32 s33, s11, 12
s_add_u32 m0, s33, 83968
s_mov_b32 s34, 2686976
buffer_load_dwordx4 v60, s[16:19], s34 offen lds
s_lshl_b32 s33, s11, 12
s_add_u32 m0, s33, 84992
s_mov_b32 s34, 2719744
buffer_load_dwordx4 v61, s[16:19], s34 offen lds
ds_read_b64_tr_b16 a[240:241], v64 offset:32768
ds_read_b64_tr_b16 a[242:243], v64 offset:33280
ds_read_b64_tr_b16 a[244:245], v64 offset:36864
ds_read_b64_tr_b16 a[246:247], v64 offset:37376
ds_read_b64_tr_b16 a[248:249], v64 offset:40960
ds_read_b64_tr_b16 a[250:251], v64 offset:41472
ds_read_b64_tr_b16 a[252:253], v64 offset:45056
ds_read_b64_tr_b16 a[254:255], v64 offset:45568
s_waitcnt lgkmcnt(0)
s_barrier
s_waitcnt vmcnt(28)
s_barrier
s_lshl_b32 s33, s11, 12
s_add_u32 m0, s33, 98304
s_mov_b32 s34, 3145728
buffer_load_dwordx4 v60, s[16:19], s34 offen lds
s_lshl_b32 s33, s11, 12
s_add_u32 m0, s33, 99328
s_mov_b32 s34, 3178496
buffer_load_dwordx4 v61, s[16:19], s34 offen lds
s_lshl_b32 s33, s11, 12
s_add_u32 m0, s33, 100352
s_mov_b32 s34, 3211264
buffer_load_dwordx4 v60, s[16:19], s34 offen lds
s_lshl_b32 s33, s11, 12
s_add_u32 m0, s33, 101376
s_mov_b32 s34, 3244032
buffer_load_dwordx4 v61, s[16:19], s34 offen lds
ds_read_b64_tr_b16 v[80:81], v64 offset:49152
ds_read_b64_tr_b16 v[82:83], v64 offset:49664
ds_read_b64_tr_b16 v[84:85], v64 offset:53248
ds_read_b64_tr_b16 v[86:87], v64 offset:53760
ds_read_b64_tr_b16 v[88:89], v64 offset:57344
ds_read_b64_tr_b16 v[90:91], v64 offset:57856
ds_read_b64_tr_b16 v[92:93], v64 offset:61440
ds_read_b64_tr_b16 v[94:95], v64 offset:61952
s_waitcnt lgkmcnt(0)
s_barrier
s_waitcnt vmcnt(28)
s_barrier
s_lshl_b32 s33, s11, 12
s_add_u32 m0, s33, 114688
s_mov_b32 s34, 3670016
buffer_load_dwordx4 v60, s[16:19], s34 offen lds
s_lshl_b32 s33, s11, 12
s_add_u32 m0, s33, 115712
s_mov_b32 s34, 3702784
buffer_load_dwordx4 v61, s[16:19], s34 offen lds
s_lshl_b32 s33, s11, 12
s_add_u32 m0, s33, 116736
s_mov_b32 s34, 3735552
buffer_load_dwordx4 v60, s[16:19], s34 offen lds
s_lshl_b32 s33, s11, 12
s_add_u32 m0, s33, 117760
s_mov_b32 s34, 3768320
buffer_load_dwordx4 v61, s[16:19], s34 offen lds
ds_read_b64_tr_b16 v[96:97], v65 offset:0
ds_read_b64_tr_b16 v[98:99], v65 offset:512
ds_read_b64_tr_b16 v[100:101], v65 offset:4096
ds_read_b64_tr_b16 v[102:103], v65 offset:4608
ds_read_b64_tr_b16 v[104:105], v65 offset:8192
ds_read_b64_tr_b16 v[106:107], v65 offset:8704
ds_read_b64_tr_b16 v[108:109], v65 offset:12288
ds_read_b64_tr_b16 v[110:111], v65 offset:12800
s_waitcnt lgkmcnt(0)
s_barrier
s_waitcnt vmcnt(28)
s_barrier
s_lshl_b32 s33, s11, 12
s_add_u32 m0, s33, 131072
s_mov_b32 s34, 4194304
buffer_load_dwordx4 v60, s[16:19], s34 offen lds
s_lshl_b32 s33, s11, 12
s_add_u32 m0, s33, 132096
s_mov_b32 s34, 4227072
buffer_load_dwordx4 v61, s[16:19], s34 offen lds
s_lshl_b32 s33, s11, 12
s_add_u32 m0, s33, 133120
s_mov_b32 s34, 4259840
buffer_load_dwordx4 v60, s[16:19], s34 offen lds
s_lshl_b32 s33, s11, 12
s_add_u32 m0, s33, 134144
s_mov_b32 s34, 4292608
buffer_load_dwordx4 v61, s[16:19], s34 offen lds
ds_read_b64_tr_b16 v[112:113], v63 offset:0
ds_read_b64_tr_b16 v[114:115], v63 offset:512
ds_read_b64_tr_b16 v[116:117], v63 offset:4096
ds_read_b64_tr_b16 v[118:119], v63 offset:4608
ds_read_b64_tr_b16 v[120:121], v63 offset:8192
ds_read_b64_tr_b16 v[122:123], v63 offset:8704
ds_read_b64_tr_b16 v[124:125], v63 offset:12288
ds_read_b64_tr_b16 v[126:127], v63 offset:12800
s_waitcnt lgkmcnt(0)
s_barrier
s_waitcnt vmcnt(28)
s_barrier
s_load_dwordx2 s[16:17], s[42:43], 40
s_waitcnt lgkmcnt(0)
s_mul_i32 s33, s10, 147456
s_add_u32 s16, s16, s33
s_addc_u32 s17, s17, 0
s_mov_b32 s18, 147456
s_lshl_b32 s33, s11, 2
s_add_u32 s33, s33, 0
s_lshl_b32 s33, s33, 6
v_add_u32 v72, s33, v0
v_mul_u32_u24 v73, 58255, v72
v_lshrrev_b32 v73, 26, v73
v_and_b32 v73, 1, v73
v_lshlrev_b32 v73, 2, v73
v_xor_b32 v72, v72, v73
v_lshlrev_b32 v62, 4, v72
s_lshl_b32 s33, s11, 12
s_add_u32 m0, s33, 0
s_nop 0
buffer_load_dwordx4 v62, s[16:19], 0 offen lds
s_lshl_b32 s33, s11, 2
s_add_u32 s33, s33, 1
s_lshl_b32 s33, s33, 6
v_add_u32 v72, s33, v0
v_mul_u32_u24 v73, 58255, v72
v_lshrrev_b32 v73, 26, v73
v_and_b32 v73, 1, v73
v_lshlrev_b32 v73, 2, v73
v_xor_b32 v72, v72, v73
v_lshlrev_b32 v62, 4, v72
s_lshl_b32 s33, s11, 12
s_add_u32 m0, s33, 1024
s_nop 0
buffer_load_dwordx4 v62, s[16:19], 0 offen lds
s_lshl_b32 s33, s11, 2
s_add_u32 s33, s33, 2
s_lshl_b32 s33, s33, 6
v_add_u32 v72, s33, v0
v_mul_u32_u24 v73, 58255, v72
v_lshrrev_b32 v73, 26, v73
v_and_b32 v73, 1, v73
v_lshlrev_b32 v73, 2, v73
v_xor_b32 v72, v72, v73
v_lshlrev_b32 v62, 4, v72
s_lshl_b32 s33, s11, 12
s_add_u32 m0, s33, 2048
s_nop 0
buffer_load_dwordx4 v62, s[16:19], 0 offen lds
s_lshl_b32 s33, s11, 2
s_add_u32 s33, s33, 3
s_lshl_b32 s33, s33, 6
v_add_u32 v72, s33, v0
v_mul_u32_u24 v73, 58255, v72
v_lshrrev_b32 v73, 26, v73
v_and_b32 v73, 1, v73
v_lshlrev_b32 v73, 2, v73
v_xor_b32 v72, v72, v73
v_lshlrev_b32 v62, 4, v72
s_lshl_b32 s33, s11, 12
s_add_u32 m0, s33, 3072
s_nop 0
buffer_load_dwordx4 v62, s[16:19], 0 offen lds
ds_read_b64_tr_b16 v[128:129], v63 offset:16384
ds_read_b64_tr_b16 v[130:131], v63 offset:16896
ds_read_b64_tr_b16 v[132:133], v63 offset:20480
ds_read_b64_tr_b16 v[134:135], v63 offset:20992
ds_read_b64_tr_b16 v[136:137], v63 offset:24576
ds_read_b64_tr_b16 v[138:139], v63 offset:25088
ds_read_b64_tr_b16 v[140:141], v63 offset:28672
ds_read_b64_tr_b16 v[142:143], v63 offset:29184
s_waitcnt lgkmcnt(0)
s_barrier
s_waitcnt vmcnt(28)
s_barrier
s_lshl_b32 s33, s11, 2
s_add_u32 s33, s33, 16
s_lshl_b32 s33, s33, 6
v_add_u32 v72, s33, v0
v_mul_u32_u24 v73, 58255, v72
v_lshrrev_b32 v73, 26, v73
v_and_b32 v73, 1, v73
v_lshlrev_b32 v73, 2, v73
v_xor_b32 v72, v72, v73
v_lshlrev_b32 v62, 4, v72
s_lshl_b32 s33, s11, 12
s_add_u32 m0, s33, 16384
s_nop 0
buffer_load_dwordx4 v62, s[16:19], 0 offen lds
s_lshl_b32 s33, s11, 2
s_add_u32 s33, s33, 17
s_lshl_b32 s33, s33, 6
v_add_u32 v72, s33, v0
v_mul_u32_u24 v73, 58255, v72
v_lshrrev_b32 v73, 26, v73
v_and_b32 v73, 1, v73
v_lshlrev_b32 v73, 2, v73
v_xor_b32 v72, v72, v73
v_lshlrev_b32 v62, 4, v72
s_lshl_b32 s33, s11, 12
s_add_u32 m0, s33, 17408
s_nop 0
buffer_load_dwordx4 v62, s[16:19], 0 offen lds
s_lshl_b32 s33, s11, 2
s_add_u32 s33, s33, 18
s_lshl_b32 s33, s33, 6
v_add_u32 v72, s33, v0
v_mul_u32_u24 v73, 58255, v72
v_lshrrev_b32 v73, 26, v73
v_and_b32 v73, 1, v73
v_lshlrev_b32 v73, 2, v73
v_xor_b32 v72, v72, v73
v_lshlrev_b32 v62, 4, v72
s_lshl_b32 s33, s11, 12
s_add_u32 m0, s33, 18432
s_nop 0
buffer_load_dwordx4 v62, s[16:19], 0 offen lds
s_lshl_b32 s33, s11, 2
s_add_u32 s33, s33, 19
s_lshl_b32 s33, s33, 6
v_add_u32 v72, s33, v0
v_mul_u32_u24 v73, 58255, v72
v_lshrrev_b32 v73, 26, v73
v_and_b32 v73, 1, v73
v_lshlrev_b32 v73, 2, v73
v_xor_b32 v72, v72, v73
v_lshlrev_b32 v62, 4, v72
s_lshl_b32 s33, s11, 12
s_add_u32 m0, s33, 19456
s_nop 0
buffer_load_dwordx4 v62, s[16:19], 0 offen lds
ds_read_b64_tr_b16 v[144:145], v63 offset:32768
ds_read_b64_tr_b16 v[146:147], v63 offset:33280
ds_read_b64_tr_b16 v[148:149], v63 offset:36864
ds_read_b64_tr_b16 v[150:151], v63 offset:37376
ds_read_b64_tr_b16 v[152:153], v63 offset:40960
ds_read_b64_tr_b16 v[154:155], v63 offset:41472
ds_read_b64_tr_b16 v[156:157], v63 offset:45056
ds_read_b64_tr_b16 v[158:159], v63 offset:45568
s_waitcnt lgkmcnt(0)
s_barrier
s_waitcnt vmcnt(28)
s_barrier
s_lshl_b32 s33, s11, 2
s_add_u32 s33, s33, 32
s_lshl_b32 s33, s33, 6
v_add_u32 v72, s33, v0
v_mul_u32_u24 v73, 58255, v72
v_lshrrev_b32 v73, 26, v73
v_and_b32 v73, 1, v73
v_lshlrev_b32 v73, 2, v73
v_xor_b32 v72, v72, v73
v_lshlrev_b32 v62, 4, v72
s_lshl_b32 s33, s11, 12
s_add_u32 m0, s33, 32768
s_nop 0
buffer_load_dwordx4 v62, s[16:19], 0 offen lds
s_lshl_b32 s33, s11, 2
s_add_u32 s33, s33, 33
s_lshl_b32 s33, s33, 6
v_add_u32 v72, s33, v0
v_mul_u32_u24 v73, 58255, v72
v_lshrrev_b32 v73, 26, v73
v_and_b32 v73, 1, v73
v_lshlrev_b32 v73, 2, v73
v_xor_b32 v72, v72, v73
v_lshlrev_b32 v62, 4, v72
s_lshl_b32 s33, s11, 12
s_add_u32 m0, s33, 33792
s_nop 0
buffer_load_dwordx4 v62, s[16:19], 0 offen lds
s_lshl_b32 s33, s11, 2
s_add_u32 s33, s33, 34
s_lshl_b32 s33, s33, 6
v_add_u32 v72, s33, v0
v_mul_u32_u24 v73, 58255, v72
v_lshrrev_b32 v73, 26, v73
v_and_b32 v73, 1, v73
v_lshlrev_b32 v73, 2, v73
v_xor_b32 v72, v72, v73
v_lshlrev_b32 v62, 4, v72
s_lshl_b32 s33, s11, 12
s_add_u32 m0, s33, 34816
s_nop 0
buffer_load_dwordx4 v62, s[16:19], 0 offen lds
s_lshl_b32 s33, s11, 2
s_add_u32 s33, s33, 35
s_lshl_b32 s33, s33, 6
v_add_u32 v72, s33, v0
v_mul_u32_u24 v73, 58255, v72
v_lshrrev_b32 v73, 26, v73
v_and_b32 v73, 1, v73
v_lshlrev_b32 v73, 2, v73
v_xor_b32 v72, v72, v73
v_lshlrev_b32 v62, 4, v72
s_lshl_b32 s33, s11, 12
s_add_u32 m0, s33, 35840
s_nop 0
buffer_load_dwordx4 v62, s[16:19], 0 offen lds
ds_read_b64_tr_b16 v[160:161], v63 offset:49152
ds_read_b64_tr_b16 v[162:163], v63 offset:49664
ds_read_b64_tr_b16 v[164:165], v63 offset:53248
ds_read_b64_tr_b16 v[166:167], v63 offset:53760
ds_read_b64_tr_b16 v[168:169], v63 offset:57344
ds_read_b64_tr_b16 v[170:171], v63 offset:57856
ds_read_b64_tr_b16 v[172:173], v63 offset:61440
ds_read_b64_tr_b16 v[174:175], v63 offset:61952
s_waitcnt lgkmcnt(0)
s_barrier
s_waitcnt vmcnt(28)
s_barrier
s_lshl_b32 s33, s11, 2
s_add_u32 s33, s33, 48
s_lshl_b32 s33, s33, 6
v_add_u32 v72, s33, v0
v_mul_u32_u24 v73, 58255, v72
v_lshrrev_b32 v73, 26, v73
v_and_b32 v73, 1, v73
v_lshlrev_b32 v73, 2, v73
v_xor_b32 v72, v72, v73
v_lshlrev_b32 v62, 4, v72
s_lshl_b32 s33, s11, 12
s_add_u32 m0, s33, 49152
s_nop 0
buffer_load_dwordx4 v62, s[16:19], 0 offen lds
s_lshl_b32 s33, s11, 2
s_add_u32 s33, s33, 49
s_lshl_b32 s33, s33, 6
v_add_u32 v72, s33, v0
v_mul_u32_u24 v73, 58255, v72
v_lshrrev_b32 v73, 26, v73
v_and_b32 v73, 1, v73
v_lshlrev_b32 v73, 2, v73
v_xor_b32 v72, v72, v73
v_lshlrev_b32 v62, 4, v72
s_lshl_b32 s33, s11, 12
s_add_u32 m0, s33, 50176
s_nop 0
buffer_load_dwordx4 v62, s[16:19], 0 offen lds
s_lshl_b32 s33, s11, 2
s_add_u32 s33, s33, 50
s_lshl_b32 s33, s33, 6
v_add_u32 v72, s33, v0
v_mul_u32_u24 v73, 58255, v72
v_lshrrev_b32 v73, 26, v73
v_and_b32 v73, 1, v73
v_lshlrev_b32 v73, 2, v73
v_xor_b32 v72, v72, v73
v_lshlrev_b32 v62, 4, v72
s_lshl_b32 s33, s11, 12
s_add_u32 m0, s33, 51200
s_nop 0
buffer_load_dwordx4 v62, s[16:19], 0 offen lds
s_lshl_b32 s33, s11, 2
s_add_u32 s33, s33, 51
s_lshl_b32 s33, s33, 6
v_add_u32 v72, s33, v0
v_mul_u32_u24 v73, 58255, v72
v_lshrrev_b32 v73, 26, v73
v_and_b32 v73, 1, v73
v_lshlrev_b32 v73, 2, v73
v_xor_b32 v72, v72, v73
v_lshlrev_b32 v62, 4, v72
s_lshl_b32 s33, s11, 12
s_add_u32 m0, s33, 52224
s_nop 0
buffer_load_dwordx4 v62, s[16:19], 0 offen lds
ds_read_b64_tr_b16 v[176:177], v64 offset:0
ds_read_b64_tr_b16 v[178:179], v64 offset:512
ds_read_b64_tr_b16 v[180:181], v64 offset:4096
ds_read_b64_tr_b16 v[182:183], v64 offset:4608
ds_read_b64_tr_b16 v[184:185], v64 offset:8192
ds_read_b64_tr_b16 v[186:187], v64 offset:8704
ds_read_b64_tr_b16 v[188:189], v64 offset:12288
ds_read_b64_tr_b16 v[190:191], v64 offset:12800
s_waitcnt lgkmcnt(0)
s_barrier
s_waitcnt vmcnt(28)
s_barrier
s_lshl_b32 s33, s11, 2
s_add_u32 s33, s33, 64
s_lshl_b32 s33, s33, 6
v_add_u32 v72, s33, v0
v_mul_u32_u24 v73, 58255, v72
v_lshrrev_b32 v73, 26, v73
v_and_b32 v73, 1, v73
v_lshlrev_b32 v73, 2, v73
v_xor_b32 v72, v72, v73
v_lshlrev_b32 v62, 4, v72
s_lshl_b32 s33, s11, 12
s_add_u32 m0, s33, 65536
s_nop 0
buffer_load_dwordx4 v62, s[16:19], 0 offen lds
s_lshl_b32 s33, s11, 2
s_add_u32 s33, s33, 65
s_lshl_b32 s33, s33, 6
v_add_u32 v72, s33, v0
v_mul_u32_u24 v73, 58255, v72
v_lshrrev_b32 v73, 26, v73
v_and_b32 v73, 1, v73
v_lshlrev_b32 v73, 2, v73
v_xor_b32 v72, v72, v73
v_lshlrev_b32 v62, 4, v72
s_lshl_b32 s33, s11, 12
s_add_u32 m0, s33, 66560
s_nop 0
buffer_load_dwordx4 v62, s[16:19], 0 offen lds
s_lshl_b32 s33, s11, 2
s_add_u32 s33, s33, 66
s_lshl_b32 s33, s33, 6
v_add_u32 v72, s33, v0
v_mul_u32_u24 v73, 58255, v72
v_lshrrev_b32 v73, 26, v73
v_and_b32 v73, 1, v73
v_lshlrev_b32 v73, 2, v73
v_xor_b32 v72, v72, v73
v_lshlrev_b32 v62, 4, v72
s_lshl_b32 s33, s11, 12
s_add_u32 m0, s33, 67584
s_nop 0
buffer_load_dwordx4 v62, s[16:19], 0 offen lds
s_lshl_b32 s33, s11, 2
s_add_u32 s33, s33, 67
s_lshl_b32 s33, s33, 6
v_add_u32 v72, s33, v0
v_mul_u32_u24 v73, 58255, v72
v_lshrrev_b32 v73, 26, v73
v_and_b32 v73, 1, v73
v_lshlrev_b32 v73, 2, v73
v_xor_b32 v72, v72, v73
v_lshlrev_b32 v62, 4, v72
s_lshl_b32 s33, s11, 12
s_add_u32 m0, s33, 68608
s_nop 0
buffer_load_dwordx4 v62, s[16:19], 0 offen lds
ds_read_b64_tr_b16 v[192:193], v64 offset:16384
ds_read_b64_tr_b16 v[194:195], v64 offset:16896
ds_read_b64_tr_b16 v[196:197], v64 offset:20480
ds_read_b64_tr_b16 v[198:199], v64 offset:20992
ds_read_b64_tr_b16 v[200:201], v64 offset:24576
ds_read_b64_tr_b16 v[202:203], v64 offset:25088
ds_read_b64_tr_b16 v[204:205], v64 offset:28672
ds_read_b64_tr_b16 v[206:207], v64 offset:29184
s_waitcnt lgkmcnt(0)
s_barrier
s_waitcnt vmcnt(28)
s_barrier
s_lshl_b32 s33, s11, 2
s_add_u32 s33, s33, 80
s_lshl_b32 s33, s33, 6
v_add_u32 v72, s33, v0
v_mul_u32_u24 v73, 58255, v72
v_lshrrev_b32 v73, 26, v73
v_and_b32 v73, 1, v73
v_lshlrev_b32 v73, 2, v73
v_xor_b32 v72, v72, v73
v_lshlrev_b32 v62, 4, v72
s_lshl_b32 s33, s11, 12
s_add_u32 m0, s33, 81920
s_nop 0
buffer_load_dwordx4 v62, s[16:19], 0 offen lds
s_lshl_b32 s33, s11, 2
s_add_u32 s33, s33, 81
s_lshl_b32 s33, s33, 6
v_add_u32 v72, s33, v0
v_mul_u32_u24 v73, 58255, v72
v_lshrrev_b32 v73, 26, v73
v_and_b32 v73, 1, v73
v_lshlrev_b32 v73, 2, v73
v_xor_b32 v72, v72, v73
v_lshlrev_b32 v62, 4, v72
s_lshl_b32 s33, s11, 12
s_add_u32 m0, s33, 82944
s_nop 0
buffer_load_dwordx4 v62, s[16:19], 0 offen lds
s_lshl_b32 s33, s11, 2
s_add_u32 s33, s33, 82
s_lshl_b32 s33, s33, 6
v_add_u32 v72, s33, v0
v_mul_u32_u24 v73, 58255, v72
v_lshrrev_b32 v73, 26, v73
v_and_b32 v73, 1, v73
v_lshlrev_b32 v73, 2, v73
v_xor_b32 v72, v72, v73
v_lshlrev_b32 v62, 4, v72
s_lshl_b32 s33, s11, 12
s_add_u32 m0, s33, 83968
s_nop 0
buffer_load_dwordx4 v62, s[16:19], 0 offen lds
s_lshl_b32 s33, s11, 2
s_add_u32 s33, s33, 83
s_lshl_b32 s33, s33, 6
v_add_u32 v72, s33, v0
v_mul_u32_u24 v73, 58255, v72
v_lshrrev_b32 v73, 26, v73
v_and_b32 v73, 1, v73
v_lshlrev_b32 v73, 2, v73
v_xor_b32 v72, v72, v73
v_lshlrev_b32 v62, 4, v72
s_lshl_b32 s33, s11, 12
s_add_u32 m0, s33, 84992
s_nop 0
buffer_load_dwordx4 v62, s[16:19], 0 offen lds
ds_read_b64_tr_b16 v[208:209], v64 offset:32768
ds_read_b64_tr_b16 v[210:211], v64 offset:33280
ds_read_b64_tr_b16 v[212:213], v64 offset:36864
ds_read_b64_tr_b16 v[214:215], v64 offset:37376
ds_read_b64_tr_b16 v[216:217], v64 offset:40960
ds_read_b64_tr_b16 v[218:219], v64 offset:41472
ds_read_b64_tr_b16 v[220:221], v64 offset:45056
ds_read_b64_tr_b16 v[222:223], v64 offset:45568
s_waitcnt lgkmcnt(0)
s_barrier
s_waitcnt vmcnt(28)
s_barrier
s_lshl_b32 s33, s11, 2
s_add_u32 s33, s33, 96
s_lshl_b32 s33, s33, 6
v_add_u32 v72, s33, v0
v_mul_u32_u24 v73, 58255, v72
v_lshrrev_b32 v73, 26, v73
v_and_b32 v73, 1, v73
v_lshlrev_b32 v73, 2, v73
v_xor_b32 v72, v72, v73
v_lshlrev_b32 v62, 4, v72
s_lshl_b32 s33, s11, 12
s_add_u32 m0, s33, 98304
s_nop 0
buffer_load_dwordx4 v62, s[16:19], 0 offen lds
s_lshl_b32 s33, s11, 2
s_add_u32 s33, s33, 97
s_lshl_b32 s33, s33, 6
v_add_u32 v72, s33, v0
v_mul_u32_u24 v73, 58255, v72
v_lshrrev_b32 v73, 26, v73
v_and_b32 v73, 1, v73
v_lshlrev_b32 v73, 2, v73
v_xor_b32 v72, v72, v73
v_lshlrev_b32 v62, 4, v72
s_lshl_b32 s33, s11, 12
s_add_u32 m0, s33, 99328
s_nop 0
buffer_load_dwordx4 v62, s[16:19], 0 offen lds
s_lshl_b32 s33, s11, 2
s_add_u32 s33, s33, 98
s_lshl_b32 s33, s33, 6
v_add_u32 v72, s33, v0
v_mul_u32_u24 v73, 58255, v72
v_lshrrev_b32 v73, 26, v73
v_and_b32 v73, 1, v73
v_lshlrev_b32 v73, 2, v73
v_xor_b32 v72, v72, v73
v_lshlrev_b32 v62, 4, v72
s_lshl_b32 s33, s11, 12
s_add_u32 m0, s33, 100352
s_nop 0
buffer_load_dwordx4 v62, s[16:19], 0 offen lds
s_lshl_b32 s33, s11, 2
s_add_u32 s33, s33, 99
s_lshl_b32 s33, s33, 6
v_add_u32 v72, s33, v0
v_mul_u32_u24 v73, 58255, v72
v_lshrrev_b32 v73, 26, v73
v_and_b32 v73, 1, v73
v_lshlrev_b32 v73, 2, v73
v_xor_b32 v72, v72, v73
v_lshlrev_b32 v62, 4, v72
s_lshl_b32 s33, s11, 12
s_add_u32 m0, s33, 101376
s_nop 0
buffer_load_dwordx4 v62, s[16:19], 0 offen lds
ds_read_b64_tr_b16 v[224:225], v64 offset:49152
ds_read_b64_tr_b16 v[226:227], v64 offset:49664
ds_read_b64_tr_b16 v[228:229], v64 offset:53248
ds_read_b64_tr_b16 v[230:231], v64 offset:53760
ds_read_b64_tr_b16 v[232:233], v64 offset:57344
ds_read_b64_tr_b16 v[234:235], v64 offset:57856
ds_read_b64_tr_b16 v[236:237], v64 offset:61440
ds_read_b64_tr_b16 v[238:239], v64 offset:61952
s_waitcnt lgkmcnt(0)
s_barrier
s_waitcnt vmcnt(28)
s_barrier
s_lshl_b32 s33, s11, 2
s_add_u32 s33, s33, 112
s_lshl_b32 s33, s33, 6
v_add_u32 v72, s33, v0
v_mul_u32_u24 v73, 58255, v72
v_lshrrev_b32 v73, 26, v73
v_and_b32 v73, 1, v73
v_lshlrev_b32 v73, 2, v73
v_xor_b32 v72, v72, v73
v_lshlrev_b32 v62, 4, v72
s_lshl_b32 s33, s11, 12
s_add_u32 m0, s33, 114688
s_nop 0
buffer_load_dwordx4 v62, s[16:19], 0 offen lds
s_lshl_b32 s33, s11, 2
s_add_u32 s33, s33, 113
s_lshl_b32 s33, s33, 6
v_add_u32 v72, s33, v0
v_mul_u32_u24 v73, 58255, v72
v_lshrrev_b32 v73, 26, v73
v_and_b32 v73, 1, v73
v_lshlrev_b32 v73, 2, v73
v_xor_b32 v72, v72, v73
v_lshlrev_b32 v62, 4, v72
s_lshl_b32 s33, s11, 12
s_add_u32 m0, s33, 115712
s_nop 0
buffer_load_dwordx4 v62, s[16:19], 0 offen lds
s_lshl_b32 s33, s11, 2
s_add_u32 s33, s33, 114
s_lshl_b32 s33, s33, 6
v_add_u32 v72, s33, v0
v_mul_u32_u24 v73, 58255, v72
v_lshrrev_b32 v73, 26, v73
v_and_b32 v73, 1, v73
v_lshlrev_b32 v73, 2, v73
v_xor_b32 v72, v72, v73
v_lshlrev_b32 v62, 4, v72
s_lshl_b32 s33, s11, 12
s_add_u32 m0, s33, 116736
s_nop 0
buffer_load_dwordx4 v62, s[16:19], 0 offen lds
s_lshl_b32 s33, s11, 2
s_add_u32 s33, s33, 115
s_lshl_b32 s33, s33, 6
v_add_u32 v72, s33, v0
v_mul_u32_u24 v73, 58255, v72
v_lshrrev_b32 v73, 26, v73
v_and_b32 v73, 1, v73
v_lshlrev_b32 v73, 2, v73
v_xor_b32 v72, v72, v73
v_lshlrev_b32 v62, 4, v72
s_lshl_b32 s33, s11, 12
s_add_u32 m0, s33, 117760
s_nop 0
buffer_load_dwordx4 v62, s[16:19], 0 offen lds
ds_read_b64_tr_b16 v[240:241], v65 offset:0
ds_read_b64_tr_b16 v[242:243], v65 offset:512
ds_read_b64_tr_b16 v[244:245], v65 offset:4096
ds_read_b64_tr_b16 v[246:247], v65 offset:4608
ds_read_b64_tr_b16 v[248:249], v65 offset:8192
ds_read_b64_tr_b16 v[250:251], v65 offset:8704
ds_read_b64_tr_b16 v[252:253], v65 offset:12288
ds_read_b64_tr_b16 v[254:255], v65 offset:12800
s_waitcnt lgkmcnt(0)
s_barrier
s_lshl_b32 s33, s11, 2
s_add_u32 s33, s33, 128
s_lshl_b32 s33, s33, 6
v_add_u32 v72, s33, v0
v_mul_u32_u24 v73, 58255, v72
v_lshrrev_b32 v73, 26, v73
v_and_b32 v73, 1, v73
v_lshlrev_b32 v73, 2, v73
v_xor_b32 v72, v72, v73
v_lshlrev_b32 v62, 4, v72
s_lshl_b32 s33, s11, 12
s_add_u32 m0, s33, 131072
s_nop 0
buffer_load_dwordx4 v62, s[16:19], 0 offen lds
s_lshl_b32 s33, s11, 2
s_add_u32 s33, s33, 129
s_lshl_b32 s33, s33, 6
v_add_u32 v72, s33, v0
v_mul_u32_u24 v73, 58255, v72
v_lshrrev_b32 v73, 26, v73
v_and_b32 v73, 1, v73
v_lshlrev_b32 v73, 2, v73
v_xor_b32 v72, v72, v73
v_lshlrev_b32 v62, 4, v72
s_lshl_b32 s33, s11, 12
s_add_u32 m0, s33, 132096
s_nop 0
buffer_load_dwordx4 v62, s[16:19], 0 offen lds
s_lshl_b32 s33, s11, 2
s_add_u32 s33, s33, 130
s_lshl_b32 s33, s33, 6
v_add_u32 v72, s33, v0
v_mul_u32_u24 v73, 58255, v72
v_lshrrev_b32 v73, 26, v73
v_and_b32 v73, 1, v73
v_lshlrev_b32 v73, 2, v73
v_xor_b32 v72, v72, v73
v_lshlrev_b32 v62, 4, v72
s_lshl_b32 s33, s11, 12
s_add_u32 m0, s33, 133120
s_nop 0
buffer_load_dwordx4 v62, s[16:19], 0 offen lds
s_lshl_b32 s33, s11, 2
s_add_u32 s33, s33, 131
s_lshl_b32 s33, s33, 6
v_add_u32 v72, s33, v0
v_mul_u32_u24 v73, 58255, v72
v_lshrrev_b32 v73, 26, v73
v_and_b32 v73, 1, v73
v_lshlrev_b32 v73, 2, v73
v_xor_b32 v72, v72, v73
v_lshlrev_b32 v62, 4, v72
s_lshl_b32 s33, s11, 12
s_add_u32 m0, s33, 134144
s_nop 0
buffer_load_dwordx4 v62, s[16:19], 0 offen lds
s_waitcnt vmcnt(0)
s_barrier
v_bfe_u32 v72, v0, 4, 1
v_bfe_u32 v73, v0, 5, 1
v_lshlrev_b32 v74, 4, v72
v_lshl_add_u32 v74, v73, 2, v74
v_bfe_u32 v75, v0, 2, 1
v_add_u32 v74, v74, v75
v_mul_u32_u24 v74, 1152, v74
v_xor_b32 v72, s11, v72
v_lshl_add_u32 v74, v72, 6, v74
v_bfe_u32 v75, v0, 3, 1
v_lshl_add_u32 v74, v75, 5, v74
v_and_b32 v75, 3, v0
v_lshl_add_u32 v66, v75, 3, v74
v_add_u32 v67, 73728, v66
s_lshl_b32 s33, s11, 11
v_add_u32 v68, s33, v4
v_add_u32 v69, s33, v5
v_add_u32 v70, s33, v6
ds_read_b64_tr_b16 v[20:21], v66 offset:0
ds_read_b64_tr_b16 v[22:23], v66 offset:2304
ds_read_b64_tr_b16 v[24:25], v66 offset:9216
ds_read_b64_tr_b16 v[26:27], v66 offset:11520
ds_read_b64_tr_b16 v[28:29], v66 offset:256
ds_read_b64_tr_b16 v[30:31], v66 offset:2560
ds_read_b64_tr_b16 v[32:33], v66 offset:9472
ds_read_b64_tr_b16 v[34:35], v66 offset:11776
s_waitcnt lgkmcnt(0)
ds_read_b64_tr_b16 v[36:37], v66 offset:512
ds_read_b64_tr_b16 v[38:39], v66 offset:2816
ds_read_b64_tr_b16 v[40:41], v66 offset:9728
ds_read_b64_tr_b16 v[42:43], v66 offset:12032
ds_read_b64_tr_b16 v[44:45], v66 offset:768
ds_read_b64_tr_b16 v[46:47], v66 offset:3072
ds_read_b64_tr_b16 v[48:49], v66 offset:9984
ds_read_b64_tr_b16 v[50:51], v66 offset:12288
s_waitcnt lgkmcnt(0)
s_cmp_lt_u32 s11, 2
s_cbranch_scc0 L_cv_1
ds_read_b64_tr_b16 v[52:53], v66 offset:1024
ds_read_b64_tr_b16 v[54:55], v66 offset:3328
ds_read_b64_tr_b16 v[56:57], v66 offset:10240
ds_read_b64_tr_b16 v[58:59], v66 offset:12544
L_cv_1:
s_waitcnt lgkmcnt(0)
s_barrier
ds_write_b128 v68, v[20:23] offset:0
ds_write_b128 v68, v[24:27] offset:1024
ds_write_b128 v68, v[28:31] offset:8192
ds_write_b128 v68, v[32:35] offset:9216
ds_write_b128 v68, v[36:39] offset:16384
ds_write_b128 v68, v[40:43] offset:17408
ds_write_b128 v68, v[44:47] offset:24576
ds_write_b128 v68, v[48:51] offset:25600
s_cmp_lt_u32 s11, 2
s_cbranch_scc0 L_cw_2
ds_write_b128 v68, v[52:55] offset:32768
ds_write_b128 v68, v[56:59] offset:33792
L_cw_2:
s_waitcnt lgkmcnt(0)
s_barrier
ds_read_b64_tr_b16 v[20:21], v66 offset:36864
ds_read_b64_tr_b16 v[22:23], v66 offset:39168
ds_read_b64_tr_b16 v[24:25], v66 offset:46080
ds_read_b64_tr_b16 v[26:27], v66 offset:48384
ds_read_b64_tr_b16 v[28:29], v66 offset:37120
ds_read_b64_tr_b16 v[30:31], v66 offset:39424
ds_read_b64_tr_b16 v[32:33], v66 offset:46336
ds_read_b64_tr_b16 v[34:35], v66 offset:48640
s_waitcnt lgkmcnt(0)
ds_read_b64_tr_b16 v[36:37], v66 offset:37376
ds_read_b64_tr_b16 v[38:39], v66 offset:39680
ds_read_b64_tr_b16 v[40:41], v66 offset:46592
ds_read_b64_tr_b16 v[42:43], v66 offset:48896
ds_read_b64_tr_b16 v[44:45], v66 offset:37632
ds_read_b64_tr_b16 v[46:47], v66 offset:39936
ds_read_b64_tr_b16 v[48:49], v66 offset:46848
ds_read_b64_tr_b16 v[50:51], v66 offset:49152
s_waitcnt lgkmcnt(0)
s_cmp_lt_u32 s11, 2
s_cbranch_scc0 L_cv_3
ds_read_b64_tr_b16 v[52:53], v66 offset:37888
ds_read_b64_tr_b16 v[54:55], v66 offset:40192
ds_read_b64_tr_b16 v[56:57], v66 offset:47104
ds_read_b64_tr_b16 v[58:59], v66 offset:49408
L_cv_3:
s_waitcnt lgkmcnt(0)
s_barrier
ds_write_b128 v68, v[20:23] offset:36864
ds_write_b128 v68, v[24:27] offset:37888
ds_write_b128 v68, v[28:31] offset:45056
ds_write_b128 v68, v[32:35] offset:46080
ds_write_b128 v69, v[36:39] offset:4096
ds_write_b128 v69, v[40:43] offset:5120
ds_write_b128 v69, v[44:47] offset:12288
ds_write_b128 v69, v[48:51] offset:13312
s_cmp_lt_u32 s11, 2
s_cbranch_scc0 L_cw_4
ds_write_b128 v69, v[52:55] offset:20480
ds_write_b128 v69, v[56:59] offset:21504
L_cw_4:
s_waitcnt lgkmcnt(0)
s_barrier
ds_read_b64_tr_b16 v[20:21], v67 offset:0
ds_read_b64_tr_b16 v[22:23], v67 offset:2304
ds_read_b64_tr_b16 v[24:25], v67 offset:9216
ds_read_b64_tr_b16 v[26:27], v67 offset:11520
ds_read_b64_tr_b16 v[28:29], v67 offset:256
ds_read_b64_tr_b16 v[30:31], v67 offset:2560
ds_read_b64_tr_b16 v[32:33], v67 offset:9472
ds_read_b64_tr_b16 v[34:35], v67 offset:11776
s_waitcnt lgkmcnt(0)
ds_read_b64_tr_b16 v[36:37], v67 offset:512
ds_read_b64_tr_b16 v[38:39], v67 offset:2816
ds_read_b64_tr_b16 v[40:41], v67 offset:9728
ds_read_b64_tr_b16 v[42:43], v67 offset:12032
ds_read_b64_tr_b16 v[44:45], v67 offset:768
ds_read_b64_tr_b16 v[46:47], v67 offset:3072
ds_read_b64_tr_b16 v[48:49], v67 offset:9984
ds_read_b64_tr_b16 v[50:51], v67 offset:12288
s_waitcnt lgkmcnt(0)
s_cmp_lt_u32 s11, 2
s_cbranch_scc0 L_cv_5
ds_read_b64_tr_b16 v[52:53], v67 offset:1024
ds_read_b64_tr_b16 v[54:55], v67 offset:3328
ds_read_b64_tr_b16 v[56:57], v67 offset:10240
ds_read_b64_tr_b16 v[58:59], v67 offset:12544
L_cv_5:
s_waitcnt lgkmcnt(0)
s_barrier
ds_write_b128 v69, v[20:23] offset:24576
ds_write_b128 v69, v[24:27] offset:25600
ds_write_b128 v69, v[28:31] offset:32768
ds_write_b128 v69, v[32:35] offset:33792
ds_write_b128 v69, v[36:39] offset:40960
ds_write_b128 v69, v[40:43] offset:41984
ds_write_b128 v70, v[44:47] offset:0
ds_write_b128 v70, v[48:51] offset:1024
s_cmp_lt_u32 s11, 2
s_cbranch_scc0 L_cw_6
ds_write_b128 v70, v[52:55] offset:8192
ds_write_b128 v70, v[56:59] offset:9216
L_cw_6:
s_waitcnt lgkmcnt(0)
s_barrier
ds_read_b64_tr_b16 v[20:21], v67 offset:36864
ds_read_b64_tr_b16 v[22:23], v67 offset:39168
ds_read_b64_tr_b16 v[24:25], v67 offset:46080
ds_read_b64_tr_b16 v[26:27], v67 offset:48384
ds_read_b64_tr_b16 v[28:29], v67 offset:37120
ds_read_b64_tr_b16 v[30:31], v67 offset:39424
ds_read_b64_tr_b16 v[32:33], v67 offset:46336
ds_read_b64_tr_b16 v[34:35], v67 offset:48640
s_waitcnt lgkmcnt(0)
ds_read_b64_tr_b16 v[36:37], v67 offset:37376
ds_read_b64_tr_b16 v[38:39], v67 offset:39680
ds_read_b64_tr_b16 v[40:41], v67 offset:46592
ds_read_b64_tr_b16 v[42:43], v67 offset:48896
ds_read_b64_tr_b16 v[44:45], v67 offset:37632
ds_read_b64_tr_b16 v[46:47], v67 offset:39936
ds_read_b64_tr_b16 v[48:49], v67 offset:46848
ds_read_b64_tr_b16 v[50:51], v67 offset:49152
s_waitcnt lgkmcnt(0)
s_cmp_lt_u32 s11, 2
s_cbranch_scc0 L_cv_7
ds_read_b64_tr_b16 v[52:53], v67 offset:37888
ds_read_b64_tr_b16 v[54:55], v67 offset:40192
ds_read_b64_tr_b16 v[56:57], v67 offset:47104
ds_read_b64_tr_b16 v[58:59], v67 offset:49408
L_cv_7:
s_waitcnt lgkmcnt(0)
s_barrier
ds_write_b128 v70, v[20:23] offset:12288
ds_write_b128 v70, v[24:27] offset:13312
ds_write_b128 v70, v[28:31] offset:20480
ds_write_b128 v70, v[32:35] offset:21504
ds_write_b128 v70, v[36:39] offset:28672
ds_write_b128 v70, v[40:43] offset:29696
ds_write_b128 v70, v[44:47] offset:36864
ds_write_b128 v70, v[48:51] offset:37888
s_cmp_lt_u32 s11, 2
s_cbranch_scc0 L_cw_8
ds_write_b128 v70, v[52:55] offset:45056
ds_write_b128 v70, v[56:59] offset:46080
L_cw_8:
s_waitcnt lgkmcnt(0)
s_barrier
s_cmp_eq_u32 s11, 0
s_cbranch_scc0 L_cb_wait
v_mov_b32 v72, 64
s_mov_b32 s33, 0
L_cb_poll:
global_load_dword v74, v72, s[40:41] sc1
s_waitcnt vmcnt(0)
v_readfirstlane_b32 s34, v74
s_add_u32 s33, s33, 1
s_cmp_gt_u32 s33, 2000000
s_cbranch_scc1 L_abort
s_cmp_ge_u32 s34, 32
s_cbranch_scc0 L_cb_poll
s_mov_b32 s35, 77596672
L_kv_poll:
buffer_load_dword v74, off, s[12:15], s35 sc1
s_waitcnt vmcnt(0)
v_readfirstlane_b32 s34, v74
s_add_u32 s33, s33, 1
s_cmp_gt_u32 s33, 4000000
s_cbranch_scc1 L_abort
s_sleep 1
s_cmp_ge_u32 s34, 64
s_cbranch_scc0 L_kv_poll
L_cb_wait:
s_barrier
s_cmp_eq_u32 s11, 3
s_cbranch_scc0 L_nf
v_mov_b32 v10, 64
L_nf:
v_lshlrev_b32 v79, 2, v1
s_lshl_b32 s33, s10, 13
s_lshl_b32 s34, s11, 12
s_and_b32 s34, s34, 4096
s_add_u32 s33, s33, s34
s_cmp_lt_u32 s11, 2
s_mov_b32 s35, 32964608
s_cselect_b32 s35, 16187392, s35
s_add_u32 s33, s33, s35
buffer_load_dword v0, v79, s[12:15], s33 offen
s_add_u32 s33, s33, 262144
buffer_load_dword v0, v79, s[12:15], s33 offen
s_add_u32 s33, s33, 262144
s_waitcnt vmcnt(0)
s_mov_b32 s20, -1
s_mov_b32 s21, 16515072
s_mov_b32 s22, 33292288
s_lshl_b32 s33, s10, 11
s_add_u32 s23, s33, 67043328
s_add_u32 s24, s33, 71237632
s_sub_u32 s26, s29, 147456
s_lshl_b32 s34, s10, 13
s_add_u32 s33, s34, 524288
s_add_u32 s54, s33, 16187392
s_add_u32 s55, s33, 32964608
s_cmp_eq_u32 s11, 0
s_cbranch_scc1 L_pre_w0
s_cmp_eq_u32 s11, 1
s_cbranch_scc1 L_pre_w1
s_and_b32 s33, s10, 1
s_lshl_b32 s34, s11, 1
s_add_u32 s33, s33, s34
s_cmp_eq_u32 s33, 4
s_cbranch_scc1 L_pre_w2e
s_cmp_eq_u32 s33, 5
s_cbranch_scc1 L_pre_w2o
s_cmp_eq_u32 s33, 6
s_cbranch_scc1 L_pre_w3e
s_branch L_pre_w3o
L_code_begin:
L_step_w0:
ds_read_b64_tr_b16 v[56:57], v2 offset:0
ds_read_b64_tr_b16 v[58:59], v2 offset:64
ds_read_b64_tr_b16 v[60:61], v2 offset:512
ds_read_b64_tr_b16 v[62:63], v2 offset:576
s_waitcnt lgkmcnt(2)
v_smfmac_f32_16x16x64_bf16 v[44:47], v[56:59], a[0:7], v3
ds_read_b64_tr_b16 v[64:65], v2 offset:1024
v_smfmac_f32_16x16x64_bf16 v[48:51], v[56:59], a[144:151], v3
ds_read_b64_tr_b16 v[66:67], v2 offset:1088
buffer_load_dwordx4 v[36:39], v11, s[12:15], s22 offen offset:0 sc1
v_smfmac_f32_16x16x64_bf16 v[52:55], v[56:59], v[112:119], v3
s_waitcnt lgkmcnt(2)
v_smfmac_f32_16x16x64_bf16 v[44:47], v[60:63], a[8:15], v3
ds_read_b64_tr_b16 v[68:69], v2 offset:1536
v_smfmac_f32_16x16x64_bf16 v[48:51], v[60:63], a[152:159], v3
ds_read_b64_tr_b16 v[70:71], v2 offset:1600
buffer_load_dwordx4 v[40:43], v11, s[12:15], s22 offen offset:256 sc1
v_smfmac_f32_16x16x64_bf16 v[52:55], v[60:63], v[120:127], v3
s_add_u32 s33, s26, 6144
buffer_load_dwordx4 v[20:23], v1, s[12:15], s33 offen sc1
buffer_load_dwordx4 v[24:27], v1, s[12:15], s33 offen offset:1024 sc1
s_waitcnt lgkmcnt(2)
v_smfmac_f32_16x16x64_bf16 v[44:47], v[64:67], a[16:23], v3
ds_read_b64_tr_b16 v[56:57], v2 offset:2048
v_smfmac_f32_16x16x64_bf16 v[48:51], v[64:67], a[160:167], v3
ds_read_b64_tr_b16 v[58:59], v2 offset:2112
v_smfmac_f32_16x16x64_bf16 v[52:55], v[64:67], v[128:135], v3
s_waitcnt lgkmcnt(2)
v_smfmac_f32_16x16x64_bf16 v[44:47], v[68:71], a[24:31], v3
ds_read_b64_tr_b16 v[60:61], v2 offset:2560
v_smfmac_f32_16x16x64_bf16 v[48:51], v[68:71], a[168:175], v3
ds_read_b64_tr_b16 v[62:63], v2 offset:2624
v_smfmac_f32_16x16x64_bf16 v[52:55], v[68:71], v[136:143], v3
s_waitcnt lgkmcnt(2)
v_smfmac_f32_16x16x64_bf16 v[44:47], v[56:59], a[32:39], v3
ds_read_b64_tr_b16 v[64:65], v2 offset:3072
v_smfmac_f32_16x16x64_bf16 v[48:51], v[56:59], a[176:183], v3
ds_read_b64_tr_b16 v[66:67], v2 offset:3136
v_smfmac_f32_16x16x64_bf16 v[52:55], v[56:59], v[144:151], v3
s_waitcnt lgkmcnt(2)
v_smfmac_f32_16x16x64_bf16 v[44:47], v[60:63], a[40:47], v3
ds_read_b64_tr_b16 v[68:69], v2 offset:3584
v_smfmac_f32_16x16x64_bf16 v[48:51], v[60:63], a[184:191], v3
ds_read_b64_tr_b16 v[70:71], v2 offset:3648
v_smfmac_f32_16x16x64_bf16 v[52:55], v[60:63], v[152:159], v3
s_barrier
s_waitcnt lgkmcnt(2)
v_smfmac_f32_16x16x64_bf16 v[44:47], v[64:67], a[48:55], v3
ds_read_b64_tr_b16 v[56:57], v2 offset:4096
v_smfmac_f32_16x16x64_bf16 v[48:51], v[64:67], a[192:199], v3
ds_read_b64_tr_b16 v[58:59], v2 offset:4160
v_smfmac_f32_16x16x64_bf16 v[52:55], v[64:67], v[160:167], v3
s_waitcnt lgkmcnt(2)
v_smfmac_f32_16x16x64_bf16 v[44:47], v[68:71], a[56:63], v3
ds_read_b64_tr_b16 v[60:61], v2 offset:4608
v_smfmac_f32_16x16x64_bf16 v[48:51], v[68:71], a[200:207], v3
ds_read_b64_tr_b16 v[62:63], v2 offset:4672
v_smfmac_f32_16x16x64_bf16 v[52:55], v[68:71], v[168:175], v3
s_waitcnt lgkmcnt(2)
v_smfmac_f32_16x16x64_bf16 v[44:47], v[56:59], a[64:71], v3
ds_read_b64_tr_b16 v[64:65], v2 offset:5120
s_waitcnt vmcnt(0)
v_max3_u32 v78, v20, v22, v24
v_smfmac_f32_16x16x64_bf16 v[48:51], v[56:59], a[208:215], v3
ds_read_b64_tr_b16 v[66:67], v2 offset:5184
v_max_u32 v78, v78, v26
v_cmp_eq_u32 vcc, -1, v78
v_smfmac_f32_16x16x64_bf16 v[52:55], v[56:59], v[176:183], v3
ds_write_b128 v1, v[20:23] offset:6144
ds_write_b128 v1, v[24:27] offset:7168
s_cbranch_vccnz L_grt_9
L_gbk_10:
s_waitcnt lgkmcnt(4)
v_smfmac_f32_16x16x64_bf16 v[44:47], v[60:63], a[72:79], v3
ds_read_b64_tr_b16 v[68:69], v2 offset:5632
v_smfmac_f32_16x16x64_bf16 v[48:51], v[60:63], a[216:223], v3
ds_read_b64_tr_b16 v[70:71], v2 offset:5696
v_smfmac_f32_16x16x64_bf16 v[52:55], v[60:63], v[184:191], v3
s_waitcnt lgkmcnt(2)
s_barrier
v_smfmac_f32_16x16x64_bf16 v[44:47], v[64:67], a[80:87], v3
ds_read_b64_tr_b16 v[56:57], v2 offset:6144
v_smfmac_f32_16x16x64_bf16 v[48:51], v[64:67], a[224:231], v3
ds_read_b64_tr_b16 v[58:59], v2 offset:6208
v_smfmac_f32_16x16x64_bf16 v[52:55], v[64:67], v[192:199], v3
s_waitcnt lgkmcnt(2)
v_smfmac_f32_16x16x64_bf16 v[44:47], v[68:71], a[88:95], v3
ds_read_b64_tr_b16 v[60:61], v2 offset:6656
v_smfmac_f32_16x16x64_bf16 v[48:51], v[68:71], a[232:239], v3
ds_read_b64_tr_b16 v[62:63], v2 offset:6720
v_smfmac_f32_16x16x64_bf16 v[52:55], v[68:71], v[200:207], v3
s_waitcnt lgkmcnt(2)
v_smfmac_f32_16x16x64_bf16 v[44:47], v[56:59], a[96:103], v3
ds_read_b64_tr_b16 v[64:65], v2 offset:7168
v_smfmac_f32_16x16x64_bf16 v[48:51], v[56:59], a[240:247], v3
ds_read_b64_tr_b16 v[66:67], v2 offset:7232
v_smfmac_f32_16x16x64_bf16 v[52:55], v[56:59], v[208:215], v3
s_waitcnt lgkmcnt(2)
v_smfmac_f32_16x16x64_bf16 v[44:47], v[60:63], a[104:111], v3
ds_read_b64_tr_b16 v[68:69], v2 offset:7680
v_smfmac_f32_16x16x64_bf16 v[48:51], v[60:63], a[248:255], v3
ds_read_b64_tr_b16 v[70:71], v2 offset:7744
v_smfmac_f32_16x16x64_bf16 v[52:55], v[60:63], v[216:223], v3
s_barrier
s_waitcnt lgkmcnt(2)
v_smfmac_f32_16x16x64_bf16 v[44:47], v[64:67], a[112:119], v3
ds_read_b64_tr_b16 v[56:57], v2 offset:8192
v_smfmac_f32_16x16x64_bf16 v[48:51], v[64:67], v[80:87], v3
ds_read_b64_tr_b16 v[58:59], v2 offset:8256
s_waitcnt lgkmcnt(2)
v_smfmac_f32_16x16x64_bf16 v[44:47], v[68:71], a[120:127], v3
ds_read_b64_tr_b16 v[60:61], v2 offset:8704
v_smfmac_f32_16x16x64_bf16 v[48:51], v[68:71], v[88:95], v3
ds_read_b64_tr_b16 v[62:63], v2 offset:8768
s_waitcnt lgkmcnt(2)
v_smfmac_f32_16x16x64_bf16 v[44:47], v[56:59], a[128:135], v3
v_smfmac_f32_16x16x64_bf16 v[48:51], v[56:59], v[96:103], v3
s_waitcnt lgkmcnt(0)
v_smfmac_f32_16x16x64_bf16 v[44:47], v[60:63], a[136:143], v3
v_smfmac_f32_16x16x64_bf16 v[48:51], v[60:63], v[104:111], v3
v_smfmac_f32_16x16x64_bf16 v[52:55], v[64:67], v[224:231], v3
v_cvt_pk_bf16_f32 v72, v44, v45
v_cvt_pk_bf16_f32 v73, v46, v47
ds_write_b64 v14, v[72:73]
v_smfmac_f32_16x16x64_bf16 v[52:55], v[68:71], v[232:239], v3
v_cvt_pk_bf16_f32 v74, v48, v49
v_cvt_pk_bf16_f32 v75, v50, v51
ds_write_b64 v14, v[74:75] offset:2048
v_smfmac_f32_16x16x64_bf16 v[52:55], v[56:59], v[240:247], v3
v_smfmac_f32_16x16x64_bf16 v[52:55], v[60:63], v[248:255], v3
s_waitcnt lgkmcnt(0)
s_barrier
ds_read_b64_tr_b16 v[20:21], v2 offset:11264
ds_read_b64_tr_b16 v[22:23], v2 offset:11328
ds_read_b64_tr_b16 v[56:57], v2 offset:9216
ds_read_b64_tr_b16 v[58:59], v2 offset:9280
ds_read_b64_tr_b16 v[24:25], v2 offset:11776
ds_read_b64_tr_b16 v[26:27], v2 offset:11840
ds_read_b64_tr_b16 v[60:61], v2 offset:9728
ds_read_b64_tr_b16 v[62:63], v2 offset:9792
ds_read_b64_tr_b16 v[28:29], v2 offset:12288
ds_read_b64_tr_b16 v[30:31], v2 offset:12352
ds_read_b64_tr_b16 v[64:65], v2 offset:10240
ds_read_b64_tr_b16 v[66:67], v2 offset:10304
s_cmp_eq_u32 s20, 63
s_cbranch_scc1 L_last_w0
s_waitcnt lgkmcnt(8)
ds_read_b64_tr_b16 v[32:33], v2 offset:12800
ds_read_b64_tr_b16 v[34:35], v2 offset:12864
ds_read_b64_tr_b16 v[68:69], v2 offset:10752
ds_read_b64_tr_b16 v[70:71], v2 offset:10816
v_mfma_f32_16x16x32_bf16 v[72:75], v[20:23], v[56:59], 0
s_waitcnt lgkmcnt(8)
v_mfma_f32_16x16x32_bf16 v[72:75], v[24:27], v[60:63], v[72:75]
s_waitcnt lgkmcnt(4)
v_mfma_f32_16x16x32_bf16 v[72:75], v[28:31], v[64:67], v[72:75]
s_waitcnt lgkmcnt(0)
v_mfma_f32_16x16x32_bf16 v[72:75], v[32:35], v[68:71], v[72:75]
v_cvt_pk_bf16_f32 v52, v52, v53
v_cvt_pk_bf16_f32 v53, v54, v55
buffer_store_dwordx2 v[52:53], v13, s[12:15], s24 offen sc1
s_nop 4
ds_write_b128 v1, v[72:75] offset:13312
s_add_u32 s32, s20, 1
s_and_b32 s33, s32, 1
s_bfe_u32 s34, s32, 0x10001
s_lshl_b32 s34, s34, 16
s_or_b32 s35, s33, s34
s_and_b32 s33, s32, 3
s_lshl_b32 s33, s33, 14
s_add_u32 s25, s33, s29
s_sub_u32 s26, s25, 147456
s_add_u32 s33, s20, 3
s_and_b32 s33, s33, 3
s_lshl_b32 s33, s33, 14
s_add_u32 s27, s33, s29
s_mov_b64 exec, s[48:49]
buffer_store_dwordx4 v[20:23], v12, s[12:15], s23 offen offset:0 sc1
buffer_store_dwordx4 v[24:27], v12, s[12:15], s23 offen offset:64 sc1
buffer_store_dwordx4 v[28:31], v12, s[12:15], s23 offen offset:128 sc1
buffer_store_dwordx4 v[32:35], v12, s[12:15], s23 offen offset:192 sc1
s_mov_b64 exec, -1
s_waitcnt lgkmcnt(0)
s_barrier
ds_read_b128 v[60:63], v1 offset:14336
ds_read_b128 v[64:67], v1 offset:15360
ds_read_b128 v[56:59], v1 offset:13312
v_mov_b32 v15, s35
s_waitcnt lgkmcnt(1)
v_max3_f32 v72, v60, v61, v62
v_max3_f32 v73, v63, v64, v65
v_max3_f32 v72, v72, v66, v67
s_waitcnt lgkmcnt(0)
v_max3_f32 v73, v73, v56, v57
v_max3_f32 v72, v72, v58, v59
v_max_f32 v72, v72, v73
v_mov_b32 v73, v72
s_nop 1
v_permlane32_swap_b32 v72, v73
v_max_f32 v72, v72, v73
v_mov_b32 v73, v72
s_nop 1
v_permlane16_swap_b32 v72, v73
v_max_f32 v72, v72, v73
v_mul_f32 v73, s47, v72
v_fma_f32 v60, v60, s47, -v73
v_fma_f32 v61, v61, s47, -v73
v_fma_f32 v62, v62, s47, -v73
v_fma_f32 v63, v63, s47, -v73
v_fma_f32 v64, v64, s47, -v73
v_fma_f32 v65, v65, s47, -v73
v_fma_f32 v66, v66, s47, -v73
v_fma_f32 v67, v67, s47, -v73
v_exp_f32 v60, v60
v_exp_f32 v61, v61
v_exp_f32 v62, v62
v_cvt_pk_bf16_f32 v20, v60, v61
v_exp_f32 v63, v63
v_exp_f32 v64, v64
v_cvt_pk_bf16_f32 v21, v62, v63
v_exp_f32 v65, v65
v_exp_f32 v66, v66
v_cvt_pk_bf16_f32 v22, v64, v65
v_exp_f32 v67, v67
v_fma_f32 v56, v56, s47, -v73
v_fma_f32 v57, v57, s47, -v73
v_fma_f32 v58, v58, s47, -v73
v_fma_f32 v59, v59, s47, -v73
v_cvt_pk_bf16_f32 v23, v66, v67
s_nop 1
v_mfma_f32_16x16x32_bf16 v[44:47], v[36:39], v[20:23], 0
v_mfma_f32_16x16x32_bf16 v[48:51], v[40:43], v[20:23], 0
v_exp_f32 v56, v56
v_exp_f32 v57, v57
v_exp_f32 v58, v58
v_exp_f32 v59, v59
v_add_f32 v74, v60, v61
v_add_f32 v75, v62, v63
v_cvt_pk_bf16_f32 v24, v56, v57
v_cvt_pk_bf16_f32 v25, v58, v59
v_cndmask_b32 v26, 0, v24, s[52:53]
v_cndmask_b32 v27, 0, v25, s[52:53]
v_cndmask_b32 v28, v24, 0, s[52:53]
v_cndmask_b32 v29, v25, 0, s[52:53]
v_mfma_f32_16x16x16_bf16 v[44:47], v[52:53], v[26:27], v[44:47]
v_mfma_f32_16x16x16_bf16 v[48:51], v[52:53], v[28:29], v[48:51]
ds_read_b128 v[20:23], v5 offset:24576
ds_read_b128 v[24:27], v5 offset:25600
ds_read_b128 v[28:31], v6 offset:12288
ds_read_b128 v[32:35], v6 offset:13312
v_add_f32 v74, v74, v64
v_add_f32 v75, v75, v65
v_add_f32 v74, v74, v66
v_add_f32 v75, v75, v67
v_add_f32 v73, v56, v57
v_add_f32 v72, v58, v59
v_add_f32 v74, v74, v75
v_add_f32 v73, v73, v72
v_fma_f32 v74, v73, 0.5, v74
v_mov_b32 v75, v74
s_nop 1
v_permlane32_swap_b32 v74, v75
v_add_f32 v74, v74, v75
v_mov_b32 v75, v74
s_nop 1
v_permlane16_swap_b32 v74, v75
v_add_f32 v74, v74, v75
v_rcp_f32 v74, v74
ds_read_b128 v[56:59], v4 offset:0
ds_read_b128 v[60:63], v4 offset:1024
ds_read_b128 v[64:67], v4 offset:36864
ds_read_b128 v[68:71], v4 offset:37888
v_pk_mul_f32 v[44:45], v[44:45], v[74:75] op_sel_hi:[1,0]
v_pk_mul_f32 v[48:49], v[48:49], v[74:75] op_sel_hi:[1,0]
v_pk_mul_f32 v[46:47], v[46:47], v[74:75] op_sel_hi:[1,0]
v_pk_mul_f32 v[50:51], v[50:51], v[74:75] op_sel_hi:[1,0]
v_cvt_pk_bf16_f32 v76, v44, v45
v_cvt_pk_bf16_f32 v77, v46, v47
v_cvt_pk_bf16_f32 v78, v48, v49
v_cvt_pk_bf16_f32 v79, v50, v51
ds_write_b128 v1, v[76:79] offset:9216
v_mov_b32 v44, 0
v_mov_b32 v45, 0
v_mov_b32 v46, 0
v_mov_b32 v47, 0
v_mov_b32 v48, 0
v_mov_b32 v49, 0
v_mov_b32 v50, 0
v_mov_b32 v51, 0
s_waitcnt lgkmcnt(0)
s_barrier
ds_read_b128 v[36:39], v1 offset:9216
ds_read_b128 v[40:43], v1 offset:10240
ds_read_b128 v[52:55], v1 offset:11264
ds_read_b128 v[76:79], v1 offset:12288
s_waitcnt lgkmcnt(3)
v_smfmac_f32_16x16x64_bf16 v[44:47], v[36:39], v[56:63], v3
ds_read_b128 v[56:59], v4 offset:8192
ds_read_b128 v[60:63], v4 offset:9216
s_waitcnt lgkmcnt(4)
v_smfmac_f32_16x16x64_bf16 v[44:47], v[40:43], v[64:71], v3
ds_read_b128 v[64:67], v4 offset:45056
ds_read_b128 v[68:71], v4 offset:46080
s_waitcnt lgkmcnt(5)
v_smfmac_f32_16x16x64_bf16 v[44:47], v[52:55], v[20:27], v3
ds_read_b128 v[20:23], v5 offset:32768
ds_read_b128 v[24:27], v5 offset:33792
s_waitcnt lgkmcnt(6)
v_smfmac_f32_16x16x64_bf16 v[44:47], v[76:79], v[28:35], v3
ds_read_b128 v[28:31], v6 offset:20480
ds_read_b128 v[32:35], v6 offset:21504
s_waitcnt lgkmcnt(6)
v_smfmac_f32_16x16x64_bf16 v[48:51], v[36:39], v[56:63], v3
ds_read_b128 v[56:59], v4 offset:16384
ds_read_b128 v[60:63], v4 offset:17408
s_nop 1
v_cvt_pk_bf16_f32 v72, v44, v45
v_cvt_pk_bf16_f32 v73, v46, v47
s_waitcnt lgkmcnt(6)
v_smfmac_f32_16x16x64_bf16 v[48:51], v[40:43], v[64:71], v3
ds_read_b128 v[64:67], v5 offset:4096
ds_read_b128 v[68:71], v5 offset:5120
v_and_or_b32 v72, v72, s46, v15
s_add_u32 s36, s28, 0
buffer_store_dwordx2 v[72:73], v7, s[12:15], s36 offen
s_waitcnt lgkmcnt(6)
v_smfmac_f32_16x16x64_bf16 v[48:51], v[52:55], v[20:27], v3
ds_read_b128 v[20:23], v5 offset:40960
ds_read_b128 v[24:27], v5 offset:41984
v_mov_b32 v44, 0
v_mov_b32 v45, 0
s_waitcnt lgkmcnt(6)
v_smfmac_f32_16x16x64_bf16 v[48:51], v[76:79], v[28:35], v3
ds_read_b128 v[28:31], v6 offset:28672
ds_read_b128 v[32:35], v6 offset:29696
v_mov_b32 v46, 0
v_mov_b32 v47, 0
s_waitcnt lgkmcnt(6)
s_nop 0
v_smfmac_f32_16x16x64_bf16 v[44:47], v[36:39], v[56:63], v3
ds_read_b128 v[56:59], v4 offset:24576
ds_read_b128 v[60:63], v4 offset:25600
v_cvt_pk_bf16_f32 v74, v48, v49
v_cvt_pk_bf16_f32 v75, v50, v51
s_waitcnt lgkmcnt(6)
v_smfmac_f32_16x16x64_bf16 v[44:47], v[40:43], v[64:71], v3
ds_read_b128 v[64:67], v5 offset:12288
ds_read_b128 v[68:71], v5 offset:13312
v_and_or_b32 v74, v74, s46, v15
s_add_u32 s36, s28, 65536
buffer_store_dwordx2 v[74:75], v7, s[12:15], s36 offen
s_waitcnt lgkmcnt(6)
v_smfmac_f32_16x16x64_bf16 v[44:47], v[52:55], v[20:27], v3
ds_read_b128 v[20:23], v6 offset:0
ds_read_b128 v[24:27], v6 offset:1024
v_mov_b32 v48, 0
v_mov_b32 v49, 0
s_waitcnt lgkmcnt(6)
v_smfmac_f32_16x16x64_bf16 v[44:47], v[76:79], v[28:35], v3
ds_read_b128 v[28:31], v6 offset:36864
ds_read_b128 v[32:35], v6 offset:37888
v_mov_b32 v50, 0
v_mov_b32 v51, 0
s_waitcnt lgkmcnt(6)
s_nop 0
v_smfmac_f32_16x16x64_bf16 v[48:51], v[36:39], v[56:63], v3
ds_read_b128 v[56:59], v4 offset:32768
ds_read_b128 v[60:63], v4 offset:33792
v_cvt_pk_bf16_f32 v72, v44, v45
v_cvt_pk_bf16_f32 v73, v46, v47
s_waitcnt lgkmcnt(6)
v_smfmac_f32_16x16x64_bf16 v[48:51], v[40:43], v[64:71], v3
ds_read_b128 v[64:67], v5 offset:20480
ds_read_b128 v[68:71], v5 offset:21504
v_and_or_b32 v72, v72, s46, v15
s_add_u32 s36, s28, 131072
buffer_store_dwordx2 v[72:73], v7, s[12:15], s36 offen
s_waitcnt lgkmcnt(6)
v_smfmac_f32_16x16x64_bf16 v[48:51], v[52:55], v[20:27], v3
ds_read_b128 v[20:23], v6 offset:8192
ds_read_b128 v[24:27], v6 offset:9216
v_mov_b32 v44, 0
v_mov_b32 v45, 0
s_waitcnt lgkmcnt(6)
v_smfmac_f32_16x16x64_bf16 v[48:51], v[76:79], v[28:35], v3
ds_read_b128 v[28:31], v6 offset:45056
ds_read_b128 v[32:35], v6 offset:46080
v_mov_b32 v46, 0
v_mov_b32 v47, 0
s_waitcnt lgkmcnt(6)
s_nop 0
v_smfmac_f32_16x16x64_bf16 v[44:47], v[36:39], v[56:63], v3
s_nop 0
v_cvt_pk_bf16_f32 v74, v48, v49
v_cvt_pk_bf16_f32 v75, v50, v51
s_waitcnt lgkmcnt(4)
v_smfmac_f32_16x16x64_bf16 v[44:47], v[40:43], v[64:71], v3
v_and_or_b32 v74, v74, s46, v15
s_add_u32 s36, s28, 196608
buffer_store_dwordx2 v[74:75], v7, s[12:15], s36 offen
s_waitcnt lgkmcnt(2)
v_smfmac_f32_16x16x64_bf16 v[44:47], v[52:55], v[20:27], v3
s_waitcnt lgkmcnt(0)
v_smfmac_f32_16x16x64_bf16 v[44:47], v[76:79], v[28:35], v3
s_nop 7
v_cvt_pk_bf16_f32 v72, v44, v45
v_cvt_pk_bf16_f32 v73, v46, v47
v_and_or_b32 v72, v72, s46, v15
s_add_u32 s36, s28, 262144
buffer_store_dwordx2 v[72:73], v7, s[12:15], s36 offen
L_pre_w0:
v_mov_b32 v44, 0
v_mov_b32 v48, 0
v_mov_b32 v52, 0
v_mov_b32 v45, 0
v_mov_b32 v49, 0
v_mov_b32 v53, 0
v_mov_b32 v46, 0
v_mov_b32 v50, 0
v_mov_b32 v54, 0
v_mov_b32 v47, 0
v_mov_b32 v51, 0
v_mov_b32 v55, 0
s_add_u32 s20, s20, 1
s_add_u32 s21, s21, 262144
s_add_u32 s22, s22, 262144
s_add_u32 s23, s23, 65536
s_add_u32 s24, s24, 65536
s_add_u32 s33, s20, 2
s_min_u32 s33, s33, 63
s_lshl_b32 s33, s33, 18
s_lshl_b32 s34, s10, 13
s_add_u32 s33, s33, s34
s_add_u32 s54, s33, 16187392
s_add_u32 s55, s33, 32964608
s_nop 15
s_nop 15
s_nop 15
s_nop 11
s_add_u32 s37, s26, 0
buffer_load_dwordx4 v[20:23], v1, s[12:15], s37 offen sc1
buffer_load_dwordx4 v[24:27], v1, s[12:15], s37 offen offset:1024 sc1
s_nop 15
s_nop 8
buffer_load_dwordx4 v[28:31], v1, s[12:15], s37 offen sc1
buffer_load_dwordx4 v[32:35], v1, s[12:15], s37 offen offset:1024 sc1
s_nop 15
s_nop 8
buffer_load_dwordx4 v[36:39], v1, s[12:15], s37 offen sc1
buffer_load_dwordx4 v[40:43], v1, s[12:15], s37 offen offset:1024 sc1
L_g0p_11:
s_waitcnt vmcnt(4)
v_max3_u32 v78, v20, v22, v24
v_max_u32 v78, v78, v26
v_cmp_eq_u32 vcc, -1, v78
s_cbranch_vccz L_g0k_13
buffer_load_dwordx4 v[20:23], v1, s[12:15], s37 offen sc1
buffer_load_dwordx4 v[24:27], v1, s[12:15], s37 offen offset:1024 sc1
s_waitcnt vmcnt(4)
v_max3_u32 v78, v28, v30, v32
v_max_u32 v78, v78, v34
v_cmp_eq_u32 vcc, -1, v78
s_cbranch_vccz L_g0k_14
buffer_load_dwordx4 v[28:31], v1, s[12:15], s37 offen sc1
buffer_load_dwordx4 v[32:35], v1, s[12:15], s37 offen offset:1024 sc1
s_waitcnt vmcnt(4)
v_max3_u32 v78, v36, v38, v40
v_max_u32 v78, v78, v42
v_cmp_eq_u32 vcc, -1, v78
s_cbranch_vccz L_g0k_15
buffer_load_dwordx4 v[36:39], v1, s[12:15], s37 offen sc1
buffer_load_dwordx4 v[40:43], v1, s[12:15], s37 offen offset:1024 sc1
s_add_u32 s45, s45, 1
s_cmp_gt_u32 s45, 1000000
s_cbranch_scc1 L_abort
s_branch L_g0p_11
L_g0k_13:
ds_write_b128 v1, v[20:23] offset:0
ds_write_b128 v1, v[24:27] offset:1024
s_branch L_g0d_12
L_g0k_14:
ds_write_b128 v1, v[28:31] offset:0
ds_write_b128 v1, v[32:35] offset:1024
s_branch L_g0d_12
L_g0k_15:
ds_write_b128 v1, v[36:39] offset:0
ds_write_b128 v1, v[40:43] offset:1024
L_g0d_12:
s_waitcnt lgkmcnt(0)
s_barrier
s_branch L_step_w0
L_last_w0:
v_cvt_pk_bf16_f32 v52, v52, v53
v_cvt_pk_bf16_f32 v53, v54, v55
buffer_store_dwordx2 v[52:53], v13, s[12:15], s24 offen sc1
ds_read_b64_tr_b16 v[32:33], v2 offset:12800
ds_read_b64_tr_b16 v[34:35], v2 offset:12864
s_waitcnt lgkmcnt(0)
s_mov_b64 exec, s[48:49]
buffer_store_dwordx4 v[20:23], v12, s[12:15], s23 offen offset:0 sc1
buffer_store_dwordx4 v[24:27], v12, s[12:15], s23 offen offset:64 sc1
buffer_store_dwordx4 v[28:31], v12, s[12:15], s23 offen offset:128 sc1
buffer_store_dwordx4 v[32:35], v12, s[12:15], s23 offen offset:192 sc1
s_mov_b64 exec, -1
s_waitcnt vmcnt(0)
s_barrier
s_branch L_finish
L_grt_9:
L_glp_16:
s_add_u32 s45, s45, 1
s_cmp_gt_u32 s45, 1000000
s_cbranch_scc1 L_abort
s_waitcnt lgkmcnt(0)
s_add_u32 s33, s26, 6144
buffer_load_dwordx4 v[20:23], v1, s[12:15], s33 offen sc1
buffer_load_dwordx4 v[24:27], v1, s[12:15], s33 offen offset:1024 sc1
s_waitcnt vmcnt(0)
v_max3_u32 v78, v20, v22, v24
v_max_u32 v78, v78, v26
v_cmp_eq_u32 vcc, -1, v78
s_cbranch_vccnz L_glp_16
ds_write_b128 v1, v[20:23] offset:6144
ds_write_b128 v1, v[24:27] offset:7168
s_waitcnt lgkmcnt(0)
s_branch L_gbk_10
L_step_w1:
ds_read_b64_tr_b16 v[56:57], v2 offset:0
ds_read_b64_tr_b16 v[58:59], v2 offset:64
ds_read_b64_tr_b16 v[60:61], v2 offset:512
ds_read_b64_tr_b16 v[62:63], v2 offset:576
s_waitcnt lgkmcnt(2)
v_smfmac_f32_16x16x64_bf16 v[44:47], v[56:59], a[0:7], v3
ds_read_b64_tr_b16 v[64:65], v2 offset:1024
v_smfmac_f32_16x16x64_bf16 v[48:51], v[56:59], a[144:151], v3
ds_read_b64_tr_b16 v[66:67], v2 offset:1088
buffer_load_dwordx4 v[20:23], v10, s[12:15], s21 offen offset:0 sc1
v_smfmac_f32_16x16x64_bf16 v[52:55], v[56:59], v[112:119], v3
s_waitcnt lgkmcnt(2)
v_smfmac_f32_16x16x64_bf16 v[44:47], v[60:63], a[8:15], v3
ds_read_b64_tr_b16 v[68:69], v2 offset:1536
v_smfmac_f32_16x16x64_bf16 v[48:51], v[60:63], a[152:159], v3
ds_read_b64_tr_b16 v[70:71], v2 offset:1600
buffer_load_dwordx4 v[24:27], v10, s[12:15], s21 offen offset:2048 sc1
v_smfmac_f32_16x16x64_bf16 v[52:55], v[60:63], v[120:127], v3
s_waitcnt lgkmcnt(2)
v_smfmac_f32_16x16x64_bf16 v[44:47], v[64:67], a[16:23], v3
ds_read_b64_tr_b16 v[56:57], v2 offset:2048
v_smfmac_f32_16x16x64_bf16 v[48:51], v[64:67], a[160:167], v3
ds_read_b64_tr_b16 v[58:59], v2 offset:2112
s_add_u32 s34, s21, 4096
buffer_load_dwordx4 v[28:31], v10, s[12:15], s34 offen offset:0 sc1
v_smfmac_f32_16x16x64_bf16 v[52:55], v[64:67], v[128:135], v3
s_waitcnt lgkmcnt(2)
v_smfmac_f32_16x16x64_bf16 v[44:47], v[68:71], a[24:31], v3
ds_read_b64_tr_b16 v[60:61], v2 offset:2560
v_smfmac_f32_16x16x64_bf16 v[48:51], v[68:71], a[168:175], v3
ds_read_b64_tr_b16 v[62:63], v2 offset:2624
s_add_u32 s34, s21, 4096
buffer_load_dwordx4 v[32:35], v10, s[12:15], s34 offen offset:2048 sc1
v_smfmac_f32_16x16x64_bf16 v[52:55], v[68:71], v[136:143], v3
s_add_u32 s33, s26, 8192
buffer_load_dwordx4 v[72:75], v1, s[12:15], s33 offen sc1
s_waitcnt lgkmcnt(2)
v_smfmac_f32_16x16x64_bf16 v[44:47], v[56:59], a[32:39], v3
ds_read_b64_tr_b16 v[64:65], v2 offset:3072
v_smfmac_f32_16x16x64_bf16 v[48:51], v[56:59], a[176:183], v3
ds_read_b64_tr_b16 v[66:67], v2 offset:3136
buffer_load_dwordx4 v[36:39], v11, s[12:15], s22 offen offset:0 sc1
v_smfmac_f32_16x16x64_bf16 v[52:55], v[56:59], v[144:151], v3
s_waitcnt lgkmcnt(2)
v_smfmac_f32_16x16x64_bf16 v[44:47], v[60:63], a[40:47], v3
ds_read_b64_tr_b16 v[68:69], v2 offset:3584
v_smfmac_f32_16x16x64_bf16 v[48:51], v[60:63], a[184:191], v3
ds_read_b64_tr_b16 v[70:71], v2 offset:3648
buffer_load_dwordx4 v[40:43], v11, s[12:15], s22 offen offset:256 sc1
v_smfmac_f32_16x16x64_bf16 v[52:55], v[60:63], v[152:159], v3
s_barrier
s_waitcnt lgkmcnt(2)
v_smfmac_f32_16x16x64_bf16 v[44:47], v[64:67], a[48:55], v3
ds_read_b64_tr_b16 v[56:57], v2 offset:4096
v_smfmac_f32_16x16x64_bf16 v[48:51], v[64:67], a[192:199], v3
ds_read_b64_tr_b16 v[58:59], v2 offset:4160
v_smfmac_f32_16x16x64_bf16 v[52:55], v[64:67], v[160:167], v3
s_waitcnt lgkmcnt(2)
v_smfmac_f32_16x16x64_bf16 v[44:47], v[68:71], a[56:63], v3
ds_read_b64_tr_b16 v[60:61], v2 offset:4608
v_smfmac_f32_16x16x64_bf16 v[48:51], v[68:71], a[200:207], v3
ds_read_b64_tr_b16 v[62:63], v2 offset:4672
v_smfmac_f32_16x16x64_bf16 v[52:55], v[68:71], v[168:175], v3
s_waitcnt lgkmcnt(2)
v_smfmac_f32_16x16x64_bf16 v[44:47], v[56:59], a[64:71], v3
ds_read_b64_tr_b16 v[64:65], v2 offset:5120
v_smfmac_f32_16x16x64_bf16 v[48:51], v[56:59], a[208:215], v3
ds_read_b64_tr_b16 v[66:67], v2 offset:5184
v_smfmac_f32_16x16x64_bf16 v[52:55], v[56:59], v[176:183], v3
s_waitcnt lgkmcnt(2)
v_smfmac_f32_16x16x64_bf16 v[44:47], v[60:63], a[72:79], v3
ds_read_b64_tr_b16 v[68:69], v2 offset:5632
v_smfmac_f32_16x16x64_bf16 v[48:51], v[60:63], a[216:223], v3
ds_read_b64_tr_b16 v[70:71], v2 offset:5696
v_smfmac_f32_16x16x64_bf16 v[52:55], v[60:63], v[184:191], v3
s_barrier
s_waitcnt lgkmcnt(2)
v_smfmac_f32_16x16x64_bf16 v[44:47], v[64:67], a[80:87], v3
ds_read_b64_tr_b16 v[56:57], v2 offset:6144
v_smfmac_f32_16x16x64_bf16 v[48:51], v[64:67], a[224:231], v3
ds_read_b64_tr_b16 v[58:59], v2 offset:6208
v_smfmac_f32_16x16x64_bf16 v[52:55], v[64:67], v[192:199], v3
s_waitcnt lgkmcnt(2)
v_smfmac_f32_16x16x64_bf16 v[44:47], v[68:71], a[88:95], v3
ds_read_b64_tr_b16 v[60:61], v2 offset:6656
v_smfmac_f32_16x16x64_bf16 v[48:51], v[68:71], a[232:239], v3
ds_read_b64_tr_b16 v[62:63], v2 offset:6720
v_smfmac_f32_16x16x64_bf16 v[52:55], v[68:71], v[200:207], v3
s_waitcnt lgkmcnt(2)
v_smfmac_f32_16x16x64_bf16 v[44:47], v[56:59], a[96:103], v3
ds_read_b64_tr_b16 v[64:65], v2 offset:7168
s_waitcnt vmcnt(2)
v_max_u32 v78, v72, v74
v_smfmac_f32_16x16x64_bf16 v[48:51], v[56:59], a[240:247], v3
ds_read_b64_tr_b16 v[66:67], v2 offset:7232
v_cmp_eq_u32 vcc, -1, v78
v_smfmac_f32_16x16x64_bf16 v[52:55], v[56:59], v[208:215], v3
ds_write_b128 v1, v[72:75] offset:8192
s_cbranch_vccnz L_grt_17
L_gbk_18:
s_waitcnt lgkmcnt(3)
v_smfmac_f32_16x16x64_bf16 v[44:47], v[60:63], a[104:111], v3
ds_read_b64_tr_b16 v[68:69], v2 offset:7680
v_smfmac_f32_16x16x64_bf16 v[48:51], v[60:63], a[248:255], v3
ds_read_b64_tr_b16 v[70:71], v2 offset:7744
v_smfmac_f32_16x16x64_bf16 v[52:55], v[60:63], v[216:223], v3
s_waitcnt lgkmcnt(2)
s_barrier
v_mov_b32 v77, s20
s_lshl_b32 s34, s10, 7
s_add_u32 s34, s34, 77613056
s_mov_b64 exec, 1
buffer_store_dword v77, off, s[12:15], s34 sc1
s_mov_b64 exec, -1
v_smfmac_f32_16x16x64_bf16 v[44:47], v[64:67], a[112:119], v3
ds_read_b64_tr_b16 v[56:57], v2 offset:8192
v_smfmac_f32_16x16x64_bf16 v[48:51], v[64:67], v[80:87], v3
ds_read_b64_tr_b16 v[58:59], v2 offset:8256
s_waitcnt lgkmcnt(2)
v_smfmac_f32_16x16x64_bf16 v[44:47], v[68:71], a[120:127], v3
ds_read_b64_tr_b16 v[60:61], v2 offset:8704
v_smfmac_f32_16x16x64_bf16 v[48:51], v[68:71], v[88:95], v3
ds_read_b64_tr_b16 v[62:63], v2 offset:8768
s_waitcnt lgkmcnt(2)
v_smfmac_f32_16x16x64_bf16 v[44:47], v[56:59], a[128:135], v3
v_smfmac_f32_16x16x64_bf16 v[48:51], v[56:59], v[96:103], v3
s_waitcnt lgkmcnt(0)
v_smfmac_f32_16x16x64_bf16 v[44:47], v[60:63], a[136:143], v3
v_smfmac_f32_16x16x64_bf16 v[48:51], v[60:63], v[104:111], v3
v_smfmac_f32_16x16x64_bf16 v[52:55], v[64:67], v[224:231], v3
v_cvt_pk_bf16_f32 v72, v44, v45
v_cvt_pk_bf16_f32 v73, v46, v47
ds_write_b64 v14, v[72:73]
v_smfmac_f32_16x16x64_bf16 v[52:55], v[68:71], v[232:239], v3
v_cvt_pk_bf16_f32 v74, v48, v49
v_cvt_pk_bf16_f32 v75, v50, v51
ds_write_b64 v14, v[74:75] offset:2048
v_smfmac_f32_16x16x64_bf16 v[52:55], v[56:59], v[240:247], v3
v_smfmac_f32_16x16x64_bf16 v[52:55], v[60:63], v[248:255], v3
s_waitcnt lgkmcnt(0)
s_barrier
ds_read_b64_tr_b16 v[56:57], v2 offset:9216
ds_read_b64_tr_b16 v[58:59], v2 offset:9280
ds_read_b64_tr_b16 v[60:61], v2 offset:9728
ds_read_b64_tr_b16 v[62:63], v2 offset:9792
ds_read_b64_tr_b16 v[64:65], v2 offset:10240
ds_read_b64_tr_b16 v[66:67], v2 offset:10304
ds_read_b64_tr_b16 v[68:69], v2 offset:10752
ds_read_b64_tr_b16 v[70:71], v2 offset:10816
s_cmp_eq_u32 s20, 63
s_cbranch_scc1 L_last_w1
s_waitcnt lgkmcnt(6)
v_mfma_f32_16x16x32_bf16 v[72:75], v[20:23], v[56:59], 0
s_waitcnt lgkmcnt(4)
v_mfma_f32_16x16x32_bf16 v[72:75], v[24:27], v[60:63], v[72:75]
s_waitcnt lgkmcnt(2)
v_mfma_f32_16x16x32_bf16 v[72:75], v[28:31], v[64:67], v[72:75]
s_waitcnt lgkmcnt(0)
v_mfma_f32_16x16x32_bf16 v[72:75], v[32:35], v[68:71], v[72:75]
v_cvt_pk_bf16_f32 v52, v52, v53
v_cvt_pk_bf16_f32 v53, v54, v55
buffer_store_dwordx2 v[52:53], v13, s[12:15], s24 offen sc1
s_nop 4
ds_write_b128 v1, v[72:75] offset:14336
s_add_u32 s32, s20, 1
s_and_b32 s33, s32, 1
s_bfe_u32 s34, s32, 0x10001
s_lshl_b32 s34, s34, 16
s_or_b32 s35, s33, s34
s_and_b32 s33, s32, 3
s_lshl_b32 s33, s33, 14
s_add_u32 s25, s33, s29
s_sub_u32 s26, s25, 147456
s_add_u32 s33, s20, 3
s_and_b32 s33, s33, 3
s_lshl_b32 s33, s33, 14
s_add_u32 s27, s33, s29
s_waitcnt lgkmcnt(0)
s_barrier
ds_read_b128 v[60:63], v1 offset:14336
ds_read_b128 v[64:67], v1 offset:15360
ds_read_b128 v[56:59], v1 offset:13312
v_mov_b32 v15, s35
s_waitcnt lgkmcnt(1)
v_max3_f32 v72, v60, v61, v62
v_max3_f32 v73, v63, v64, v65
v_max3_f32 v72, v72, v66, v67
s_waitcnt lgkmcnt(0)
v_max3_f32 v73, v73, v56, v57
v_max3_f32 v72, v72, v58, v59
v_max_f32 v72, v72, v73
v_mov_b32 v73, v72
s_nop 1
v_permlane32_swap_b32 v72, v73
v_max_f32 v72, v72, v73
v_mov_b32 v73, v72
s_nop 1
v_permlane16_swap_b32 v72, v73
v_max_f32 v72, v72, v73
v_mul_f32 v73, s47, v72
v_fma_f32 v60, v60, s47, -v73
v_fma_f32 v61, v61, s47, -v73
v_fma_f32 v62, v62, s47, -v73
v_fma_f32 v63, v63, s47, -v73
v_fma_f32 v64, v64, s47, -v73
v_fma_f32 v65, v65, s47, -v73
v_fma_f32 v66, v66, s47, -v73
v_fma_f32 v67, v67, s47, -v73
v_exp_f32 v60, v60
v_exp_f32 v61, v61
v_exp_f32 v62, v62
v_cvt_pk_bf16_f32 v20, v60, v61
v_exp_f32 v63, v63
v_exp_f32 v64, v64
v_cvt_pk_bf16_f32 v21, v62, v63
v_exp_f32 v65, v65
v_exp_f32 v66, v66
v_cvt_pk_bf16_f32 v22, v64, v65
v_exp_f32 v67, v67
v_fma_f32 v56, v56, s47, -v73
v_fma_f32 v57, v57, s47, -v73
v_fma_f32 v58, v58, s47, -v73
v_fma_f32 v59, v59, s47, -v73
v_cvt_pk_bf16_f32 v23, v66, v67
s_waitcnt vmcnt(2)
s_nop 0
v_mfma_f32_16x16x32_bf16 v[44:47], v[36:39], v[20:23], 0
v_mfma_f32_16x16x32_bf16 v[48:51], v[40:43], v[20:23], 0
v_exp_f32 v56, v56
v_exp_f32 v57, v57
v_exp_f32 v58, v58
v_exp_f32 v59, v59
v_add_f32 v74, v60, v61
v_add_f32 v75, v62, v63
v_cvt_pk_bf16_f32 v24, v56, v57
v_cvt_pk_bf16_f32 v25, v58, v59
v_cndmask_b32 v26, 0, v24, s[52:53]
v_cndmask_b32 v27, 0, v25, s[52:53]
v_cndmask_b32 v28, v24, 0, s[52:53]
v_cndmask_b32 v29, v25, 0, s[52:53]
v_mfma_f32_16x16x16_bf16 v[44:47], v[52:53], v[26:27], v[44:47]
v_mfma_f32_16x16x16_bf16 v[48:51], v[52:53], v[28:29], v[48:51]
ds_read_b128 v[20:23], v5 offset:26624
ds_read_b128 v[24:27], v5 offset:27648
ds_read_b128 v[28:31], v6 offset:14336
ds_read_b128 v[32:35], v6 offset:15360
v_add_f32 v74, v74, v64
v_add_f32 v75, v75, v65
v_add_f32 v74, v74, v66
v_add_f32 v75, v75, v67
v_add_f32 v73, v56, v57
v_add_f32 v72, v58, v59
v_add_f32 v74, v74, v75
v_add_f32 v73, v73, v72
v_fma_f32 v74, v73, 0.5, v74
v_mov_b32 v75, v74
s_nop 1
v_permlane32_swap_b32 v74, v75
v_add_f32 v74, v74, v75
v_mov_b32 v75, v74
s_nop 1
v_permlane16_swap_b32 v74, v75
v_add_f32 v74, v74, v75
v_rcp_f32 v74, v74
ds_read_b128 v[56:59], v4 offset:2048
ds_read_b128 v[60:63], v4 offset:3072
ds_read_b128 v[64:67], v4 offset:38912
ds_read_b128 v[68:71], v4 offset:39936
v_pk_mul_f32 v[44:45], v[44:45], v[74:75] op_sel_hi:[1,0]
v_pk_mul_f32 v[48:49], v[48:49], v[74:75] op_sel_hi:[1,0]
v_pk_mul_f32 v[46:47], v[46:47], v[74:75] op_sel_hi:[1,0]
v_pk_mul_f32 v[50:51], v[50:51], v[74:75] op_sel_hi:[1,0]
v_cvt_pk_bf16_f32 v76, v44, v45
v_cvt_pk_bf16_f32 v77, v46, v47
v_cvt_pk_bf16_f32 v78, v48, v49
v_cvt_pk_bf16_f32 v79, v50, v51
ds_write_b128 v1, v[76:79] offset:10240
v_mov_b32 v44, 0
v_mov_b32 v45, 0
v_mov_b32 v46, 0
v_mov_b32 v47, 0
v_mov_b32 v48, 0
v_mov_b32 v49, 0
v_mov_b32 v50, 0
v_mov_b32 v51, 0
s_waitcnt lgkmcnt(0)
s_barrier
ds_read_b128 v[36:39], v1 offset:9216
ds_read_b128 v[40:43], v1 offset:10240
ds_read_b128 v[52:55], v1 offset:11264
ds_read_b128 v[76:79], v1 offset:12288
s_waitcnt lgkmcnt(3)
v_smfmac_f32_16x16x64_bf16 v[44:47], v[36:39], v[56:63], v3
ds_read_b128 v[56:59], v4 offset:10240
ds_read_b128 v[60:63], v4 offset:11264
s_waitcnt lgkmcnt(4)
v_smfmac_f32_16x16x64_bf16 v[44:47], v[40:43], v[64:71], v3
ds_read_b128 v[64:67], v4 offset:47104
ds_read_b128 v[68:71], v4 offset:48128
s_waitcnt lgkmcnt(5)
v_smfmac_f32_16x16x64_bf16 v[44:47], v[52:55], v[20:27], v3
ds_read_b128 v[20:23], v5 offset:34816
ds_read_b128 v[24:27], v5 offset:35840
s_waitcnt lgkmcnt(6)
v_smfmac_f32_16x16x64_bf16 v[44:47], v[76:79], v[28:35], v3
ds_read_b128 v[28:31], v6 offset:22528
ds_read_b128 v[32:35], v6 offset:23552
s_waitcnt lgkmcnt(6)
v_smfmac_f32_16x16x64_bf16 v[48:51], v[36:39], v[56:63], v3
ds_read_b128 v[56:59], v4 offset:18432
ds_read_b128 v[60:63], v4 offset:19456
s_nop 1
v_cvt_pk_bf16_f32 v72, v44, v45
v_cvt_pk_bf16_f32 v73, v46, v47
s_waitcnt lgkmcnt(6)
v_smfmac_f32_16x16x64_bf16 v[48:51], v[40:43], v[64:71], v3
ds_read_b128 v[64:67], v5 offset:6144
ds_read_b128 v[68:71], v5 offset:7168
v_and_or_b32 v72, v72, s46, v15
s_add_u32 s36, s28, 16384
buffer_store_dwordx2 v[72:73], v7, s[12:15], s36 offen
s_waitcnt lgkmcnt(6)
v_smfmac_f32_16x16x64_bf16 v[48:51], v[52:55], v[20:27], v3
ds_read_b128 v[20:23], v5 offset:43008
ds_read_b128 v[24:27], v5 offset:44032
v_mov_b32 v44, 0
v_mov_b32 v45, 0
s_waitcnt lgkmcnt(6)
v_smfmac_f32_16x16x64_bf16 v[48:51], v[76:79], v[28:35], v3
ds_read_b128 v[28:31], v6 offset:30720
ds_read_b128 v[32:35], v6 offset:31744
v_mov_b32 v46, 0
v_mov_b32 v47, 0
s_waitcnt lgkmcnt(6)
s_nop 0
v_smfmac_f32_16x16x64_bf16 v[44:47], v[36:39], v[56:63], v3
ds_read_b128 v[56:59], v4 offset:26624
ds_read_b128 v[60:63], v4 offset:27648
v_cvt_pk_bf16_f32 v74, v48, v49
v_cvt_pk_bf16_f32 v75, v50, v51
s_waitcnt lgkmcnt(6)
v_smfmac_f32_16x16x64_bf16 v[44:47], v[40:43], v[64:71], v3
ds_read_b128 v[64:67], v5 offset:14336
ds_read_b128 v[68:71], v5 offset:15360
v_and_or_b32 v74, v74, s46, v15
s_add_u32 s36, s28, 81920
buffer_store_dwordx2 v[74:75], v7, s[12:15], s36 offen
s_waitcnt lgkmcnt(6)
v_smfmac_f32_16x16x64_bf16 v[44:47], v[52:55], v[20:27], v3
ds_read_b128 v[20:23], v6 offset:2048
ds_read_b128 v[24:27], v6 offset:3072
v_mov_b32 v48, 0
v_mov_b32 v49, 0
s_waitcnt lgkmcnt(6)
v_smfmac_f32_16x16x64_bf16 v[44:47], v[76:79], v[28:35], v3
ds_read_b128 v[28:31], v6 offset:38912
ds_read_b128 v[32:35], v6 offset:39936
v_mov_b32 v50, 0
v_mov_b32 v51, 0
s_waitcnt lgkmcnt(6)
s_nop 0
v_smfmac_f32_16x16x64_bf16 v[48:51], v[36:39], v[56:63], v3
ds_read_b128 v[56:59], v4 offset:34816
ds_read_b128 v[60:63], v4 offset:35840
v_cvt_pk_bf16_f32 v72, v44, v45
v_cvt_pk_bf16_f32 v73, v46, v47
s_waitcnt lgkmcnt(6)
v_smfmac_f32_16x16x64_bf16 v[48:51], v[40:43], v[64:71], v3
ds_read_b128 v[64:67], v5 offset:22528
ds_read_b128 v[68:71], v5 offset:23552
v_and_or_b32 v72, v72, s46, v15
s_add_u32 s36, s28, 147456
buffer_store_dwordx2 v[72:73], v7, s[12:15], s36 offen
s_waitcnt lgkmcnt(6)
v_smfmac_f32_16x16x64_bf16 v[48:51], v[52:55], v[20:27], v3
ds_read_b128 v[20:23], v6 offset:10240
ds_read_b128 v[24:27], v6 offset:11264
v_mov_b32 v44, 0
v_mov_b32 v45, 0
s_waitcnt lgkmcnt(6)
v_smfmac_f32_16x16x64_bf16 v[48:51], v[76:79], v[28:35], v3
ds_read_b128 v[28:31], v6 offset:47104
ds_read_b128 v[32:35], v6 offset:48128
v_mov_b32 v46, 0
v_mov_b32 v47, 0
s_waitcnt lgkmcnt(6)
s_nop 0
v_smfmac_f32_16x16x64_bf16 v[44:47], v[36:39], v[56:63], v3
s_nop 0
v_cvt_pk_bf16_f32 v74, v48, v49
v_cvt_pk_bf16_f32 v75, v50, v51
s_waitcnt lgkmcnt(4)
v_smfmac_f32_16x16x64_bf16 v[44:47], v[40:43], v[64:71], v3
v_and_or_b32 v74, v74, s46, v15
s_add_u32 s36, s28, 212992
buffer_store_dwordx2 v[74:75], v7, s[12:15], s36 offen
s_waitcnt lgkmcnt(2)
v_smfmac_f32_16x16x64_bf16 v[44:47], v[52:55], v[20:27], v3
s_waitcnt lgkmcnt(0)
v_smfmac_f32_16x16x64_bf16 v[44:47], v[76:79], v[28:35], v3
s_nop 7
v_cvt_pk_bf16_f32 v72, v44, v45
v_cvt_pk_bf16_f32 v73, v46, v47
v_and_or_b32 v72, v72, s46, v15
s_add_u32 s36, s28, 278528
buffer_store_dwordx2 v[72:73], v7, s[12:15], s36 offen
s_cmp_eq_u32 s31, 1
s_cbranch_scc0 L_nt_19
s_nop 15
s_nop 13
buffer_load_dwordx4 v[20:23], v8, s[12:15], s28 offen offset:0 sc1
buffer_load_dwordx4 v[24:27], v8, s[12:15], s28 offen offset:1024 sc1
buffer_load_dwordx4 v[28:31], v8, s[12:15], s28 offen offset:2048 sc1
buffer_load_dwordx4 v[32:35], v8, s[12:15], s28 offen offset:3072 sc1
s_nop 15
s_nop 15
s_nop 7
buffer_load_dwordx4 v[56:59], v8, s[12:15], s28 offen offset:0 sc1
buffer_load_dwordx4 v[60:63], v8, s[12:15], s28 offen offset:1024 sc1
buffer_load_dwordx4 v[64:67], v8, s[12:15], s28 offen offset:2048 sc1
buffer_load_dwordx4 v[68:71], v8, s[12:15], s28 offen offset:3072 sc1
s_waitcnt vmcnt(4)
v_xor_b32 v78, v20, v15
v_bitop3_b32 v78, v78, v24, v15 bitop3:0xf6
v_bitop3_b32 v78, v78, v28, v15 bitop3:0xf6
v_bitop3_b32 v78, v78, v32, v15 bitop3:0xf6
v_and_b32 v78, 0x10001, v78
v_cmp_ne_u32 vcc, 0, v78
s_cbranch_vccz L_rk_22
buffer_load_dwordx4 v[20:23], v8, s[12:15], s28 offen offset:0 sc1
buffer_load_dwordx4 v[24:27], v8, s[12:15], s28 offen offset:1024 sc1
buffer_load_dwordx4 v[28:31], v8, s[12:15], s28 offen offset:2048 sc1
buffer_load_dwordx4 v[32:35], v8, s[12:15], s28 offen offset:3072 sc1
L_rp_20:
s_waitcnt vmcnt(4)
v_xor_b32 v78, v56, v15
v_bitop3_b32 v78, v78, v60, v15 bitop3:0xf6
v_bitop3_b32 v78, v78, v64, v15 bitop3:0xf6
v_bitop3_b32 v78, v78, v68, v15 bitop3:0xf6
v_and_b32 v78, 0x10001, v78
v_cmp_ne_u32 vcc, 0, v78
s_cbranch_vccz L_rk_23
buffer_load_dwordx4 v[56:59], v8, s[12:15], s28 offen offset:0 sc1
buffer_load_dwordx4 v[60:63], v8, s[12:15], s28 offen offset:1024 sc1
buffer_load_dwordx4 v[64:67], v8, s[12:15], s28 offen offset:2048 sc1
buffer_load_dwordx4 v[68:71], v8, s[12:15], s28 offen offset:3072 sc1
s_waitcnt vmcnt(4)
v_xor_b32 v78, v20, v15
v_bitop3_b32 v78, v78, v24, v15 bitop3:0xf6
v_bitop3_b32 v78, v78, v28, v15 bitop3:0xf6
v_bitop3_b32 v78, v78, v32, v15 bitop3:0xf6
v_and_b32 v78, 0x10001, v78
v_cmp_ne_u32 vcc, 0, v78
s_cbranch_vccz L_rk_22
buffer_load_dwordx4 v[20:23], v8, s[12:15], s28 offen offset:0 sc1
buffer_load_dwordx4 v[24:27], v8, s[12:15], s28 offen offset:1024 sc1
buffer_load_dwordx4 v[28:31], v8, s[12:15], s28 offen offset:2048 sc1
buffer_load_dwordx4 v[32:35], v8, s[12:15], s28 offen offset:3072 sc1
s_add_u32 s44, s44, 1
s_cmp_gt_u32 s44, 1000000
s_cbranch_scc1 L_abort
s_branch L_rp_20
L_rk_22:
v_mfma_f32_16x16x32_bf16 v[52:55], v[16:19], v[20:23], 0
v_mfma_f32_16x16x32_bf16 v[52:55], v[16:19], v[24:27], v[52:55]
v_mfma_f32_16x16x32_bf16 v[52:55], v[16:19], v[28:31], v[52:55]
v_mfma_f32_16x16x32_bf16 v[52:55], v[16:19], v[32:35], v[52:55]
s_branch L_rd_21
L_rk_23:
v_mfma_f32_16x16x32_bf16 v[52:55], v[16:19], v[56:59], 0
v_mfma_f32_16x16x32_bf16 v[52:55], v[16:19], v[60:63], v[52:55]
v_mfma_f32_16x16x32_bf16 v[52:55], v[16:19], v[64:67], v[52:55]
v_mfma_f32_16x16x32_bf16 v[52:55], v[16:19], v[68:71], v[52:55]
L_rd_21:
s_nop 7
v_add_f32_dpp v52, v52, v52 row_ror:8 row_mask:0xf bank_mask:0xf
v_add_f32_dpp v53, v53, v53 row_ror:8 row_mask:0xf bank_mask:0xf
v_add_f32_dpp v54, v54, v54 row_ror:8 row_mask:0xf bank_mask:0xf
v_add_f32_dpp v55, v55, v55 row_ror:8 row_mask:0xf bank_mask:0xf
v_cvt_pk_bf16_f32 v76, v52, v53
v_cvt_pk_bf16_f32 v77, v54, v55
s_mov_b64 exec, s[50:51]
v_min_u32 v76, -2, v76
buffer_store_dwordx2 v[76:77], v9, s[12:15], s25 offen
v_mov_b32 v78, -1
v_mov_b32 v79, -1
buffer_store_dwordx2 v[78:79], v9, s[12:15], s27 offen
s_mov_b64 exec, -1
s_waitcnt vmcnt(2)
L_nt_19:
L_pre_w1:
v_mov_b32 v44, 0
v_mov_b32 v48, 0
v_mov_b32 v52, 0
v_mov_b32 v45, 0
v_mov_b32 v49, 0
v_mov_b32 v53, 0
v_mov_b32 v46, 0
v_mov_b32 v50, 0
v_mov_b32 v54, 0
v_mov_b32 v47, 0
v_mov_b32 v51, 0
v_mov_b32 v55, 0
s_add_u32 s20, s20, 1
s_add_u32 s21, s21, 262144
s_add_u32 s22, s22, 262144
s_add_u32 s23, s23, 65536
s_add_u32 s24, s24, 65536
s_add_u32 s33, s20, 2
s_min_u32 s33, s33, 63
s_lshl_b32 s33, s33, 18
s_lshl_b32 s34, s10, 13
s_add_u32 s33, s33, s34
s_add_u32 s54, s33, 16187392
s_add_u32 s55, s33, 32964608
s_barrier
s_branch L_step_w1
L_last_w1:
v_cvt_pk_bf16_f32 v52, v52, v53
v_cvt_pk_bf16_f32 v53, v54, v55
buffer_store_dwordx2 v[52:53], v13, s[12:15], s24 offen sc1
s_waitcnt vmcnt(0)
s_barrier
v_mov_b32 v77, 64
s_lshl_b32 s34, s10, 7
s_add_u32 s34, s34, 77613056
s_mov_b64 exec, 1
buffer_store_dword v77, off, s[12:15], s34 sc1
s_mov_b64 exec, -1
s_branch L_finish
L_grt_17:
L_glp_25:
s_add_u32 s45, s45, 1
s_cmp_gt_u32 s45, 1000000
s_cbranch_scc1 L_abort
s_waitcnt lgkmcnt(0)
s_add_u32 s33, s26, 8192
buffer_load_dwordx4 v[72:75], v1, s[12:15], s33 offen sc1
s_waitcnt vmcnt(0)
v_max_u32 v78, v72, v74
v_cmp_eq_u32 vcc, -1, v78
s_cbranch_vccnz L_glp_25
ds_write_b128 v1, v[72:75] offset:8192
s_waitcnt lgkmcnt(0)
s_branch L_gbk_18
L_step_w2e:
ds_read_b64_tr_b16 v[56:57], v2 offset:0
ds_read_b64_tr_b16 v[58:59], v2 offset:64
ds_read_b64_tr_b16 v[60:61], v2 offset:512
ds_read_b64_tr_b16 v[62:63], v2 offset:576
s_waitcnt lgkmcnt(2)
v_smfmac_f32_16x16x64_bf16 v[44:47], v[56:59], a[0:7], v3
ds_read_b64_tr_b16 v[64:65], v2 offset:1024
v_smfmac_f32_16x16x64_bf16 v[48:51], v[56:59], a[144:151], v3
ds_read_b64_tr_b16 v[66:67], v2 offset:1088
buffer_load_dwordx4 v[20:23], v10, s[12:15], s21 offen offset:0 sc1
v_smfmac_f32_16x16x64_bf16 v[52:55], v[56:59], v[112:119], v3
s_waitcnt lgkmcnt(2)
v_smfmac_f32_16x16x64_bf16 v[44:47], v[60:63], a[8:15], v3
ds_read_b64_tr_b16 v[68:69], v2 offset:1536
v_smfmac_f32_16x16x64_bf16 v[48:51], v[60:63], a[152:159], v3
ds_read_b64_tr_b16 v[70:71], v2 offset:1600
buffer_load_dwordx4 v[24:27], v10, s[12:15], s21 offen offset:2048 sc1
v_smfmac_f32_16x16x64_bf16 v[52:55], v[60:63], v[120:127], v3
s_waitcnt lgkmcnt(2)
v_smfmac_f32_16x16x64_bf16 v[44:47], v[64:67], a[16:23], v3
ds_read_b64_tr_b16 v[56:57], v2 offset:2048
v_smfmac_f32_16x16x64_bf16 v[48:51], v[64:67], a[160:167], v3
ds_read_b64_tr_b16 v[58:59], v2 offset:2112
s_add_u32 s34, s21, 4096
buffer_load_dwordx4 v[28:31], v10, s[12:15], s34 offen offset:0 sc1
v_smfmac_f32_16x16x64_bf16 v[52:55], v[64:67], v[128:135], v3
s_waitcnt lgkmcnt(2)
v_smfmac_f32_16x16x64_bf16 v[44:47], v[68:71], a[24:31], v3
ds_read_b64_tr_b16 v[60:61], v2 offset:2560
v_smfmac_f32_16x16x64_bf16 v[48:51], v[68:71], a[168:175], v3
ds_read_b64_tr_b16 v[62:63], v2 offset:2624
s_add_u32 s34, s21, 4096
buffer_load_dwordx4 v[32:35], v10, s[12:15], s34 offen offset:2048 sc1
v_smfmac_f32_16x16x64_bf16 v[52:55], v[68:71], v[136:143], v3
s_waitcnt lgkmcnt(2)
v_smfmac_f32_16x16x64_bf16 v[44:47], v[56:59], a[32:39], v3
ds_read_b64_tr_b16 v[64:65], v2 offset:3072
v_smfmac_f32_16x16x64_bf16 v[48:51], v[56:59], a[176:183], v3
ds_read_b64_tr_b16 v[66:67], v2 offset:3136
buffer_load_dwordx4 v[36:39], v11, s[12:15], s22 offen offset:0 sc1
v_smfmac_f32_16x16x64_bf16 v[52:55], v[56:59], v[144:151], v3
s_waitcnt lgkmcnt(2)
v_smfmac_f32_16x16x64_bf16 v[44:47], v[60:63], a[40:47], v3
ds_read_b64_tr_b16 v[68:69], v2 offset:3584
v_smfmac_f32_16x16x64_bf16 v[48:51], v[60:63], a[184:191], v3
ds_read_b64_tr_b16 v[70:71], v2 offset:3648
buffer_load_dwordx4 v[40:43], v11, s[12:15], s22 offen offset:256 sc1
v_smfmac_f32_16x16x64_bf16 v[52:55], v[60:63], v[152:159], v3
s_barrier
s_waitcnt lgkmcnt(2)
v_smfmac_f32_16x16x64_bf16 v[44:47], v[64:67], a[48:55], v3
ds_read_b64_tr_b16 v[56:57], v2 offset:4096
v_smfmac_f32_16x16x64_bf16 v[48:51], v[64:67], a[192:199], v3
ds_read_b64_tr_b16 v[58:59], v2 offset:4160
v_smfmac_f32_16x16x64_bf16 v[52:55], v[64:67], v[160:167], v3
s_waitcnt lgkmcnt(2)
v_smfmac_f32_16x16x64_bf16 v[44:47], v[68:71], a[56:63], v3
ds_read_b64_tr_b16 v[60:61], v2 offset:4608
v_smfmac_f32_16x16x64_bf16 v[48:51], v[68:71], a[200:207], v3
ds_read_b64_tr_b16 v[62:63], v2 offset:4672
v_smfmac_f32_16x16x64_bf16 v[52:55], v[68:71], v[168:175], v3
s_waitcnt lgkmcnt(2)
v_smfmac_f32_16x16x64_bf16 v[44:47], v[56:59], a[64:71], v3
ds_read_b64_tr_b16 v[64:65], v2 offset:5120
v_smfmac_f32_16x16x64_bf16 v[48:51], v[56:59], a[208:215], v3
ds_read_b64_tr_b16 v[66:67], v2 offset:5184
v_smfmac_f32_16x16x64_bf16 v[52:55], v[56:59], v[176:183], v3
s_waitcnt lgkmcnt(2)
v_smfmac_f32_16x16x64_bf16 v[44:47], v[60:63], a[72:79], v3
ds_read_b64_tr_b16 v[68:69], v2 offset:5632
v_smfmac_f32_16x16x64_bf16 v[48:51], v[60:63], a[216:223], v3
ds_read_b64_tr_b16 v[70:71], v2 offset:5696
v_smfmac_f32_16x16x64_bf16 v[52:55], v[60:63], v[184:191], v3
s_barrier
s_waitcnt lgkmcnt(2)
v_smfmac_f32_16x16x64_bf16 v[44:47], v[64:67], a[80:87], v3
ds_read_b64_tr_b16 v[56:57], v2 offset:6144
v_smfmac_f32_16x16x64_bf16 v[48:51], v[64:67], a[224:231], v3
ds_read_b64_tr_b16 v[58:59], v2 offset:6208
v_smfmac_f32_16x16x64_bf16 v[52:55], v[64:67], v[192:199], v3
s_waitcnt lgkmcnt(2)
v_smfmac_f32_16x16x64_bf16 v[44:47], v[68:71], a[88:95], v3
ds_read_b64_tr_b16 v[60:61], v2 offset:6656
v_smfmac_f32_16x16x64_bf16 v[48:51], v[68:71], a[232:239], v3
ds_read_b64_tr_b16 v[62:63], v2 offset:6720
v_smfmac_f32_16x16x64_bf16 v[52:55], v[68:71], v[200:207], v3
s_waitcnt lgkmcnt(2)
v_smfmac_f32_16x16x64_bf16 v[44:47], v[56:59], a[96:103], v3
ds_read_b64_tr_b16 v[64:65], v2 offset:7168
v_smfmac_f32_16x16x64_bf16 v[48:51], v[56:59], a[240:247], v3
ds_read_b64_tr_b16 v[66:67], v2 offset:7232
v_smfmac_f32_16x16x64_bf16 v[52:55], v[56:59], v[208:215], v3
s_waitcnt lgkmcnt(2)
v_smfmac_f32_16x16x64_bf16 v[44:47], v[60:63], a[104:111], v3
ds_read_b64_tr_b16 v[68:69], v2 offset:7680
v_smfmac_f32_16x16x64_bf16 v[48:51], v[60:63], a[248:255], v3
ds_read_b64_tr_b16 v[70:71], v2 offset:7744
v_smfmac_f32_16x16x64_bf16 v[52:55], v[60:63], v[216:223], v3
s_barrier
s_waitcnt lgkmcnt(2)
v_smfmac_f32_16x16x64_bf16 v[44:47], v[64:67], a[112:119], v3
ds_read_b64_tr_b16 v[56:57], v2 offset:8192
v_smfmac_f32_16x16x64_bf16 v[48:51], v[64:67], v[80:87], v3
ds_read_b64_tr_b16 v[58:59], v2 offset:8256
s_waitcnt lgkmcnt(2)
v_smfmac_f32_16x16x64_bf16 v[44:47], v[68:71], a[120:127], v3
ds_read_b64_tr_b16 v[60:61], v2 offset:8704
v_smfmac_f32_16x16x64_bf16 v[48:51], v[68:71], v[88:95], v3
ds_read_b64_tr_b16 v[62:63], v2 offset:8768
s_waitcnt lgkmcnt(2)
v_smfmac_f32_16x16x64_bf16 v[44:47], v[56:59], a[128:135], v3
v_smfmac_f32_16x16x64_bf16 v[48:51], v[56:59], v[96:103], v3
s_waitcnt lgkmcnt(0)
v_smfmac_f32_16x16x64_bf16 v[44:47], v[60:63], a[136:143], v3
v_smfmac_f32_16x16x64_bf16 v[48:51], v[60:63], v[104:111], v3
v_smfmac_f32_16x16x64_bf16 v[52:55], v[64:67], v[224:231], v3
v_cvt_pk_bf16_f32 v72, v44, v45
v_cvt_pk_bf16_f32 v73, v46, v47
ds_write_b64 v14, v[72:73]
v_smfmac_f32_16x16x64_bf16 v[52:55], v[68:71], v[232:239], v3
v_cvt_pk_bf16_f32 v74, v48, v49
v_cvt_pk_bf16_f32 v75, v50, v51
ds_write_b64 v14, v[74:75] offset:2048
v_smfmac_f32_16x16x64_bf16 v[52:55], v[56:59], v[240:247], v3
v_smfmac_f32_16x16x64_bf16 v[52:55], v[60:63], v[248:255], v3
s_waitcnt lgkmcnt(0)
s_barrier
ds_read_b64_tr_b16 v[56:57], v2 offset:9216
ds_read_b64_tr_b16 v[58:59], v2 offset:9280
ds_read_b64_tr_b16 v[60:61], v2 offset:9728
ds_read_b64_tr_b16 v[62:63], v2 offset:9792
ds_read_b64_tr_b16 v[64:65], v2 offset:10240
ds_read_b64_tr_b16 v[66:67], v2 offset:10304
ds_read_b64_tr_b16 v[68:69], v2 offset:10752
ds_read_b64_tr_b16 v[70:71], v2 offset:10816
s_cmp_eq_u32 s20, 63
s_cbranch_scc1 L_last_w2e
s_waitcnt vmcnt(2)
s_waitcnt lgkmcnt(6)
v_mfma_f32_16x16x32_bf16 v[72:75], v[20:23], v[56:59], 0
s_waitcnt lgkmcnt(4)
v_mfma_f32_16x16x32_bf16 v[72:75], v[24:27], v[60:63], v[72:75]
s_waitcnt lgkmcnt(2)
v_mfma_f32_16x16x32_bf16 v[72:75], v[28:31], v[64:67], v[72:75]
s_waitcnt lgkmcnt(0)
v_mfma_f32_16x16x32_bf16 v[72:75], v[32:35], v[68:71], v[72:75]
v_cvt_pk_bf16_f32 v52, v52, v53
v_cvt_pk_bf16_f32 v53, v54, v55
buffer_store_dwordx2 v[52:53], v13, s[12:15], s24 offen sc1
s_nop 4
ds_write_b128 v1, v[72:75] offset:15360
s_add_u32 s32, s20, 1
s_and_b32 s33, s32, 1
s_bfe_u32 s34, s32, 0x10001
s_lshl_b32 s34, s34, 16
s_or_b32 s35, s33, s34
s_and_b32 s33, s32, 3
s_lshl_b32 s33, s33, 14
s_add_u32 s25, s33, s29
s_sub_u32 s26, s25, 147456
s_add_u32 s33, s20, 3
s_and_b32 s33, s33, 3
s_lshl_b32 s33, s33, 14
s_add_u32 s27, s33, s29
s_waitcnt lgkmcnt(0)
s_barrier
ds_read_b128 v[60:63], v1 offset:14336
ds_read_b128 v[64:67], v1 offset:15360
ds_read_b128 v[56:59], v1 offset:13312
v_mov_b32 v15, s35
s_waitcnt lgkmcnt(1)
v_max3_f32 v72, v60, v61, v62
v_max3_f32 v73, v63, v64, v65
v_max3_f32 v72, v72, v66, v67
s_waitcnt lgkmcnt(0)
v_max3_f32 v73, v73, v56, v57
v_max3_f32 v72, v72, v58, v59
v_max_f32 v72, v72, v73
v_mov_b32 v73, v72
s_nop 1
v_permlane32_swap_b32 v72, v73
v_max_f32 v72, v72, v73
v_mov_b32 v73, v72
s_nop 1
v_permlane16_swap_b32 v72, v73
v_max_f32 v72, v72, v73
v_mul_f32 v73, s47, v72
v_fma_f32 v60, v60, s47, -v73
v_fma_f32 v61, v61, s47, -v73
v_fma_f32 v62, v62, s47, -v73
v_fma_f32 v63, v63, s47, -v73
v_fma_f32 v64, v64, s47, -v73
v_fma_f32 v65, v65, s47, -v73
v_fma_f32 v66, v66, s47, -v73
v_fma_f32 v67, v67, s47, -v73
v_exp_f32 v60, v60
v_exp_f32 v61, v61
v_exp_f32 v62, v62
v_cvt_pk_bf16_f32 v20, v60, v61
v_exp_f32 v63, v63
v_exp_f32 v64, v64
v_cvt_pk_bf16_f32 v21, v62, v63
v_exp_f32 v65, v65
v_exp_f32 v66, v66
v_cvt_pk_bf16_f32 v22, v64, v65
v_exp_f32 v67, v67
v_fma_f32 v56, v56, s47, -v73
v_fma_f32 v57, v57, s47, -v73
v_fma_f32 v58, v58, s47, -v73
v_fma_f32 v59, v59, s47, -v73
v_cvt_pk_bf16_f32 v23, v66, v67
s_waitcnt vmcnt(1)
s_nop 0
v_mfma_f32_16x16x32_bf16 v[44:47], v[36:39], v[20:23], 0
v_mfma_f32_16x16x32_bf16 v[48:51], v[40:43], v[20:23], 0
v_exp_f32 v56, v56
v_exp_f32 v57, v57
v_exp_f32 v58, v58
v_exp_f32 v59, v59
v_add_f32 v74, v60, v61
v_add_f32 v75, v62, v63
v_cvt_pk_bf16_f32 v24, v56, v57
v_cvt_pk_bf16_f32 v25, v58, v59
v_cndmask_b32 v26, 0, v24, s[52:53]
v_cndmask_b32 v27, 0, v25, s[52:53]
v_cndmask_b32 v28, v24, 0, s[52:53]
v_cndmask_b32 v29, v25, 0, s[52:53]
v_mfma_f32_16x16x16_bf16 v[44:47], v[52:53], v[26:27], v[44:47]
v_mfma_f32_16x16x16_bf16 v[48:51], v[52:53], v[28:29], v[48:51]
ds_read_b128 v[20:23], v5 offset:28672
ds_read_b128 v[24:27], v5 offset:29696
ds_read_b128 v[28:31], v6 offset:16384
ds_read_b128 v[32:35], v6 offset:17408
v_add_f32 v74, v74, v64
v_add_f32 v75, v75, v65
v_add_f32 v74, v74, v66
v_add_f32 v75, v75, v67
v_add_f32 v73, v56, v57
v_add_f32 v72, v58, v59
v_add_f32 v74, v74, v75
v_add_f32 v73, v73, v72
v_fma_f32 v74, v73, 0.5, v74
v_mov_b32 v75, v74
s_nop 1
v_permlane32_swap_b32 v74, v75
v_add_f32 v74, v74, v75
v_mov_b32 v75, v74
s_nop 1
v_permlane16_swap_b32 v74, v75
v_add_f32 v74, v74, v75
v_rcp_f32 v74, v74
ds_read_b128 v[56:59], v4 offset:4096
ds_read_b128 v[60:63], v4 offset:5120
ds_read_b128 v[64:67], v4 offset:40960
ds_read_b128 v[68:71], v4 offset:41984
v_pk_mul_f32 v[44:45], v[44:45], v[74:75] op_sel_hi:[1,0]
v_pk_mul_f32 v[48:49], v[48:49], v[74:75] op_sel_hi:[1,0]
v_pk_mul_f32 v[46:47], v[46:47], v[74:75] op_sel_hi:[1,0]
v_pk_mul_f32 v[50:51], v[50:51], v[74:75] op_sel_hi:[1,0]
v_cvt_pk_bf16_f32 v76, v44, v45
v_cvt_pk_bf16_f32 v77, v46, v47
v_cvt_pk_bf16_f32 v78, v48, v49
v_cvt_pk_bf16_f32 v79, v50, v51
ds_write_b128 v1, v[76:79] offset:11264
v_mov_b32 v44, 0
v_mov_b32 v45, 0
v_mov_b32 v46, 0
v_mov_b32 v47, 0
v_mov_b32 v48, 0
v_mov_b32 v49, 0
v_mov_b32 v50, 0
v_mov_b32 v51, 0
s_waitcnt lgkmcnt(0)
s_barrier
ds_read_b128 v[36:39], v1 offset:9216
ds_read_b128 v[40:43], v1 offset:10240
ds_read_b128 v[52:55], v1 offset:11264
ds_read_b128 v[76:79], v1 offset:12288
s_waitcnt lgkmcnt(3)
v_smfmac_f32_16x16x64_bf16 v[44:47], v[36:39], v[56:63], v3
ds_read_b128 v[56:59], v4 offset:12288
ds_read_b128 v[60:63], v4 offset:13312
s_waitcnt lgkmcnt(4)
v_smfmac_f32_16x16x64_bf16 v[44:47], v[40:43], v[64:71], v3
ds_read_b128 v[64:67], v5 offset:0
ds_read_b128 v[68:71], v5 offset:1024
s_waitcnt lgkmcnt(5)
v_smfmac_f32_16x16x64_bf16 v[44:47], v[52:55], v[20:27], v3
ds_read_b128 v[20:23], v5 offset:36864
ds_read_b128 v[24:27], v5 offset:37888
s_waitcnt lgkmcnt(6)
v_smfmac_f32_16x16x64_bf16 v[44:47], v[76:79], v[28:35], v3
ds_read_b128 v[28:31], v6 offset:24576
ds_read_b128 v[32:35], v6 offset:25600
s_waitcnt lgkmcnt(6)
v_smfmac_f32_16x16x64_bf16 v[48:51], v[36:39], v[56:63], v3
ds_read_b128 v[56:59], v4 offset:20480
ds_read_b128 v[60:63], v4 offset:21504
s_nop 1
v_cvt_pk_bf16_f32 v72, v44, v45
v_cvt_pk_bf16_f32 v73, v46, v47
s_waitcnt lgkmcnt(6)
v_smfmac_f32_16x16x64_bf16 v[48:51], v[40:43], v[64:71], v3
ds_read_b128 v[64:67], v5 offset:8192
ds_read_b128 v[68:71], v5 offset:9216
v_and_or_b32 v72, v72, s46, v15
s_add_u32 s36, s28, 32768
buffer_store_dwordx2 v[72:73], v7, s[12:15], s36 offen
s_waitcnt lgkmcnt(6)
v_smfmac_f32_16x16x64_bf16 v[48:51], v[52:55], v[20:27], v3
ds_read_b128 v[20:23], v5 offset:45056
ds_read_b128 v[24:27], v5 offset:46080
v_mov_b32 v44, 0
v_mov_b32 v45, 0
s_waitcnt lgkmcnt(6)
v_smfmac_f32_16x16x64_bf16 v[48:51], v[76:79], v[28:35], v3
ds_read_b128 v[28:31], v6 offset:32768
ds_read_b128 v[32:35], v6 offset:33792
v_mov_b32 v46, 0
v_mov_b32 v47, 0
s_waitcnt lgkmcnt(6)
s_nop 0
v_smfmac_f32_16x16x64_bf16 v[44:47], v[36:39], v[56:63], v3
s_nop 0
v_cvt_pk_bf16_f32 v74, v48, v49
v_cvt_pk_bf16_f32 v75, v50, v51
s_waitcnt lgkmcnt(4)
v_smfmac_f32_16x16x64_bf16 v[44:47], v[40:43], v[64:71], v3
v_and_or_b32 v74, v74, s46, v15
s_add_u32 s36, s28, 98304
buffer_store_dwordx2 v[74:75], v7, s[12:15], s36 offen
s_waitcnt lgkmcnt(2)
v_smfmac_f32_16x16x64_bf16 v[44:47], v[52:55], v[20:27], v3
s_waitcnt lgkmcnt(0)
v_smfmac_f32_16x16x64_bf16 v[44:47], v[76:79], v[28:35], v3
s_nop 7
v_cvt_pk_bf16_f32 v72, v44, v45
v_cvt_pk_bf16_f32 v73, v46, v47
v_and_or_b32 v72, v72, s46, v15
s_add_u32 s36, s28, 163840
buffer_store_dwordx2 v[72:73], v7, s[12:15], s36 offen
buffer_load_dwordx4 v[20:23], v8, s[12:15], s28 offen offset:0 sc1
buffer_load_dwordx4 v[24:27], v8, s[12:15], s28 offen offset:1024 sc1
buffer_load_dwordx4 v[28:31], v8, s[12:15], s28 offen offset:2048 sc1
buffer_load_dwordx4 v[32:35], v8, s[12:15], s28 offen offset:3072 sc1
s_nop 15
s_nop 15
s_nop 7
buffer_load_dwordx4 v[56:59], v8, s[12:15], s28 offen offset:0 sc1
buffer_load_dwordx4 v[60:63], v8, s[12:15], s28 offen offset:1024 sc1
buffer_load_dwordx4 v[64:67], v8, s[12:15], s28 offen offset:2048 sc1
buffer_load_dwordx4 v[68:71], v8, s[12:15], s28 offen offset:3072 sc1
s_waitcnt vmcnt(4)
v_xor_b32 v78, v20, v15
v_bitop3_b32 v78, v78, v24, v15 bitop3:0xf6
v_bitop3_b32 v78, v78, v28, v15 bitop3:0xf6
v_bitop3_b32 v78, v78, v32, v15 bitop3:0xf6
v_and_b32 v78, 0x10001, v78
v_cmp_ne_u32 vcc, 0, v78
s_cbranch_vccz L_rk_29
buffer_load_dwordx4 v[20:23], v8, s[12:15], s28 offen offset:0 sc1
buffer_load_dwordx4 v[24:27], v8, s[12:15], s28 offen offset:1024 sc1
buffer_load_dwordx4 v[28:31], v8, s[12:15], s28 offen offset:2048 sc1
buffer_load_dwordx4 v[32:35], v8, s[12:15], s28 offen offset:3072 sc1
L_rp_27:
s_waitcnt vmcnt(4)
v_xor_b32 v78, v56, v15
v_bitop3_b32 v78, v78, v60, v15 bitop3:0xf6
v_bitop3_b32 v78, v78, v64, v15 bitop3:0xf6
v_bitop3_b32 v78, v78, v68, v15 bitop3:0xf6
v_and_b32 v78, 0x10001, v78
v_cmp_ne_u32 vcc, 0, v78
s_cbranch_vccz L_rk_30
buffer_load_dwordx4 v[56:59], v8, s[12:15], s28 offen offset:0 sc1
buffer_load_dwordx4 v[60:63], v8, s[12:15], s28 offen offset:1024 sc1
buffer_load_dwordx4 v[64:67], v8, s[12:15], s28 offen offset:2048 sc1
buffer_load_dwordx4 v[68:71], v8, s[12:15], s28 offen offset:3072 sc1
s_waitcnt vmcnt(4)
v_xor_b32 v78, v20, v15
v_bitop3_b32 v78, v78, v24, v15 bitop3:0xf6
v_bitop3_b32 v78, v78, v28, v15 bitop3:0xf6
v_bitop3_b32 v78, v78, v32, v15 bitop3:0xf6
v_and_b32 v78, 0x10001, v78
v_cmp_ne_u32 vcc, 0, v78
s_cbranch_vccz L_rk_29
buffer_load_dwordx4 v[20:23], v8, s[12:15], s28 offen offset:0 sc1
buffer_load_dwordx4 v[24:27], v8, s[12:15], s28 offen offset:1024 sc1
buffer_load_dwordx4 v[28:31], v8, s[12:15], s28 offen offset:2048 sc1
buffer_load_dwordx4 v[32:35], v8, s[12:15], s28 offen offset:3072 sc1
s_add_u32 s44, s44, 1
s_cmp_gt_u32 s44, 1000000
s_cbranch_scc1 L_abort
s_branch L_rp_27
L_rk_29:
v_mfma_f32_16x16x32_bf16 v[52:55], v[16:19], v[20:23], 0
v_mfma_f32_16x16x32_bf16 v[52:55], v[16:19], v[24:27], v[52:55]
v_mfma_f32_16x16x32_bf16 v[52:55], v[16:19], v[28:31], v[52:55]
v_mfma_f32_16x16x32_bf16 v[52:55], v[16:19], v[32:35], v[52:55]
s_branch L_rd_28
L_rk_30:
v_mfma_f32_16x16x32_bf16 v[52:55], v[16:19], v[56:59], 0
v_mfma_f32_16x16x32_bf16 v[52:55], v[16:19], v[60:63], v[52:55]
v_mfma_f32_16x16x32_bf16 v[52:55], v[16:19], v[64:67], v[52:55]
v_mfma_f32_16x16x32_bf16 v[52:55], v[16:19], v[68:71], v[52:55]
L_rd_28:
s_nop 7
v_add_f32_dpp v52, v52, v52 row_ror:8 row_mask:0xf bank_mask:0xf
v_add_f32_dpp v53, v53, v53 row_ror:8 row_mask:0xf bank_mask:0xf
v_add_f32_dpp v54, v54, v54 row_ror:8 row_mask:0xf bank_mask:0xf
v_add_f32_dpp v55, v55, v55 row_ror:8 row_mask:0xf bank_mask:0xf
v_cvt_pk_bf16_f32 v76, v52, v53
v_cvt_pk_bf16_f32 v77, v54, v55
s_mov_b64 exec, s[50:51]
v_min_u32 v76, -2, v76
buffer_store_dwordx2 v[76:77], v9, s[12:15], s25 offen
v_mov_b32 v78, -1
v_mov_b32 v79, -1
buffer_store_dwordx2 v[78:79], v9, s[12:15], s27 offen
s_mov_b64 exec, -1
s_waitcnt vmcnt(2)
L_nt_26:
L_pre_w2e:
v_mov_b32 v44, 0
v_mov_b32 v48, 0
v_mov_b32 v52, 0
v_mov_b32 v45, 0
v_mov_b32 v49, 0
v_mov_b32 v53, 0
v_mov_b32 v46, 0
v_mov_b32 v50, 0
v_mov_b32 v54, 0
v_mov_b32 v47, 0
v_mov_b32 v51, 0
v_mov_b32 v55, 0
s_add_u32 s20, s20, 1
s_add_u32 s21, s21, 262144
s_add_u32 s22, s22, 262144
s_add_u32 s23, s23, 65536
s_add_u32 s24, s24, 65536
s_add_u32 s33, s20, 2
s_min_u32 s33, s33, 63
s_lshl_b32 s33, s33, 18
s_lshl_b32 s34, s10, 13
s_add_u32 s33, s33, s34
s_add_u32 s54, s33, 16187392
s_add_u32 s55, s33, 32964608
s_nop 9
s_add_u32 s37, s26, 2048
buffer_load_dwordx4 v[20:23], v1, s[12:15], s37 offen sc1
buffer_load_dwordx4 v[24:27], v1, s[12:15], s37 offen offset:1024 sc1
s_nop 15
s_nop 8
buffer_load_dwordx4 v[28:31], v1, s[12:15], s37 offen sc1
buffer_load_dwordx4 v[32:35], v1, s[12:15], s37 offen offset:1024 sc1
s_nop 15
s_nop 8
buffer_load_dwordx4 v[36:39], v1, s[12:15], s37 offen sc1
buffer_load_dwordx4 v[40:43], v1, s[12:15], s37 offen offset:1024 sc1
L_g0p_32:
s_waitcnt vmcnt(4)
v_max3_u32 v78, v20, v22, v24
v_max_u32 v78, v78, v26
v_cmp_eq_u32 vcc, -1, v78
s_cbranch_vccz L_g0k_34
buffer_load_dwordx4 v[20:23], v1, s[12:15], s37 offen sc1
buffer_load_dwordx4 v[24:27], v1, s[12:15], s37 offen offset:1024 sc1
s_waitcnt vmcnt(4)
v_max3_u32 v78, v28, v30, v32
v_max_u32 v78, v78, v34
v_cmp_eq_u32 vcc, -1, v78
s_cbranch_vccz L_g0k_35
buffer_load_dwordx4 v[28:31], v1, s[12:15], s37 offen sc1
buffer_load_dwordx4 v[32:35], v1, s[12:15], s37 offen offset:1024 sc1
s_waitcnt vmcnt(4)
v_max3_u32 v78, v36, v38, v40
v_max_u32 v78, v78, v42
v_cmp_eq_u32 vcc, -1, v78
s_cbranch_vccz L_g0k_36
buffer_load_dwordx4 v[36:39], v1, s[12:15], s37 offen sc1
buffer_load_dwordx4 v[40:43], v1, s[12:15], s37 offen offset:1024 sc1
s_add_u32 s45, s45, 1
s_cmp_gt_u32 s45, 1000000
s_cbranch_scc1 L_abort
s_branch L_g0p_32
L_g0k_34:
ds_write_b128 v1, v[20:23] offset:2048
ds_write_b128 v1, v[24:27] offset:3072
s_branch L_g0d_33
L_g0k_35:
ds_write_b128 v1, v[28:31] offset:2048
ds_write_b128 v1, v[32:35] offset:3072
s_branch L_g0d_33
L_g0k_36:
ds_write_b128 v1, v[36:39] offset:2048
ds_write_b128 v1, v[40:43] offset:3072
L_g0d_33:
s_waitcnt lgkmcnt(0)
s_barrier
s_branch L_step_w2e
L_last_w2e:
v_cvt_pk_bf16_f32 v52, v52, v53
v_cvt_pk_bf16_f32 v53, v54, v55
buffer_store_dwordx2 v[52:53], v13, s[12:15], s24 offen sc1
s_waitcnt vmcnt(0)
s_barrier
s_branch L_finish
L_step_w2o:
ds_read_b64_tr_b16 v[56:57], v2 offset:0
ds_read_b64_tr_b16 v[58:59], v2 offset:64
ds_read_b64_tr_b16 v[60:61], v2 offset:512
ds_read_b64_tr_b16 v[62:63], v2 offset:576
s_waitcnt lgkmcnt(2)
v_smfmac_f32_16x16x64_bf16 v[44:47], v[56:59], a[0:7], v3
ds_read_b64_tr_b16 v[64:65], v2 offset:1024
v_smfmac_f32_16x16x64_bf16 v[48:51], v[56:59], a[144:151], v3
ds_read_b64_tr_b16 v[66:67], v2 offset:1088
buffer_load_dwordx4 v[20:23], v10, s[12:15], s21 offen offset:0 sc1
v_smfmac_f32_16x16x64_bf16 v[52:55], v[56:59], v[112:119], v3
s_waitcnt lgkmcnt(2)
v_smfmac_f32_16x16x64_bf16 v[44:47], v[60:63], a[8:15], v3
ds_read_b64_tr_b16 v[68:69], v2 offset:1536
v_smfmac_f32_16x16x64_bf16 v[48:51], v[60:63], a[152:159], v3
ds_read_b64_tr_b16 v[70:71], v2 offset:1600
buffer_load_dwordx4 v[24:27], v10, s[12:15], s21 offen offset:2048 sc1
v_smfmac_f32_16x16x64_bf16 v[52:55], v[60:63], v[120:127], v3
s_waitcnt lgkmcnt(2)
v_smfmac_f32_16x16x64_bf16 v[44:47], v[64:67], a[16:23], v3
ds_read_b64_tr_b16 v[56:57], v2 offset:2048
v_smfmac_f32_16x16x64_bf16 v[48:51], v[64:67], a[160:167], v3
ds_read_b64_tr_b16 v[58:59], v2 offset:2112
s_add_u32 s34, s21, 4096
buffer_load_dwordx4 v[28:31], v10, s[12:15], s34 offen offset:0 sc1
v_smfmac_f32_16x16x64_bf16 v[52:55], v[64:67], v[128:135], v3
s_waitcnt lgkmcnt(2)
v_smfmac_f32_16x16x64_bf16 v[44:47], v[68:71], a[24:31], v3
ds_read_b64_tr_b16 v[60:61], v2 offset:2560
v_smfmac_f32_16x16x64_bf16 v[48:51], v[68:71], a[168:175], v3
ds_read_b64_tr_b16 v[62:63], v2 offset:2624
s_add_u32 s34, s21, 4096
buffer_load_dwordx4 v[32:35], v10, s[12:15], s34 offen offset:2048 sc1
v_smfmac_f32_16x16x64_bf16 v[52:55], v[68:71], v[136:143], v3
s_waitcnt lgkmcnt(2)
v_smfmac_f32_16x16x64_bf16 v[44:47], v[56:59], a[32:39], v3
ds_read_b64_tr_b16 v[64:65], v2 offset:3072
v_smfmac_f32_16x16x64_bf16 v[48:51], v[56:59], a[176:183], v3
ds_read_b64_tr_b16 v[66:67], v2 offset:3136
buffer_load_dwordx4 v[36:39], v11, s[12:15], s22 offen offset:0 sc1
v_smfmac_f32_16x16x64_bf16 v[52:55], v[56:59], v[144:151], v3
s_waitcnt lgkmcnt(2)
v_smfmac_f32_16x16x64_bf16 v[44:47], v[60:63], a[40:47], v3
ds_read_b64_tr_b16 v[68:69], v2 offset:3584
v_smfmac_f32_16x16x64_bf16 v[48:51], v[60:63], a[184:191], v3
ds_read_b64_tr_b16 v[70:71], v2 offset:3648
buffer_load_dwordx4 v[40:43], v11, s[12:15], s22 offen offset:256 sc1
v_smfmac_f32_16x16x64_bf16 v[52:55], v[60:63], v[152:159], v3
s_barrier
s_waitcnt lgkmcnt(2)
v_smfmac_f32_16x16x64_bf16 v[44:47], v[64:67], a[48:55], v3
ds_read_b64_tr_b16 v[56:57], v2 offset:4096
v_smfmac_f32_16x16x64_bf16 v[48:51], v[64:67], a[192:199], v3
ds_read_b64_tr_b16 v[58:59], v2 offset:4160
v_smfmac_f32_16x16x64_bf16 v[52:55], v[64:67], v[160:167], v3
s_waitcnt lgkmcnt(2)
v_smfmac_f32_16x16x64_bf16 v[44:47], v[68:71], a[56:63], v3
ds_read_b64_tr_b16 v[60:61], v2 offset:4608
v_smfmac_f32_16x16x64_bf16 v[48:51], v[68:71], a[200:207], v3
ds_read_b64_tr_b16 v[62:63], v2 offset:4672
v_smfmac_f32_16x16x64_bf16 v[52:55], v[68:71], v[168:175], v3
s_waitcnt lgkmcnt(2)
v_smfmac_f32_16x16x64_bf16 v[44:47], v[56:59], a[64:71], v3
ds_read_b64_tr_b16 v[64:65], v2 offset:5120
v_smfmac_f32_16x16x64_bf16 v[48:51], v[56:59], a[208:215], v3
ds_read_b64_tr_b16 v[66:67], v2 offset:5184
v_smfmac_f32_16x16x64_bf16 v[52:55], v[56:59], v[176:183], v3
s_waitcnt lgkmcnt(2)
v_smfmac_f32_16x16x64_bf16 v[44:47], v[60:63], a[72:79], v3
ds_read_b64_tr_b16 v[68:69], v2 offset:5632
v_smfmac_f32_16x16x64_bf16 v[48:51], v[60:63], a[216:223], v3
ds_read_b64_tr_b16 v[70:71], v2 offset:5696
v_smfmac_f32_16x16x64_bf16 v[52:55], v[60:63], v[184:191], v3
s_barrier
s_waitcnt lgkmcnt(2)
v_smfmac_f32_16x16x64_bf16 v[44:47], v[64:67], a[80:87], v3
ds_read_b64_tr_b16 v[56:57], v2 offset:6144
v_smfmac_f32_16x16x64_bf16 v[48:51], v[64:67], a[224:231], v3
ds_read_b64_tr_b16 v[58:59], v2 offset:6208
v_smfmac_f32_16x16x64_bf16 v[52:55], v[64:67], v[192:199], v3
s_waitcnt lgkmcnt(2)
v_smfmac_f32_16x16x64_bf16 v[44:47], v[68:71], a[88:95], v3
ds_read_b64_tr_b16 v[60:61], v2 offset:6656
v_smfmac_f32_16x16x64_bf16 v[48:51], v[68:71], a[232:239], v3
ds_read_b64_tr_b16 v[62:63], v2 offset:6720
v_smfmac_f32_16x16x64_bf16 v[52:55], v[68:71], v[200:207], v3
s_waitcnt lgkmcnt(2)
v_smfmac_f32_16x16x64_bf16 v[44:47], v[56:59], a[96:103], v3
ds_read_b64_tr_b16 v[64:65], v2 offset:7168
v_smfmac_f32_16x16x64_bf16 v[48:51], v[56:59], a[240:247], v3
ds_read_b64_tr_b16 v[66:67], v2 offset:7232
v_smfmac_f32_16x16x64_bf16 v[52:55], v[56:59], v[208:215], v3
s_waitcnt lgkmcnt(2)
v_smfmac_f32_16x16x64_bf16 v[44:47], v[60:63], a[104:111], v3
ds_read_b64_tr_b16 v[68:69], v2 offset:7680
v_smfmac_f32_16x16x64_bf16 v[48:51], v[60:63], a[248:255], v3
ds_read_b64_tr_b16 v[70:71], v2 offset:7744
v_smfmac_f32_16x16x64_bf16 v[52:55], v[60:63], v[216:223], v3
s_barrier
s_waitcnt lgkmcnt(2)
v_smfmac_f32_16x16x64_bf16 v[44:47], v[64:67], a[112:119], v3
ds_read_b64_tr_b16 v[56:57], v2 offset:8192
v_smfmac_f32_16x16x64_bf16 v[48:51], v[64:67], v[80:87], v3
ds_read_b64_tr_b16 v[58:59], v2 offset:8256
s_waitcnt lgkmcnt(2)
v_smfmac_f32_16x16x64_bf16 v[44:47], v[68:71], a[120:127], v3
ds_read_b64_tr_b16 v[60:61], v2 offset:8704
v_smfmac_f32_16x16x64_bf16 v[48:51], v[68:71], v[88:95], v3
ds_read_b64_tr_b16 v[62:63], v2 offset:8768
s_waitcnt lgkmcnt(2)
v_smfmac_f32_16x16x64_bf16 v[44:47], v[56:59], a[128:135], v3
v_smfmac_f32_16x16x64_bf16 v[48:51], v[56:59], v[96:103], v3
s_waitcnt lgkmcnt(0)
v_smfmac_f32_16x16x64_bf16 v[44:47], v[60:63], a[136:143], v3
v_smfmac_f32_16x16x64_bf16 v[48:51], v[60:63], v[104:111], v3
v_smfmac_f32_16x16x64_bf16 v[52:55], v[64:67], v[224:231], v3
v_cvt_pk_bf16_f32 v72, v44, v45
v_cvt_pk_bf16_f32 v73, v46, v47
ds_write_b64 v14, v[72:73]
v_smfmac_f32_16x16x64_bf16 v[52:55], v[68:71], v[232:239], v3
v_cvt_pk_bf16_f32 v74, v48, v49
v_cvt_pk_bf16_f32 v75, v50, v51
ds_write_b64 v14, v[74:75] offset:2048
v_smfmac_f32_16x16x64_bf16 v[52:55], v[56:59], v[240:247], v3
v_smfmac_f32_16x16x64_bf16 v[52:55], v[60:63], v[248:255], v3
s_waitcnt lgkmcnt(0)
s_barrier
ds_read_b64_tr_b16 v[56:57], v2 offset:9216
ds_read_b64_tr_b16 v[58:59], v2 offset:9280
ds_read_b64_tr_b16 v[60:61], v2 offset:9728
ds_read_b64_tr_b16 v[62:63], v2 offset:9792
ds_read_b64_tr_b16 v[64:65], v2 offset:10240
ds_read_b64_tr_b16 v[66:67], v2 offset:10304
ds_read_b64_tr_b16 v[68:69], v2 offset:10752
ds_read_b64_tr_b16 v[70:71], v2 offset:10816
s_cmp_eq_u32 s20, 63
s_cbranch_scc1 L_last_w2o
s_waitcnt vmcnt(2)
s_waitcnt lgkmcnt(6)
v_mfma_f32_16x16x32_bf16 v[72:75], v[20:23], v[56:59], 0
s_waitcnt lgkmcnt(4)
v_mfma_f32_16x16x32_bf16 v[72:75], v[24:27], v[60:63], v[72:75]
s_waitcnt lgkmcnt(2)
v_mfma_f32_16x16x32_bf16 v[72:75], v[28:31], v[64:67], v[72:75]
s_waitcnt lgkmcnt(0)
v_mfma_f32_16x16x32_bf16 v[72:75], v[32:35], v[68:71], v[72:75]
v_cvt_pk_bf16_f32 v52, v52, v53
v_cvt_pk_bf16_f32 v53, v54, v55
buffer_store_dwordx2 v[52:53], v13, s[12:15], s24 offen sc1
s_nop 4
ds_write_b128 v1, v[72:75] offset:15360
s_add_u32 s32, s20, 1
s_and_b32 s33, s32, 1
s_bfe_u32 s34, s32, 0x10001
s_lshl_b32 s34, s34, 16
s_or_b32 s35, s33, s34
s_and_b32 s33, s32, 3
s_lshl_b32 s33, s33, 14
s_add_u32 s25, s33, s29
s_sub_u32 s26, s25, 147456
s_add_u32 s33, s20, 3
s_and_b32 s33, s33, 3
s_lshl_b32 s33, s33, 14
s_add_u32 s27, s33, s29
s_waitcnt lgkmcnt(0)
s_barrier
ds_read_b128 v[60:63], v1 offset:14336
ds_read_b128 v[64:67], v1 offset:15360
ds_read_b128 v[56:59], v1 offset:13312
v_mov_b32 v15, s35
s_waitcnt lgkmcnt(1)
v_max3_f32 v72, v60, v61, v62
v_max3_f32 v73, v63, v64, v65
v_max3_f32 v72, v72, v66, v67
s_waitcnt lgkmcnt(0)
v_max3_f32 v73, v73, v56, v57
v_max3_f32 v72, v72, v58, v59
v_max_f32 v72, v72, v73
v_mov_b32 v73, v72
s_nop 1
v_permlane32_swap_b32 v72, v73
v_max_f32 v72, v72, v73
v_mov_b32 v73, v72
s_nop 1
v_permlane16_swap_b32 v72, v73
v_max_f32 v72, v72, v73
v_mul_f32 v73, s47, v72
v_fma_f32 v60, v60, s47, -v73
v_fma_f32 v61, v61, s47, -v73
v_fma_f32 v62, v62, s47, -v73
v_fma_f32 v63, v63, s47, -v73
v_fma_f32 v64, v64, s47, -v73
v_fma_f32 v65, v65, s47, -v73
v_fma_f32 v66, v66, s47, -v73
v_fma_f32 v67, v67, s47, -v73
v_exp_f32 v60, v60
v_exp_f32 v61, v61
v_exp_f32 v62, v62
v_cvt_pk_bf16_f32 v20, v60, v61
v_exp_f32 v63, v63
v_exp_f32 v64, v64
v_cvt_pk_bf16_f32 v21, v62, v63
v_exp_f32 v65, v65
v_exp_f32 v66, v66
v_cvt_pk_bf16_f32 v22, v64, v65
v_exp_f32 v67, v67
v_fma_f32 v56, v56, s47, -v73
v_fma_f32 v57, v57, s47, -v73
v_fma_f32 v58, v58, s47, -v73
v_fma_f32 v59, v59, s47, -v73
v_cvt_pk_bf16_f32 v23, v66, v67
s_waitcnt vmcnt(1)
s_nop 0
v_mfma_f32_16x16x32_bf16 v[44:47], v[36:39], v[20:23], 0
v_mfma_f32_16x16x32_bf16 v[48:51], v[40:43], v[20:23], 0
v_exp_f32 v56, v56
v_exp_f32 v57, v57
v_exp_f32 v58, v58
v_exp_f32 v59, v59
v_add_f32 v74, v60, v61
v_add_f32 v75, v62, v63
v_cvt_pk_bf16_f32 v24, v56, v57
v_cvt_pk_bf16_f32 v25, v58, v59
v_cndmask_b32 v26, 0, v24, s[52:53]
v_cndmask_b32 v27, 0, v25, s[52:53]
v_cndmask_b32 v28, v24, 0, s[52:53]
v_cndmask_b32 v29, v25, 0, s[52:53]
v_mfma_f32_16x16x16_bf16 v[44:47], v[52:53], v[26:27], v[44:47]
v_mfma_f32_16x16x16_bf16 v[48:51], v[52:53], v[28:29], v[48:51]
ds_read_b128 v[20:23], v5 offset:28672
ds_read_b128 v[24:27], v5 offset:29696
ds_read_b128 v[28:31], v6 offset:16384
ds_read_b128 v[32:35], v6 offset:17408
v_add_f32 v74, v74, v64
v_add_f32 v75, v75, v65
v_add_f32 v74, v74, v66
v_add_f32 v75, v75, v67
v_add_f32 v73, v56, v57
v_add_f32 v72, v58, v59
v_add_f32 v74, v74, v75
v_add_f32 v73, v73, v72
v_fma_f32 v74, v73, 0.5, v74
v_mov_b32 v75, v74
s_nop 1
v_permlane32_swap_b32 v74, v75
v_add_f32 v74, v74, v75
v_mov_b32 v75, v74
s_nop 1
v_permlane16_swap_b32 v74, v75
v_add_f32 v74, v74, v75
v_rcp_f32 v74, v74
ds_read_b128 v[56:59], v4 offset:4096
ds_read_b128 v[60:63], v4 offset:5120
ds_read_b128 v[64:67], v4 offset:40960
ds_read_b128 v[68:71], v4 offset:41984
v_pk_mul_f32 v[44:45], v[44:45], v[74:75] op_sel_hi:[1,0]
v_pk_mul_f32 v[48:49], v[48:49], v[74:75] op_sel_hi:[1,0]
v_pk_mul_f32 v[46:47], v[46:47], v[74:75] op_sel_hi:[1,0]
v_pk_mul_f32 v[50:51], v[50:51], v[74:75] op_sel_hi:[1,0]
v_cvt_pk_bf16_f32 v76, v44, v45
v_cvt_pk_bf16_f32 v77, v46, v47
v_cvt_pk_bf16_f32 v78, v48, v49
v_cvt_pk_bf16_f32 v79, v50, v51
ds_write_b128 v1, v[76:79] offset:11264
v_mov_b32 v44, 0
v_mov_b32 v45, 0
v_mov_b32 v46, 0
v_mov_b32 v47, 0
v_mov_b32 v48, 0
v_mov_b32 v49, 0
v_mov_b32 v50, 0
v_mov_b32 v51, 0
s_waitcnt lgkmcnt(0)
s_barrier
ds_read_b128 v[36:39], v1 offset:9216
ds_read_b128 v[40:43], v1 offset:10240
ds_read_b128 v[52:55], v1 offset:11264
ds_read_b128 v[76:79], v1 offset:12288
s_waitcnt lgkmcnt(3)
v_smfmac_f32_16x16x64_bf16 v[44:47], v[36:39], v[56:63], v3
ds_read_b128 v[56:59], v4 offset:12288
ds_read_b128 v[60:63], v4 offset:13312
s_waitcnt lgkmcnt(4)
v_smfmac_f32_16x16x64_bf16 v[44:47], v[40:43], v[64:71], v3
ds_read_b128 v[64:67], v5 offset:0
ds_read_b128 v[68:71], v5 offset:1024
s_waitcnt lgkmcnt(5)
v_smfmac_f32_16x16x64_bf16 v[44:47], v[52:55], v[20:27], v3
ds_read_b128 v[20:23], v5 offset:36864
ds_read_b128 v[24:27], v5 offset:37888
s_waitcnt lgkmcnt(6)
v_smfmac_f32_16x16x64_bf16 v[44:47], v[76:79], v[28:35], v3
ds_read_b128 v[28:31], v6 offset:24576
ds_read_b128 v[32:35], v6 offset:25600
s_waitcnt lgkmcnt(6)
v_smfmac_f32_16x16x64_bf16 v[48:51], v[36:39], v[56:63], v3
ds_read_b128 v[56:59], v4 offset:20480
ds_read_b128 v[60:63], v4 offset:21504
s_nop 1
v_cvt_pk_bf16_f32 v72, v44, v45
v_cvt_pk_bf16_f32 v73, v46, v47
s_waitcnt lgkmcnt(6)
v_smfmac_f32_16x16x64_bf16 v[48:51], v[40:43], v[64:71], v3
ds_read_b128 v[64:67], v5 offset:8192
ds_read_b128 v[68:71], v5 offset:9216
v_and_or_b32 v72, v72, s46, v15
s_add_u32 s36, s28, 32768
buffer_store_dwordx2 v[72:73], v7, s[12:15], s36 offen
s_waitcnt lgkmcnt(6)
v_smfmac_f32_16x16x64_bf16 v[48:51], v[52:55], v[20:27], v3
ds_read_b128 v[20:23], v5 offset:45056
ds_read_b128 v[24:27], v5 offset:46080
v_mov_b32 v44, 0
v_mov_b32 v45, 0
s_waitcnt lgkmcnt(6)
v_smfmac_f32_16x16x64_bf16 v[48:51], v[76:79], v[28:35], v3
ds_read_b128 v[28:31], v6 offset:32768
ds_read_b128 v[32:35], v6 offset:33792
v_mov_b32 v46, 0
v_mov_b32 v47, 0
s_waitcnt lgkmcnt(6)
s_nop 0
v_smfmac_f32_16x16x64_bf16 v[44:47], v[36:39], v[56:63], v3
s_nop 0
v_cvt_pk_bf16_f32 v74, v48, v49
v_cvt_pk_bf16_f32 v75, v50, v51
s_waitcnt lgkmcnt(4)
v_smfmac_f32_16x16x64_bf16 v[44:47], v[40:43], v[64:71], v3
v_and_or_b32 v74, v74, s46, v15
s_add_u32 s36, s28, 98304
buffer_store_dwordx2 v[74:75], v7, s[12:15], s36 offen
s_waitcnt lgkmcnt(2)
v_smfmac_f32_16x16x64_bf16 v[44:47], v[52:55], v[20:27], v3
s_waitcnt lgkmcnt(0)
v_smfmac_f32_16x16x64_bf16 v[44:47], v[76:79], v[28:35], v3
s_nop 7
v_cvt_pk_bf16_f32 v72, v44, v45
v_cvt_pk_bf16_f32 v73, v46, v47
v_and_or_b32 v72, v72, s46, v15
s_add_u32 s36, s28, 163840
buffer_store_dwordx2 v[72:73], v7, s[12:15], s36 offen
s_nop 4
buffer_load_dwordx4 v[20:23], v8, s[12:15], s28 offen offset:0 sc1
buffer_load_dwordx4 v[24:27], v8, s[12:15], s28 offen offset:1024 sc1
buffer_load_dwordx4 v[28:31], v8, s[12:15], s28 offen offset:2048 sc1
buffer_load_dwordx4 v[32:35], v8, s[12:15], s28 offen offset:3072 sc1
s_nop 15
s_nop 15
s_nop 7
buffer_load_dwordx4 v[56:59], v8, s[12:15], s28 offen offset:0 sc1
buffer_load_dwordx4 v[60:63], v8, s[12:15], s28 offen offset:1024 sc1
buffer_load_dwordx4 v[64:67], v8, s[12:15], s28 offen offset:2048 sc1
buffer_load_dwordx4 v[68:71], v8, s[12:15], s28 offen offset:3072 sc1
s_waitcnt vmcnt(4)
v_xor_b32 v78, v20, v15
v_bitop3_b32 v78, v78, v24, v15 bitop3:0xf6
v_bitop3_b32 v78, v78, v28, v15 bitop3:0xf6
v_bitop3_b32 v78, v78, v32, v15 bitop3:0xf6
v_and_b32 v78, 0x10001, v78
v_cmp_ne_u32 vcc, 0, v78
s_cbranch_vccz L_rk_40
buffer_load_dwordx4 v[20:23], v8, s[12:15], s28 offen offset:0 sc1
buffer_load_dwordx4 v[24:27], v8, s[12:15], s28 offen offset:1024 sc1
buffer_load_dwordx4 v[28:31], v8, s[12:15], s28 offen offset:2048 sc1
buffer_load_dwordx4 v[32:35], v8, s[12:15], s28 offen offset:3072 sc1
L_rp_38:
s_waitcnt vmcnt(4)
v_xor_b32 v78, v56, v15
v_bitop3_b32 v78, v78, v60, v15 bitop3:0xf6
v_bitop3_b32 v78, v78, v64, v15 bitop3:0xf6
v_bitop3_b32 v78, v78, v68, v15 bitop3:0xf6
v_and_b32 v78, 0x10001, v78
v_cmp_ne_u32 vcc, 0, v78
s_cbranch_vccz L_rk_41
buffer_load_dwordx4 v[56:59], v8, s[12:15], s28 offen offset:0 sc1
buffer_load_dwordx4 v[60:63], v8, s[12:15], s28 offen offset:1024 sc1
buffer_load_dwordx4 v[64:67], v8, s[12:15], s28 offen offset:2048 sc1
buffer_load_dwordx4 v[68:71], v8, s[12:15], s28 offen offset:3072 sc1
s_waitcnt vmcnt(4)
v_xor_b32 v78, v20, v15
v_bitop3_b32 v78, v78, v24, v15 bitop3:0xf6
v_bitop3_b32 v78, v78, v28, v15 bitop3:0xf6
v_bitop3_b32 v78, v78, v32, v15 bitop3:0xf6
v_and_b32 v78, 0x10001, v78
v_cmp_ne_u32 vcc, 0, v78
s_cbranch_vccz L_rk_40
buffer_load_dwordx4 v[20:23], v8, s[12:15], s28 offen offset:0 sc1
buffer_load_dwordx4 v[24:27], v8, s[12:15], s28 offen offset:1024 sc1
buffer_load_dwordx4 v[28:31], v8, s[12:15], s28 offen offset:2048 sc1
buffer_load_dwordx4 v[32:35], v8, s[12:15], s28 offen offset:3072 sc1
s_add_u32 s44, s44, 1
s_cmp_gt_u32 s44, 1000000
s_cbranch_scc1 L_abort
s_branch L_rp_38
L_rk_40:
v_mfma_f32_16x16x32_bf16 v[52:55], v[16:19], v[20:23], 0
v_mfma_f32_16x16x32_bf16 v[52:55], v[16:19], v[24:27], v[52:55]
v_mfma_f32_16x16x32_bf16 v[52:55], v[16:19], v[28:31], v[52:55]
v_mfma_f32_16x16x32_bf16 v[52:55], v[16:19], v[32:35], v[52:55]
s_branch L_rd_39
L_rk_41:
v_mfma_f32_16x16x32_bf16 v[52:55], v[16:19], v[56:59], 0
v_mfma_f32_16x16x32_bf16 v[52:55], v[16:19], v[60:63], v[52:55]
v_mfma_f32_16x16x32_bf16 v[52:55], v[16:19], v[64:67], v[52:55]
v_mfma_f32_16x16x32_bf16 v[52:55], v[16:19], v[68:71], v[52:55]
L_rd_39:
s_nop 7
v_add_f32_dpp v52, v52, v52 row_ror:8 row_mask:0xf bank_mask:0xf
v_add_f32_dpp v53, v53, v53 row_ror:8 row_mask:0xf bank_mask:0xf
v_add_f32_dpp v54, v54, v54 row_ror:8 row_mask:0xf bank_mask:0xf
v_add_f32_dpp v55, v55, v55 row_ror:8 row_mask:0xf bank_mask:0xf
v_cvt_pk_bf16_f32 v76, v52, v53
v_cvt_pk_bf16_f32 v77, v54, v55
s_mov_b64 exec, s[50:51]
v_min_u32 v76, -2, v76
buffer_store_dwordx2 v[76:77], v9, s[12:15], s25 offen
v_mov_b32 v78, -1
v_mov_b32 v79, -1
buffer_store_dwordx2 v[78:79], v9, s[12:15], s27 offen
s_mov_b64 exec, -1
s_waitcnt vmcnt(2)
L_nt_37:
L_pre_w2o:
v_mov_b32 v44, 0
v_mov_b32 v48, 0
v_mov_b32 v52, 0
v_mov_b32 v45, 0
v_mov_b32 v49, 0
v_mov_b32 v53, 0
v_mov_b32 v46, 0
v_mov_b32 v50, 0
v_mov_b32 v54, 0
v_mov_b32 v47, 0
v_mov_b32 v51, 0
v_mov_b32 v55, 0
s_add_u32 s20, s20, 1
s_add_u32 s21, s21, 262144
s_add_u32 s22, s22, 262144
s_add_u32 s23, s23, 65536
s_add_u32 s24, s24, 65536
s_add_u32 s33, s20, 2
s_min_u32 s33, s33, 63
s_lshl_b32 s33, s33, 18
s_lshl_b32 s34, s10, 13
s_add_u32 s33, s33, s34
s_add_u32 s54, s33, 16187392
s_add_u32 s55, s33, 32964608
s_nop 4
s_add_u32 s37, s26, 2048
buffer_load_dwordx4 v[20:23], v1, s[12:15], s37 offen sc1
buffer_load_dwordx4 v[24:27], v1, s[12:15], s37 offen offset:1024 sc1
s_nop 15
s_nop 8
buffer_load_dwordx4 v[28:31], v1, s[12:15], s37 offen sc1
buffer_load_dwordx4 v[32:35], v1, s[12:15], s37 offen offset:1024 sc1
s_nop 15
s_nop 8
buffer_load_dwordx4 v[36:39], v1, s[12:15], s37 offen sc1
buffer_load_dwordx4 v[40:43], v1, s[12:15], s37 offen offset:1024 sc1
L_g0p_43:
s_waitcnt vmcnt(4)
v_max3_u32 v78, v20, v22, v24
v_max_u32 v78, v78, v26
v_cmp_eq_u32 vcc, -1, v78
s_cbranch_vccz L_g0k_45
buffer_load_dwordx4 v[20:23], v1, s[12:15], s37 offen sc1
buffer_load_dwordx4 v[24:27], v1, s[12:15], s37 offen offset:1024 sc1
s_waitcnt vmcnt(4)
v_max3_u32 v78, v28, v30, v32
v_max_u32 v78, v78, v34
v_cmp_eq_u32 vcc, -1, v78
s_cbranch_vccz L_g0k_46
buffer_load_dwordx4 v[28:31], v1, s[12:15], s37 offen sc1
buffer_load_dwordx4 v[32:35], v1, s[12:15], s37 offen offset:1024 sc1
s_waitcnt vmcnt(4)
v_max3_u32 v78, v36, v38, v40
v_max_u32 v78, v78, v42
v_cmp_eq_u32 vcc, -1, v78
s_cbranch_vccz L_g0k_47
buffer_load_dwordx4 v[36:39], v1, s[12:15], s37 offen sc1
buffer_load_dwordx4 v[40:43], v1, s[12:15], s37 offen offset:1024 sc1
s_add_u32 s45, s45, 1
s_cmp_gt_u32 s45, 1000000
s_cbranch_scc1 L_abort
s_branch L_g0p_43
L_g0k_45:
ds_write_b128 v1, v[20:23] offset:2048
ds_write_b128 v1, v[24:27] offset:3072
s_branch L_g0d_44
L_g0k_46:
ds_write_b128 v1, v[28:31] offset:2048
ds_write_b128 v1, v[32:35] offset:3072
s_branch L_g0d_44
L_g0k_47:
ds_write_b128 v1, v[36:39] offset:2048
ds_write_b128 v1, v[40:43] offset:3072
L_g0d_44:
s_waitcnt lgkmcnt(0)
s_barrier
s_branch L_step_w2o
L_last_w2o:
v_cvt_pk_bf16_f32 v52, v52, v53
v_cvt_pk_bf16_f32 v53, v54, v55
buffer_store_dwordx2 v[52:53], v13, s[12:15], s24 offen sc1
s_waitcnt vmcnt(0)
s_barrier
s_branch L_finish
L_step_w3e:
ds_read_b64_tr_b16 v[56:57], v2 offset:0
ds_read_b64_tr_b16 v[58:59], v2 offset:64
ds_read_b64_tr_b16 v[60:61], v2 offset:512
ds_read_b64_tr_b16 v[62:63], v2 offset:576
s_waitcnt lgkmcnt(2)
v_smfmac_f32_16x16x64_bf16 v[44:47], v[56:59], a[0:7], v3
ds_read_b64_tr_b16 v[64:65], v2 offset:1024
v_smfmac_f32_16x16x64_bf16 v[48:51], v[56:59], a[144:151], v3
ds_read_b64_tr_b16 v[66:67], v2 offset:1088
v_smfmac_f32_16x16x64_bf16 v[52:55], v[56:59], v[112:119], v3
s_add_u32 s33, s26, 4096
buffer_load_dwordx4 v[20:23], v1, s[12:15], s33 offen sc1
buffer_load_dwordx4 v[24:27], v1, s[12:15], s33 offen offset:1024 sc1
s_waitcnt lgkmcnt(2)
v_smfmac_f32_16x16x64_bf16 v[44:47], v[60:63], a[8:15], v3
ds_read_b64_tr_b16 v[68:69], v2 offset:1536
v_smfmac_f32_16x16x64_bf16 v[48:51], v[60:63], a[152:159], v3
ds_read_b64_tr_b16 v[70:71], v2 offset:1600
buffer_load_dwordx4 v[36:39], v11, s[12:15], s22 offen offset:0 sc1
v_smfmac_f32_16x16x64_bf16 v[52:55], v[60:63], v[120:127], v3
s_waitcnt lgkmcnt(2)
v_smfmac_f32_16x16x64_bf16 v[44:47], v[64:67], a[16:23], v3
ds_read_b64_tr_b16 v[56:57], v2 offset:2048
v_smfmac_f32_16x16x64_bf16 v[48:51], v[64:67], a[160:167], v3
ds_read_b64_tr_b16 v[58:59], v2 offset:2112
buffer_load_dwordx4 v[40:43], v11, s[12:15], s22 offen offset:256 sc1
v_smfmac_f32_16x16x64_bf16 v[52:55], v[64:67], v[128:135], v3
s_waitcnt lgkmcnt(2)
v_smfmac_f32_16x16x64_bf16 v[44:47], v[68:71], a[24:31], v3
ds_read_b64_tr_b16 v[60:61], v2 offset:2560
v_smfmac_f32_16x16x64_bf16 v[48:51], v[68:71], a[168:175], v3
ds_read_b64_tr_b16 v[62:63], v2 offset:2624
v_smfmac_f32_16x16x64_bf16 v[52:55], v[68:71], v[136:143], v3
s_waitcnt lgkmcnt(2)
v_smfmac_f32_16x16x64_bf16 v[44:47], v[56:59], a[32:39], v3
ds_read_b64_tr_b16 v[64:65], v2 offset:3072
s_waitcnt vmcnt(2)
v_max3_u32 v78, v20, v22, v24
v_smfmac_f32_16x16x64_bf16 v[48:51], v[56:59], a[176:183], v3
ds_read_b64_tr_b16 v[66:67], v2 offset:3136
v_max_u32 v78, v78, v26
v_cmp_eq_u32 vcc, -1, v78
v_smfmac_f32_16x16x64_bf16 v[52:55], v[56:59], v[144:151], v3
ds_write_b128 v1, v[20:23] offset:4096
ds_write_b128 v1, v[24:27] offset:5120
s_cbranch_vccnz L_grt_48
L_gbk_49:
s_waitcnt lgkmcnt(4)
v_smfmac_f32_16x16x64_bf16 v[44:47], v[60:63], a[40:47], v3
ds_read_b64_tr_b16 v[68:69], v2 offset:3584
v_smfmac_f32_16x16x64_bf16 v[48:51], v[60:63], a[184:191], v3
ds_read_b64_tr_b16 v[70:71], v2 offset:3648
v_smfmac_f32_16x16x64_bf16 v[52:55], v[60:63], v[152:159], v3
s_waitcnt lgkmcnt(2)
s_barrier
v_smfmac_f32_16x16x64_bf16 v[44:47], v[64:67], a[48:55], v3
ds_read_b64_tr_b16 v[56:57], v2 offset:4096
v_smfmac_f32_16x16x64_bf16 v[48:51], v[64:67], a[192:199], v3
ds_read_b64_tr_b16 v[58:59], v2 offset:4160
v_smfmac_f32_16x16x64_bf16 v[52:55], v[64:67], v[160:167], v3
s_waitcnt lgkmcnt(2)
v_smfmac_f32_16x16x64_bf16 v[44:47], v[68:71], a[56:63], v3
ds_read_b64_tr_b16 v[60:61], v2 offset:4608
v_smfmac_f32_16x16x64_bf16 v[48:51], v[68:71], a[200:207], v3
ds_read_b64_tr_b16 v[62:63], v2 offset:4672
v_smfmac_f32_16x16x64_bf16 v[52:55], v[68:71], v[168:175], v3
v_readfirstlane_b32 s34, v10
s_nop 0
s_cmp_ge_u32 s34, 64
s_cbranch_scc0 L_kvr_50
L_kvb_51:
v_lshlrev_b32 v79, 2, v1
s_add_u32 s34, s54, 0
buffer_load_dword v0, v79, s[12:15], s34 offen
s_waitcnt lgkmcnt(2)
v_smfmac_f32_16x16x64_bf16 v[44:47], v[56:59], a[64:71], v3
ds_read_b64_tr_b16 v[64:65], v2 offset:5120
v_smfmac_f32_16x16x64_bf16 v[48:51], v[56:59], a[208:215], v3
ds_read_b64_tr_b16 v[66:67], v2 offset:5184
v_smfmac_f32_16x16x64_bf16 v[52:55], v[56:59], v[176:183], v3
v_lshlrev_b32 v79, 2, v1
s_add_u32 s34, s54, 4096
buffer_load_dword v0, v79, s[12:15], s34 offen
s_waitcnt lgkmcnt(2)
v_smfmac_f32_16x16x64_bf16 v[44:47], v[60:63], a[72:79], v3
ds_read_b64_tr_b16 v[68:69], v2 offset:5632
v_smfmac_f32_16x16x64_bf16 v[48:51], v[60:63], a[216:223], v3
ds_read_b64_tr_b16 v[70:71], v2 offset:5696
v_smfmac_f32_16x16x64_bf16 v[52:55], v[60:63], v[184:191], v3
v_lshlrev_b32 v79, 2, v1
s_add_u32 s34, s55, 0
buffer_load_dword v0, v79, s[12:15], s34 offen
s_barrier
s_waitcnt lgkmcnt(2)
v_smfmac_f32_16x16x64_bf16 v[44:47], v[64:67], a[80:87], v3
ds_read_b64_tr_b16 v[56:57], v2 offset:6144
v_smfmac_f32_16x16x64_bf16 v[48:51], v[64:67], a[224:231], v3
ds_read_b64_tr_b16 v[58:59], v2 offset:6208
v_smfmac_f32_16x16x64_bf16 v[52:55], v[64:67], v[192:199], v3
v_lshlrev_b32 v79, 2, v1
s_add_u32 s34, s55, 4096
buffer_load_dword v0, v79, s[12:15], s34 offen
s_add_u32 s35, s20, 3
s_min_u32 s35, s35, 63
s_lshr_b32 s35, s35, 2
s_lshl_b32 s35, s35, 7
s_add_u32 s35, s35, 77596672
buffer_load_dword v10, off, s[12:15], s35 sc1
s_waitcnt lgkmcnt(2)
v_smfmac_f32_16x16x64_bf16 v[44:47], v[68:71], a[88:95], v3
ds_read_b64_tr_b16 v[60:61], v2 offset:6656
v_smfmac_f32_16x16x64_bf16 v[48:51], v[68:71], a[232:239], v3
ds_read_b64_tr_b16 v[62:63], v2 offset:6720
v_smfmac_f32_16x16x64_bf16 v[52:55], v[68:71], v[200:207], v3
s_waitcnt lgkmcnt(2)
v_smfmac_f32_16x16x64_bf16 v[44:47], v[56:59], a[96:103], v3
ds_read_b64_tr_b16 v[64:65], v2 offset:7168
v_smfmac_f32_16x16x64_bf16 v[48:51], v[56:59], a[240:247], v3
ds_read_b64_tr_b16 v[66:67], v2 offset:7232
v_smfmac_f32_16x16x64_bf16 v[52:55], v[56:59], v[208:215], v3
s_waitcnt lgkmcnt(2)
v_smfmac_f32_16x16x64_bf16 v[44:47], v[60:63], a[104:111], v3
ds_read_b64_tr_b16 v[68:69], v2 offset:7680
v_smfmac_f32_16x16x64_bf16 v[48:51], v[60:63], a[248:255], v3
ds_read_b64_tr_b16 v[70:71], v2 offset:7744
v_smfmac_f32_16x16x64_bf16 v[52:55], v[60:63], v[216:223], v3
s_barrier
s_waitcnt lgkmcnt(2)
v_smfmac_f32_16x16x64_bf16 v[44:47], v[64:67], a[112:119], v3
ds_read_b64_tr_b16 v[56:57], v2 offset:8192
v_smfmac_f32_16x16x64_bf16 v[48:51], v[64:67], v[80:87], v3
ds_read_b64_tr_b16 v[58:59], v2 offset:8256
s_waitcnt lgkmcnt(2)
v_smfmac_f32_16x16x64_bf16 v[44:47], v[68:71], a[120:127], v3
ds_read_b64_tr_b16 v[60:61], v2 offset:8704
v_smfmac_f32_16x16x64_bf16 v[48:51], v[68:71], v[88:95], v3
ds_read_b64_tr_b16 v[62:63], v2 offset:8768
s_waitcnt lgkmcnt(2)
v_smfmac_f32_16x16x64_bf16 v[44:47], v[56:59], a[128:135], v3
v_smfmac_f32_16x16x64_bf16 v[48:51], v[56:59], v[96:103], v3
s_waitcnt lgkmcnt(0)
v_smfmac_f32_16x16x64_bf16 v[44:47], v[60:63], a[136:143], v3
v_smfmac_f32_16x16x64_bf16 v[48:51], v[60:63], v[104:111], v3
v_smfmac_f32_16x16x64_bf16 v[52:55], v[64:67], v[224:231], v3
v_cvt_pk_bf16_f32 v72, v44, v45
v_cvt_pk_bf16_f32 v73, v46, v47
ds_write_b64 v14, v[72:73]
v_smfmac_f32_16x16x64_bf16 v[52:55], v[68:71], v[232:239], v3
v_cvt_pk_bf16_f32 v74, v48, v49
v_cvt_pk_bf16_f32 v75, v50, v51
ds_write_b64 v14, v[74:75] offset:2048
v_smfmac_f32_16x16x64_bf16 v[52:55], v[56:59], v[240:247], v3
v_smfmac_f32_16x16x64_bf16 v[52:55], v[60:63], v[248:255], v3
s_waitcnt lgkmcnt(0)
s_barrier
s_cmp_eq_u32 s20, 63
s_cbranch_scc1 L_last_w3e
s_nop 3
v_cvt_pk_bf16_f32 v52, v52, v53
v_cvt_pk_bf16_f32 v53, v54, v55
buffer_store_dwordx2 v[52:53], v13, s[12:15], s24 offen sc1
s_add_u32 s32, s20, 1
s_and_b32 s33, s32, 1
s_bfe_u32 s34, s32, 0x10001
s_lshl_b32 s34, s34, 16
s_or_b32 s35, s33, s34
s_and_b32 s33, s32, 3
s_lshl_b32 s33, s33, 14
s_add_u32 s25, s33, s29
s_sub_u32 s26, s25, 147456
s_add_u32 s33, s20, 3
s_and_b32 s33, s33, 3
s_lshl_b32 s33, s33, 14
s_add_u32 s27, s33, s29
s_barrier
ds_read_b128 v[60:63], v1 offset:14336
ds_read_b128 v[64:67], v1 offset:15360
ds_read_b128 v[56:59], v1 offset:13312
v_mov_b32 v15, s35
s_waitcnt lgkmcnt(1)
v_max3_f32 v72, v60, v61, v62
v_max3_f32 v73, v63, v64, v65
v_max3_f32 v72, v72, v66, v67
s_waitcnt lgkmcnt(0)
v_max3_f32 v73, v73, v56, v57
v_max3_f32 v72, v72, v58, v59
v_max_f32 v72, v72, v73
v_mov_b32 v73, v72
s_nop 1
v_permlane32_swap_b32 v72, v73
v_max_f32 v72, v72, v73
v_mov_b32 v73, v72
s_nop 1
v_permlane16_swap_b32 v72, v73
v_max_f32 v72, v72, v73
v_mul_f32 v73, s47, v72
v_fma_f32 v60, v60, s47, -v73
v_fma_f32 v61, v61, s47, -v73
v_fma_f32 v62, v62, s47, -v73
v_fma_f32 v63, v63, s47, -v73
v_fma_f32 v64, v64, s47, -v73
v_fma_f32 v65, v65, s47, -v73
v_fma_f32 v66, v66, s47, -v73
v_fma_f32 v67, v67, s47, -v73
v_exp_f32 v60, v60
v_exp_f32 v61, v61
v_exp_f32 v62, v62
v_cvt_pk_bf16_f32 v20, v60, v61
v_exp_f32 v63, v63
v_exp_f32 v64, v64
v_cvt_pk_bf16_f32 v21, v62, v63
v_exp_f32 v65, v65
v_exp_f32 v66, v66
v_cvt_pk_bf16_f32 v22, v64, v65
v_exp_f32 v67, v67
v_fma_f32 v56, v56, s47, -v73
v_fma_f32 v57, v57, s47, -v73
v_fma_f32 v58, v58, s47, -v73
v_fma_f32 v59, v59, s47, -v73
v_cvt_pk_bf16_f32 v23, v66, v67
s_waitcnt vmcnt(6)
s_nop 0
v_mfma_f32_16x16x32_bf16 v[44:47], v[36:39], v[20:23], 0
v_mfma_f32_16x16x32_bf16 v[48:51], v[40:43], v[20:23], 0
v_exp_f32 v56, v56
v_exp_f32 v57, v57
v_exp_f32 v58, v58
v_exp_f32 v59, v59
v_add_f32 v74, v60, v61
v_add_f32 v75, v62, v63
v_cvt_pk_bf16_f32 v24, v56, v57
v_cvt_pk_bf16_f32 v25, v58, v59
v_cndmask_b32 v26, 0, v24, s[52:53]
v_cndmask_b32 v27, 0, v25, s[52:53]
v_cndmask_b32 v28, v24, 0, s[52:53]
v_cndmask_b32 v29, v25, 0, s[52:53]
v_mfma_f32_16x16x16_bf16 v[44:47], v[52:53], v[26:27], v[44:47]
v_mfma_f32_16x16x16_bf16 v[48:51], v[52:53], v[28:29], v[48:51]
ds_read_b128 v[20:23], v5 offset:30720
ds_read_b128 v[24:27], v5 offset:31744
ds_read_b128 v[28:31], v6 offset:18432
ds_read_b128 v[32:35], v6 offset:19456
v_add_f32 v74, v74, v64
v_add_f32 v75, v75, v65
v_add_f32 v74, v74, v66
v_add_f32 v75, v75, v67
v_add_f32 v73, v56, v57
v_add_f32 v72, v58, v59
v_add_f32 v74, v74, v75
v_add_f32 v73, v73, v72
v_fma_f32 v74, v73, 0.5, v74
v_mov_b32 v75, v74
s_nop 1
v_permlane32_swap_b32 v74, v75
v_add_f32 v74, v74, v75
v_mov_b32 v75, v74
s_nop 1
v_permlane16_swap_b32 v74, v75
v_add_f32 v74, v74, v75
v_rcp_f32 v74, v74
ds_read_b128 v[56:59], v4 offset:6144
ds_read_b128 v[60:63], v4 offset:7168
ds_read_b128 v[64:67], v4 offset:43008
ds_read_b128 v[68:71], v4 offset:44032
v_pk_mul_f32 v[44:45], v[44:45], v[74:75] op_sel_hi:[1,0]
v_pk_mul_f32 v[48:49], v[48:49], v[74:75] op_sel_hi:[1,0]
v_pk_mul_f32 v[46:47], v[46:47], v[74:75] op_sel_hi:[1,0]
v_pk_mul_f32 v[50:51], v[50:51], v[74:75] op_sel_hi:[1,0]
v_cvt_pk_bf16_f32 v76, v44, v45
v_cvt_pk_bf16_f32 v77, v46, v47
v_cvt_pk_bf16_f32 v78, v48, v49
v_cvt_pk_bf16_f32 v79, v50, v51
ds_write_b128 v1, v[76:79] offset:12288
v_mov_b32 v44, 0
v_mov_b32 v45, 0
v_mov_b32 v46, 0
v_mov_b32 v47, 0
v_mov_b32 v48, 0
v_mov_b32 v49, 0
v_mov_b32 v50, 0
v_mov_b32 v51, 0
s_waitcnt lgkmcnt(0)
s_barrier
ds_read_b128 v[36:39], v1 offset:9216
ds_read_b128 v[40:43], v1 offset:10240
ds_read_b128 v[52:55], v1 offset:11264
ds_read_b128 v[76:79], v1 offset:12288
s_waitcnt lgkmcnt(3)
v_smfmac_f32_16x16x64_bf16 v[44:47], v[36:39], v[56:63], v3
ds_read_b128 v[56:59], v4 offset:14336
ds_read_b128 v[60:63], v4 offset:15360
s_waitcnt lgkmcnt(4)
v_smfmac_f32_16x16x64_bf16 v[44:47], v[40:43], v[64:71], v3
ds_read_b128 v[64:67], v5 offset:2048
ds_read_b128 v[68:71], v5 offset:3072
s_waitcnt lgkmcnt(5)
v_smfmac_f32_16x16x64_bf16 v[44:47], v[52:55], v[20:27], v3
ds_read_b128 v[20:23], v5 offset:38912
ds_read_b128 v[24:27], v5 offset:39936
s_waitcnt lgkmcnt(6)
v_smfmac_f32_16x16x64_bf16 v[44:47], v[76:79], v[28:35], v3
ds_read_b128 v[28:31], v6 offset:26624
ds_read_b128 v[32:35], v6 offset:27648
s_waitcnt lgkmcnt(6)
v_smfmac_f32_16x16x64_bf16 v[48:51], v[36:39], v[56:63], v3
ds_read_b128 v[56:59], v4 offset:22528
ds_read_b128 v[60:63], v4 offset:23552
s_nop 1
v_cvt_pk_bf16_f32 v72, v44, v45
v_cvt_pk_bf16_f32 v73, v46, v47
s_waitcnt lgkmcnt(6)
v_smfmac_f32_16x16x64_bf16 v[48:51], v[40:43], v[64:71], v3
ds_read_b128 v[64:67], v5 offset:10240
ds_read_b128 v[68:71], v5 offset:11264
v_and_or_b32 v72, v72, s46, v15
s_add_u32 s36, s28, 49152
buffer_store_dwordx2 v[72:73], v7, s[12:15], s36 offen
s_waitcnt lgkmcnt(6)
v_smfmac_f32_16x16x64_bf16 v[48:51], v[52:55], v[20:27], v3
ds_read_b128 v[20:23], v5 offset:47104
ds_read_b128 v[24:27], v5 offset:48128
v_mov_b32 v44, 0
v_mov_b32 v45, 0
s_waitcnt lgkmcnt(6)
v_smfmac_f32_16x16x64_bf16 v[48:51], v[76:79], v[28:35], v3
ds_read_b128 v[28:31], v6 offset:34816
ds_read_b128 v[32:35], v6 offset:35840
v_mov_b32 v46, 0
v_mov_b32 v47, 0
s_waitcnt lgkmcnt(6)
s_nop 0
v_smfmac_f32_16x16x64_bf16 v[44:47], v[36:39], v[56:63], v3
ds_read_b128 v[56:59], v4 offset:30720
ds_read_b128 v[60:63], v4 offset:31744
v_cvt_pk_bf16_f32 v74, v48, v49
v_cvt_pk_bf16_f32 v75, v50, v51
s_waitcnt lgkmcnt(6)
v_smfmac_f32_16x16x64_bf16 v[44:47], v[40:43], v[64:71], v3
ds_read_b128 v[64:67], v5 offset:18432
ds_read_b128 v[68:71], v5 offset:19456
v_and_or_b32 v74, v74, s46, v15
s_add_u32 s36, s28, 114688
buffer_store_dwordx2 v[74:75], v7, s[12:15], s36 offen
s_waitcnt lgkmcnt(6)
v_smfmac_f32_16x16x64_bf16 v[44:47], v[52:55], v[20:27], v3
ds_read_b128 v[20:23], v6 offset:6144
ds_read_b128 v[24:27], v6 offset:7168
v_mov_b32 v48, 0
v_mov_b32 v49, 0
s_waitcnt lgkmcnt(6)
v_smfmac_f32_16x16x64_bf16 v[44:47], v[76:79], v[28:35], v3
ds_read_b128 v[28:31], v6 offset:43008
ds_read_b128 v[32:35], v6 offset:44032
v_mov_b32 v50, 0
v_mov_b32 v51, 0
s_waitcnt lgkmcnt(6)
s_nop 0
v_smfmac_f32_16x16x64_bf16 v[48:51], v[36:39], v[56:63], v3
ds_read_b128 v[56:59], v4 offset:28672
ds_read_b128 v[60:63], v4 offset:29696
v_cvt_pk_bf16_f32 v72, v44, v45
v_cvt_pk_bf16_f32 v73, v46, v47
s_waitcnt lgkmcnt(6)
v_smfmac_f32_16x16x64_bf16 v[48:51], v[40:43], v[64:71], v3
ds_read_b128 v[64:67], v5 offset:16384
ds_read_b128 v[68:71], v5 offset:17408
v_and_or_b32 v72, v72, s46, v15
s_add_u32 s36, s28, 180224
buffer_store_dwordx2 v[72:73], v7, s[12:15], s36 offen
s_waitcnt lgkmcnt(6)
v_smfmac_f32_16x16x64_bf16 v[48:51], v[52:55], v[20:27], v3
ds_read_b128 v[20:23], v6 offset:4096
ds_read_b128 v[24:27], v6 offset:5120
v_mov_b32 v44, 0
v_mov_b32 v45, 0
s_waitcnt lgkmcnt(6)
v_smfmac_f32_16x16x64_bf16 v[48:51], v[76:79], v[28:35], v3
ds_read_b128 v[28:31], v6 offset:40960
ds_read_b128 v[32:35], v6 offset:41984
v_mov_b32 v46, 0
v_mov_b32 v47, 0
s_waitcnt lgkmcnt(6)
s_nop 0
v_smfmac_f32_16x16x64_bf16 v[44:47], v[36:39], v[56:63], v3
s_nop 0
v_cvt_pk_bf16_f32 v74, v48, v49
v_cvt_pk_bf16_f32 v75, v50, v51
s_waitcnt lgkmcnt(4)
v_smfmac_f32_16x16x64_bf16 v[44:47], v[40:43], v[64:71], v3
v_and_or_b32 v74, v74, s46, v15
s_add_u32 s36, s28, 245760
buffer_store_dwordx2 v[74:75], v7, s[12:15], s36 offen
s_waitcnt lgkmcnt(2)
v_smfmac_f32_16x16x64_bf16 v[44:47], v[52:55], v[20:27], v3
s_waitcnt lgkmcnt(0)
v_smfmac_f32_16x16x64_bf16 v[44:47], v[76:79], v[28:35], v3
s_nop 7
v_cvt_pk_bf16_f32 v72, v44, v45
v_cvt_pk_bf16_f32 v73, v46, v47
v_and_or_b32 v72, v72, s46, v15
s_add_u32 s36, s28, 229376
buffer_store_dwordx2 v[72:73], v7, s[12:15], s36 offen
buffer_load_dwordx4 v[20:23], v8, s[12:15], s28 offen offset:0 sc1
buffer_load_dwordx4 v[24:27], v8, s[12:15], s28 offen offset:1024 sc1
buffer_load_dwordx4 v[28:31], v8, s[12:15], s28 offen offset:2048 sc1
buffer_load_dwordx4 v[32:35], v8, s[12:15], s28 offen offset:3072 sc1
s_nop 15
s_nop 15
s_nop 7
buffer_load_dwordx4 v[56:59], v8, s[12:15], s28 offen offset:0 sc1
buffer_load_dwordx4 v[60:63], v8, s[12:15], s28 offen offset:1024 sc1
buffer_load_dwordx4 v[64:67], v8, s[12:15], s28 offen offset:2048 sc1
buffer_load_dwordx4 v[68:71], v8, s[12:15], s28 offen offset:3072 sc1
s_waitcnt vmcnt(4)
v_xor_b32 v78, v20, v15
v_bitop3_b32 v78, v78, v24, v15 bitop3:0xf6
v_bitop3_b32 v78, v78, v28, v15 bitop3:0xf6
v_bitop3_b32 v78, v78, v32, v15 bitop3:0xf6
v_and_b32 v78, 0x10001, v78
v_cmp_ne_u32 vcc, 0, v78
s_cbranch_vccz L_rk_55
buffer_load_dwordx4 v[20:23], v8, s[12:15], s28 offen offset:0 sc1
buffer_load_dwordx4 v[24:27], v8, s[12:15], s28 offen offset:1024 sc1
buffer_load_dwordx4 v[28:31], v8, s[12:15], s28 offen offset:2048 sc1
buffer_load_dwordx4 v[32:35], v8, s[12:15], s28 offen offset:3072 sc1
L_rp_53:
s_waitcnt vmcnt(4)
v_xor_b32 v78, v56, v15
v_bitop3_b32 v78, v78, v60, v15 bitop3:0xf6
v_bitop3_b32 v78, v78, v64, v15 bitop3:0xf6
v_bitop3_b32 v78, v78, v68, v15 bitop3:0xf6
v_and_b32 v78, 0x10001, v78
v_cmp_ne_u32 vcc, 0, v78
s_cbranch_vccz L_rk_56
buffer_load_dwordx4 v[56:59], v8, s[12:15], s28 offen offset:0 sc1
buffer_load_dwordx4 v[60:63], v8, s[12:15], s28 offen offset:1024 sc1
buffer_load_dwordx4 v[64:67], v8, s[12:15], s28 offen offset:2048 sc1
buffer_load_dwordx4 v[68:71], v8, s[12:15], s28 offen offset:3072 sc1
s_waitcnt vmcnt(4)
v_xor_b32 v78, v20, v15
v_bitop3_b32 v78, v78, v24, v15 bitop3:0xf6
v_bitop3_b32 v78, v78, v28, v15 bitop3:0xf6
v_bitop3_b32 v78, v78, v32, v15 bitop3:0xf6
v_and_b32 v78, 0x10001, v78
v_cmp_ne_u32 vcc, 0, v78
s_cbranch_vccz L_rk_55
buffer_load_dwordx4 v[20:23], v8, s[12:15], s28 offen offset:0 sc1
buffer_load_dwordx4 v[24:27], v8, s[12:15], s28 offen offset:1024 sc1
buffer_load_dwordx4 v[28:31], v8, s[12:15], s28 offen offset:2048 sc1
buffer_load_dwordx4 v[32:35], v8, s[12:15], s28 offen offset:3072 sc1
s_add_u32 s44, s44, 1
s_cmp_gt_u32 s44, 1000000
s_cbranch_scc1 L_abort
s_branch L_rp_53
L_rk_55:
v_mfma_f32_16x16x32_bf16 v[52:55], v[16:19], v[20:23], 0
v_mfma_f32_16x16x32_bf16 v[52:55], v[16:19], v[24:27], v[52:55]
v_mfma_f32_16x16x32_bf16 v[52:55], v[16:19], v[28:31], v[52:55]
v_mfma_f32_16x16x32_bf16 v[52:55], v[16:19], v[32:35], v[52:55]
s_branch L_rd_54
L_rk_56:
v_mfma_f32_16x16x32_bf16 v[52:55], v[16:19], v[56:59], 0
v_mfma_f32_16x16x32_bf16 v[52:55], v[16:19], v[60:63], v[52:55]
v_mfma_f32_16x16x32_bf16 v[52:55], v[16:19], v[64:67], v[52:55]
v_mfma_f32_16x16x32_bf16 v[52:55], v[16:19], v[68:71], v[52:55]
L_rd_54:
s_nop 7
v_add_f32_dpp v52, v52, v52 row_ror:8 row_mask:0xf bank_mask:0xf
v_add_f32_dpp v53, v53, v53 row_ror:8 row_mask:0xf bank_mask:0xf
v_add_f32_dpp v54, v54, v54 row_ror:8 row_mask:0xf bank_mask:0xf
v_add_f32_dpp v55, v55, v55 row_ror:8 row_mask:0xf bank_mask:0xf
v_cvt_pk_bf16_f32 v76, v52, v53
v_cvt_pk_bf16_f32 v77, v54, v55
s_mov_b64 exec, s[50:51]
v_min_u32 v76, -2, v76
buffer_store_dwordx2 v[76:77], v9, s[12:15], s25 offen
v_mov_b32 v78, -1
v_mov_b32 v79, -1
buffer_store_dwordx2 v[78:79], v9, s[12:15], s27 offen
s_mov_b64 exec, -1
s_waitcnt vmcnt(2)
L_nt_52:
L_pre_w3e:
v_mov_b32 v44, 0
v_mov_b32 v48, 0
v_mov_b32 v52, 0
v_mov_b32 v45, 0
v_mov_b32 v49, 0
v_mov_b32 v53, 0
v_mov_b32 v46, 0
v_mov_b32 v50, 0
v_mov_b32 v54, 0
v_mov_b32 v47, 0
v_mov_b32 v51, 0
v_mov_b32 v55, 0
s_add_u32 s20, s20, 1
s_add_u32 s21, s21, 262144
s_add_u32 s22, s22, 262144
s_add_u32 s23, s23, 65536
s_add_u32 s24, s24, 65536
s_add_u32 s33, s20, 2
s_min_u32 s33, s33, 63
s_lshl_b32 s33, s33, 18
s_lshl_b32 s34, s10, 13
s_add_u32 s33, s33, s34
s_add_u32 s54, s33, 16187392
s_add_u32 s55, s33, 32964608
s_barrier
s_branch L_step_w3e
L_last_w3e:
s_nop 3
v_cvt_pk_bf16_f32 v52, v52, v53
v_cvt_pk_bf16_f32 v53, v54, v55
buffer_store_dwordx2 v[52:53], v13, s[12:15], s24 offen sc1
s_waitcnt vmcnt(0)
s_barrier
s_branch L_finish
L_grt_48:
L_glp_58:
s_add_u32 s45, s45, 1
s_cmp_gt_u32 s45, 1000000
s_cbranch_scc1 L_abort
s_waitcnt lgkmcnt(0)
s_add_u32 s33, s26, 4096
buffer_load_dwordx4 v[20:23], v1, s[12:15], s33 offen sc1
buffer_load_dwordx4 v[24:27], v1, s[12:15], s33 offen offset:1024 sc1
s_waitcnt vmcnt(0)
v_max3_u32 v78, v20, v22, v24
v_max_u32 v78, v78, v26
v_cmp_eq_u32 vcc, -1, v78
s_cbranch_vccnz L_glp_58
ds_write_b128 v1, v[20:23] offset:4096
ds_write_b128 v1, v[24:27] offset:5120
s_waitcnt lgkmcnt(0)
s_branch L_gbk_49
L_kvr_50:
s_add_u32 s35, s20, 2
s_min_u32 s35, s35, 63
s_lshr_b32 s35, s35, 2
s_lshl_b32 s35, s35, 7
s_add_u32 s35, s35, 77596672
L_kvl_59:
buffer_load_dword v10, off, s[12:15], s35 sc1
s_waitcnt vmcnt(0)
v_readfirstlane_b32 s34, v10
s_add_u32 s45, s45, 1
s_cmp_gt_u32 s45, 4000000
s_cbranch_scc1 L_abort
s_sleep 1
s_cmp_ge_u32 s34, 64
s_cbranch_scc0 L_kvl_59
s_branch L_kvb_51
L_step_w3o:
ds_read_b64_tr_b16 v[56:57], v2 offset:0
ds_read_b64_tr_b16 v[58:59], v2 offset:64
ds_read_b64_tr_b16 v[60:61], v2 offset:512
ds_read_b64_tr_b16 v[62:63], v2 offset:576
s_waitcnt lgkmcnt(2)
v_smfmac_f32_16x16x64_bf16 v[44:47], v[56:59], a[0:7], v3
ds_read_b64_tr_b16 v[64:65], v2 offset:1024
v_smfmac_f32_16x16x64_bf16 v[48:51], v[56:59], a[144:151], v3
ds_read_b64_tr_b16 v[66:67], v2 offset:1088
v_smfmac_f32_16x16x64_bf16 v[52:55], v[56:59], v[112:119], v3
s_add_u32 s33, s26, 4096
buffer_load_dwordx4 v[20:23], v1, s[12:15], s33 offen sc1
buffer_load_dwordx4 v[24:27], v1, s[12:15], s33 offen offset:1024 sc1
s_waitcnt lgkmcnt(2)
v_smfmac_f32_16x16x64_bf16 v[44:47], v[60:63], a[8:15], v3
ds_read_b64_tr_b16 v[68:69], v2 offset:1536
v_smfmac_f32_16x16x64_bf16 v[48:51], v[60:63], a[152:159], v3
ds_read_b64_tr_b16 v[70:71], v2 offset:1600
buffer_load_dwordx4 v[36:39], v11, s[12:15], s22 offen offset:0 sc1
v_smfmac_f32_16x16x64_bf16 v[52:55], v[60:63], v[120:127], v3
s_waitcnt lgkmcnt(2)
v_smfmac_f32_16x16x64_bf16 v[44:47], v[64:67], a[16:23], v3
ds_read_b64_tr_b16 v[56:57], v2 offset:2048
v_smfmac_f32_16x16x64_bf16 v[48:51], v[64:67], a[160:167], v3
ds_read_b64_tr_b16 v[58:59], v2 offset:2112
buffer_load_dwordx4 v[40:43], v11, s[12:15], s22 offen offset:256 sc1
v_smfmac_f32_16x16x64_bf16 v[52:55], v[64:67], v[128:135], v3
s_waitcnt lgkmcnt(2)
v_smfmac_f32_16x16x64_bf16 v[44:47], v[68:71], a[24:31], v3
ds_read_b64_tr_b16 v[60:61], v2 offset:2560
v_smfmac_f32_16x16x64_bf16 v[48:51], v[68:71], a[168:175], v3
ds_read_b64_tr_b16 v[62:63], v2 offset:2624
v_smfmac_f32_16x16x64_bf16 v[52:55], v[68:71], v[136:143], v3
s_waitcnt lgkmcnt(2)
v_smfmac_f32_16x16x64_bf16 v[44:47], v[56:59], a[32:39], v3
ds_read_b64_tr_b16 v[64:65], v2 offset:3072
s_waitcnt vmcnt(2)
v_max3_u32 v78, v20, v22, v24
v_smfmac_f32_16x16x64_bf16 v[48:51], v[56:59], a[176:183], v3
ds_read_b64_tr_b16 v[66:67], v2 offset:3136
v_max_u32 v78, v78, v26
v_cmp_eq_u32 vcc, -1, v78
v_smfmac_f32_16x16x64_bf16 v[52:55], v[56:59], v[144:151], v3
ds_write_b128 v1, v[20:23] offset:4096
ds_write_b128 v1, v[24:27] offset:5120
s_cbranch_vccnz L_grt_60
L_gbk_61:
s_waitcnt lgkmcnt(4)
v_smfmac_f32_16x16x64_bf16 v[44:47], v[60:63], a[40:47], v3
ds_read_b64_tr_b16 v[68:69], v2 offset:3584
v_smfmac_f32_16x16x64_bf16 v[48:51], v[60:63], a[184:191], v3
ds_read_b64_tr_b16 v[70:71], v2 offset:3648
v_smfmac_f32_16x16x64_bf16 v[52:55], v[60:63], v[152:159], v3
s_waitcnt lgkmcnt(2)
s_barrier
v_smfmac_f32_16x16x64_bf16 v[44:47], v[64:67], a[48:55], v3
ds_read_b64_tr_b16 v[56:57], v2 offset:4096
v_smfmac_f32_16x16x64_bf16 v[48:51], v[64:67], a[192:199], v3
ds_read_b64_tr_b16 v[58:59], v2 offset:4160
v_smfmac_f32_16x16x64_bf16 v[52:55], v[64:67], v[160:167], v3
s_waitcnt lgkmcnt(2)
v_smfmac_f32_16x16x64_bf16 v[44:47], v[68:71], a[56:63], v3
ds_read_b64_tr_b16 v[60:61], v2 offset:4608
v_smfmac_f32_16x16x64_bf16 v[48:51], v[68:71], a[200:207], v3
ds_read_b64_tr_b16 v[62:63], v2 offset:4672
v_smfmac_f32_16x16x64_bf16 v[52:55], v[68:71], v[168:175], v3
v_readfirstlane_b32 s34, v10
s_nop 0
s_cmp_ge_u32 s34, 64
s_cbranch_scc0 L_kvr_62
L_kvb_63:
v_lshlrev_b32 v79, 2, v1
s_add_u32 s34, s54, 0
buffer_load_dword v0, v79, s[12:15], s34 offen
s_waitcnt lgkmcnt(2)
v_smfmac_f32_16x16x64_bf16 v[44:47], v[56:59], a[64:71], v3
ds_read_b64_tr_b16 v[64:65], v2 offset:5120
v_smfmac_f32_16x16x64_bf16 v[48:51], v[56:59], a[208:215], v3
ds_read_b64_tr_b16 v[66:67], v2 offset:5184
v_smfmac_f32_16x16x64_bf16 v[52:55], v[56:59], v[176:183], v3
v_lshlrev_b32 v79, 2, v1
s_add_u32 s34, s54, 4096
buffer_load_dword v0, v79, s[12:15], s34 offen
s_waitcnt lgkmcnt(2)
v_smfmac_f32_16x16x64_bf16 v[44:47], v[60:63], a[72:79], v3
ds_read_b64_tr_b16 v[68:69], v2 offset:5632
v_smfmac_f32_16x16x64_bf16 v[48:51], v[60:63], a[216:223], v3
ds_read_b64_tr_b16 v[70:71], v2 offset:5696
v_smfmac_f32_16x16x64_bf16 v[52:55], v[60:63], v[184:191], v3
v_lshlrev_b32 v79, 2, v1
s_add_u32 s34, s55, 0
buffer_load_dword v0, v79, s[12:15], s34 offen
s_barrier
s_waitcnt lgkmcnt(2)
v_smfmac_f32_16x16x64_bf16 v[44:47], v[64:67], a[80:87], v3
ds_read_b64_tr_b16 v[56:57], v2 offset:6144
v_smfmac_f32_16x16x64_bf16 v[48:51], v[64:67], a[224:231], v3
ds_read_b64_tr_b16 v[58:59], v2 offset:6208
v_smfmac_f32_16x16x64_bf16 v[52:55], v[64:67], v[192:199], v3
v_lshlrev_b32 v79, 2, v1
s_add_u32 s34, s55, 4096
buffer_load_dword v0, v79, s[12:15], s34 offen
s_add_u32 s35, s20, 3
s_min_u32 s35, s35, 63
s_lshr_b32 s35, s35, 2
s_lshl_b32 s35, s35, 7
s_add_u32 s35, s35, 77596672
buffer_load_dword v10, off, s[12:15], s35 sc1
s_waitcnt lgkmcnt(2)
v_smfmac_f32_16x16x64_bf16 v[44:47], v[68:71], a[88:95], v3
ds_read_b64_tr_b16 v[60:61], v2 offset:6656
v_smfmac_f32_16x16x64_bf16 v[48:51], v[68:71], a[232:239], v3
ds_read_b64_tr_b16 v[62:63], v2 offset:6720
v_smfmac_f32_16x16x64_bf16 v[52:55], v[68:71], v[200:207], v3
s_waitcnt lgkmcnt(2)
v_smfmac_f32_16x16x64_bf16 v[44:47], v[56:59], a[96:103], v3
ds_read_b64_tr_b16 v[64:65], v2 offset:7168
v_smfmac_f32_16x16x64_bf16 v[48:51], v[56:59], a[240:247], v3
ds_read_b64_tr_b16 v[66:67], v2 offset:7232
v_smfmac_f32_16x16x64_bf16 v[52:55], v[56:59], v[208:215], v3
s_waitcnt lgkmcnt(2)
v_smfmac_f32_16x16x64_bf16 v[44:47], v[60:63], a[104:111], v3
ds_read_b64_tr_b16 v[68:69], v2 offset:7680
v_smfmac_f32_16x16x64_bf16 v[48:51], v[60:63], a[248:255], v3
ds_read_b64_tr_b16 v[70:71], v2 offset:7744
v_smfmac_f32_16x16x64_bf16 v[52:55], v[60:63], v[216:223], v3
s_barrier
s_waitcnt lgkmcnt(2)
v_smfmac_f32_16x16x64_bf16 v[44:47], v[64:67], a[112:119], v3
ds_read_b64_tr_b16 v[56:57], v2 offset:8192
v_smfmac_f32_16x16x64_bf16 v[48:51], v[64:67], v[80:87], v3
ds_read_b64_tr_b16 v[58:59], v2 offset:8256
s_waitcnt lgkmcnt(2)
v_smfmac_f32_16x16x64_bf16 v[44:47], v[68:71], a[120:127], v3
ds_read_b64_tr_b16 v[60:61], v2 offset:8704
v_smfmac_f32_16x16x64_bf16 v[48:51], v[68:71], v[88:95], v3
ds_read_b64_tr_b16 v[62:63], v2 offset:8768
s_waitcnt lgkmcnt(2)
v_smfmac_f32_16x16x64_bf16 v[44:47], v[56:59], a[128:135], v3
v_smfmac_f32_16x16x64_bf16 v[48:51], v[56:59], v[96:103], v3
s_waitcnt lgkmcnt(0)
v_smfmac_f32_16x16x64_bf16 v[44:47], v[60:63], a[136:143], v3
v_smfmac_f32_16x16x64_bf16 v[48:51], v[60:63], v[104:111], v3
v_smfmac_f32_16x16x64_bf16 v[52:55], v[64:67], v[224:231], v3
v_cvt_pk_bf16_f32 v72, v44, v45
v_cvt_pk_bf16_f32 v73, v46, v47
ds_write_b64 v14, v[72:73]
v_smfmac_f32_16x16x64_bf16 v[52:55], v[68:71], v[232:239], v3
v_cvt_pk_bf16_f32 v74, v48, v49
v_cvt_pk_bf16_f32 v75, v50, v51
ds_write_b64 v14, v[74:75] offset:2048
v_smfmac_f32_16x16x64_bf16 v[52:55], v[56:59], v[240:247], v3
v_smfmac_f32_16x16x64_bf16 v[52:55], v[60:63], v[248:255], v3
s_waitcnt lgkmcnt(0)
s_barrier
s_cmp_eq_u32 s20, 63
s_cbranch_scc1 L_last_w3o
s_nop 3
v_cvt_pk_bf16_f32 v52, v52, v53
v_cvt_pk_bf16_f32 v53, v54, v55
buffer_store_dwordx2 v[52:53], v13, s[12:15], s24 offen sc1
s_add_u32 s32, s20, 1
s_and_b32 s33, s32, 1
s_bfe_u32 s34, s32, 0x10001
s_lshl_b32 s34, s34, 16
s_or_b32 s35, s33, s34
s_and_b32 s33, s32, 3
s_lshl_b32 s33, s33, 14
s_add_u32 s25, s33, s29
s_sub_u32 s26, s25, 147456
s_add_u32 s33, s20, 3
s_and_b32 s33, s33, 3
s_lshl_b32 s33, s33, 14
s_add_u32 s27, s33, s29
s_barrier
ds_read_b128 v[60:63], v1 offset:14336
ds_read_b128 v[64:67], v1 offset:15360
ds_read_b128 v[56:59], v1 offset:13312
v_mov_b32 v15, s35
s_waitcnt lgkmcnt(1)
v_max3_f32 v72, v60, v61, v62
v_max3_f32 v73, v63, v64, v65
v_max3_f32 v72, v72, v66, v67
s_waitcnt lgkmcnt(0)
v_max3_f32 v73, v73, v56, v57
v_max3_f32 v72, v72, v58, v59
v_max_f32 v72, v72, v73
v_mov_b32 v73, v72
s_nop 1
v_permlane32_swap_b32 v72, v73
v_max_f32 v72, v72, v73
v_mov_b32 v73, v72
s_nop 1
v_permlane16_swap_b32 v72, v73
v_max_f32 v72, v72, v73
v_mul_f32 v73, s47, v72
v_fma_f32 v60, v60, s47, -v73
v_fma_f32 v61, v61, s47, -v73
v_fma_f32 v62, v62, s47, -v73
v_fma_f32 v63, v63, s47, -v73
v_fma_f32 v64, v64, s47, -v73
v_fma_f32 v65, v65, s47, -v73
v_fma_f32 v66, v66, s47, -v73
v_fma_f32 v67, v67, s47, -v73
v_exp_f32 v60, v60
v_exp_f32 v61, v61
v_exp_f32 v62, v62
v_cvt_pk_bf16_f32 v20, v60, v61
v_exp_f32 v63, v63
v_exp_f32 v64, v64
v_cvt_pk_bf16_f32 v21, v62, v63
v_exp_f32 v65, v65
v_exp_f32 v66, v66
v_cvt_pk_bf16_f32 v22, v64, v65
v_exp_f32 v67, v67
v_fma_f32 v56, v56, s47, -v73
v_fma_f32 v57, v57, s47, -v73
v_fma_f32 v58, v58, s47, -v73
v_fma_f32 v59, v59, s47, -v73
v_cvt_pk_bf16_f32 v23, v66, v67
s_waitcnt vmcnt(6)
s_nop 0
v_mfma_f32_16x16x32_bf16 v[44:47], v[36:39], v[20:23], 0
v_mfma_f32_16x16x32_bf16 v[48:51], v[40:43], v[20:23], 0
v_exp_f32 v56, v56
v_exp_f32 v57, v57
v_exp_f32 v58, v58
v_exp_f32 v59, v59
v_add_f32 v74, v60, v61
v_add_f32 v75, v62, v63
v_cvt_pk_bf16_f32 v24, v56, v57
v_cvt_pk_bf16_f32 v25, v58, v59
v_cndmask_b32 v26, 0, v24, s[52:53]
v_cndmask_b32 v27, 0, v25, s[52:53]
v_cndmask_b32 v28, v24, 0, s[52:53]
v_cndmask_b32 v29, v25, 0, s[52:53]
v_mfma_f32_16x16x16_bf16 v[44:47], v[52:53], v[26:27], v[44:47]
v_mfma_f32_16x16x16_bf16 v[48:51], v[52:53], v[28:29], v[48:51]
ds_read_b128 v[20:23], v5 offset:30720
ds_read_b128 v[24:27], v5 offset:31744
ds_read_b128 v[28:31], v6 offset:18432
ds_read_b128 v[32:35], v6 offset:19456
v_add_f32 v74, v74, v64
v_add_f32 v75, v75, v65
v_add_f32 v74, v74, v66
v_add_f32 v75, v75, v67
v_add_f32 v73, v56, v57
v_add_f32 v72, v58, v59
v_add_f32 v74, v74, v75
v_add_f32 v73, v73, v72
v_fma_f32 v74, v73, 0.5, v74
v_mov_b32 v75, v74
s_nop 1
v_permlane32_swap_b32 v74, v75
v_add_f32 v74, v74, v75
v_mov_b32 v75, v74
s_nop 1
v_permlane16_swap_b32 v74, v75
v_add_f32 v74, v74, v75
v_rcp_f32 v74, v74
ds_read_b128 v[56:59], v4 offset:6144
ds_read_b128 v[60:63], v4 offset:7168
ds_read_b128 v[64:67], v4 offset:43008
ds_read_b128 v[68:71], v4 offset:44032
v_pk_mul_f32 v[44:45], v[44:45], v[74:75] op_sel_hi:[1,0]
v_pk_mul_f32 v[48:49], v[48:49], v[74:75] op_sel_hi:[1,0]
v_pk_mul_f32 v[46:47], v[46:47], v[74:75] op_sel_hi:[1,0]
v_pk_mul_f32 v[50:51], v[50:51], v[74:75] op_sel_hi:[1,0]
v_cvt_pk_bf16_f32 v76, v44, v45
v_cvt_pk_bf16_f32 v77, v46, v47
v_cvt_pk_bf16_f32 v78, v48, v49
v_cvt_pk_bf16_f32 v79, v50, v51
ds_write_b128 v1, v[76:79] offset:12288
v_mov_b32 v44, 0
v_mov_b32 v45, 0
v_mov_b32 v46, 0
v_mov_b32 v47, 0
v_mov_b32 v48, 0
v_mov_b32 v49, 0
v_mov_b32 v50, 0
v_mov_b32 v51, 0
s_waitcnt lgkmcnt(0)
s_barrier
ds_read_b128 v[36:39], v1 offset:9216
ds_read_b128 v[40:43], v1 offset:10240
ds_read_b128 v[52:55], v1 offset:11264
ds_read_b128 v[76:79], v1 offset:12288
s_waitcnt lgkmcnt(3)
v_smfmac_f32_16x16x64_bf16 v[44:47], v[36:39], v[56:63], v3
ds_read_b128 v[56:59], v4 offset:14336
ds_read_b128 v[60:63], v4 offset:15360
s_waitcnt lgkmcnt(4)
v_smfmac_f32_16x16x64_bf16 v[44:47], v[40:43], v[64:71], v3
ds_read_b128 v[64:67], v5 offset:2048
ds_read_b128 v[68:71], v5 offset:3072
s_waitcnt lgkmcnt(5)
v_smfmac_f32_16x16x64_bf16 v[44:47], v[52:55], v[20:27], v3
ds_read_b128 v[20:23], v5 offset:38912
ds_read_b128 v[24:27], v5 offset:39936
s_waitcnt lgkmcnt(6)
v_smfmac_f32_16x16x64_bf16 v[44:47], v[76:79], v[28:35], v3
ds_read_b128 v[28:31], v6 offset:26624
ds_read_b128 v[32:35], v6 offset:27648
s_waitcnt lgkmcnt(6)
v_smfmac_f32_16x16x64_bf16 v[48:51], v[36:39], v[56:63], v3
ds_read_b128 v[56:59], v4 offset:22528
ds_read_b128 v[60:63], v4 offset:23552
s_nop 1
v_cvt_pk_bf16_f32 v72, v44, v45
v_cvt_pk_bf16_f32 v73, v46, v47
s_waitcnt lgkmcnt(6)
v_smfmac_f32_16x16x64_bf16 v[48:51], v[40:43], v[64:71], v3
ds_read_b128 v[64:67], v5 offset:10240
ds_read_b128 v[68:71], v5 offset:11264
v_and_or_b32 v72, v72, s46, v15
s_add_u32 s36, s28, 49152
buffer_store_dwordx2 v[72:73], v7, s[12:15], s36 offen
s_waitcnt lgkmcnt(6)
v_smfmac_f32_16x16x64_bf16 v[48:51], v[52:55], v[20:27], v3
ds_read_b128 v[20:23], v5 offset:47104
ds_read_b128 v[24:27], v5 offset:48128
v_mov_b32 v44, 0
v_mov_b32 v45, 0
s_waitcnt lgkmcnt(6)
v_smfmac_f32_16x16x64_bf16 v[48:51], v[76:79], v[28:35], v3
ds_read_b128 v[28:31], v6 offset:34816
ds_read_b128 v[32:35], v6 offset:35840
v_mov_b32 v46, 0
v_mov_b32 v47, 0
s_waitcnt lgkmcnt(6)
s_nop 0
v_smfmac_f32_16x16x64_bf16 v[44:47], v[36:39], v[56:63], v3
ds_read_b128 v[56:59], v4 offset:30720
ds_read_b128 v[60:63], v4 offset:31744
v_cvt_pk_bf16_f32 v74, v48, v49
v_cvt_pk_bf16_f32 v75, v50, v51
s_waitcnt lgkmcnt(6)
v_smfmac_f32_16x16x64_bf16 v[44:47], v[40:43], v[64:71], v3
ds_read_b128 v[64:67], v5 offset:18432
ds_read_b128 v[68:71], v5 offset:19456
v_and_or_b32 v74, v74, s46, v15
s_add_u32 s36, s28, 114688
buffer_store_dwordx2 v[74:75], v7, s[12:15], s36 offen
s_waitcnt lgkmcnt(6)
v_smfmac_f32_16x16x64_bf16 v[44:47], v[52:55], v[20:27], v3
ds_read_b128 v[20:23], v6 offset:6144
ds_read_b128 v[24:27], v6 offset:7168
v_mov_b32 v48, 0
v_mov_b32 v49, 0
s_waitcnt lgkmcnt(6)
v_smfmac_f32_16x16x64_bf16 v[44:47], v[76:79], v[28:35], v3
ds_read_b128 v[28:31], v6 offset:43008
ds_read_b128 v[32:35], v6 offset:44032
v_mov_b32 v50, 0
v_mov_b32 v51, 0
s_waitcnt lgkmcnt(6)
s_nop 0
v_smfmac_f32_16x16x64_bf16 v[48:51], v[36:39], v[56:63], v3
ds_read_b128 v[56:59], v4 offset:28672
ds_read_b128 v[60:63], v4 offset:29696
v_cvt_pk_bf16_f32 v72, v44, v45
v_cvt_pk_bf16_f32 v73, v46, v47
s_waitcnt lgkmcnt(6)
v_smfmac_f32_16x16x64_bf16 v[48:51], v[40:43], v[64:71], v3
ds_read_b128 v[64:67], v5 offset:16384
ds_read_b128 v[68:71], v5 offset:17408
v_and_or_b32 v72, v72, s46, v15
s_add_u32 s36, s28, 180224
buffer_store_dwordx2 v[72:73], v7, s[12:15], s36 offen
s_waitcnt lgkmcnt(6)
v_smfmac_f32_16x16x64_bf16 v[48:51], v[52:55], v[20:27], v3
ds_read_b128 v[20:23], v6 offset:4096
ds_read_b128 v[24:27], v6 offset:5120
v_mov_b32 v44, 0
v_mov_b32 v45, 0
s_waitcnt lgkmcnt(6)
v_smfmac_f32_16x16x64_bf16 v[48:51], v[76:79], v[28:35], v3
ds_read_b128 v[28:31], v6 offset:40960
ds_read_b128 v[32:35], v6 offset:41984
v_mov_b32 v46, 0
v_mov_b32 v47, 0
s_waitcnt lgkmcnt(6)
s_nop 0
v_smfmac_f32_16x16x64_bf16 v[44:47], v[36:39], v[56:63], v3
s_nop 0
v_cvt_pk_bf16_f32 v74, v48, v49
v_cvt_pk_bf16_f32 v75, v50, v51
s_waitcnt lgkmcnt(4)
v_smfmac_f32_16x16x64_bf16 v[44:47], v[40:43], v[64:71], v3
v_and_or_b32 v74, v74, s46, v15
s_add_u32 s36, s28, 245760
buffer_store_dwordx2 v[74:75], v7, s[12:15], s36 offen
s_waitcnt lgkmcnt(2)
v_smfmac_f32_16x16x64_bf16 v[44:47], v[52:55], v[20:27], v3
s_waitcnt lgkmcnt(0)
v_smfmac_f32_16x16x64_bf16 v[44:47], v[76:79], v[28:35], v3
s_nop 7
v_cvt_pk_bf16_f32 v72, v44, v45
v_cvt_pk_bf16_f32 v73, v46, v47
v_and_or_b32 v72, v72, s46, v15
s_add_u32 s36, s28, 229376
buffer_store_dwordx2 v[72:73], v7, s[12:15], s36 offen
s_nop 15
s_nop 13
buffer_load_dwordx4 v[20:23], v8, s[12:15], s28 offen offset:0 sc1
buffer_load_dwordx4 v[24:27], v8, s[12:15], s28 offen offset:1024 sc1
buffer_load_dwordx4 v[28:31], v8, s[12:15], s28 offen offset:2048 sc1
buffer_load_dwordx4 v[32:35], v8, s[12:15], s28 offen offset:3072 sc1
s_nop 15
s_nop 15
s_nop 7
buffer_load_dwordx4 v[56:59], v8, s[12:15], s28 offen offset:0 sc1
buffer_load_dwordx4 v[60:63], v8, s[12:15], s28 offen offset:1024 sc1
buffer_load_dwordx4 v[64:67], v8, s[12:15], s28 offen offset:2048 sc1
buffer_load_dwordx4 v[68:71], v8, s[12:15], s28 offen offset:3072 sc1
s_waitcnt vmcnt(4)
v_xor_b32 v78, v20, v15
v_bitop3_b32 v78, v78, v24, v15 bitop3:0xf6
v_bitop3_b32 v78, v78, v28, v15 bitop3:0xf6
v_bitop3_b32 v78, v78, v32, v15 bitop3:0xf6
v_and_b32 v78, 0x10001, v78
v_cmp_ne_u32 vcc, 0, v78
s_cbranch_vccz L_rk_67
buffer_load_dwordx4 v[20:23], v8, s[12:15], s28 offen offset:0 sc1
buffer_load_dwordx4 v[24:27], v8, s[12:15], s28 offen offset:1024 sc1
buffer_load_dwordx4 v[28:31], v8, s[12:15], s28 offen offset:2048 sc1
buffer_load_dwordx4 v[32:35], v8, s[12:15], s28 offen offset:3072 sc1
L_rp_65:
s_waitcnt vmcnt(4)
v_xor_b32 v78, v56, v15
v_bitop3_b32 v78, v78, v60, v15 bitop3:0xf6
v_bitop3_b32 v78, v78, v64, v15 bitop3:0xf6
v_bitop3_b32 v78, v78, v68, v15 bitop3:0xf6
v_and_b32 v78, 0x10001, v78
v_cmp_ne_u32 vcc, 0, v78
s_cbranch_vccz L_rk_68
buffer_load_dwordx4 v[56:59], v8, s[12:15], s28 offen offset:0 sc1
buffer_load_dwordx4 v[60:63], v8, s[12:15], s28 offen offset:1024 sc1
buffer_load_dwordx4 v[64:67], v8, s[12:15], s28 offen offset:2048 sc1
buffer_load_dwordx4 v[68:71], v8, s[12:15], s28 offen offset:3072 sc1
s_waitcnt vmcnt(4)
v_xor_b32 v78, v20, v15
v_bitop3_b32 v78, v78, v24, v15 bitop3:0xf6
v_bitop3_b32 v78, v78, v28, v15 bitop3:0xf6
v_bitop3_b32 v78, v78, v32, v15 bitop3:0xf6
v_and_b32 v78, 0x10001, v78
v_cmp_ne_u32 vcc, 0, v78
s_cbranch_vccz L_rk_67
buffer_load_dwordx4 v[20:23], v8, s[12:15], s28 offen offset:0 sc1
buffer_load_dwordx4 v[24:27], v8, s[12:15], s28 offen offset:1024 sc1
buffer_load_dwordx4 v[28:31], v8, s[12:15], s28 offen offset:2048 sc1
buffer_load_dwordx4 v[32:35], v8, s[12:15], s28 offen offset:3072 sc1
s_add_u32 s44, s44, 1
s_cmp_gt_u32 s44, 1000000
s_cbranch_scc1 L_abort
s_branch L_rp_65
L_rk_67:
v_mfma_f32_16x16x32_bf16 v[52:55], v[16:19], v[20:23], 0
v_mfma_f32_16x16x32_bf16 v[52:55], v[16:19], v[24:27], v[52:55]
v_mfma_f32_16x16x32_bf16 v[52:55], v[16:19], v[28:31], v[52:55]
v_mfma_f32_16x16x32_bf16 v[52:55], v[16:19], v[32:35], v[52:55]
s_branch L_rd_66
L_rk_68:
v_mfma_f32_16x16x32_bf16 v[52:55], v[16:19], v[56:59], 0
v_mfma_f32_16x16x32_bf16 v[52:55], v[16:19], v[60:63], v[52:55]
v_mfma_f32_16x16x32_bf16 v[52:55], v[16:19], v[64:67], v[52:55]
v_mfma_f32_16x16x32_bf16 v[52:55], v[16:19], v[68:71], v[52:55]
L_rd_66:
s_nop 7
v_add_f32_dpp v52, v52, v52 row_ror:8 row_mask:0xf bank_mask:0xf
v_add_f32_dpp v53, v53, v53 row_ror:8 row_mask:0xf bank_mask:0xf
v_add_f32_dpp v54, v54, v54 row_ror:8 row_mask:0xf bank_mask:0xf
v_add_f32_dpp v55, v55, v55 row_ror:8 row_mask:0xf bank_mask:0xf
v_cvt_pk_bf16_f32 v76, v52, v53
v_cvt_pk_bf16_f32 v77, v54, v55
s_mov_b64 exec, s[50:51]
v_min_u32 v76, -2, v76
buffer_store_dwordx2 v[76:77], v9, s[12:15], s25 offen
v_mov_b32 v78, -1
v_mov_b32 v79, -1
buffer_store_dwordx2 v[78:79], v9, s[12:15], s27 offen
s_mov_b64 exec, -1
s_waitcnt vmcnt(2)
L_nt_64:
L_pre_w3o:
v_mov_b32 v44, 0
v_mov_b32 v48, 0
v_mov_b32 v52, 0
v_mov_b32 v45, 0
v_mov_b32 v49, 0
v_mov_b32 v53, 0
v_mov_b32 v46, 0
v_mov_b32 v50, 0
v_mov_b32 v54, 0
v_mov_b32 v47, 0
v_mov_b32 v51, 0
v_mov_b32 v55, 0
s_add_u32 s20, s20, 1
s_add_u32 s21, s21, 262144
s_add_u32 s22, s22, 262144
s_add_u32 s23, s23, 65536
s_add_u32 s24, s24, 65536
s_add_u32 s33, s20, 2
s_min_u32 s33, s33, 63
s_lshl_b32 s33, s33, 18
s_lshl_b32 s34, s10, 13
s_add_u32 s33, s33, s34
s_add_u32 s54, s33, 16187392
s_add_u32 s55, s33, 32964608
s_barrier
s_branch L_step_w3o
L_last_w3o:
s_nop 3
v_cvt_pk_bf16_f32 v52, v52, v53
v_cvt_pk_bf16_f32 v53, v54, v55
buffer_store_dwordx2 v[52:53], v13, s[12:15], s24 offen sc1
s_waitcnt vmcnt(0)
s_barrier
s_branch L_finish
L_grt_60:
L_glp_70:
s_add_u32 s45, s45, 1
s_cmp_gt_u32 s45, 1000000
s_cbranch_scc1 L_abort
s_waitcnt lgkmcnt(0)
s_add_u32 s33, s26, 4096
buffer_load_dwordx4 v[20:23], v1, s[12:15], s33 offen sc1
buffer_load_dwordx4 v[24:27], v1, s[12:15], s33 offen offset:1024 sc1
s_waitcnt vmcnt(0)
v_max3_u32 v78, v20, v22, v24
v_max_u32 v78, v78, v26
v_cmp_eq_u32 vcc, -1, v78
s_cbranch_vccnz L_glp_70
ds_write_b128 v1, v[20:23] offset:4096
ds_write_b128 v1, v[24:27] offset:5120
s_waitcnt lgkmcnt(0)
s_branch L_gbk_61
L_kvr_62:
s_add_u32 s35, s20, 2
s_min_u32 s35, s35, 63
s_lshr_b32 s35, s35, 2
s_lshl_b32 s35, s35, 7
s_add_u32 s35, s35, 77596672
L_kvl_71:
buffer_load_dword v10, off, s[12:15], s35 sc1
s_waitcnt vmcnt(0)
v_readfirstlane_b32 s34, v10
s_add_u32 s45, s45, 1
s_cmp_gt_u32 s45, 4000000
s_cbranch_scc1 L_abort
s_sleep 1
s_cmp_ge_u32 s34, 64
s_cbranch_scc0 L_kvl_71
s_branch L_kvb_63
L_finish:
L_abort:
s_waitcnt vmcnt(0)
s_endpgm
L_work:
s_sub_u32 s10, s4, 1
s_lshl_b32 s10, s10, 5
s_add_u32 s10, s10, s5
s_load_dwordx2 s[12:13], s[0:1], 112
v_lshrrev_b32 v1, 6, v0
v_and_b32 v0, 63, v0
v_readfirstlane_b32 s11, v1
s_mov_b32 s14, 268435456
s_mov_b32 s15, 0x20000
s_mov_b32 s19, 0x20000
s_mov_b32 s23, 0x20000
s_waitcnt lgkmcnt(0)
s_load_dwordx2 s[16:17], s[0:1], 0
s_mov_b32 s18, 2359296
s_waitcnt lgkmcnt(0)
v_lshlrev_b32 v2, 4, v0
v_lshlrev_b32 v3, 2, v0
v_add_u32 v3, 1024, v3
v_mov_b32 v5, 0x7ff00000
v_cmp_gt_u32 vcc, 32, v0
s_nop 1
v_cndmask_b32 v3, v5, v3, vcc
v_cndmask_b32 v4, 0, 1.0, vcc
s_lshl_b32 s43, s10, 2
s_add_u32 s43, s43, s11
s_add_u32 s24, s43, 0
s_mul_i32 s24, s24, 1152
buffer_load_dwordx4 v[8:11], v2, s[16:19], s24 offen
buffer_load_dword v12, v3, s[16:19], s24 offen
s_add_u32 s24, s43, 896
s_mul_i32 s24, s24, 1152
buffer_load_dwordx4 v[16:19], v2, s[16:19], s24 offen
buffer_load_dword v20, v3, s[16:19], s24 offen
s_add_u32 s24, s43, 1792
s_mul_i32 s24, s24, 1152
buffer_load_dwordx4 v[24:27], v2, s[16:19], s24 offen
buffer_load_dword v28, v3, s[16:19], s24 offen
s_load_dwordx2 s[64:65], s[0:1], 104
s_waitcnt lgkmcnt(0)
v_mov_b32 v6, 72
s_waitcnt vmcnt(0)
s_add_u32 s24, s43, 0
s_cmp_ge_u32 s24, 2048
s_cbranch_scc1 L_ln_72
s_mul_i32 s24, s24, 1152
v_lshlrev_b32 v40, 16, v8
v_and_b32 v41, 0xffff0000, v8
v_lshlrev_b32 v42, 16, v9
v_and_b32 v43, 0xffff0000, v9
v_lshlrev_b32 v44, 16, v10
v_and_b32 v45, 0xffff0000, v10
v_lshlrev_b32 v46, 16, v11
v_and_b32 v47, 0xffff0000, v11
v_lshlrev_b32 v48, 16, v12
v_and_b32 v49, 0xffff0000, v12
v_add_f32 v52, v40, v41
v_add_f32 v52, v52, v42
v_add_f32 v52, v52, v43
v_add_f32 v52, v52, v44
v_add_f32 v52, v52, v45
v_add_f32 v52, v52, v46
v_add_f32 v52, v52, v47
v_add_f32 v52, v52, v48
v_add_f32 v52, v52, v49
s_nop 1
v_add_f32_dpp v52, v52, v52 row_ror:8 row_mask:0xf bank_mask:0xf
s_nop 1
v_add_f32_dpp v52, v52, v52 row_ror:4 row_mask:0xf bank_mask:0xf
s_nop 1
v_add_f32_dpp v52, v52, v52 row_ror:2 row_mask:0xf bank_mask:0xf
s_nop 1
v_add_f32_dpp v52, v52, v52 row_ror:1 row_mask:0xf bank_mask:0xf
v_mov_b32 v53, v52
s_nop 1
v_permlane16_swap_b32 v52, v53
v_add_f32 v52, v52, v53
v_mov_b32 v53, v52
s_nop 1
v_permlane32_swap_b32 v52, v53
v_add_f32 v52, v52, v53
v_mul_f32 v52, 0x3ae38e39, v52
v_sub_f32 v55, v40, v52
v_mul_f32 v54, v55, v55
v_sub_f32 v55, v41, v52
v_fmac_f32 v54, v55, v55
v_sub_f32 v55, v42, v52
v_fmac_f32 v54, v55, v55
v_sub_f32 v55, v43, v52
v_fmac_f32 v54, v55, v55
v_sub_f32 v55, v44, v52
v_fmac_f32 v54, v55, v55
v_sub_f32 v55, v45, v52
v_fmac_f32 v54, v55, v55
v_sub_f32 v55, v46, v52
v_fmac_f32 v54, v55, v55
v_sub_f32 v55, v47, v52
v_fmac_f32 v54, v55, v55
v_sub_f32 v55, v48, v52
v_mul_f32 v55, v55, v4
v_fmac_f32 v54, v55, v55
v_sub_f32 v55, v49, v52
v_mul_f32 v55, v55, v4
v_fmac_f32 v54, v55, v55
s_nop 1
v_add_f32_dpp v54, v54, v54 row_ror:8 row_mask:0xf bank_mask:0xf
s_nop 1
v_add_f32_dpp v54, v54, v54 row_ror:4 row_mask:0xf bank_mask:0xf
s_nop 1
v_add_f32_dpp v54, v54, v54 row_ror:2 row_mask:0xf bank_mask:0xf
s_nop 1
v_add_f32_dpp v54, v54, v54 row_ror:1 row_mask:0xf bank_mask:0xf
v_mov_b32 v53, v54
s_nop 1
v_permlane16_swap_b32 v54, v53
v_add_f32 v54, v54, v53
v_mov_b32 v53, v54
s_nop 1
v_permlane32_swap_b32 v54, v53
v_add_f32 v54, v54, v53
v_mul_f32 v54, 0x3ae38e39, v54
v_cvt_pk_bf16_f32 v54, v54, v54
v_and_b32 v54, 0xffff0000, v54
v_cvt_pk_bf16_f32 v52, v52, v52
v_and_b32 v52, 0xffff0000, v52
v_add_f32 v54, 0x3727c5ac, v54
v_cvt_pk_bf16_f32 v54, v54, v54
v_and_b32 v54, 0xffff0000, v54
v_sqrt_f32 v54, v54
s_nop 0
v_cvt_pk_bf16_f32 v54, v54, v54
v_and_b32 v54, 0xffff0000, v54
v_rcp_f32 v54, v54
v_sub_f32 v40, v40, v52
v_sub_f32 v41, v41, v52
v_cvt_pk_bf16_f32 v55, v40, v41
v_lshlrev_b32 v40, 16, v55
v_and_b32 v41, 0xffff0000, v55
v_mul_f32 v40, v40, v54
v_mul_f32 v41, v41, v54
v_cvt_pk_bf16_f32 v55, v40, v41
v_mov_b32 v56, v55
v_lshlrev_b32 v40, 16, v55
v_and_b32 v41, 0xffff0000, v55
v_sub_f32 v42, v42, v52
v_sub_f32 v43, v43, v52
v_cvt_pk_bf16_f32 v55, v42, v43
v_lshlrev_b32 v42, 16, v55
v_and_b32 v43, 0xffff0000, v55
v_mul_f32 v42, v42, v54
v_mul_f32 v43, v43, v54
v_cvt_pk_bf16_f32 v55, v42, v43
v_mov_b32 v57, v55
v_lshlrev_b32 v42, 16, v55
v_and_b32 v43, 0xffff0000, v55
v_sub_f32 v44, v44, v52
v_sub_f32 v45, v45, v52
v_cvt_pk_bf16_f32 v55, v44, v45
v_lshlrev_b32 v44, 16, v55
v_and_b32 v45, 0xffff0000, v55
v_mul_f32 v44, v44, v54
v_mul_f32 v45, v45, v54
v_cvt_pk_bf16_f32 v55, v44, v45
v_mov_b32 v58, v55
v_lshlrev_b32 v44, 16, v55
v_and_b32 v45, 0xffff0000, v55
v_sub_f32 v46, v46, v52
v_sub_f32 v47, v47, v52
v_cvt_pk_bf16_f32 v55, v46, v47
v_lshlrev_b32 v46, 16, v55
v_and_b32 v47, 0xffff0000, v55
v_mul_f32 v46, v46, v54
v_mul_f32 v47, v47, v54
v_cvt_pk_bf16_f32 v55, v46, v47
v_mov_b32 v59, v55
v_lshlrev_b32 v46, 16, v55
v_and_b32 v47, 0xffff0000, v55
v_sub_f32 v48, v48, v52
v_sub_f32 v49, v49, v52
v_cvt_pk_bf16_f32 v55, v48, v49
v_lshlrev_b32 v48, 16, v55
v_and_b32 v49, 0xffff0000, v55
v_mul_f32 v48, v48, v54
v_mul_f32 v49, v49, v54
v_cvt_pk_bf16_f32 v55, v48, v49
v_mov_b32 v60, v55
v_lshlrev_b32 v48, 16, v55
v_and_b32 v49, 0xffff0000, v55
v_mul_f32 v48, v48, v4
v_mul_f32 v49, v49, v4
s_add_u32 s25, s24, 0
v_mov_b32 v64, v56
v_mov_b32 v65, v57
v_mov_b32 v66, v58
v_mov_b32 v67, v59
v_mov_b32 v68, v60
buffer_store_dwordx4 v[64:67], v2, s[12:15], s25 offen sc1
buffer_store_dword v68, v3, s[12:15], s25 offen sc1
v_add_f32 v52, v40, v41
v_add_f32 v52, v52, v42
v_add_f32 v52, v52, v43
v_add_f32 v52, v52, v44
v_add_f32 v52, v52, v45
v_add_f32 v52, v52, v46
v_add_f32 v52, v52, v47
v_add_f32 v52, v52, v48
v_add_f32 v52, v52, v49
s_nop 1
v_add_f32_dpp v52, v52, v52 row_ror:8 row_mask:0xf bank_mask:0xf
s_nop 1
v_add_f32_dpp v52, v52, v52 row_ror:4 row_mask:0xf bank_mask:0xf
s_nop 1
v_add_f32_dpp v52, v52, v52 row_ror:2 row_mask:0xf bank_mask:0xf
s_nop 1
v_add_f32_dpp v52, v52, v52 row_ror:1 row_mask:0xf bank_mask:0xf
v_mov_b32 v53, v52
s_nop 1
v_permlane16_swap_b32 v52, v53
v_add_f32 v52, v52, v53
v_mov_b32 v53, v52
s_nop 1
v_permlane32_swap_b32 v52, v53
v_add_f32 v52, v52, v53
v_mul_f32 v52, 0x3ae38e39, v52
v_sub_f32 v55, v40, v52
v_mul_f32 v54, v55, v55
v_sub_f32 v55, v41, v52
v_fmac_f32 v54, v55, v55
v_sub_f32 v55, v42, v52
v_fmac_f32 v54, v55, v55
v_sub_f32 v55, v43, v52
v_fmac_f32 v54, v55, v55
v_sub_f32 v55, v44, v52
v_fmac_f32 v54, v55, v55
v_sub_f32 v55, v45, v52
v_fmac_f32 v54, v55, v55
v_sub_f32 v55, v46, v52
v_fmac_f32 v54, v55, v55
v_sub_f32 v55, v47, v52
v_fmac_f32 v54, v55, v55
v_sub_f32 v55, v48, v52
v_mul_f32 v55, v55, v4
v_fmac_f32 v54, v55, v55
v_sub_f32 v55, v49, v52
v_mul_f32 v55, v55, v4
v_fmac_f32 v54, v55, v55
s_nop 1
v_add_f32_dpp v54, v54, v54 row_ror:8 row_mask:0xf bank_mask:0xf
s_nop 1
v_add_f32_dpp v54, v54, v54 row_ror:4 row_mask:0xf bank_mask:0xf
s_nop 1
v_add_f32_dpp v54, v54, v54 row_ror:2 row_mask:0xf bank_mask:0xf
s_nop 1
v_add_f32_dpp v54, v54, v54 row_ror:1 row_mask:0xf bank_mask:0xf
v_mov_b32 v53, v54
s_nop 1
v_permlane16_swap_b32 v54, v53
v_add_f32 v54, v54, v53
v_mov_b32 v53, v54
s_nop 1
v_permlane32_swap_b32 v54, v53
v_add_f32 v54, v54, v53
v_mul_f32 v54, 0x3ae38e39, v54
v_cvt_pk_bf16_f32 v54, v54, v54
v_and_b32 v54, 0xffff0000, v54
v_cvt_pk_bf16_f32 v52, v52, v52
v_and_b32 v52, 0xffff0000, v52
v_add_f32 v54, 0x3727c5ac, v54
v_cvt_pk_bf16_f32 v54, v54, v54
v_and_b32 v54, 0xffff0000, v54
v_sqrt_f32 v54, v54
s_nop 0
v_cvt_pk_bf16_f32 v54, v54, v54
v_and_b32 v54, 0xffff0000, v54
v_rcp_f32 v54, v54
v_sub_f32 v40, v40, v52
v_sub_f32 v41, v41, v52
v_cvt_pk_bf16_f32 v55, v40, v41
v_lshlrev_b32 v40, 16, v55
v_and_b32 v41, 0xffff0000, v55
v_mul_f32 v40, v40, v54
v_mul_f32 v41, v41, v54
v_cvt_pk_bf16_f32 v55, v40, v41
v_mov_b32 v56, v55
v_lshlrev_b32 v40, 16, v55
v_and_b32 v41, 0xffff0000, v55
v_sub_f32 v42, v42, v52
v_sub_f32 v43, v43, v52
v_cvt_pk_bf16_f32 v55, v42, v43
v_lshlrev_b32 v42, 16, v55
v_and_b32 v43, 0xffff0000, v55
v_mul_f32 v42, v42, v54
v_mul_f32 v43, v43, v54
v_cvt_pk_bf16_f32 v55, v42, v43
v_mov_b32 v57, v55
v_lshlrev_b32 v42, 16, v55
v_and_b32 v43, 0xffff0000, v55
v_sub_f32 v44, v44, v52
v_sub_f32 v45, v45, v52
v_cvt_pk_bf16_f32 v55, v44, v45
v_lshlrev_b32 v44, 16, v55
v_and_b32 v45, 0xffff0000, v55
v_mul_f32 v44, v44, v54
v_mul_f32 v45, v45, v54
v_cvt_pk_bf16_f32 v55, v44, v45
v_mov_b32 v58, v55
v_lshlrev_b32 v44, 16, v55
v_and_b32 v45, 0xffff0000, v55
v_sub_f32 v46, v46, v52
v_sub_f32 v47, v47, v52
v_cvt_pk_bf16_f32 v55, v46, v47
v_lshlrev_b32 v46, 16, v55
v_and_b32 v47, 0xffff0000, v55
v_mul_f32 v46, v46, v54
v_mul_f32 v47, v47, v54
v_cvt_pk_bf16_f32 v55, v46, v47
v_mov_b32 v59, v55
v_lshlrev_b32 v46, 16, v55
v_and_b32 v47, 0xffff0000, v55
v_sub_f32 v48, v48, v52
v_sub_f32 v49, v49, v52
v_cvt_pk_bf16_f32 v55, v48, v49
v_lshlrev_b32 v48, 16, v55
v_and_b32 v49, 0xffff0000, v55
v_mul_f32 v48, v48, v54
v_mul_f32 v49, v49, v54
v_cvt_pk_bf16_f32 v55, v48, v49
v_mov_b32 v60, v55
v_lshlrev_b32 v48, 16, v55
v_and_b32 v49, 0xffff0000, v55
v_mul_f32 v48, v48, v4
v_mul_f32 v49, v49, v4
s_add_u32 s25, s24, 3145728
v_mov_b32 v72, v56
v_mov_b32 v73, v57
v_mov_b32 v74, v58
v_mov_b32 v75, v59
v_mov_b32 v76, v60
buffer_store_dwordx4 v[72:75], v2, s[12:15], s25 offen sc1
buffer_store_dword v76, v3, s[12:15], s25 offen sc1
L_ln_72:
s_mov_b32 s61, 0
L_ini_73:
global_load_dword v1, v6, s[64:65] sc1
s_waitcnt vmcnt(0)
v_readfirstlane_b32 s62, v1
s_nop 0
s_cmp_eq_u32 s62, 1
s_cbranch_scc1 L_iok_74
s_add_u32 s61, s61, 1
s_cmp_gt_u32 s61, 4000000
s_cbranch_scc1 L_abortw
s_sleep 2
s_branch L_ini_73
L_iok_74:
s_add_u32 s24, s43, 0
s_cmp_ge_u32 s24, 2048
s_cbranch_scc1 L_lns_75
s_lshr_b32 s24, s24, 7
s_lshl_b32 s24, s24, 7
s_add_u32 s24, s24, 77594624
s_mov_b32 s60, s24
v_mov_b32 v1, 1
s_mov_b64 exec, 1
buffer_atomic_add v1, off, s[12:15], s60
s_mov_b64 exec, -1
L_lns_75:
s_add_u32 s24, s43, 896
s_cmp_ge_u32 s24, 2048
s_cbranch_scc1 L_ln_76
s_mul_i32 s24, s24, 1152
v_lshlrev_b32 v40, 16, v16
v_and_b32 v41, 0xffff0000, v16
v_lshlrev_b32 v42, 16, v17
v_and_b32 v43, 0xffff0000, v17
v_lshlrev_b32 v44, 16, v18
v_and_b32 v45, 0xffff0000, v18
v_lshlrev_b32 v46, 16, v19
v_and_b32 v47, 0xffff0000, v19
v_lshlrev_b32 v48, 16, v20
v_and_b32 v49, 0xffff0000, v20
v_add_f32 v52, v40, v41
v_add_f32 v52, v52, v42
v_add_f32 v52, v52, v43
v_add_f32 v52, v52, v44
v_add_f32 v52, v52, v45
v_add_f32 v52, v52, v46
v_add_f32 v52, v52, v47
v_add_f32 v52, v52, v48
v_add_f32 v52, v52, v49
s_nop 1
v_add_f32_dpp v52, v52, v52 row_ror:8 row_mask:0xf bank_mask:0xf
s_nop 1
v_add_f32_dpp v52, v52, v52 row_ror:4 row_mask:0xf bank_mask:0xf
s_nop 1
v_add_f32_dpp v52, v52, v52 row_ror:2 row_mask:0xf bank_mask:0xf
s_nop 1
v_add_f32_dpp v52, v52, v52 row_ror:1 row_mask:0xf bank_mask:0xf
v_mov_b32 v53, v52
s_nop 1
v_permlane16_swap_b32 v52, v53
v_add_f32 v52, v52, v53
v_mov_b32 v53, v52
s_nop 1
v_permlane32_swap_b32 v52, v53
v_add_f32 v52, v52, v53
v_mul_f32 v52, 0x3ae38e39, v52
v_sub_f32 v55, v40, v52
v_mul_f32 v54, v55, v55
v_sub_f32 v55, v41, v52
v_fmac_f32 v54, v55, v55
v_sub_f32 v55, v42, v52
v_fmac_f32 v54, v55, v55
v_sub_f32 v55, v43, v52
v_fmac_f32 v54, v55, v55
v_sub_f32 v55, v44, v52
v_fmac_f32 v54, v55, v55
v_sub_f32 v55, v45, v52
v_fmac_f32 v54, v55, v55
v_sub_f32 v55, v46, v52
v_fmac_f32 v54, v55, v55
v_sub_f32 v55, v47, v52
v_fmac_f32 v54, v55, v55
v_sub_f32 v55, v48, v52
v_mul_f32 v55, v55, v4
v_fmac_f32 v54, v55, v55
v_sub_f32 v55, v49, v52
v_mul_f32 v55, v55, v4
v_fmac_f32 v54, v55, v55
s_nop 1
v_add_f32_dpp v54, v54, v54 row_ror:8 row_mask:0xf bank_mask:0xf
s_nop 1
v_add_f32_dpp v54, v54, v54 row_ror:4 row_mask:0xf bank_mask:0xf
s_nop 1
v_add_f32_dpp v54, v54, v54 row_ror:2 row_mask:0xf bank_mask:0xf
s_nop 1
v_add_f32_dpp v54, v54, v54 row_ror:1 row_mask:0xf bank_mask:0xf
v_mov_b32 v53, v54
s_nop 1
v_permlane16_swap_b32 v54, v53
v_add_f32 v54, v54, v53
v_mov_b32 v53, v54
s_nop 1
v_permlane32_swap_b32 v54, v53
v_add_f32 v54, v54, v53
v_mul_f32 v54, 0x3ae38e39, v54
v_cvt_pk_bf16_f32 v54, v54, v54
v_and_b32 v54, 0xffff0000, v54
v_cvt_pk_bf16_f32 v52, v52, v52
v_and_b32 v52, 0xffff0000, v52
v_add_f32 v54, 0x3727c5ac, v54
v_cvt_pk_bf16_f32 v54, v54, v54
v_and_b32 v54, 0xffff0000, v54
v_sqrt_f32 v54, v54
s_nop 0
v_cvt_pk_bf16_f32 v54, v54, v54
v_and_b32 v54, 0xffff0000, v54
v_rcp_f32 v54, v54
v_sub_f32 v40, v40, v52
v_sub_f32 v41, v41, v52
v_cvt_pk_bf16_f32 v55, v40, v41
v_lshlrev_b32 v40, 16, v55
v_and_b32 v41, 0xffff0000, v55
v_mul_f32 v40, v40, v54
v_mul_f32 v41, v41, v54
v_cvt_pk_bf16_f32 v55, v40, v41
v_mov_b32 v56, v55
v_lshlrev_b32 v40, 16, v55
v_and_b32 v41, 0xffff0000, v55
v_sub_f32 v42, v42, v52
v_sub_f32 v43, v43, v52
v_cvt_pk_bf16_f32 v55, v42, v43
v_lshlrev_b32 v42, 16, v55
v_and_b32 v43, 0xffff0000, v55
v_mul_f32 v42, v42, v54
v_mul_f32 v43, v43, v54
v_cvt_pk_bf16_f32 v55, v42, v43
v_mov_b32 v57, v55
v_lshlrev_b32 v42, 16, v55
v_and_b32 v43, 0xffff0000, v55
v_sub_f32 v44, v44, v52
v_sub_f32 v45, v45, v52
v_cvt_pk_bf16_f32 v55, v44, v45
v_lshlrev_b32 v44, 16, v55
v_and_b32 v45, 0xffff0000, v55
v_mul_f32 v44, v44, v54
v_mul_f32 v45, v45, v54
v_cvt_pk_bf16_f32 v55, v44, v45
v_mov_b32 v58, v55
v_lshlrev_b32 v44, 16, v55
v_and_b32 v45, 0xffff0000, v55
v_sub_f32 v46, v46, v52
v_sub_f32 v47, v47, v52
v_cvt_pk_bf16_f32 v55, v46, v47
v_lshlrev_b32 v46, 16, v55
v_and_b32 v47, 0xffff0000, v55
v_mul_f32 v46, v46, v54
v_mul_f32 v47, v47, v54
v_cvt_pk_bf16_f32 v55, v46, v47
v_mov_b32 v59, v55
v_lshlrev_b32 v46, 16, v55
v_and_b32 v47, 0xffff0000, v55
v_sub_f32 v48, v48, v52
v_sub_f32 v49, v49, v52
v_cvt_pk_bf16_f32 v55, v48, v49
v_lshlrev_b32 v48, 16, v55
v_and_b32 v49, 0xffff0000, v55
v_mul_f32 v48, v48, v54
v_mul_f32 v49, v49, v54
v_cvt_pk_bf16_f32 v55, v48, v49
v_mov_b32 v60, v55
v_lshlrev_b32 v48, 16, v55
v_and_b32 v49, 0xffff0000, v55
v_mul_f32 v48, v48, v4
v_mul_f32 v49, v49, v4
s_add_u32 s25, s24, 0
v_mov_b32 v80, v56
v_mov_b32 v81, v57
v_mov_b32 v82, v58
v_mov_b32 v83, v59
v_mov_b32 v84, v60
buffer_store_dwordx4 v[80:83], v2, s[12:15], s25 offen sc1
buffer_store_dword v84, v3, s[12:15], s25 offen sc1
v_add_f32 v52, v40, v41
v_add_f32 v52, v52, v42
v_add_f32 v52, v52, v43
v_add_f32 v52, v52, v44
v_add_f32 v52, v52, v45
v_add_f32 v52, v52, v46
v_add_f32 v52, v52, v47
v_add_f32 v52, v52, v48
v_add_f32 v52, v52, v49
s_nop 1
v_add_f32_dpp v52, v52, v52 row_ror:8 row_mask:0xf bank_mask:0xf
s_nop 1
v_add_f32_dpp v52, v52, v52 row_ror:4 row_mask:0xf bank_mask:0xf
s_nop 1
v_add_f32_dpp v52, v52, v52 row_ror:2 row_mask:0xf bank_mask:0xf
s_nop 1
v_add_f32_dpp v52, v52, v52 row_ror:1 row_mask:0xf bank_mask:0xf
v_mov_b32 v53, v52
s_nop 1
v_permlane16_swap_b32 v52, v53
v_add_f32 v52, v52, v53
v_mov_b32 v53, v52
s_nop 1
v_permlane32_swap_b32 v52, v53
v_add_f32 v52, v52, v53
v_mul_f32 v52, 0x3ae38e39, v52
v_sub_f32 v55, v40, v52
v_mul_f32 v54, v55, v55
v_sub_f32 v55, v41, v52
v_fmac_f32 v54, v55, v55
v_sub_f32 v55, v42, v52
v_fmac_f32 v54, v55, v55
v_sub_f32 v55, v43, v52
v_fmac_f32 v54, v55, v55
v_sub_f32 v55, v44, v52
v_fmac_f32 v54, v55, v55
v_sub_f32 v55, v45, v52
v_fmac_f32 v54, v55, v55
v_sub_f32 v55, v46, v52
v_fmac_f32 v54, v55, v55
v_sub_f32 v55, v47, v52
v_fmac_f32 v54, v55, v55
v_sub_f32 v55, v48, v52
v_mul_f32 v55, v55, v4
v_fmac_f32 v54, v55, v55
v_sub_f32 v55, v49, v52
v_mul_f32 v55, v55, v4
v_fmac_f32 v54, v55, v55
s_nop 1
v_add_f32_dpp v54, v54, v54 row_ror:8 row_mask:0xf bank_mask:0xf
s_nop 1
v_add_f32_dpp v54, v54, v54 row_ror:4 row_mask:0xf bank_mask:0xf
s_nop 1
v_add_f32_dpp v54, v54, v54 row_ror:2 row_mask:0xf bank_mask:0xf
s_nop 1
v_add_f32_dpp v54, v54, v54 row_ror:1 row_mask:0xf bank_mask:0xf
v_mov_b32 v53, v54
s_nop 1
v_permlane16_swap_b32 v54, v53
v_add_f32 v54, v54, v53
v_mov_b32 v53, v54
s_nop 1
v_permlane32_swap_b32 v54, v53
v_add_f32 v54, v54, v53
v_mul_f32 v54, 0x3ae38e39, v54
v_cvt_pk_bf16_f32 v54, v54, v54
v_and_b32 v54, 0xffff0000, v54
v_cvt_pk_bf16_f32 v52, v52, v52
v_and_b32 v52, 0xffff0000, v52
v_add_f32 v54, 0x3727c5ac, v54
v_cvt_pk_bf16_f32 v54, v54, v54
v_and_b32 v54, 0xffff0000, v54
v_sqrt_f32 v54, v54
s_nop 0
v_cvt_pk_bf16_f32 v54, v54, v54
v_and_b32 v54, 0xffff0000, v54
v_rcp_f32 v54, v54
v_sub_f32 v40, v40, v52
v_sub_f32 v41, v41, v52
v_cvt_pk_bf16_f32 v55, v40, v41
v_lshlrev_b32 v40, 16, v55
v_and_b32 v41, 0xffff0000, v55
v_mul_f32 v40, v40, v54
v_mul_f32 v41, v41, v54
v_cvt_pk_bf16_f32 v55, v40, v41
v_mov_b32 v56, v55
v_lshlrev_b32 v40, 16, v55
v_and_b32 v41, 0xffff0000, v55
v_sub_f32 v42, v42, v52
v_sub_f32 v43, v43, v52
v_cvt_pk_bf16_f32 v55, v42, v43
v_lshlrev_b32 v42, 16, v55
v_and_b32 v43, 0xffff0000, v55
v_mul_f32 v42, v42, v54
v_mul_f32 v43, v43, v54
v_cvt_pk_bf16_f32 v55, v42, v43
v_mov_b32 v57, v55
v_lshlrev_b32 v42, 16, v55
v_and_b32 v43, 0xffff0000, v55
v_sub_f32 v44, v44, v52
v_sub_f32 v45, v45, v52
v_cvt_pk_bf16_f32 v55, v44, v45
v_lshlrev_b32 v44, 16, v55
v_and_b32 v45, 0xffff0000, v55
v_mul_f32 v44, v44, v54
v_mul_f32 v45, v45, v54
v_cvt_pk_bf16_f32 v55, v44, v45
v_mov_b32 v58, v55
v_lshlrev_b32 v44, 16, v55
v_and_b32 v45, 0xffff0000, v55
v_sub_f32 v46, v46, v52
v_sub_f32 v47, v47, v52
v_cvt_pk_bf16_f32 v55, v46, v47
v_lshlrev_b32 v46, 16, v55
v_and_b32 v47, 0xffff0000, v55
v_mul_f32 v46, v46, v54
v_mul_f32 v47, v47, v54
v_cvt_pk_bf16_f32 v55, v46, v47
v_mov_b32 v59, v55
v_lshlrev_b32 v46, 16, v55
v_and_b32 v47, 0xffff0000, v55
v_sub_f32 v48, v48, v52
v_sub_f32 v49, v49, v52
v_cvt_pk_bf16_f32 v55, v48, v49
v_lshlrev_b32 v48, 16, v55
v_and_b32 v49, 0xffff0000, v55
v_mul_f32 v48, v48, v54
v_mul_f32 v49, v49, v54
v_cvt_pk_bf16_f32 v55, v48, v49
v_mov_b32 v60, v55
v_lshlrev_b32 v48, 16, v55
v_and_b32 v49, 0xffff0000, v55
v_mul_f32 v48, v48, v4
v_mul_f32 v49, v49, v4
s_add_u32 s25, s24, 3145728
v_mov_b32 v88, v56
v_mov_b32 v89, v57
v_mov_b32 v90, v58
v_mov_b32 v91, v59
v_mov_b32 v92, v60
buffer_store_dwordx4 v[88:91], v2, s[12:15], s25 offen sc1
buffer_store_dword v92, v3, s[12:15], s25 offen sc1
L_ln_76:
s_add_u32 s24, s43, 1792
s_cmp_ge_u32 s24, 2048
s_cbranch_scc1 L_ln_77
s_mul_i32 s24, s24, 1152
v_lshlrev_b32 v40, 16, v24
v_and_b32 v41, 0xffff0000, v24
v_lshlrev_b32 v42, 16, v25
v_and_b32 v43, 0xffff0000, v25
v_lshlrev_b32 v44, 16, v26
v_and_b32 v45, 0xffff0000, v26
v_lshlrev_b32 v46, 16, v27
v_and_b32 v47, 0xffff0000, v27
v_lshlrev_b32 v48, 16, v28
v_and_b32 v49, 0xffff0000, v28
v_add_f32 v52, v40, v41
v_add_f32 v52, v52, v42
v_add_f32 v52, v52, v43
v_add_f32 v52, v52, v44
v_add_f32 v52, v52, v45
v_add_f32 v52, v52, v46
v_add_f32 v52, v52, v47
v_add_f32 v52, v52, v48
v_add_f32 v52, v52, v49
s_nop 1
v_add_f32_dpp v52, v52, v52 row_ror:8 row_mask:0xf bank_mask:0xf
s_nop 1
v_add_f32_dpp v52, v52, v52 row_ror:4 row_mask:0xf bank_mask:0xf
s_nop 1
v_add_f32_dpp v52, v52, v52 row_ror:2 row_mask:0xf bank_mask:0xf
s_nop 1
v_add_f32_dpp v52, v52, v52 row_ror:1 row_mask:0xf bank_mask:0xf
v_mov_b32 v53, v52
s_nop 1
v_permlane16_swap_b32 v52, v53
v_add_f32 v52, v52, v53
v_mov_b32 v53, v52
s_nop 1
v_permlane32_swap_b32 v52, v53
v_add_f32 v52, v52, v53
v_mul_f32 v52, 0x3ae38e39, v52
v_sub_f32 v55, v40, v52
v_mul_f32 v54, v55, v55
v_sub_f32 v55, v41, v52
v_fmac_f32 v54, v55, v55
v_sub_f32 v55, v42, v52
v_fmac_f32 v54, v55, v55
v_sub_f32 v55, v43, v52
v_fmac_f32 v54, v55, v55
v_sub_f32 v55, v44, v52
v_fmac_f32 v54, v55, v55
v_sub_f32 v55, v45, v52
v_fmac_f32 v54, v55, v55
v_sub_f32 v55, v46, v52
v_fmac_f32 v54, v55, v55
v_sub_f32 v55, v47, v52
v_fmac_f32 v54, v55, v55
v_sub_f32 v55, v48, v52
v_mul_f32 v55, v55, v4
v_fmac_f32 v54, v55, v55
v_sub_f32 v55, v49, v52
v_mul_f32 v55, v55, v4
v_fmac_f32 v54, v55, v55
s_nop 1
v_add_f32_dpp v54, v54, v54 row_ror:8 row_mask:0xf bank_mask:0xf
s_nop 1
v_add_f32_dpp v54, v54, v54 row_ror:4 row_mask:0xf bank_mask:0xf
s_nop 1
v_add_f32_dpp v54, v54, v54 row_ror:2 row_mask:0xf bank_mask:0xf
s_nop 1
v_add_f32_dpp v54, v54, v54 row_ror:1 row_mask:0xf bank_mask:0xf
v_mov_b32 v53, v54
s_nop 1
v_permlane16_swap_b32 v54, v53
v_add_f32 v54, v54, v53
v_mov_b32 v53, v54
s_nop 1
v_permlane32_swap_b32 v54, v53
v_add_f32 v54, v54, v53
v_mul_f32 v54, 0x3ae38e39, v54
v_cvt_pk_bf16_f32 v54, v54, v54
v_and_b32 v54, 0xffff0000, v54
v_cvt_pk_bf16_f32 v52, v52, v52
v_and_b32 v52, 0xffff0000, v52
v_add_f32 v54, 0x3727c5ac, v54
v_cvt_pk_bf16_f32 v54, v54, v54
v_and_b32 v54, 0xffff0000, v54
v_sqrt_f32 v54, v54
s_nop 0
v_cvt_pk_bf16_f32 v54, v54, v54
v_and_b32 v54, 0xffff0000, v54
v_rcp_f32 v54, v54
v_sub_f32 v40, v40, v52
v_sub_f32 v41, v41, v52
v_cvt_pk_bf16_f32 v55, v40, v41
v_lshlrev_b32 v40, 16, v55
v_and_b32 v41, 0xffff0000, v55
v_mul_f32 v40, v40, v54
v_mul_f32 v41, v41, v54
v_cvt_pk_bf16_f32 v55, v40, v41
v_mov_b32 v56, v55
v_lshlrev_b32 v40, 16, v55
v_and_b32 v41, 0xffff0000, v55
v_sub_f32 v42, v42, v52
v_sub_f32 v43, v43, v52
v_cvt_pk_bf16_f32 v55, v42, v43
v_lshlrev_b32 v42, 16, v55
v_and_b32 v43, 0xffff0000, v55
v_mul_f32 v42, v42, v54
v_mul_f32 v43, v43, v54
v_cvt_pk_bf16_f32 v55, v42, v43
v_mov_b32 v57, v55
v_lshlrev_b32 v42, 16, v55
v_and_b32 v43, 0xffff0000, v55
v_sub_f32 v44, v44, v52
v_sub_f32 v45, v45, v52
v_cvt_pk_bf16_f32 v55, v44, v45
v_lshlrev_b32 v44, 16, v55
v_and_b32 v45, 0xffff0000, v55
v_mul_f32 v44, v44, v54
v_mul_f32 v45, v45, v54
v_cvt_pk_bf16_f32 v55, v44, v45
v_mov_b32 v58, v55
v_lshlrev_b32 v44, 16, v55
v_and_b32 v45, 0xffff0000, v55
v_sub_f32 v46, v46, v52
v_sub_f32 v47, v47, v52
v_cvt_pk_bf16_f32 v55, v46, v47
v_lshlrev_b32 v46, 16, v55
v_and_b32 v47, 0xffff0000, v55
v_mul_f32 v46, v46, v54
v_mul_f32 v47, v47, v54
v_cvt_pk_bf16_f32 v55, v46, v47
v_mov_b32 v59, v55
v_lshlrev_b32 v46, 16, v55
v_and_b32 v47, 0xffff0000, v55
v_sub_f32 v48, v48, v52
v_sub_f32 v49, v49, v52
v_cvt_pk_bf16_f32 v55, v48, v49
v_lshlrev_b32 v48, 16, v55
v_and_b32 v49, 0xffff0000, v55
v_mul_f32 v48, v48, v54
v_mul_f32 v49, v49, v54
v_cvt_pk_bf16_f32 v55, v48, v49
v_mov_b32 v60, v55
v_lshlrev_b32 v48, 16, v55
v_and_b32 v49, 0xffff0000, v55
v_mul_f32 v48, v48, v4
v_mul_f32 v49, v49, v4
s_add_u32 s25, s24, 0
v_mov_b32 v96, v56
v_mov_b32 v97, v57
v_mov_b32 v98, v58
v_mov_b32 v99, v59
v_mov_b32 v100, v60
buffer_store_dwordx4 v[96:99], v2, s[12:15], s25 offen sc1
buffer_store_dword v100, v3, s[12:15], s25 offen sc1
v_add_f32 v52, v40, v41
v_add_f32 v52, v52, v42
v_add_f32 v52, v52, v43
v_add_f32 v52, v52, v44
v_add_f32 v52, v52, v45
v_add_f32 v52, v52, v46
v_add_f32 v52, v52, v47
v_add_f32 v52, v52, v48
v_add_f32 v52, v52, v49
s_nop 1
v_add_f32_dpp v52, v52, v52 row_ror:8 row_mask:0xf bank_mask:0xf
s_nop 1
v_add_f32_dpp v52, v52, v52 row_ror:4 row_mask:0xf bank_mask:0xf
s_nop 1
v_add_f32_dpp v52, v52, v52 row_ror:2 row_mask:0xf bank_mask:0xf
s_nop 1
v_add_f32_dpp v52, v52, v52 row_ror:1 row_mask:0xf bank_mask:0xf
v_mov_b32 v53, v52
s_nop 1
v_permlane16_swap_b32 v52, v53
v_add_f32 v52, v52, v53
v_mov_b32 v53, v52
s_nop 1
v_permlane32_swap_b32 v52, v53
v_add_f32 v52, v52, v53
v_mul_f32 v52, 0x3ae38e39, v52
v_sub_f32 v55, v40, v52
v_mul_f32 v54, v55, v55
v_sub_f32 v55, v41, v52
v_fmac_f32 v54, v55, v55
v_sub_f32 v55, v42, v52
v_fmac_f32 v54, v55, v55
v_sub_f32 v55, v43, v52
v_fmac_f32 v54, v55, v55
v_sub_f32 v55, v44, v52
v_fmac_f32 v54, v55, v55
v_sub_f32 v55, v45, v52
v_fmac_f32 v54, v55, v55
v_sub_f32 v55, v46, v52
v_fmac_f32 v54, v55, v55
v_sub_f32 v55, v47, v52
v_fmac_f32 v54, v55, v55
v_sub_f32 v55, v48, v52
v_mul_f32 v55, v55, v4
v_fmac_f32 v54, v55, v55
v_sub_f32 v55, v49, v52
v_mul_f32 v55, v55, v4
v_fmac_f32 v54, v55, v55
s_nop 1
v_add_f32_dpp v54, v54, v54 row_ror:8 row_mask:0xf bank_mask:0xf
s_nop 1
v_add_f32_dpp v54, v54, v54 row_ror:4 row_mask:0xf bank_mask:0xf
s_nop 1
v_add_f32_dpp v54, v54, v54 row_ror:2 row_mask:0xf bank_mask:0xf
s_nop 1
v_add_f32_dpp v54, v54, v54 row_ror:1 row_mask:0xf bank_mask:0xf
v_mov_b32 v53, v54
s_nop 1
v_permlane16_swap_b32 v54, v53
v_add_f32 v54, v54, v53
v_mov_b32 v53, v54
s_nop 1
v_permlane32_swap_b32 v54, v53
v_add_f32 v54, v54, v53
v_mul_f32 v54, 0x3ae38e39, v54
v_cvt_pk_bf16_f32 v54, v54, v54
v_and_b32 v54, 0xffff0000, v54
v_cvt_pk_bf16_f32 v52, v52, v52
v_and_b32 v52, 0xffff0000, v52
v_add_f32 v54, 0x3727c5ac, v54
v_cvt_pk_bf16_f32 v54, v54, v54
v_and_b32 v54, 0xffff0000, v54
v_sqrt_f32 v54, v54
s_nop 0
v_cvt_pk_bf16_f32 v54, v54, v54
v_and_b32 v54, 0xffff0000, v54
v_rcp_f32 v54, v54
v_sub_f32 v40, v40, v52
v_sub_f32 v41, v41, v52
v_cvt_pk_bf16_f32 v55, v40, v41
v_lshlrev_b32 v40, 16, v55
v_and_b32 v41, 0xffff0000, v55
v_mul_f32 v40, v40, v54
v_mul_f32 v41, v41, v54
v_cvt_pk_bf16_f32 v55, v40, v41
v_mov_b32 v56, v55
v_lshlrev_b32 v40, 16, v55
v_and_b32 v41, 0xffff0000, v55
v_sub_f32 v42, v42, v52
v_sub_f32 v43, v43, v52
v_cvt_pk_bf16_f32 v55, v42, v43
v_lshlrev_b32 v42, 16, v55
v_and_b32 v43, 0xffff0000, v55
v_mul_f32 v42, v42, v54
v_mul_f32 v43, v43, v54
v_cvt_pk_bf16_f32 v55, v42, v43
v_mov_b32 v57, v55
v_lshlrev_b32 v42, 16, v55
v_and_b32 v43, 0xffff0000, v55
v_sub_f32 v44, v44, v52
v_sub_f32 v45, v45, v52
v_cvt_pk_bf16_f32 v55, v44, v45
v_lshlrev_b32 v44, 16, v55
v_and_b32 v45, 0xffff0000, v55
v_mul_f32 v44, v44, v54
v_mul_f32 v45, v45, v54
v_cvt_pk_bf16_f32 v55, v44, v45
v_mov_b32 v58, v55
v_lshlrev_b32 v44, 16, v55
v_and_b32 v45, 0xffff0000, v55
v_sub_f32 v46, v46, v52
v_sub_f32 v47, v47, v52
v_cvt_pk_bf16_f32 v55, v46, v47
v_lshlrev_b32 v46, 16, v55
v_and_b32 v47, 0xffff0000, v55
v_mul_f32 v46, v46, v54
v_mul_f32 v47, v47, v54
v_cvt_pk_bf16_f32 v55, v46, v47
v_mov_b32 v59, v55
v_lshlrev_b32 v46, 16, v55
v_and_b32 v47, 0xffff0000, v55
v_sub_f32 v48, v48, v52
v_sub_f32 v49, v49, v52
v_cvt_pk_bf16_f32 v55, v48, v49
v_lshlrev_b32 v48, 16, v55
v_and_b32 v49, 0xffff0000, v55
v_mul_f32 v48, v48, v54
v_mul_f32 v49, v49, v54
v_cvt_pk_bf16_f32 v55, v48, v49
v_mov_b32 v60, v55
v_lshlrev_b32 v48, 16, v55
v_and_b32 v49, 0xffff0000, v55
v_mul_f32 v48, v48, v4
v_mul_f32 v49, v49, v4
s_add_u32 s25, s24, 3145728
v_mov_b32 v104, v56
v_mov_b32 v105, v57
v_mov_b32 v106, v58
v_mov_b32 v107, v59
v_mov_b32 v108, v60
buffer_store_dwordx4 v[104:107], v2, s[12:15], s25 offen sc1
buffer_store_dword v108, v3, s[12:15], s25 offen sc1
L_ln_77:
s_waitcnt vmcnt(0)
s_add_u32 s24, s43, 896
s_cmp_ge_u32 s24, 2048
s_cbranch_scc1 L_lns_78
s_lshr_b32 s24, s24, 7
s_lshl_b32 s24, s24, 7
s_add_u32 s24, s24, 77594624
s_mov_b32 s60, s24
v_mov_b32 v1, 1
s_mov_b64 exec, 1
buffer_atomic_add v1, off, s[12:15], s60
s_mov_b64 exec, -1
L_lns_78:
s_add_u32 s24, s43, 1792
s_cmp_ge_u32 s24, 2048
s_cbranch_scc1 L_lns_79
s_lshr_b32 s24, s24, 7
s_lshl_b32 s24, s24, 7
s_add_u32 s24, s24, 77594624
s_mov_b32 s60, s24
v_mov_b32 v1, 1
s_mov_b64 exec, 1
buffer_atomic_add v1, off, s[12:15], s60
s_mov_b64 exec, -1
L_lns_79:
s_mov_b32 s42, s10
s_branch L_dispatch
L_next:
s_barrier
s_cmp_lg_u32 s11, 0
s_cbranch_scc1 L_tk2
s_mov_b32 s60, 77617152
v_mov_b32 v1, 1
s_mov_b64 exec, 1
buffer_atomic_add v1, off, s[12:15], s60 sc0
s_waitcnt vmcnt(0)
v_mov_b32 v2, 160000
ds_write_b32 v2, v1
s_waitcnt lgkmcnt(0)
s_mov_b64 exec, -1
L_tk2:
s_barrier
v_mov_b32 v2, 160000
ds_read_b32 v1, v2
s_waitcnt lgkmcnt(0)
v_readfirstlane_b32 s42, v1
s_nop 0
s_add_u32 s42, s42, 224
L_dispatch:
s_cmp_ge_u32 s42, 1196
s_cbranch_scc1 L_p4
s_cmp_lt_u32 s42, 256
s_cbranch_scc1 L_t_h
s_cmp_lt_u32 s42, 640
s_cbranch_scc1 L_t_kv
s_cmp_lt_u32 s42, 748
s_cbranch_scc1 L_t_g2
s_cmp_lt_u32 s42, 1004
s_cbranch_scc1 L_t_q
s_branch L_t_g3
L_t_q:
s_sub_u32 s24, s42, 748
s_mov_b32 s43, 0
s_lshr_b32 s44, s24, 4
s_and_b32 s45, s24, 15
s_branch L_t_g1
L_t_kv:
s_sub_u32 s24, s42, 256
s_lshr_b32 s44, s24, 5
s_add_u32 s44, s44, 4
s_bfe_u32 s43, s24, 0x10004
s_add_u32 s43, s43, 1
s_and_b32 s45, s24, 15
L_t_g1:
s_add_u32 s16, s12, 0
s_addc_u32 s17, s13, 0
s_mov_b32 s18, 2359296
s_lshl_b32 s24, s43, 3
s_add_u32 s24, s24, 16
s_load_dwordx2 s[20:21], s[0:1], s24
s_mov_b32 s22, 4718592
v_lshrrev_b32 v24, 3, v0
v_mul_u32_u24 v24, 1152, v24
v_and_b32 v25, 7, v0
v_lshrrev_b32 v26, 4, v0
v_xor_b32 v27, v25, v26
v_lshl_add_u32 v2, v27, 4, v24
v_xor_b32 v27, 4, v27
v_lshl_add_u32 v3, v27, 4, v24
v_lshrrev_b32 v24, 5, v0
v_lshlrev_b32 v25, 2, v24
v_lshlrev_b32 v24, 13, v24
v_and_b32 v26, 31, v0
v_xor_b32 v27, v26, v25
v_lshl_add_u32 v5, v27, 4, v24
v_xor_b32 v27, 8, v27
v_lshl_add_u32 v6, v27, 4, v24
s_lshl_b32 s24, s44, 7
s_lshl_b32 s25, s11, 5
s_add_u32 s24, s24, s25
s_mul_i32 s36, s24, 1152
s_lshl_b32 s37, s11, 17
s_lshl_b32 s24, s45, 9
s_add_u32 s37, s37, s24
s_and_b32 s24, s11, 1
s_lshl_b32 s24, s24, 6
v_and_b32 v24, 31, v0
v_add_u32 v24, s24, v24
v_lshrrev_b32 v25, 5, v0
v_bfe_u32 v26, v24, 1, 3
v_lshlrev_b32 v24, 7, v24
v_add_u32 v27, 0, v25
v_xor_b32 v27, v27, v26
v_lshl_add_u32 v8, v27, 4, v24
v_add_u32 v27, 2, v25
v_xor_b32 v27, v27, v26
v_lshl_add_u32 v9, v27, 4, v24
v_add_u32 v27, 4, v25
v_xor_b32 v27, v27, v26
v_lshl_add_u32 v10, v27, 4, v24
v_add_u32 v27, 6, v25
v_xor_b32 v27, v27, v26
v_lshl_add_u32 v11, v27, 4, v24
s_lshr_b32 s24, s11, 1
s_lshl_b32 s24, s24, 4
v_bfe_u32 v24, v0, 4, 1
v_bfe_u32 v25, v0, 5, 1
v_bfe_u32 v26, v0, 2, 2
v_and_b32 v27, 3, v0
v_lshl_add_u32 v28, v25, 3, v26
v_mul_u32_u24 v28, 512, v28
v_and_b32 v29, 1, v27
v_lshl_add_u32 v28, v29, 3, v28
v_lshrrev_b32 v29, 1, v27
v_lshl_add_u32 v29, v24, 1, v29
v_add_u32 v29, s24, v29
v_lshlrev_b32 v30, 2, v26
v_add_u32 v31, 0, v29
v_xor_b32 v31, v31, v30
v_lshl_add_u32 v12, v31, 4, v28
v_add_u32 v31, 4, v29
v_xor_b32 v31, v31, v30
v_lshl_add_u32 v13, v31, 4, v28
v_add_u32 v31, 8, v29
v_xor_b32 v31, v31, v30
v_lshl_add_u32 v14, v31, 4, v28
v_add_u32 v31, 12, v29
v_xor_b32 v31, v31, v30
v_lshl_add_u32 v15, v31, 4, v28
s_waitcnt lgkmcnt(0)
s_cmp_eq_u32 s43, 2
s_cbranch_scc1 L_g1v_80
s_barrier
s_mov_b32 s39, 0
s_mov_b32 s38, 0
s_lshl_b32 s26, s11, 13
s_add_u32 s26, s26, s39
s_add_u32 m0, s26, 16384
s_add_u32 s27, s37, 0
buffer_load_dwordx4 v5, s[20:23], s27 offen lds
s_lshl_b32 s26, s11, 13
s_add_u32 s26, s26, s39
s_add_u32 m0, s26, 17408
s_add_u32 s27, s37, 16384
buffer_load_dwordx4 v6, s[20:23], s27 offen lds
s_lshl_b32 s26, s11, 13
s_add_u32 s26, s26, s39
s_add_u32 m0, s26, 18432
s_add_u32 s27, s37, 32768
buffer_load_dwordx4 v5, s[20:23], s27 offen lds
s_lshl_b32 s26, s11, 13
s_add_u32 s26, s26, s39
s_add_u32 m0, s26, 19456
s_add_u32 s27, s37, 49152
buffer_load_dwordx4 v6, s[20:23], s27 offen lds
s_lshl_b32 s26, s11, 13
s_add_u32 s26, s26, s39
s_add_u32 m0, s26, 20480
s_add_u32 s27, s37, 65536
buffer_load_dwordx4 v5, s[20:23], s27 offen lds
s_lshl_b32 s26, s11, 13
s_add_u32 s26, s26, s39
s_add_u32 m0, s26, 21504
s_add_u32 s27, s37, 81920
buffer_load_dwordx4 v6, s[20:23], s27 offen lds
s_lshl_b32 s26, s11, 13
s_add_u32 s26, s26, s39
s_add_u32 m0, s26, 22528
s_add_u32 s27, s37, 98304
buffer_load_dwordx4 v5, s[20:23], s27 offen lds
s_lshl_b32 s26, s11, 13
s_add_u32 s26, s26, s39
s_add_u32 m0, s26, 23552
s_add_u32 s27, s37, 114688
buffer_load_dwordx4 v6, s[20:23], s27 offen lds
s_add_u32 s37, s37, 524288
s_lshl_b32 s76, s44, 7
s_add_u32 s76, s76, 77594624
s_cmp_lg_u32 s11, 0
s_cbranch_scc1 L_wd_82
s_mov_b32 s60, s76
s_mov_b32 s61, 0
L_wp_83:
buffer_load_dword v1, off, s[12:15], s60 sc1
s_waitcnt vmcnt(0)
v_readfirstlane_b32 s62, v1
s_nop 0
s_cmp_ge_u32 s62, 128
s_cbranch_scc1 L_wd_82
s_add_u32 s61, s61, 1
s_cmp_gt_u32 s61, 4000000
s_cbranch_scc1 L_abortw
s_sleep 1
s_branch L_wp_83
L_wd_82:
s_barrier
s_lshl_b32 s26, s11, 12
s_add_u32 s26, s26, s39
s_add_u32 m0, s26, 0
s_add_u32 s27, s36, 0
buffer_load_dwordx4 v2, s[16:19], s27 offen sc1 lds
s_lshl_b32 s26, s11, 12
s_add_u32 s26, s26, s39
s_add_u32 m0, s26, 1024
s_add_u32 s27, s36, 9216
buffer_load_dwordx4 v3, s[16:19], s27 offen sc1 lds
s_lshl_b32 s26, s11, 12
s_add_u32 s26, s26, s39
s_add_u32 m0, s26, 2048
s_add_u32 s27, s36, 18432
buffer_load_dwordx4 v2, s[16:19], s27 offen sc1 lds
s_lshl_b32 s26, s11, 12
s_add_u32 s26, s26, s39
s_add_u32 m0, s26, 3072
s_add_u32 s27, s36, 27648
buffer_load_dwordx4 v3, s[16:19], s27 offen sc1 lds
s_add_u32 s36, s36, 128
s_add_u32 s39, s39, 49152
s_cmp_eq_u32 s39, 147456
s_cselect_b32 s39, 0, s39
s_lshl_b32 s26, s11, 12
s_add_u32 s26, s26, s39
s_add_u32 m0, s26, 0
s_add_u32 s27, s36, 0
buffer_load_dwordx4 v2, s[16:19], s27 offen sc1 lds
s_lshl_b32 s26, s11, 12
s_add_u32 s26, s26, s39
s_add_u32 m0, s26, 1024
s_add_u32 s27, s36, 9216
buffer_load_dwordx4 v3, s[16:19], s27 offen sc1 lds
s_lshl_b32 s26, s11, 12
s_add_u32 s26, s26, s39
s_add_u32 m0, s26, 2048
s_add_u32 s27, s36, 18432
buffer_load_dwordx4 v2, s[16:19], s27 offen sc1 lds
s_lshl_b32 s26, s11, 12
s_add_u32 s26, s26, s39
s_add_u32 m0, s26, 3072
s_add_u32 s27, s36, 27648
buffer_load_dwordx4 v3, s[16:19], s27 offen sc1 lds
s_add_u32 s36, s36, 128
s_lshl_b32 s26, s11, 13
s_add_u32 s26, s26, s39
s_add_u32 m0, s26, 16384
s_add_u32 s27, s37, 0
buffer_load_dwordx4 v5, s[20:23], s27 offen lds
s_lshl_b32 s26, s11, 13
s_add_u32 s26, s26, s39
s_add_u32 m0, s26, 17408
s_add_u32 s27, s37, 16384
buffer_load_dwordx4 v6, s[20:23], s27 offen lds
s_lshl_b32 s26, s11, 13
s_add_u32 s26, s26, s39
s_add_u32 m0, s26, 18432
s_add_u32 s27, s37, 32768
buffer_load_dwordx4 v5, s[20:23], s27 offen lds
s_lshl_b32 s26, s11, 13
s_add_u32 s26, s26, s39
s_add_u32 m0, s26, 19456
s_add_u32 s27, s37, 49152
buffer_load_dwordx4 v6, s[20:23], s27 offen lds
s_lshl_b32 s26, s11, 13
s_add_u32 s26, s26, s39
s_add_u32 m0, s26, 20480
s_add_u32 s27, s37, 65536
buffer_load_dwordx4 v5, s[20:23], s27 offen lds
s_lshl_b32 s26, s11, 13
s_add_u32 s26, s26, s39
s_add_u32 m0, s26, 21504
s_add_u32 s27, s37, 81920
buffer_load_dwordx4 v6, s[20:23], s27 offen lds
s_lshl_b32 s26, s11, 13
s_add_u32 s26, s26, s39
s_add_u32 m0, s26, 22528
s_add_u32 s27, s37, 98304
buffer_load_dwordx4 v5, s[20:23], s27 offen lds
s_lshl_b32 s26, s11, 13
s_add_u32 s26, s26, s39
s_add_u32 m0, s26, 23552
s_add_u32 s27, s37, 114688
buffer_load_dwordx4 v6, s[20:23], s27 offen lds
s_add_u32 s37, s37, 524288
s_add_u32 s39, s39, 49152
s_cmp_eq_u32 s39, 147456
s_cselect_b32 s39, 0, s39
s_lshl_b32 s26, s11, 12
s_add_u32 s26, s26, s39
s_add_u32 m0, s26, 0
s_add_u32 s27, s36, 0
buffer_load_dwordx4 v2, s[16:19], s27 offen sc1 lds
s_lshl_b32 s26, s11, 12
s_add_u32 s26, s26, s39
s_add_u32 m0, s26, 1024
s_add_u32 s27, s36, 9216
buffer_load_dwordx4 v3, s[16:19], s27 offen sc1 lds
s_lshl_b32 s26, s11, 12
s_add_u32 s26, s26, s39
s_add_u32 m0, s26, 2048
s_add_u32 s27, s36, 18432
buffer_load_dwordx4 v2, s[16:19], s27 offen sc1 lds
s_lshl_b32 s26, s11, 12
s_add_u32 s26, s26, s39
s_add_u32 m0, s26, 3072
s_add_u32 s27, s36, 27648
buffer_load_dwordx4 v3, s[16:19], s27 offen sc1 lds
s_add_u32 s36, s36, 128
s_lshl_b32 s26, s11, 13
s_add_u32 s26, s26, s39
s_add_u32 m0, s26, 16384
s_add_u32 s27, s37, 0
buffer_load_dwordx4 v5, s[20:23], s27 offen lds
s_lshl_b32 s26, s11, 13
s_add_u32 s26, s26, s39
s_add_u32 m0, s26, 17408
s_add_u32 s27, s37, 16384
buffer_load_dwordx4 v6, s[20:23], s27 offen lds
s_lshl_b32 s26, s11, 13
s_add_u32 s26, s26, s39
s_add_u32 m0, s26, 18432
s_add_u32 s27, s37, 32768
buffer_load_dwordx4 v5, s[20:23], s27 offen lds
s_lshl_b32 s26, s11, 13
s_add_u32 s26, s26, s39
s_add_u32 m0, s26, 19456
s_add_u32 s27, s37, 49152
buffer_load_dwordx4 v6, s[20:23], s27 offen lds
s_lshl_b32 s26, s11, 13
s_add_u32 s26, s26, s39
s_add_u32 m0, s26, 20480
s_add_u32 s27, s37, 65536
buffer_load_dwordx4 v5, s[20:23], s27 offen lds
s_lshl_b32 s26, s11, 13
s_add_u32 s26, s26, s39
s_add_u32 m0, s26, 21504
s_add_u32 s27, s37, 81920
buffer_load_dwordx4 v6, s[20:23], s27 offen lds
s_lshl_b32 s26, s11, 13
s_add_u32 s26, s26, s39
s_add_u32 m0, s26, 22528
s_add_u32 s27, s37, 98304
buffer_load_dwordx4 v5, s[20:23], s27 offen lds
s_lshl_b32 s26, s11, 13
s_add_u32 s26, s26, s39
s_add_u32 m0, s26, 23552
s_add_u32 s27, s37, 114688
buffer_load_dwordx4 v6, s[20:23], s27 offen lds
s_add_u32 s37, s37, 524288
s_add_u32 s39, s39, 49152
s_cmp_eq_u32 s39, 147456
s_cselect_b32 s39, 0, s39
s_waitcnt vmcnt(24)
s_barrier
v_add_u32 v16, s38, v8
v_add_u32 v17, s38, v9
v_add_u32 v18, s38, v10
v_add_u32 v19, s38, v11
s_add_u32 s25, s38, 16384
v_add_u32 v20, s25, v12
v_add_u32 v21, s25, v13
v_add_u32 v22, s25, v14
v_add_u32 v23, s25, v15
ds_read_b128 v[32:35], v16 offset:0
ds_read_b128 v[36:39], v16 offset:4096
ds_read_b64_tr_b16 v[64:65], v20 offset:0
ds_read_b64_tr_b16 v[66:67], v20 offset:2048
ds_read_b64_tr_b16 v[68:69], v21 offset:0
ds_read_b64_tr_b16 v[70:71], v21 offset:2048
ds_read_b64_tr_b16 v[72:73], v22 offset:0
ds_read_b64_tr_b16 v[74:75], v22 offset:2048
ds_read_b64_tr_b16 v[76:77], v23 offset:0
ds_read_b64_tr_b16 v[78:79], v23 offset:2048
s_waitcnt lgkmcnt(0)
ds_read_b128 v[40:43], v17 offset:0
ds_read_b128 v[44:47], v17 offset:4096
ds_read_b64_tr_b16 v[80:81], v20 offset:8192
ds_read_b64_tr_b16 v[82:83], v20 offset:10240
ds_read_b64_tr_b16 v[84:85], v21 offset:8192
ds_read_b64_tr_b16 v[86:87], v21 offset:10240
ds_read_b64_tr_b16 v[88:89], v22 offset:8192
ds_read_b64_tr_b16 v[90:91], v22 offset:10240
ds_read_b64_tr_b16 v[92:93], v23 offset:8192
ds_read_b64_tr_b16 v[94:95], v23 offset:10240
v_mfma_f32_32x32x16_bf16 v[128:143], v[64:67], v[32:35], 0
v_mfma_f32_32x32x16_bf16 v[144:159], v[64:67], v[36:39], 0
v_mfma_f32_32x32x16_bf16 v[160:175], v[68:71], v[32:35], 0
v_mfma_f32_32x32x16_bf16 v[176:191], v[68:71], v[36:39], 0
v_mfma_f32_32x32x16_bf16 v[192:207], v[72:75], v[32:35], 0
v_mfma_f32_32x32x16_bf16 v[208:223], v[72:75], v[36:39], 0
v_mfma_f32_32x32x16_bf16 v[224:239], v[76:79], v[32:35], 0
v_mfma_f32_32x32x16_bf16 v[240:255], v[76:79], v[36:39], 0
s_waitcnt lgkmcnt(0)
ds_read_b128 v[32:35], v18 offset:0
ds_read_b128 v[36:39], v18 offset:4096
ds_read_b64_tr_b16 v[64:65], v20 offset:16384
ds_read_b64_tr_b16 v[66:67], v20 offset:18432
ds_read_b64_tr_b16 v[68:69], v21 offset:16384
ds_read_b64_tr_b16 v[70:71], v21 offset:18432
ds_read_b64_tr_b16 v[72:73], v22 offset:16384
ds_read_b64_tr_b16 v[74:75], v22 offset:18432
ds_read_b64_tr_b16 v[76:77], v23 offset:16384
ds_read_b64_tr_b16 v[78:79], v23 offset:18432
v_mfma_f32_32x32x16_bf16 v[128:143], v[80:83], v[40:43], v[128:143]
v_mfma_f32_32x32x16_bf16 v[144:159], v[80:83], v[44:47], v[144:159]
v_mfma_f32_32x32x16_bf16 v[160:175], v[84:87], v[40:43], v[160:175]
v_mfma_f32_32x32x16_bf16 v[176:191], v[84:87], v[44:47], v[176:191]
v_mfma_f32_32x32x16_bf16 v[192:207], v[88:91], v[40:43], v[192:207]
v_mfma_f32_32x32x16_bf16 v[208:223], v[88:91], v[44:47], v[208:223]
v_mfma_f32_32x32x16_bf16 v[224:239], v[92:95], v[40:43], v[224:239]
v_mfma_f32_32x32x16_bf16 v[240:255], v[92:95], v[44:47], v[240:255]
s_waitcnt lgkmcnt(0)
ds_read_b128 v[40:43], v19 offset:0
ds_read_b128 v[44:47], v19 offset:4096
ds_read_b64_tr_b16 v[80:81], v20 offset:24576
ds_read_b64_tr_b16 v[82:83], v20 offset:26624
ds_read_b64_tr_b16 v[84:85], v21 offset:24576
ds_read_b64_tr_b16 v[86:87], v21 offset:26624
ds_read_b64_tr_b16 v[88:89], v22 offset:24576
ds_read_b64_tr_b16 v[90:91], v22 offset:26624
ds_read_b64_tr_b16 v[92:93], v23 offset:24576
ds_read_b64_tr_b16 v[94:95], v23 offset:26624
v_mfma_f32_32x32x16_bf16 v[128:143], v[64:67], v[32:35], v[128:143]
v_mfma_f32_32x32x16_bf16 v[144:159], v[64:67], v[36:39], v[144:159]
v_mfma_f32_32x32x16_bf16 v[160:175], v[68:71], v[32:35], v[160:175]
v_mfma_f32_32x32x16_bf16 v[176:191], v[68:71], v[36:39], v[176:191]
v_mfma_f32_32x32x16_bf16 v[192:207], v[72:75], v[32:35], v[192:207]
v_mfma_f32_32x32x16_bf16 v[208:223], v[72:75], v[36:39], v[208:223]
v_mfma_f32_32x32x16_bf16 v[224:239], v[76:79], v[32:35], v[224:239]
v_mfma_f32_32x32x16_bf16 v[240:255], v[76:79], v[36:39], v[240:255]
s_waitcnt lgkmcnt(0)
s_waitcnt vmcnt(12)
s_barrier
s_add_u32 s38, s38, 49152
s_cmp_eq_u32 s38, 147456
s_cselect_b32 s38, 0, s38
v_add_u32 v16, s38, v8
v_add_u32 v17, s38, v9
v_add_u32 v18, s38, v10
v_add_u32 v19, s38, v11
s_add_u32 s25, s38, 16384
v_add_u32 v20, s25, v12
v_add_u32 v21, s25, v13
v_add_u32 v22, s25, v14
v_add_u32 v23, s25, v15
ds_read_b128 v[32:35], v16 offset:0
ds_read_b128 v[36:39], v16 offset:4096
ds_read_b64_tr_b16 v[64:65], v20 offset:0
ds_read_b64_tr_b16 v[66:67], v20 offset:2048
ds_read_b64_tr_b16 v[68:69], v21 offset:0
ds_read_b64_tr_b16 v[70:71], v21 offset:2048
ds_read_b64_tr_b16 v[72:73], v22 offset:0
ds_read_b64_tr_b16 v[74:75], v22 offset:2048
ds_read_b64_tr_b16 v[76:77], v23 offset:0
ds_read_b64_tr_b16 v[78:79], v23 offset:2048
v_mfma_f32_32x32x16_bf16 v[128:143], v[80:83], v[40:43], v[128:143]
v_mfma_f32_32x32x16_bf16 v[144:159], v[80:83], v[44:47], v[144:159]
v_mfma_f32_32x32x16_bf16 v[160:175], v[84:87], v[40:43], v[160:175]
v_mfma_f32_32x32x16_bf16 v[176:191], v[84:87], v[44:47], v[176:191]
v_mfma_f32_32x32x16_bf16 v[192:207], v[88:91], v[40:43], v[192:207]
v_mfma_f32_32x32x16_bf16 v[208:223], v[88:91], v[44:47], v[208:223]
v_mfma_f32_32x32x16_bf16 v[224:239], v[92:95], v[40:43], v[224:239]
v_mfma_f32_32x32x16_bf16 v[240:255], v[92:95], v[44:47], v[240:255]
s_mov_b32 s40, 1
L_gl_84:
s_waitcnt lgkmcnt(0)
ds_read_b128 v[40:43], v17 offset:0
ds_read_b128 v[44:47], v17 offset:4096
ds_read_b64_tr_b16 v[80:81], v20 offset:8192
ds_read_b64_tr_b16 v[82:83], v20 offset:10240
ds_read_b64_tr_b16 v[84:85], v21 offset:8192
ds_read_b64_tr_b16 v[86:87], v21 offset:10240
ds_read_b64_tr_b16 v[88:89], v22 offset:8192
ds_read_b64_tr_b16 v[90:91], v22 offset:10240
ds_read_b64_tr_b16 v[92:93], v23 offset:8192
ds_read_b64_tr_b16 v[94:95], v23 offset:10240
v_mfma_f32_32x32x16_bf16 v[128:143], v[64:67], v[32:35], v[128:143]
s_lshl_b32 s26, s11, 12
s_add_u32 s26, s26, s39
s_add_u32 m0, s26, 0
s_add_u32 s27, s36, 0
buffer_load_dwordx4 v2, s[16:19], s27 offen sc1 lds
v_mfma_f32_32x32x16_bf16 v[144:159], v[64:67], v[36:39], v[144:159]
s_lshl_b32 s26, s11, 12
s_add_u32 s26, s26, s39
s_add_u32 m0, s26, 1024
s_add_u32 s27, s36, 9216
buffer_load_dwordx4 v3, s[16:19], s27 offen sc1 lds
v_mfma_f32_32x32x16_bf16 v[160:175], v[68:71], v[32:35], v[160:175]
s_lshl_b32 s26, s11, 12
s_add_u32 s26, s26, s39
s_add_u32 m0, s26, 2048
s_add_u32 s27, s36, 18432
buffer_load_dwordx4 v2, s[16:19], s27 offen sc1 lds
v_mfma_f32_32x32x16_bf16 v[176:191], v[68:71], v[36:39], v[176:191]
s_lshl_b32 s26, s11, 12
s_add_u32 s26, s26, s39
s_add_u32 m0, s26, 3072
s_add_u32 s27, s36, 27648
buffer_load_dwordx4 v3, s[16:19], s27 offen sc1 lds
v_mfma_f32_32x32x16_bf16 v[192:207], v[72:75], v[32:35], v[192:207]
v_mfma_f32_32x32x16_bf16 v[208:223], v[72:75], v[36:39], v[208:223]
v_mfma_f32_32x32x16_bf16 v[224:239], v[76:79], v[32:35], v[224:239]
v_mfma_f32_32x32x16_bf16 v[240:255], v[76:79], v[36:39], v[240:255]
s_waitcnt lgkmcnt(0)
ds_read_b128 v[32:35], v18 offset:0
ds_read_b128 v[36:39], v18 offset:4096
ds_read_b64_tr_b16 v[64:65], v20 offset:16384
ds_read_b64_tr_b16 v[66:67], v20 offset:18432
ds_read_b64_tr_b16 v[68:69], v21 offset:16384
ds_read_b64_tr_b16 v[70:71], v21 offset:18432
ds_read_b64_tr_b16 v[72:73], v22 offset:16384
ds_read_b64_tr_b16 v[74:75], v22 offset:18432
ds_read_b64_tr_b16 v[76:77], v23 offset:16384
ds_read_b64_tr_b16 v[78:79], v23 offset:18432
v_mfma_f32_32x32x16_bf16 v[128:143], v[80:83], v[40:43], v[128:143]
s_add_u32 s36, s36, 128
s_lshl_b32 s26, s11, 13
s_add_u32 s26, s26, s39
s_add_u32 m0, s26, 16384
s_add_u32 s27, s37, 0
buffer_load_dwordx4 v5, s[20:23], s27 offen lds
v_mfma_f32_32x32x16_bf16 v[144:159], v[80:83], v[44:47], v[144:159]
s_lshl_b32 s26, s11, 13
s_add_u32 s26, s26, s39
s_add_u32 m0, s26, 17408
s_add_u32 s27, s37, 16384
buffer_load_dwordx4 v6, s[20:23], s27 offen lds
v_mfma_f32_32x32x16_bf16 v[160:175], v[84:87], v[40:43], v[160:175]
s_lshl_b32 s26, s11, 13
s_add_u32 s26, s26, s39
s_add_u32 m0, s26, 18432
s_add_u32 s27, s37, 32768
buffer_load_dwordx4 v5, s[20:23], s27 offen lds
v_mfma_f32_32x32x16_bf16 v[176:191], v[84:87], v[44:47], v[176:191]
s_lshl_b32 s26, s11, 13
s_add_u32 s26, s26, s39
s_add_u32 m0, s26, 19456
s_add_u32 s27, s37, 49152
buffer_load_dwordx4 v6, s[20:23], s27 offen lds
v_mfma_f32_32x32x16_bf16 v[192:207], v[88:91], v[40:43], v[192:207]
v_mfma_f32_32x32x16_bf16 v[208:223], v[88:91], v[44:47], v[208:223]
v_mfma_f32_32x32x16_bf16 v[224:239], v[92:95], v[40:43], v[224:239]
v_mfma_f32_32x32x16_bf16 v[240:255], v[92:95], v[44:47], v[240:255]
s_waitcnt lgkmcnt(0)
ds_read_b128 v[40:43], v19 offset:0
ds_read_b128 v[44:47], v19 offset:4096
ds_read_b64_tr_b16 v[80:81], v20 offset:24576
ds_read_b64_tr_b16 v[82:83], v20 offset:26624
ds_read_b64_tr_b16 v[84:85], v21 offset:24576
ds_read_b64_tr_b16 v[86:87], v21 offset:26624
ds_read_b64_tr_b16 v[88:89], v22 offset:24576
ds_read_b64_tr_b16 v[90:91], v22 offset:26624
ds_read_b64_tr_b16 v[92:93], v23 offset:24576
ds_read_b64_tr_b16 v[94:95], v23 offset:26624
v_mfma_f32_32x32x16_bf16 v[128:143], v[64:67], v[32:35], v[128:143]
s_lshl_b32 s26, s11, 13
s_add_u32 s26, s26, s39
s_add_u32 m0, s26, 20480
s_add_u32 s27, s37, 65536
buffer_load_dwordx4 v5, s[20:23], s27 offen lds
v_mfma_f32_32x32x16_bf16 v[144:159], v[64:67], v[36:39], v[144:159]
s_lshl_b32 s26, s11, 13
s_add_u32 s26, s26, s39
s_add_u32 m0, s26, 21504
s_add_u32 s27, s37, 81920
buffer_load_dwordx4 v6, s[20:23], s27 offen lds
v_mfma_f32_32x32x16_bf16 v[160:175], v[68:71], v[32:35], v[160:175]
s_lshl_b32 s26, s11, 13
s_add_u32 s26, s26, s39
s_add_u32 m0, s26, 22528
s_add_u32 s27, s37, 98304
buffer_load_dwordx4 v5, s[20:23], s27 offen lds
v_mfma_f32_32x32x16_bf16 v[176:191], v[68:71], v[36:39], v[176:191]
s_lshl_b32 s26, s11, 13
s_add_u32 s26, s26, s39
s_add_u32 m0, s26, 23552
s_add_u32 s27, s37, 114688
buffer_load_dwordx4 v6, s[20:23], s27 offen lds
s_add_u32 s37, s37, 524288
v_mfma_f32_32x32x16_bf16 v[192:207], v[72:75], v[32:35], v[192:207]
v_mfma_f32_32x32x16_bf16 v[208:223], v[72:75], v[36:39], v[208:223]
v_mfma_f32_32x32x16_bf16 v[224:239], v[76:79], v[32:35], v[224:239]
v_mfma_f32_32x32x16_bf16 v[240:255], v[76:79], v[36:39], v[240:255]
s_waitcnt lgkmcnt(0)
s_waitcnt vmcnt(12)
s_barrier
s_add_u32 s38, s38, 49152
s_cmp_eq_u32 s38, 147456
s_cselect_b32 s38, 0, s38
v_add_u32 v16, s38, v8
v_add_u32 v17, s38, v9
v_add_u32 v18, s38, v10
v_add_u32 v19, s38, v11
s_add_u32 s25, s38, 16384
v_add_u32 v20, s25, v12
v_add_u32 v21, s25, v13
v_add_u32 v22, s25, v14
v_add_u32 v23, s25, v15
ds_read_b128 v[32:35], v16 offset:0
ds_read_b128 v[36:39], v16 offset:4096
ds_read_b64_tr_b16 v[64:65], v20 offset:0
ds_read_b64_tr_b16 v[66:67], v20 offset:2048
ds_read_b64_tr_b16 v[68:69], v21 offset:0
ds_read_b64_tr_b16 v[70:71], v21 offset:2048
ds_read_b64_tr_b16 v[72:73], v22 offset:0
ds_read_b64_tr_b16 v[74:75], v22 offset:2048
ds_read_b64_tr_b16 v[76:77], v23 offset:0
ds_read_b64_tr_b16 v[78:79], v23 offset:2048
v_mfma_f32_32x32x16_bf16 v[128:143], v[80:83], v[40:43], v[128:143]
v_mfma_f32_32x32x16_bf16 v[144:159], v[80:83], v[44:47], v[144:159]
v_mfma_f32_32x32x16_bf16 v[160:175], v[84:87], v[40:43], v[160:175]
v_mfma_f32_32x32x16_bf16 v[176:191], v[84:87], v[44:47], v[176:191]
v_mfma_f32_32x32x16_bf16 v[192:207], v[88:91], v[40:43], v[192:207]
v_mfma_f32_32x32x16_bf16 v[208:223], v[88:91], v[44:47], v[208:223]
v_mfma_f32_32x32x16_bf16 v[224:239], v[92:95], v[40:43], v[224:239]
v_mfma_f32_32x32x16_bf16 v[240:255], v[92:95], v[44:47], v[240:255]
s_add_u32 s39, s39, 49152
s_cmp_eq_u32 s39, 147456
s_cselect_b32 s39, 0, s39
s_add_u32 s40, s40, 1
s_cmp_lt_u32 s40, 7
s_cbranch_scc1 L_gl_84
s_waitcnt lgkmcnt(0)
ds_read_b128 v[40:43], v17 offset:0
ds_read_b128 v[44:47], v17 offset:4096
ds_read_b64_tr_b16 v[80:81], v20 offset:8192
ds_read_b64_tr_b16 v[82:83], v20 offset:10240
ds_read_b64_tr_b16 v[84:85], v21 offset:8192
ds_read_b64_tr_b16 v[86:87], v21 offset:10240
ds_read_b64_tr_b16 v[88:89], v22 offset:8192
ds_read_b64_tr_b16 v[90:91], v22 offset:10240
ds_read_b64_tr_b16 v[92:93], v23 offset:8192
ds_read_b64_tr_b16 v[94:95], v23 offset:10240
v_mfma_f32_32x32x16_bf16 v[128:143], v[64:67], v[32:35], v[128:143]
v_mfma_f32_32x32x16_bf16 v[144:159], v[64:67], v[36:39], v[144:159]
v_mfma_f32_32x32x16_bf16 v[160:175], v[68:71], v[32:35], v[160:175]
v_mfma_f32_32x32x16_bf16 v[176:191], v[68:71], v[36:39], v[176:191]
v_mfma_f32_32x32x16_bf16 v[192:207], v[72:75], v[32:35], v[192:207]
v_mfma_f32_32x32x16_bf16 v[208:223], v[72:75], v[36:39], v[208:223]
v_mfma_f32_32x32x16_bf16 v[224:239], v[76:79], v[32:35], v[224:239]
v_mfma_f32_32x32x16_bf16 v[240:255], v[76:79], v[36:39], v[240:255]
s_waitcnt lgkmcnt(0)
ds_read_b128 v[32:35], v18 offset:0
ds_read_b128 v[36:39], v18 offset:4096
ds_read_b64_tr_b16 v[64:65], v20 offset:16384
ds_read_b64_tr_b16 v[66:67], v20 offset:18432
ds_read_b64_tr_b16 v[68:69], v21 offset:16384
ds_read_b64_tr_b16 v[70:71], v21 offset:18432
ds_read_b64_tr_b16 v[72:73], v22 offset:16384
ds_read_b64_tr_b16 v[74:75], v22 offset:18432
ds_read_b64_tr_b16 v[76:77], v23 offset:16384
ds_read_b64_tr_b16 v[78:79], v23 offset:18432
v_mfma_f32_32x32x16_bf16 v[128:143], v[80:83], v[40:43], v[128:143]
v_mfma_f32_32x32x16_bf16 v[144:159], v[80:83], v[44:47], v[144:159]
v_mfma_f32_32x32x16_bf16 v[160:175], v[84:87], v[40:43], v[160:175]
v_mfma_f32_32x32x16_bf16 v[176:191], v[84:87], v[44:47], v[176:191]
v_mfma_f32_32x32x16_bf16 v[192:207], v[88:91], v[40:43], v[192:207]
v_mfma_f32_32x32x16_bf16 v[208:223], v[88:91], v[44:47], v[208:223]
v_mfma_f32_32x32x16_bf16 v[224:239], v[92:95], v[40:43], v[224:239]
v_mfma_f32_32x32x16_bf16 v[240:255], v[92:95], v[44:47], v[240:255]
s_waitcnt lgkmcnt(0)
ds_read_b128 v[40:43], v19 offset:0
ds_read_b128 v[44:47], v19 offset:4096
ds_read_b64_tr_b16 v[80:81], v20 offset:24576
ds_read_b64_tr_b16 v[82:83], v20 offset:26624
ds_read_b64_tr_b16 v[84:85], v21 offset:24576
ds_read_b64_tr_b16 v[86:87], v21 offset:26624
ds_read_b64_tr_b16 v[88:89], v22 offset:24576
ds_read_b64_tr_b16 v[90:91], v22 offset:26624
ds_read_b64_tr_b16 v[92:93], v23 offset:24576
ds_read_b64_tr_b16 v[94:95], v23 offset:26624
v_mfma_f32_32x32x16_bf16 v[128:143], v[64:67], v[32:35], v[128:143]
v_mfma_f32_32x32x16_bf16 v[144:159], v[64:67], v[36:39], v[144:159]
v_mfma_f32_32x32x16_bf16 v[160:175], v[68:71], v[32:35], v[160:175]
v_mfma_f32_32x32x16_bf16 v[176:191], v[68:71], v[36:39], v[176:191]
v_mfma_f32_32x32x16_bf16 v[192:207], v[72:75], v[32:35], v[192:207]
v_mfma_f32_32x32x16_bf16 v[208:223], v[72:75], v[36:39], v[208:223]
v_mfma_f32_32x32x16_bf16 v[224:239], v[76:79], v[32:35], v[224:239]
v_mfma_f32_32x32x16_bf16 v[240:255], v[76:79], v[36:39], v[240:255]
s_waitcnt lgkmcnt(0)
s_waitcnt vmcnt(0)
s_barrier
s_add_u32 s38, s38, 49152
s_cmp_eq_u32 s38, 147456
s_cselect_b32 s38, 0, s38
v_add_u32 v16, s38, v8
v_add_u32 v17, s38, v9
v_add_u32 v18, s38, v10
v_add_u32 v19, s38, v11
s_add_u32 s25, s38, 16384
v_add_u32 v20, s25, v12
v_add_u32 v21, s25, v13
v_add_u32 v22, s25, v14
v_add_u32 v23, s25, v15
ds_read_b128 v[32:35], v16 offset:0
ds_read_b128 v[36:39], v16 offset:4096
ds_read_b64_tr_b16 v[64:65], v20 offset:0
ds_read_b64_tr_b16 v[66:67], v20 offset:2048
ds_read_b64_tr_b16 v[68:69], v21 offset:0
ds_read_b64_tr_b16 v[70:71], v21 offset:2048
ds_read_b64_tr_b16 v[72:73], v22 offset:0
ds_read_b64_tr_b16 v[74:75], v22 offset:2048
ds_read_b64_tr_b16 v[76:77], v23 offset:0
ds_read_b64_tr_b16 v[78:79], v23 offset:2048
v_mfma_f32_32x32x16_bf16 v[128:143], v[80:83], v[40:43], v[128:143]
v_mfma_f32_32x32x16_bf16 v[144:159], v[80:83], v[44:47], v[144:159]
v_mfma_f32_32x32x16_bf16 v[160:175], v[84:87], v[40:43], v[160:175]
v_mfma_f32_32x32x16_bf16 v[176:191], v[84:87], v[44:47], v[176:191]
v_mfma_f32_32x32x16_bf16 v[192:207], v[88:91], v[40:43], v[192:207]
v_mfma_f32_32x32x16_bf16 v[208:223], v[88:91], v[44:47], v[208:223]
v_mfma_f32_32x32x16_bf16 v[224:239], v[92:95], v[40:43], v[224:239]
v_mfma_f32_32x32x16_bf16 v[240:255], v[92:95], v[44:47], v[240:255]
s_waitcnt lgkmcnt(0)
ds_read_b128 v[40:43], v17 offset:0
ds_read_b128 v[44:47], v17 offset:4096
ds_read_b64_tr_b16 v[80:81], v20 offset:8192
ds_read_b64_tr_b16 v[82:83], v20 offset:10240
ds_read_b64_tr_b16 v[84:85], v21 offset:8192
ds_read_b64_tr_b16 v[86:87], v21 offset:10240
ds_read_b64_tr_b16 v[88:89], v22 offset:8192
ds_read_b64_tr_b16 v[90:91], v22 offset:10240
ds_read_b64_tr_b16 v[92:93], v23 offset:8192
ds_read_b64_tr_b16 v[94:95], v23 offset:10240
v_mfma_f32_32x32x16_bf16 v[128:143], v[64:67], v[32:35], v[128:143]
v_mfma_f32_32x32x16_bf16 v[144:159], v[64:67], v[36:39], v[144:159]
v_mfma_f32_32x32x16_bf16 v[160:175], v[68:71], v[32:35], v[160:175]
v_mfma_f32_32x32x16_bf16 v[176:191], v[68:71], v[36:39], v[176:191]
v_mfma_f32_32x32x16_bf16 v[192:207], v[72:75], v[32:35], v[192:207]
v_mfma_f32_32x32x16_bf16 v[208:223], v[72:75], v[36:39], v[208:223]
v_mfma_f32_32x32x16_bf16 v[224:239], v[76:79], v[32:35], v[224:239]
v_mfma_f32_32x32x16_bf16 v[240:255], v[76:79], v[36:39], v[240:255]
s_waitcnt lgkmcnt(0)
ds_read_b128 v[32:35], v18 offset:0
ds_read_b128 v[36:39], v18 offset:4096
ds_read_b64_tr_b16 v[64:65], v20 offset:16384
ds_read_b64_tr_b16 v[66:67], v20 offset:18432
ds_read_b64_tr_b16 v[68:69], v21 offset:16384
ds_read_b64_tr_b16 v[70:71], v21 offset:18432
ds_read_b64_tr_b16 v[72:73], v22 offset:16384
ds_read_b64_tr_b16 v[74:75], v22 offset:18432
ds_read_b64_tr_b16 v[76:77], v23 offset:16384
ds_read_b64_tr_b16 v[78:79], v23 offset:18432
v_mfma_f32_32x32x16_bf16 v[128:143], v[80:83], v[40:43], v[128:143]
v_mfma_f32_32x32x16_bf16 v[144:159], v[80:83], v[44:47], v[144:159]
v_mfma_f32_32x32x16_bf16 v[160:175], v[84:87], v[40:43], v[160:175]
v_mfma_f32_32x32x16_bf16 v[176:191], v[84:87], v[44:47], v[176:191]
v_mfma_f32_32x32x16_bf16 v[192:207], v[88:91], v[40:43], v[192:207]
v_mfma_f32_32x32x16_bf16 v[208:223], v[88:91], v[44:47], v[208:223]
v_mfma_f32_32x32x16_bf16 v[224:239], v[92:95], v[40:43], v[224:239]
v_mfma_f32_32x32x16_bf16 v[240:255], v[92:95], v[44:47], v[240:255]
s_waitcnt lgkmcnt(0)
ds_read_b128 v[40:43], v19 offset:0
ds_read_b128 v[44:47], v19 offset:4096
ds_read_b64_tr_b16 v[80:81], v20 offset:24576
ds_read_b64_tr_b16 v[82:83], v20 offset:26624
ds_read_b64_tr_b16 v[84:85], v21 offset:24576
ds_read_b64_tr_b16 v[86:87], v21 offset:26624
ds_read_b64_tr_b16 v[88:89], v22 offset:24576
ds_read_b64_tr_b16 v[90:91], v22 offset:26624
ds_read_b64_tr_b16 v[92:93], v23 offset:24576
ds_read_b64_tr_b16 v[94:95], v23 offset:26624
v_mfma_f32_32x32x16_bf16 v[128:143], v[64:67], v[32:35], v[128:143]
v_mfma_f32_32x32x16_bf16 v[144:159], v[64:67], v[36:39], v[144:159]
v_mfma_f32_32x32x16_bf16 v[160:175], v[68:71], v[32:35], v[160:175]
v_mfma_f32_32x32x16_bf16 v[176:191], v[68:71], v[36:39], v[176:191]
v_mfma_f32_32x32x16_bf16 v[192:207], v[72:75], v[32:35], v[192:207]
v_mfma_f32_32x32x16_bf16 v[208:223], v[72:75], v[36:39], v[208:223]
v_mfma_f32_32x32x16_bf16 v[224:239], v[76:79], v[32:35], v[224:239]
v_mfma_f32_32x32x16_bf16 v[240:255], v[76:79], v[36:39], v[240:255]
s_waitcnt lgkmcnt(0)
v_mfma_f32_32x32x16_bf16 v[128:143], v[80:83], v[40:43], v[128:143]
v_mfma_f32_32x32x16_bf16 v[144:159], v[80:83], v[44:47], v[144:159]
v_mfma_f32_32x32x16_bf16 v[160:175], v[84:87], v[40:43], v[160:175]
v_mfma_f32_32x32x16_bf16 v[176:191], v[84:87], v[44:47], v[176:191]
v_mfma_f32_32x32x16_bf16 v[192:207], v[88:91], v[40:43], v[192:207]
v_mfma_f32_32x32x16_bf16 v[208:223], v[88:91], v[44:47], v[208:223]
v_mfma_f32_32x32x16_bf16 v[224:239], v[92:95], v[40:43], v[224:239]
v_mfma_f32_32x32x16_bf16 v[240:255], v[92:95], v[44:47], v[240:255]
s_nop 15
s_cmp_eq_u32 s43, 0
s_mov_b32 s41, 16777216
s_cselect_b32 s41, 50331648, s41
s_and_b32 s24, s11, 1
s_lshl_b32 s24, s24, 1
s_lshl_b32 s25, s44, 2
s_add_u32 s24, s24, s25
s_lshl_b32 s24, s24, 18
s_add_u32 s41, s41, s24
s_lshl_b32 s24, s45, 1
s_lshr_b32 s25, s11, 1
s_add_u32 s24, s24, s25
s_lshl_b32 s24, s24, 13
s_add_u32 s41, s41, s24
v_and_b32 v24, 31, v0
v_lshlrev_b32 v24, 4, v24
v_lshrrev_b32 v25, 5, v0
v_lshl_add_u32 v24, v25, 9, v24
v_cvt_pk_bf16_f32 v32, v128, v129
v_cvt_pk_bf16_f32 v33, v130, v131
v_cvt_pk_bf16_f32 v34, v132, v133
v_cvt_pk_bf16_f32 v35, v134, v135
s_nop 0
v_permlane32_swap_b32 v32, v34
v_permlane32_swap_b32 v33, v35
s_add_u32 s24, s41, 0
buffer_store_dwordx4 v[32:35], v24, s[12:15], s24 offen sc1
v_cvt_pk_bf16_f32 v36, v136, v137
v_cvt_pk_bf16_f32 v37, v138, v139
v_cvt_pk_bf16_f32 v38, v140, v141
v_cvt_pk_bf16_f32 v39, v142, v143
s_nop 0
v_permlane32_swap_b32 v36, v38
v_permlane32_swap_b32 v37, v39
s_add_u32 s24, s41, 1024
buffer_store_dwordx4 v[36:39], v24, s[12:15], s24 offen sc1
v_cvt_pk_bf16_f32 v40, v160, v161
v_cvt_pk_bf16_f32 v41, v162, v163
v_cvt_pk_bf16_f32 v42, v164, v165
v_cvt_pk_bf16_f32 v43, v166, v167
s_nop 0
v_permlane32_swap_b32 v40, v42
v_permlane32_swap_b32 v41, v43
s_add_u32 s24, s41, 2048
buffer_store_dwordx4 v[40:43], v24, s[12:15], s24 offen sc1
v_cvt_pk_bf16_f32 v44, v168, v169
v_cvt_pk_bf16_f32 v45, v170, v171
v_cvt_pk_bf16_f32 v46, v172, v173
v_cvt_pk_bf16_f32 v47, v174, v175
s_nop 0
v_permlane32_swap_b32 v44, v46
v_permlane32_swap_b32 v45, v47
s_add_u32 s24, s41, 3072
buffer_store_dwordx4 v[44:47], v24, s[12:15], s24 offen sc1
v_cvt_pk_bf16_f32 v48, v192, v193
v_cvt_pk_bf16_f32 v49, v194, v195
v_cvt_pk_bf16_f32 v50, v196, v197
v_cvt_pk_bf16_f32 v51, v198, v199
s_nop 0
v_permlane32_swap_b32 v48, v50
v_permlane32_swap_b32 v49, v51
s_add_u32 s24, s41, 4096
buffer_store_dwordx4 v[48:51], v24, s[12:15], s24 offen sc1
v_cvt_pk_bf16_f32 v52, v200, v201
v_cvt_pk_bf16_f32 v53, v202, v203
v_cvt_pk_bf16_f32 v54, v204, v205
v_cvt_pk_bf16_f32 v55, v206, v207
s_nop 0
v_permlane32_swap_b32 v52, v54
v_permlane32_swap_b32 v53, v55
s_add_u32 s24, s41, 5120
buffer_store_dwordx4 v[52:55], v24, s[12:15], s24 offen sc1
v_cvt_pk_bf16_f32 v56, v224, v225
v_cvt_pk_bf16_f32 v57, v226, v227
v_cvt_pk_bf16_f32 v58, v228, v229
v_cvt_pk_bf16_f32 v59, v230, v231
s_nop 0
v_permlane32_swap_b32 v56, v58
v_permlane32_swap_b32 v57, v59
s_add_u32 s24, s41, 6144
buffer_store_dwordx4 v[56:59], v24, s[12:15], s24 offen sc1
v_cvt_pk_bf16_f32 v60, v232, v233
v_cvt_pk_bf16_f32 v61, v234, v235
v_cvt_pk_bf16_f32 v62, v236, v237
v_cvt_pk_bf16_f32 v63, v238, v239
s_nop 0
v_permlane32_swap_b32 v60, v62
v_permlane32_swap_b32 v61, v63
s_add_u32 s24, s41, 7168
buffer_store_dwordx4 v[60:63], v24, s[12:15], s24 offen sc1
v_cvt_pk_bf16_f32 v32, v144, v145
v_cvt_pk_bf16_f32 v33, v146, v147
v_cvt_pk_bf16_f32 v34, v148, v149
v_cvt_pk_bf16_f32 v35, v150, v151
s_nop 0
v_permlane32_swap_b32 v32, v34
v_permlane32_swap_b32 v33, v35
s_add_u32 s24, s41, 262144
buffer_store_dwordx4 v[32:35], v24, s[12:15], s24 offen sc1
v_cvt_pk_bf16_f32 v36, v152, v153
v_cvt_pk_bf16_f32 v37, v154, v155
v_cvt_pk_bf16_f32 v38, v156, v157
v_cvt_pk_bf16_f32 v39, v158, v159
s_nop 0
v_permlane32_swap_b32 v36, v38
v_permlane32_swap_b32 v37, v39
s_add_u32 s24, s41, 263168
buffer_store_dwordx4 v[36:39], v24, s[12:15], s24 offen sc1
v_cvt_pk_bf16_f32 v40, v176, v177
v_cvt_pk_bf16_f32 v41, v178, v179
v_cvt_pk_bf16_f32 v42, v180, v181
v_cvt_pk_bf16_f32 v43, v182, v183
s_nop 0
v_permlane32_swap_b32 v40, v42
v_permlane32_swap_b32 v41, v43
s_add_u32 s24, s41, 264192
buffer_store_dwordx4 v[40:43], v24, s[12:15], s24 offen sc1
v_cvt_pk_bf16_f32 v44, v184, v185
v_cvt_pk_bf16_f32 v45, v186, v187
v_cvt_pk_bf16_f32 v46, v188, v189
v_cvt_pk_bf16_f32 v47, v190, v191
s_nop 0
v_permlane32_swap_b32 v44, v46
v_permlane32_swap_b32 v45, v47
s_add_u32 s24, s41, 265216
buffer_store_dwordx4 v[44:47], v24, s[12:15], s24 offen sc1
v_cvt_pk_bf16_f32 v48, v208, v209
v_cvt_pk_bf16_f32 v49, v210, v211
v_cvt_pk_bf16_f32 v50, v212, v213
v_cvt_pk_bf16_f32 v51, v214, v215
s_nop 0
v_permlane32_swap_b32 v48, v50
v_permlane32_swap_b32 v49, v51
s_add_u32 s24, s41, 266240
buffer_store_dwordx4 v[48:51], v24, s[12:15], s24 offen sc1
v_cvt_pk_bf16_f32 v52, v216, v217
v_cvt_pk_bf16_f32 v53, v218, v219
v_cvt_pk_bf16_f32 v54, v220, v221
v_cvt_pk_bf16_f32 v55, v222, v223
s_nop 0
v_permlane32_swap_b32 v52, v54
v_permlane32_swap_b32 v53, v55
s_add_u32 s24, s41, 267264
buffer_store_dwordx4 v[52:55], v24, s[12:15], s24 offen sc1
v_cvt_pk_bf16_f32 v56, v240, v241
v_cvt_pk_bf16_f32 v57, v242, v243
v_cvt_pk_bf16_f32 v58, v244, v245
v_cvt_pk_bf16_f32 v59, v246, v247
s_nop 0
v_permlane32_swap_b32 v56, v58
v_permlane32_swap_b32 v57, v59
s_add_u32 s24, s41, 268288
buffer_store_dwordx4 v[56:59], v24, s[12:15], s24 offen sc1
v_cvt_pk_bf16_f32 v60, v248, v249
v_cvt_pk_bf16_f32 v61, v250, v251
v_cvt_pk_bf16_f32 v62, v252, v253
v_cvt_pk_bf16_f32 v63, v254, v255
s_nop 0
v_permlane32_swap_b32 v60, v62
v_permlane32_swap_b32 v61, v63
s_add_u32 s24, s41, 269312
buffer_store_dwordx4 v[60:63], v24, s[12:15], s24 offen sc1
s_branch L_g1e_81
L_g1v_80:
s_barrier
s_mov_b32 s39, 0
s_mov_b32 s38, 0
s_lshl_b32 s26, s11, 13
s_add_u32 s26, s26, s39
s_add_u32 m0, s26, 16384
s_add_u32 s27, s37, 0
buffer_load_dwordx4 v5, s[20:23], s27 offen lds
s_lshl_b32 s26, s11, 13
s_add_u32 s26, s26, s39
s_add_u32 m0, s26, 17408
s_add_u32 s27, s37, 16384
buffer_load_dwordx4 v6, s[20:23], s27 offen lds
s_lshl_b32 s26, s11, 13
s_add_u32 s26, s26, s39
s_add_u32 m0, s26, 18432
s_add_u32 s27, s37, 32768
buffer_load_dwordx4 v5, s[20:23], s27 offen lds
s_lshl_b32 s26, s11, 13
s_add_u32 s26, s26, s39
s_add_u32 m0, s26, 19456
s_add_u32 s27, s37, 49152
buffer_load_dwordx4 v6, s[20:23], s27 offen lds
s_lshl_b32 s26, s11, 13
s_add_u32 s26, s26, s39
s_add_u32 m0, s26, 20480
s_add_u32 s27, s37, 65536
buffer_load_dwordx4 v5, s[20:23], s27 offen lds
s_lshl_b32 s26, s11, 13
s_add_u32 s26, s26, s39
s_add_u32 m0, s26, 21504
s_add_u32 s27, s37, 81920
buffer_load_dwordx4 v6, s[20:23], s27 offen lds
s_lshl_b32 s26, s11, 13
s_add_u32 s26, s26, s39
s_add_u32 m0, s26, 22528
s_add_u32 s27, s37, 98304
buffer_load_dwordx4 v5, s[20:23], s27 offen lds
s_lshl_b32 s26, s11, 13
s_add_u32 s26, s26, s39
s_add_u32 m0, s26, 23552
s_add_u32 s27, s37, 114688
buffer_load_dwordx4 v6, s[20:23], s27 offen lds
s_add_u32 s37, s37, 524288
s_lshl_b32 s76, s44, 7
s_add_u32 s76, s76, 77594624
s_cmp_lg_u32 s11, 0
s_cbranch_scc1 L_wd_85
s_mov_b32 s60, s76
s_mov_b32 s61, 0
L_wp_86:
buffer_load_dword v1, off, s[12:15], s60 sc1
s_waitcnt vmcnt(0)
v_readfirstlane_b32 s62, v1
s_nop 0
s_cmp_ge_u32 s62, 128
s_cbranch_scc1 L_wd_85
s_add_u32 s61, s61, 1
s_cmp_gt_u32 s61, 4000000
s_cbranch_scc1 L_abortw
s_sleep 1
s_branch L_wp_86
L_wd_85:
s_barrier
s_lshl_b32 s26, s11, 12
s_add_u32 s26, s26, s39
s_add_u32 m0, s26, 0
s_add_u32 s27, s36, 0
buffer_load_dwordx4 v2, s[16:19], s27 offen sc1 lds
s_lshl_b32 s26, s11, 12
s_add_u32 s26, s26, s39
s_add_u32 m0, s26, 1024
s_add_u32 s27, s36, 9216
buffer_load_dwordx4 v3, s[16:19], s27 offen sc1 lds
s_lshl_b32 s26, s11, 12
s_add_u32 s26, s26, s39
s_add_u32 m0, s26, 2048
s_add_u32 s27, s36, 18432
buffer_load_dwordx4 v2, s[16:19], s27 offen sc1 lds
s_lshl_b32 s26, s11, 12
s_add_u32 s26, s26, s39
s_add_u32 m0, s26, 3072
s_add_u32 s27, s36, 27648
buffer_load_dwordx4 v3, s[16:19], s27 offen sc1 lds
s_add_u32 s36, s36, 128
s_add_u32 s39, s39, 49152
s_cmp_eq_u32 s39, 147456
s_cselect_b32 s39, 0, s39
s_lshl_b32 s26, s11, 12
s_add_u32 s26, s26, s39
s_add_u32 m0, s26, 0
s_add_u32 s27, s36, 0
buffer_load_dwordx4 v2, s[16:19], s27 offen sc1 lds
s_lshl_b32 s26, s11, 12
s_add_u32 s26, s26, s39
s_add_u32 m0, s26, 1024
s_add_u32 s27, s36, 9216
buffer_load_dwordx4 v3, s[16:19], s27 offen sc1 lds
s_lshl_b32 s26, s11, 12
s_add_u32 s26, s26, s39
s_add_u32 m0, s26, 2048
s_add_u32 s27, s36, 18432
buffer_load_dwordx4 v2, s[16:19], s27 offen sc1 lds
s_lshl_b32 s26, s11, 12
s_add_u32 s26, s26, s39
s_add_u32 m0, s26, 3072
s_add_u32 s27, s36, 27648
buffer_load_dwordx4 v3, s[16:19], s27 offen sc1 lds
s_add_u32 s36, s36, 128
s_lshl_b32 s26, s11, 13
s_add_u32 s26, s26, s39
s_add_u32 m0, s26, 16384
s_add_u32 s27, s37, 0
buffer_load_dwordx4 v5, s[20:23], s27 offen lds
s_lshl_b32 s26, s11, 13
s_add_u32 s26, s26, s39
s_add_u32 m0, s26, 17408
s_add_u32 s27, s37, 16384
buffer_load_dwordx4 v6, s[20:23], s27 offen lds
s_lshl_b32 s26, s11, 13
s_add_u32 s26, s26, s39
s_add_u32 m0, s26, 18432
s_add_u32 s27, s37, 32768
buffer_load_dwordx4 v5, s[20:23], s27 offen lds
s_lshl_b32 s26, s11, 13
s_add_u32 s26, s26, s39
s_add_u32 m0, s26, 19456
s_add_u32 s27, s37, 49152
buffer_load_dwordx4 v6, s[20:23], s27 offen lds
s_lshl_b32 s26, s11, 13
s_add_u32 s26, s26, s39
s_add_u32 m0, s26, 20480
s_add_u32 s27, s37, 65536
buffer_load_dwordx4 v5, s[20:23], s27 offen lds
s_lshl_b32 s26, s11, 13
s_add_u32 s26, s26, s39
s_add_u32 m0, s26, 21504
s_add_u32 s27, s37, 81920
buffer_load_dwordx4 v6, s[20:23], s27 offen lds
s_lshl_b32 s26, s11, 13
s_add_u32 s26, s26, s39
s_add_u32 m0, s26, 22528
s_add_u32 s27, s37, 98304
buffer_load_dwordx4 v5, s[20:23], s27 offen lds
s_lshl_b32 s26, s11, 13
s_add_u32 s26, s26, s39
s_add_u32 m0, s26, 23552
s_add_u32 s27, s37, 114688
buffer_load_dwordx4 v6, s[20:23], s27 offen lds
s_add_u32 s37, s37, 524288
s_add_u32 s39, s39, 49152
s_cmp_eq_u32 s39, 147456
s_cselect_b32 s39, 0, s39
s_lshl_b32 s26, s11, 12
s_add_u32 s26, s26, s39
s_add_u32 m0, s26, 0
s_add_u32 s27, s36, 0
buffer_load_dwordx4 v2, s[16:19], s27 offen sc1 lds
s_lshl_b32 s26, s11, 12
s_add_u32 s26, s26, s39
s_add_u32 m0, s26, 1024
s_add_u32 s27, s36, 9216
buffer_load_dwordx4 v3, s[16:19], s27 offen sc1 lds
s_lshl_b32 s26, s11, 12
s_add_u32 s26, s26, s39
s_add_u32 m0, s26, 2048
s_add_u32 s27, s36, 18432
buffer_load_dwordx4 v2, s[16:19], s27 offen sc1 lds
s_lshl_b32 s26, s11, 12
s_add_u32 s26, s26, s39
s_add_u32 m0, s26, 3072
s_add_u32 s27, s36, 27648
buffer_load_dwordx4 v3, s[16:19], s27 offen sc1 lds
s_add_u32 s36, s36, 128
s_lshl_b32 s26, s11, 13
s_add_u32 s26, s26, s39
s_add_u32 m0, s26, 16384
s_add_u32 s27, s37, 0
buffer_load_dwordx4 v5, s[20:23], s27 offen lds
s_lshl_b32 s26, s11, 13
s_add_u32 s26, s26, s39
s_add_u32 m0, s26, 17408
s_add_u32 s27, s37, 16384
buffer_load_dwordx4 v6, s[20:23], s27 offen lds
s_lshl_b32 s26, s11, 13
s_add_u32 s26, s26, s39
s_add_u32 m0, s26, 18432
s_add_u32 s27, s37, 32768
buffer_load_dwordx4 v5, s[20:23], s27 offen lds
s_lshl_b32 s26, s11, 13
s_add_u32 s26, s26, s39
s_add_u32 m0, s26, 19456
s_add_u32 s27, s37, 49152
buffer_load_dwordx4 v6, s[20:23], s27 offen lds
s_lshl_b32 s26, s11, 13
s_add_u32 s26, s26, s39
s_add_u32 m0, s26, 20480
s_add_u32 s27, s37, 65536
buffer_load_dwordx4 v5, s[20:23], s27 offen lds
s_lshl_b32 s26, s11, 13
s_add_u32 s26, s26, s39
s_add_u32 m0, s26, 21504
s_add_u32 s27, s37, 81920
buffer_load_dwordx4 v6, s[20:23], s27 offen lds
s_lshl_b32 s26, s11, 13
s_add_u32 s26, s26, s39
s_add_u32 m0, s26, 22528
s_add_u32 s27, s37, 98304
buffer_load_dwordx4 v5, s[20:23], s27 offen lds
s_lshl_b32 s26, s11, 13
s_add_u32 s26, s26, s39
s_add_u32 m0, s26, 23552
s_add_u32 s27, s37, 114688
buffer_load_dwordx4 v6, s[20:23], s27 offen lds
s_add_u32 s37, s37, 524288
s_add_u32 s39, s39, 49152
s_cmp_eq_u32 s39, 147456
s_cselect_b32 s39, 0, s39
s_waitcnt vmcnt(24)
s_barrier
v_add_u32 v16, s38, v8
v_add_u32 v17, s38, v9
v_add_u32 v18, s38, v10
v_add_u32 v19, s38, v11
s_add_u32 s25, s38, 16384
v_add_u32 v20, s25, v12
v_add_u32 v21, s25, v13
v_add_u32 v22, s25, v14
v_add_u32 v23, s25, v15
ds_read_b128 v[32:35], v16 offset:0
ds_read_b128 v[36:39], v16 offset:4096
ds_read_b64_tr_b16 v[64:65], v20 offset:0
ds_read_b64_tr_b16 v[66:67], v20 offset:2048
ds_read_b64_tr_b16 v[68:69], v21 offset:0
ds_read_b64_tr_b16 v[70:71], v21 offset:2048
ds_read_b64_tr_b16 v[72:73], v22 offset:0
ds_read_b64_tr_b16 v[74:75], v22 offset:2048
ds_read_b64_tr_b16 v[76:77], v23 offset:0
ds_read_b64_tr_b16 v[78:79], v23 offset:2048
s_waitcnt lgkmcnt(0)
ds_read_b128 v[40:43], v17 offset:0
ds_read_b128 v[44:47], v17 offset:4096
ds_read_b64_tr_b16 v[80:81], v20 offset:8192
ds_read_b64_tr_b16 v[82:83], v20 offset:10240
ds_read_b64_tr_b16 v[84:85], v21 offset:8192
ds_read_b64_tr_b16 v[86:87], v21 offset:10240
ds_read_b64_tr_b16 v[88:89], v22 offset:8192
ds_read_b64_tr_b16 v[90:91], v22 offset:10240
ds_read_b64_tr_b16 v[92:93], v23 offset:8192
ds_read_b64_tr_b16 v[94:95], v23 offset:10240
v_mfma_f32_32x32x16_bf16 v[128:143], v[32:35], v[64:67], 0
v_mfma_f32_32x32x16_bf16 v[144:159], v[36:39], v[64:67], 0
v_mfma_f32_32x32x16_bf16 v[160:175], v[32:35], v[68:71], 0
v_mfma_f32_32x32x16_bf16 v[176:191], v[36:39], v[68:71], 0
v_mfma_f32_32x32x16_bf16 v[192:207], v[32:35], v[72:75], 0
v_mfma_f32_32x32x16_bf16 v[208:223], v[36:39], v[72:75], 0
v_mfma_f32_32x32x16_bf16 v[224:239], v[32:35], v[76:79], 0
v_mfma_f32_32x32x16_bf16 v[240:255], v[36:39], v[76:79], 0
s_waitcnt lgkmcnt(0)
ds_read_b128 v[32:35], v18 offset:0
ds_read_b128 v[36:39], v18 offset:4096
ds_read_b64_tr_b16 v[64:65], v20 offset:16384
ds_read_b64_tr_b16 v[66:67], v20 offset:18432
ds_read_b64_tr_b16 v[68:69], v21 offset:16384
ds_read_b64_tr_b16 v[70:71], v21 offset:18432
ds_read_b64_tr_b16 v[72:73], v22 offset:16384
ds_read_b64_tr_b16 v[74:75], v22 offset:18432
ds_read_b64_tr_b16 v[76:77], v23 offset:16384
ds_read_b64_tr_b16 v[78:79], v23 offset:18432
v_mfma_f32_32x32x16_bf16 v[128:143], v[40:43], v[80:83], v[128:143]
v_mfma_f32_32x32x16_bf16 v[144:159], v[44:47], v[80:83], v[144:159]
v_mfma_f32_32x32x16_bf16 v[160:175], v[40:43], v[84:87], v[160:175]
v_mfma_f32_32x32x16_bf16 v[176:191], v[44:47], v[84:87], v[176:191]
v_mfma_f32_32x32x16_bf16 v[192:207], v[40:43], v[88:91], v[192:207]
v_mfma_f32_32x32x16_bf16 v[208:223], v[44:47], v[88:91], v[208:223]
v_mfma_f32_32x32x16_bf16 v[224:239], v[40:43], v[92:95], v[224:239]
v_mfma_f32_32x32x16_bf16 v[240:255], v[44:47], v[92:95], v[240:255]
s_waitcnt lgkmcnt(0)
ds_read_b128 v[40:43], v19 offset:0
ds_read_b128 v[44:47], v19 offset:4096
ds_read_b64_tr_b16 v[80:81], v20 offset:24576
ds_read_b64_tr_b16 v[82:83], v20 offset:26624
ds_read_b64_tr_b16 v[84:85], v21 offset:24576
ds_read_b64_tr_b16 v[86:87], v21 offset:26624
ds_read_b64_tr_b16 v[88:89], v22 offset:24576
ds_read_b64_tr_b16 v[90:91], v22 offset:26624
ds_read_b64_tr_b16 v[92:93], v23 offset:24576
ds_read_b64_tr_b16 v[94:95], v23 offset:26624
v_mfma_f32_32x32x16_bf16 v[128:143], v[32:35], v[64:67], v[128:143]
v_mfma_f32_32x32x16_bf16 v[144:159], v[36:39], v[64:67], v[144:159]
v_mfma_f32_32x32x16_bf16 v[160:175], v[32:35], v[68:71], v[160:175]
v_mfma_f32_32x32x16_bf16 v[176:191], v[36:39], v[68:71], v[176:191]
v_mfma_f32_32x32x16_bf16 v[192:207], v[32:35], v[72:75], v[192:207]
v_mfma_f32_32x32x16_bf16 v[208:223], v[36:39], v[72:75], v[208:223]
v_mfma_f32_32x32x16_bf16 v[224:239], v[32:35], v[76:79], v[224:239]
v_mfma_f32_32x32x16_bf16 v[240:255], v[36:39], v[76:79], v[240:255]
s_waitcnt lgkmcnt(0)
s_waitcnt vmcnt(12)
s_barrier
s_add_u32 s38, s38, 49152
s_cmp_eq_u32 s38, 147456
s_cselect_b32 s38, 0, s38
v_add_u32 v16, s38, v8
v_add_u32 v17, s38, v9
v_add_u32 v18, s38, v10
v_add_u32 v19, s38, v11
s_add_u32 s25, s38, 16384
v_add_u32 v20, s25, v12
v_add_u32 v21, s25, v13
v_add_u32 v22, s25, v14
v_add_u32 v23, s25, v15
ds_read_b128 v[32:35], v16 offset:0
ds_read_b128 v[36:39], v16 offset:4096
ds_read_b64_tr_b16 v[64:65], v20 offset:0
ds_read_b64_tr_b16 v[66:67], v20 offset:2048
ds_read_b64_tr_b16 v[68:69], v21 offset:0
ds_read_b64_tr_b16 v[70:71], v21 offset:2048
ds_read_b64_tr_b16 v[72:73], v22 offset:0
ds_read_b64_tr_b16 v[74:75], v22 offset:2048
ds_read_b64_tr_b16 v[76:77], v23 offset:0
ds_read_b64_tr_b16 v[78:79], v23 offset:2048
v_mfma_f32_32x32x16_bf16 v[128:143], v[40:43], v[80:83], v[128:143]
v_mfma_f32_32x32x16_bf16 v[144:159], v[44:47], v[80:83], v[144:159]
v_mfma_f32_32x32x16_bf16 v[160:175], v[40:43], v[84:87], v[160:175]
v_mfma_f32_32x32x16_bf16 v[176:191], v[44:47], v[84:87], v[176:191]
v_mfma_f32_32x32x16_bf16 v[192:207], v[40:43], v[88:91], v[192:207]
v_mfma_f32_32x32x16_bf16 v[208:223], v[44:47], v[88:91], v[208:223]
v_mfma_f32_32x32x16_bf16 v[224:239], v[40:43], v[92:95], v[224:239]
v_mfma_f32_32x32x16_bf16 v[240:255], v[44:47], v[92:95], v[240:255]
s_mov_b32 s40, 1
L_gl_87:
s_waitcnt lgkmcnt(0)
ds_read_b128 v[40:43], v17 offset:0
ds_read_b128 v[44:47], v17 offset:4096
ds_read_b64_tr_b16 v[80:81], v20 offset:8192
ds_read_b64_tr_b16 v[82:83], v20 offset:10240
ds_read_b64_tr_b16 v[84:85], v21 offset:8192
ds_read_b64_tr_b16 v[86:87], v21 offset:10240
ds_read_b64_tr_b16 v[88:89], v22 offset:8192
ds_read_b64_tr_b16 v[90:91], v22 offset:10240
ds_read_b64_tr_b16 v[92:93], v23 offset:8192
ds_read_b64_tr_b16 v[94:95], v23 offset:10240
v_mfma_f32_32x32x16_bf16 v[128:143], v[32:35], v[64:67], v[128:143]
s_lshl_b32 s26, s11, 12
s_add_u32 s26, s26, s39
s_add_u32 m0, s26, 0
s_add_u32 s27, s36, 0
buffer_load_dwordx4 v2, s[16:19], s27 offen sc1 lds
v_mfma_f32_32x32x16_bf16 v[144:159], v[36:39], v[64:67], v[144:159]
s_lshl_b32 s26, s11, 12
s_add_u32 s26, s26, s39
s_add_u32 m0, s26, 1024
s_add_u32 s27, s36, 9216
buffer_load_dwordx4 v3, s[16:19], s27 offen sc1 lds
v_mfma_f32_32x32x16_bf16 v[160:175], v[32:35], v[68:71], v[160:175]
s_lshl_b32 s26, s11, 12
s_add_u32 s26, s26, s39
s_add_u32 m0, s26, 2048
s_add_u32 s27, s36, 18432
buffer_load_dwordx4 v2, s[16:19], s27 offen sc1 lds
v_mfma_f32_32x32x16_bf16 v[176:191], v[36:39], v[68:71], v[176:191]
s_lshl_b32 s26, s11, 12
s_add_u32 s26, s26, s39
s_add_u32 m0, s26, 3072
s_add_u32 s27, s36, 27648
buffer_load_dwordx4 v3, s[16:19], s27 offen sc1 lds
v_mfma_f32_32x32x16_bf16 v[192:207], v[32:35], v[72:75], v[192:207]
v_mfma_f32_32x32x16_bf16 v[208:223], v[36:39], v[72:75], v[208:223]
v_mfma_f32_32x32x16_bf16 v[224:239], v[32:35], v[76:79], v[224:239]
v_mfma_f32_32x32x16_bf16 v[240:255], v[36:39], v[76:79], v[240:255]
s_waitcnt lgkmcnt(0)
ds_read_b128 v[32:35], v18 offset:0
ds_read_b128 v[36:39], v18 offset:4096
ds_read_b64_tr_b16 v[64:65], v20 offset:16384
ds_read_b64_tr_b16 v[66:67], v20 offset:18432
ds_read_b64_tr_b16 v[68:69], v21 offset:16384
ds_read_b64_tr_b16 v[70:71], v21 offset:18432
ds_read_b64_tr_b16 v[72:73], v22 offset:16384
ds_read_b64_tr_b16 v[74:75], v22 offset:18432
ds_read_b64_tr_b16 v[76:77], v23 offset:16384
ds_read_b64_tr_b16 v[78:79], v23 offset:18432
v_mfma_f32_32x32x16_bf16 v[128:143], v[40:43], v[80:83], v[128:143]
s_add_u32 s36, s36, 128
s_lshl_b32 s26, s11, 13
s_add_u32 s26, s26, s39
s_add_u32 m0, s26, 16384
s_add_u32 s27, s37, 0
buffer_load_dwordx4 v5, s[20:23], s27 offen lds
v_mfma_f32_32x32x16_bf16 v[144:159], v[44:47], v[80:83], v[144:159]
s_lshl_b32 s26, s11, 13
s_add_u32 s26, s26, s39
s_add_u32 m0, s26, 17408
s_add_u32 s27, s37, 16384
buffer_load_dwordx4 v6, s[20:23], s27 offen lds
v_mfma_f32_32x32x16_bf16 v[160:175], v[40:43], v[84:87], v[160:175]
s_lshl_b32 s26, s11, 13
s_add_u32 s26, s26, s39
s_add_u32 m0, s26, 18432
s_add_u32 s27, s37, 32768
buffer_load_dwordx4 v5, s[20:23], s27 offen lds
v_mfma_f32_32x32x16_bf16 v[176:191], v[44:47], v[84:87], v[176:191]
s_lshl_b32 s26, s11, 13
s_add_u32 s26, s26, s39
s_add_u32 m0, s26, 19456
s_add_u32 s27, s37, 49152
buffer_load_dwordx4 v6, s[20:23], s27 offen lds
v_mfma_f32_32x32x16_bf16 v[192:207], v[40:43], v[88:91], v[192:207]
v_mfma_f32_32x32x16_bf16 v[208:223], v[44:47], v[88:91], v[208:223]
v_mfma_f32_32x32x16_bf16 v[224:239], v[40:43], v[92:95], v[224:239]
v_mfma_f32_32x32x16_bf16 v[240:255], v[44:47], v[92:95], v[240:255]
s_waitcnt lgkmcnt(0)
ds_read_b128 v[40:43], v19 offset:0
ds_read_b128 v[44:47], v19 offset:4096
ds_read_b64_tr_b16 v[80:81], v20 offset:24576
ds_read_b64_tr_b16 v[82:83], v20 offset:26624
ds_read_b64_tr_b16 v[84:85], v21 offset:24576
ds_read_b64_tr_b16 v[86:87], v21 offset:26624
ds_read_b64_tr_b16 v[88:89], v22 offset:24576
ds_read_b64_tr_b16 v[90:91], v22 offset:26624
ds_read_b64_tr_b16 v[92:93], v23 offset:24576
ds_read_b64_tr_b16 v[94:95], v23 offset:26624
v_mfma_f32_32x32x16_bf16 v[128:143], v[32:35], v[64:67], v[128:143]
s_lshl_b32 s26, s11, 13
s_add_u32 s26, s26, s39
s_add_u32 m0, s26, 20480
s_add_u32 s27, s37, 65536
buffer_load_dwordx4 v5, s[20:23], s27 offen lds
v_mfma_f32_32x32x16_bf16 v[144:159], v[36:39], v[64:67], v[144:159]
s_lshl_b32 s26, s11, 13
s_add_u32 s26, s26, s39
s_add_u32 m0, s26, 21504
s_add_u32 s27, s37, 81920
buffer_load_dwordx4 v6, s[20:23], s27 offen lds
v_mfma_f32_32x32x16_bf16 v[160:175], v[32:35], v[68:71], v[160:175]
s_lshl_b32 s26, s11, 13
s_add_u32 s26, s26, s39
s_add_u32 m0, s26, 22528
s_add_u32 s27, s37, 98304
buffer_load_dwordx4 v5, s[20:23], s27 offen lds
v_mfma_f32_32x32x16_bf16 v[176:191], v[36:39], v[68:71], v[176:191]
s_lshl_b32 s26, s11, 13
s_add_u32 s26, s26, s39
s_add_u32 m0, s26, 23552
s_add_u32 s27, s37, 114688
buffer_load_dwordx4 v6, s[20:23], s27 offen lds
s_add_u32 s37, s37, 524288
v_mfma_f32_32x32x16_bf16 v[192:207], v[32:35], v[72:75], v[192:207]
v_mfma_f32_32x32x16_bf16 v[208:223], v[36:39], v[72:75], v[208:223]
v_mfma_f32_32x32x16_bf16 v[224:239], v[32:35], v[76:79], v[224:239]
v_mfma_f32_32x32x16_bf16 v[240:255], v[36:39], v[76:79], v[240:255]
s_waitcnt lgkmcnt(0)
s_waitcnt vmcnt(12)
s_barrier
s_add_u32 s38, s38, 49152
s_cmp_eq_u32 s38, 147456
s_cselect_b32 s38, 0, s38
v_add_u32 v16, s38, v8
v_add_u32 v17, s38, v9
v_add_u32 v18, s38, v10
v_add_u32 v19, s38, v11
s_add_u32 s25, s38, 16384
v_add_u32 v20, s25, v12
v_add_u32 v21, s25, v13
v_add_u32 v22, s25, v14
v_add_u32 v23, s25, v15
ds_read_b128 v[32:35], v16 offset:0
ds_read_b128 v[36:39], v16 offset:4096
ds_read_b64_tr_b16 v[64:65], v20 offset:0
ds_read_b64_tr_b16 v[66:67], v20 offset:2048
ds_read_b64_tr_b16 v[68:69], v21 offset:0
ds_read_b64_tr_b16 v[70:71], v21 offset:2048
ds_read_b64_tr_b16 v[72:73], v22 offset:0
ds_read_b64_tr_b16 v[74:75], v22 offset:2048
ds_read_b64_tr_b16 v[76:77], v23 offset:0
ds_read_b64_tr_b16 v[78:79], v23 offset:2048
v_mfma_f32_32x32x16_bf16 v[128:143], v[40:43], v[80:83], v[128:143]
v_mfma_f32_32x32x16_bf16 v[144:159], v[44:47], v[80:83], v[144:159]
v_mfma_f32_32x32x16_bf16 v[160:175], v[40:43], v[84:87], v[160:175]
v_mfma_f32_32x32x16_bf16 v[176:191], v[44:47], v[84:87], v[176:191]
v_mfma_f32_32x32x16_bf16 v[192:207], v[40:43], v[88:91], v[192:207]
v_mfma_f32_32x32x16_bf16 v[208:223], v[44:47], v[88:91], v[208:223]
v_mfma_f32_32x32x16_bf16 v[224:239], v[40:43], v[92:95], v[224:239]
v_mfma_f32_32x32x16_bf16 v[240:255], v[44:47], v[92:95], v[240:255]
s_add_u32 s39, s39, 49152
s_cmp_eq_u32 s39, 147456
s_cselect_b32 s39, 0, s39
s_add_u32 s40, s40, 1
s_cmp_lt_u32 s40, 7
s_cbranch_scc1 L_gl_87
s_waitcnt lgkmcnt(0)
ds_read_b128 v[40:43], v17 offset:0
ds_read_b128 v[44:47], v17 offset:4096
ds_read_b64_tr_b16 v[80:81], v20 offset:8192
ds_read_b64_tr_b16 v[82:83], v20 offset:10240
ds_read_b64_tr_b16 v[84:85], v21 offset:8192
ds_read_b64_tr_b16 v[86:87], v21 offset:10240
ds_read_b64_tr_b16 v[88:89], v22 offset:8192
ds_read_b64_tr_b16 v[90:91], v22 offset:10240
ds_read_b64_tr_b16 v[92:93], v23 offset:8192
ds_read_b64_tr_b16 v[94:95], v23 offset:10240
v_mfma_f32_32x32x16_bf16 v[128:143], v[32:35], v[64:67], v[128:143]
v_mfma_f32_32x32x16_bf16 v[144:159], v[36:39], v[64:67], v[144:159]
v_mfma_f32_32x32x16_bf16 v[160:175], v[32:35], v[68:71], v[160:175]
v_mfma_f32_32x32x16_bf16 v[176:191], v[36:39], v[68:71], v[176:191]
v_mfma_f32_32x32x16_bf16 v[192:207], v[32:35], v[72:75], v[192:207]
v_mfma_f32_32x32x16_bf16 v[208:223], v[36:39], v[72:75], v[208:223]
v_mfma_f32_32x32x16_bf16 v[224:239], v[32:35], v[76:79], v[224:239]
v_mfma_f32_32x32x16_bf16 v[240:255], v[36:39], v[76:79], v[240:255]
s_waitcnt lgkmcnt(0)
ds_read_b128 v[32:35], v18 offset:0
ds_read_b128 v[36:39], v18 offset:4096
ds_read_b64_tr_b16 v[64:65], v20 offset:16384
ds_read_b64_tr_b16 v[66:67], v20 offset:18432
ds_read_b64_tr_b16 v[68:69], v21 offset:16384
ds_read_b64_tr_b16 v[70:71], v21 offset:18432
ds_read_b64_tr_b16 v[72:73], v22 offset:16384
ds_read_b64_tr_b16 v[74:75], v22 offset:18432
ds_read_b64_tr_b16 v[76:77], v23 offset:16384
ds_read_b64_tr_b16 v[78:79], v23 offset:18432
v_mfma_f32_32x32x16_bf16 v[128:143], v[40:43], v[80:83], v[128:143]
v_mfma_f32_32x32x16_bf16 v[144:159], v[44:47], v[80:83], v[144:159]
v_mfma_f32_32x32x16_bf16 v[160:175], v[40:43], v[84:87], v[160:175]
v_mfma_f32_32x32x16_bf16 v[176:191], v[44:47], v[84:87], v[176:191]
v_mfma_f32_32x32x16_bf16 v[192:207], v[40:43], v[88:91], v[192:207]
v_mfma_f32_32x32x16_bf16 v[208:223], v[44:47], v[88:91], v[208:223]
v_mfma_f32_32x32x16_bf16 v[224:239], v[40:43], v[92:95], v[224:239]
v_mfma_f32_32x32x16_bf16 v[240:255], v[44:47], v[92:95], v[240:255]
s_waitcnt lgkmcnt(0)
ds_read_b128 v[40:43], v19 offset:0
ds_read_b128 v[44:47], v19 offset:4096
ds_read_b64_tr_b16 v[80:81], v20 offset:24576
ds_read_b64_tr_b16 v[82:83], v20 offset:26624
ds_read_b64_tr_b16 v[84:85], v21 offset:24576
ds_read_b64_tr_b16 v[86:87], v21 offset:26624
ds_read_b64_tr_b16 v[88:89], v22 offset:24576
ds_read_b64_tr_b16 v[90:91], v22 offset:26624
ds_read_b64_tr_b16 v[92:93], v23 offset:24576
ds_read_b64_tr_b16 v[94:95], v23 offset:26624
v_mfma_f32_32x32x16_bf16 v[128:143], v[32:35], v[64:67], v[128:143]
v_mfma_f32_32x32x16_bf16 v[144:159], v[36:39], v[64:67], v[144:159]
v_mfma_f32_32x32x16_bf16 v[160:175], v[32:35], v[68:71], v[160:175]
v_mfma_f32_32x32x16_bf16 v[176:191], v[36:39], v[68:71], v[176:191]
v_mfma_f32_32x32x16_bf16 v[192:207], v[32:35], v[72:75], v[192:207]
v_mfma_f32_32x32x16_bf16 v[208:223], v[36:39], v[72:75], v[208:223]
v_mfma_f32_32x32x16_bf16 v[224:239], v[32:35], v[76:79], v[224:239]
v_mfma_f32_32x32x16_bf16 v[240:255], v[36:39], v[76:79], v[240:255]
s_waitcnt lgkmcnt(0)
s_waitcnt vmcnt(0)
s_barrier
s_add_u32 s38, s38, 49152
s_cmp_eq_u32 s38, 147456
s_cselect_b32 s38, 0, s38
v_add_u32 v16, s38, v8
v_add_u32 v17, s38, v9
v_add_u32 v18, s38, v10
v_add_u32 v19, s38, v11
s_add_u32 s25, s38, 16384
v_add_u32 v20, s25, v12
v_add_u32 v21, s25, v13
v_add_u32 v22, s25, v14
v_add_u32 v23, s25, v15
ds_read_b128 v[32:35], v16 offset:0
ds_read_b128 v[36:39], v16 offset:4096
ds_read_b64_tr_b16 v[64:65], v20 offset:0
ds_read_b64_tr_b16 v[66:67], v20 offset:2048
ds_read_b64_tr_b16 v[68:69], v21 offset:0
ds_read_b64_tr_b16 v[70:71], v21 offset:2048
ds_read_b64_tr_b16 v[72:73], v22 offset:0
ds_read_b64_tr_b16 v[74:75], v22 offset:2048
ds_read_b64_tr_b16 v[76:77], v23 offset:0
ds_read_b64_tr_b16 v[78:79], v23 offset:2048
v_mfma_f32_32x32x16_bf16 v[128:143], v[40:43], v[80:83], v[128:143]
v_mfma_f32_32x32x16_bf16 v[144:159], v[44:47], v[80:83], v[144:159]
v_mfma_f32_32x32x16_bf16 v[160:175], v[40:43], v[84:87], v[160:175]
v_mfma_f32_32x32x16_bf16 v[176:191], v[44:47], v[84:87], v[176:191]
v_mfma_f32_32x32x16_bf16 v[192:207], v[40:43], v[88:91], v[192:207]
v_mfma_f32_32x32x16_bf16 v[208:223], v[44:47], v[88:91], v[208:223]
v_mfma_f32_32x32x16_bf16 v[224:239], v[40:43], v[92:95], v[224:239]
v_mfma_f32_32x32x16_bf16 v[240:255], v[44:47], v[92:95], v[240:255]
s_waitcnt lgkmcnt(0)
ds_read_b128 v[40:43], v17 offset:0
ds_read_b128 v[44:47], v17 offset:4096
ds_read_b64_tr_b16 v[80:81], v20 offset:8192
ds_read_b64_tr_b16 v[82:83], v20 offset:10240
ds_read_b64_tr_b16 v[84:85], v21 offset:8192
ds_read_b64_tr_b16 v[86:87], v21 offset:10240
ds_read_b64_tr_b16 v[88:89], v22 offset:8192
ds_read_b64_tr_b16 v[90:91], v22 offset:10240
ds_read_b64_tr_b16 v[92:93], v23 offset:8192
ds_read_b64_tr_b16 v[94:95], v23 offset:10240
v_mfma_f32_32x32x16_bf16 v[128:143], v[32:35], v[64:67], v[128:143]
v_mfma_f32_32x32x16_bf16 v[144:159], v[36:39], v[64:67], v[144:159]
v_mfma_f32_32x32x16_bf16 v[160:175], v[32:35], v[68:71], v[160:175]
v_mfma_f32_32x32x16_bf16 v[176:191], v[36:39], v[68:71], v[176:191]
v_mfma_f32_32x32x16_bf16 v[192:207], v[32:35], v[72:75], v[192:207]
v_mfma_f32_32x32x16_bf16 v[208:223], v[36:39], v[72:75], v[208:223]
v_mfma_f32_32x32x16_bf16 v[224:239], v[32:35], v[76:79], v[224:239]
v_mfma_f32_32x32x16_bf16 v[240:255], v[36:39], v[76:79], v[240:255]
s_waitcnt lgkmcnt(0)
ds_read_b128 v[32:35], v18 offset:0
ds_read_b128 v[36:39], v18 offset:4096
ds_read_b64_tr_b16 v[64:65], v20 offset:16384
ds_read_b64_tr_b16 v[66:67], v20 offset:18432
ds_read_b64_tr_b16 v[68:69], v21 offset:16384
ds_read_b64_tr_b16 v[70:71], v21 offset:18432
ds_read_b64_tr_b16 v[72:73], v22 offset:16384
ds_read_b64_tr_b16 v[74:75], v22 offset:18432
ds_read_b64_tr_b16 v[76:77], v23 offset:16384
ds_read_b64_tr_b16 v[78:79], v23 offset:18432
v_mfma_f32_32x32x16_bf16 v[128:143], v[40:43], v[80:83], v[128:143]
v_mfma_f32_32x32x16_bf16 v[144:159], v[44:47], v[80:83], v[144:159]
v_mfma_f32_32x32x16_bf16 v[160:175], v[40:43], v[84:87], v[160:175]
v_mfma_f32_32x32x16_bf16 v[176:191], v[44:47], v[84:87], v[176:191]
v_mfma_f32_32x32x16_bf16 v[192:207], v[40:43], v[88:91], v[192:207]
v_mfma_f32_32x32x16_bf16 v[208:223], v[44:47], v[88:91], v[208:223]
v_mfma_f32_32x32x16_bf16 v[224:239], v[40:43], v[92:95], v[224:239]
v_mfma_f32_32x32x16_bf16 v[240:255], v[44:47], v[92:95], v[240:255]
s_waitcnt lgkmcnt(0)
ds_read_b128 v[40:43], v19 offset:0
ds_read_b128 v[44:47], v19 offset:4096
ds_read_b64_tr_b16 v[80:81], v20 offset:24576
ds_read_b64_tr_b16 v[82:83], v20 offset:26624
ds_read_b64_tr_b16 v[84:85], v21 offset:24576
ds_read_b64_tr_b16 v[86:87], v21 offset:26624
ds_read_b64_tr_b16 v[88:89], v22 offset:24576
ds_read_b64_tr_b16 v[90:91], v22 offset:26624
ds_read_b64_tr_b16 v[92:93], v23 offset:24576
ds_read_b64_tr_b16 v[94:95], v23 offset:26624
v_mfma_f32_32x32x16_bf16 v[128:143], v[32:35], v[64:67], v[128:143]
v_mfma_f32_32x32x16_bf16 v[144:159], v[36:39], v[64:67], v[144:159]
v_mfma_f32_32x32x16_bf16 v[160:175], v[32:35], v[68:71], v[160:175]
v_mfma_f32_32x32x16_bf16 v[176:191], v[36:39], v[68:71], v[176:191]
v_mfma_f32_32x32x16_bf16 v[192:207], v[32:35], v[72:75], v[192:207]
v_mfma_f32_32x32x16_bf16 v[208:223], v[36:39], v[72:75], v[208:223]
v_mfma_f32_32x32x16_bf16 v[224:239], v[32:35], v[76:79], v[224:239]
v_mfma_f32_32x32x16_bf16 v[240:255], v[36:39], v[76:79], v[240:255]
s_waitcnt lgkmcnt(0)
v_mfma_f32_32x32x16_bf16 v[128:143], v[40:43], v[80:83], v[128:143]
v_mfma_f32_32x32x16_bf16 v[144:159], v[44:47], v[80:83], v[144:159]
v_mfma_f32_32x32x16_bf16 v[160:175], v[40:43], v[84:87], v[160:175]
v_mfma_f32_32x32x16_bf16 v[176:191], v[44:47], v[84:87], v[176:191]
v_mfma_f32_32x32x16_bf16 v[192:207], v[40:43], v[88:91], v[192:207]
v_mfma_f32_32x32x16_bf16 v[208:223], v[44:47], v[88:91], v[208:223]
v_mfma_f32_32x32x16_bf16 v[224:239], v[40:43], v[92:95], v[224:239]
v_mfma_f32_32x32x16_bf16 v[240:255], v[44:47], v[92:95], v[240:255]
s_nop 15
s_and_b32 s24, s11, 1
s_lshl_b32 s24, s24, 1
s_lshl_b32 s25, s44, 2
s_add_u32 s24, s24, s25
s_lshl_b32 s24, s24, 18
s_add_u32 s41, s24, 33554432
s_lshl_b32 s24, s45, 1
s_lshr_b32 s25, s11, 1
s_add_u32 s24, s24, s25
s_lshl_b32 s24, s24, 13
s_add_u32 s41, s41, s24
v_and_b32 v24, 31, v0
v_lshlrev_b32 v24, 4, v24
v_lshrrev_b32 v25, 5, v0
v_lshl_add_u32 v24, v25, 11, v24
v_cvt_pk_bf16_f32 v32, v128, v129
v_cvt_pk_bf16_f32 v33, v130, v131
v_cvt_pk_bf16_f32 v34, v136, v137
v_cvt_pk_bf16_f32 v35, v138, v139
s_add_u32 s24, s41, 0
buffer_store_dwordx4 v[32:35], v24, s[12:15], s24 offen sc1
v_cvt_pk_bf16_f32 v36, v132, v133
v_cvt_pk_bf16_f32 v37, v134, v135
v_cvt_pk_bf16_f32 v38, v140, v141
v_cvt_pk_bf16_f32 v39, v142, v143
s_add_u32 s24, s41, 4096
buffer_store_dwordx4 v[36:39], v24, s[12:15], s24 offen sc1
v_cvt_pk_bf16_f32 v40, v160, v161
v_cvt_pk_bf16_f32 v41, v162, v163
v_cvt_pk_bf16_f32 v42, v168, v169
v_cvt_pk_bf16_f32 v43, v170, v171
s_add_u32 s24, s41, 512
buffer_store_dwordx4 v[40:43], v24, s[12:15], s24 offen sc1
v_cvt_pk_bf16_f32 v44, v164, v165
v_cvt_pk_bf16_f32 v45, v166, v167
v_cvt_pk_bf16_f32 v46, v172, v173
v_cvt_pk_bf16_f32 v47, v174, v175
s_add_u32 s24, s41, 4608
buffer_store_dwordx4 v[44:47], v24, s[12:15], s24 offen sc1
v_cvt_pk_bf16_f32 v48, v192, v193
v_cvt_pk_bf16_f32 v49, v194, v195
v_cvt_pk_bf16_f32 v50, v200, v201
v_cvt_pk_bf16_f32 v51, v202, v203
s_add_u32 s24, s41, 1024
buffer_store_dwordx4 v[48:51], v24, s[12:15], s24 offen sc1
v_cvt_pk_bf16_f32 v52, v196, v197
v_cvt_pk_bf16_f32 v53, v198, v199
v_cvt_pk_bf16_f32 v54, v204, v205
v_cvt_pk_bf16_f32 v55, v206, v207
s_add_u32 s24, s41, 5120
buffer_store_dwordx4 v[52:55], v24, s[12:15], s24 offen sc1
v_cvt_pk_bf16_f32 v56, v224, v225
v_cvt_pk_bf16_f32 v57, v226, v227
v_cvt_pk_bf16_f32 v58, v232, v233
v_cvt_pk_bf16_f32 v59, v234, v235
s_add_u32 s24, s41, 1536
buffer_store_dwordx4 v[56:59], v24, s[12:15], s24 offen sc1
v_cvt_pk_bf16_f32 v60, v228, v229
v_cvt_pk_bf16_f32 v61, v230, v231
v_cvt_pk_bf16_f32 v62, v236, v237
v_cvt_pk_bf16_f32 v63, v238, v239
s_add_u32 s24, s41, 5632
buffer_store_dwordx4 v[60:63], v24, s[12:15], s24 offen sc1
v_cvt_pk_bf16_f32 v32, v144, v145
v_cvt_pk_bf16_f32 v33, v146, v147
v_cvt_pk_bf16_f32 v34, v152, v153
v_cvt_pk_bf16_f32 v35, v154, v155
s_add_u32 s24, s41, 262144
buffer_store_dwordx4 v[32:35], v24, s[12:15], s24 offen sc1
v_cvt_pk_bf16_f32 v36, v148, v149
v_cvt_pk_bf16_f32 v37, v150, v151
v_cvt_pk_bf16_f32 v38, v156, v157
v_cvt_pk_bf16_f32 v39, v158, v159
s_add_u32 s24, s41, 266240
buffer_store_dwordx4 v[36:39], v24, s[12:15], s24 offen sc1
v_cvt_pk_bf16_f32 v40, v176, v177
v_cvt_pk_bf16_f32 v41, v178, v179
v_cvt_pk_bf16_f32 v42, v184, v185
v_cvt_pk_bf16_f32 v43, v186, v187
s_add_u32 s24, s41, 262656
buffer_store_dwordx4 v[40:43], v24, s[12:15], s24 offen sc1
v_cvt_pk_bf16_f32 v44, v180, v181
v_cvt_pk_bf16_f32 v45, v182, v183
v_cvt_pk_bf16_f32 v46, v188, v189
v_cvt_pk_bf16_f32 v47, v190, v191
s_add_u32 s24, s41, 266752
buffer_store_dwordx4 v[44:47], v24, s[12:15], s24 offen sc1
v_cvt_pk_bf16_f32 v48, v208, v209
v_cvt_pk_bf16_f32 v49, v210, v211
v_cvt_pk_bf16_f32 v50, v216, v217
v_cvt_pk_bf16_f32 v51, v218, v219
s_add_u32 s24, s41, 263168
buffer_store_dwordx4 v[48:51], v24, s[12:15], s24 offen sc1
v_cvt_pk_bf16_f32 v52, v212, v213
v_cvt_pk_bf16_f32 v53, v214, v215
v_cvt_pk_bf16_f32 v54, v220, v221
v_cvt_pk_bf16_f32 v55, v222, v223
s_add_u32 s24, s41, 267264
buffer_store_dwordx4 v[52:55], v24, s[12:15], s24 offen sc1
v_cvt_pk_bf16_f32 v56, v240, v241
v_cvt_pk_bf16_f32 v57, v242, v243
v_cvt_pk_bf16_f32 v58, v248, v249
v_cvt_pk_bf16_f32 v59, v250, v251
s_add_u32 s24, s41, 263680
buffer_store_dwordx4 v[56:59], v24, s[12:15], s24 offen sc1
v_cvt_pk_bf16_f32 v60, v244, v245
v_cvt_pk_bf16_f32 v61, v246, v247
v_cvt_pk_bf16_f32 v62, v252, v253
v_cvt_pk_bf16_f32 v63, v254, v255
s_add_u32 s24, s41, 267776
buffer_store_dwordx4 v[60:63], v24, s[12:15], s24 offen sc1
L_g1e_81:
s_waitcnt vmcnt(0)
s_cmp_eq_u32 s43, 0
s_cbranch_scc1 L_sig_q
s_lshl_b32 s24, s44, 7
s_add_u32 s24, s24, 77596672
s_barrier
s_cmp_lg_u32 s11, 0
s_cbranch_scc1 L_sg_88
s_mov_b32 s60, s24
v_mov_b32 v1, 2
s_mov_b64 exec, 1
buffer_atomic_add v1, off, s[12:15], s60
s_mov_b64 exec, -1
L_sg_88:
s_branch L_next
L_sig_q:
s_lshl_b32 s24, s44, 7
s_add_u32 s24, s24, 77598720
s_barrier
s_cmp_lg_u32 s11, 0
s_cbranch_scc1 L_sg_89
s_mov_b32 s60, s24
v_mov_b32 v1, 1
s_mov_b64 exec, 1
buffer_atomic_add v1, off, s[12:15], s60
s_mov_b64 exec, -1
L_sg_89:
s_branch L_next
L_t_h:
s_cmp_lt_u32 s42, 192
s_cbranch_scc0 L_t_h2
s_mul_i32 s24, s42, 21846
s_lshr_b32 s24, s24, 16
s_mul_i32 s25, s24, 3
s_sub_u32 s44, s42, s25
s_branch L_t_h3
L_t_h2:
s_mov_b32 s44, 3
s_sub_u32 s24, s42, 192
L_t_h3:
s_lshr_b32 s43, s24, 5
s_add_u32 s43, s43, 1
s_and_b32 s45, s24, 31
s_add_u32 s16, s12, 0
s_addc_u32 s17, s13, 0
s_mov_b32 s18, 2359296
s_lshl_b32 s24, s43, 3
s_add_u32 s24, s24, 16
s_load_dwordx2 s[20:21], s[0:1], s24
s_mov_b32 s22, 4718592
v_lshrrev_b32 v24, 3, v0
v_mul_u32_u24 v24, 1152, v24
v_and_b32 v25, 7, v0
v_lshrrev_b32 v26, 4, v0
v_xor_b32 v27, v25, v26
v_lshl_add_u32 v2, v27, 4, v24
v_xor_b32 v27, 4, v27
v_lshl_add_u32 v3, v27, 4, v24
v_lshrrev_b32 v24, 4, v0
v_lshlrev_b32 v25, 2, v24
v_lshlrev_b32 v24, 13, v24
v_and_b32 v26, 15, v0
v_xor_b32 v26, v26, v25
v_lshl_add_u32 v5, v26, 4, v24
s_lshl_b32 s24, s44, 7
s_lshl_b32 s25, s11, 5
s_add_u32 s24, s24, s25
s_mul_i32 s36, s24, 1152
s_lshl_b32 s37, s11, 17
s_lshl_b32 s24, s45, 8
s_add_u32 s37, s37, s24
s_and_b32 s24, s11, 1
s_lshl_b32 s24, s24, 6
v_and_b32 v24, 31, v0
v_add_u32 v24, s24, v24
v_lshrrev_b32 v25, 5, v0
v_bfe_u32 v26, v24, 1, 3
v_lshlrev_b32 v24, 7, v24
v_add_u32 v27, 0, v25
v_xor_b32 v27, v27, v26
v_lshl_add_u32 v8, v27, 4, v24
v_add_u32 v27, 2, v25
v_xor_b32 v27, v27, v26
v_lshl_add_u32 v9, v27, 4, v24
v_add_u32 v27, 4, v25
v_xor_b32 v27, v27, v26
v_lshl_add_u32 v10, v27, 4, v24
v_add_u32 v27, 6, v25
v_xor_b32 v27, v27, v26
v_lshl_add_u32 v11, v27, 4, v24
s_lshr_b32 s24, s11, 1
s_lshl_b32 s24, s24, 3
v_bfe_u32 v24, v0, 4, 1
v_bfe_u32 v25, v0, 5, 1
v_bfe_u32 v26, v0, 2, 2
v_and_b32 v27, 3, v0
v_lshl_add_u32 v28, v25, 3, v26
v_mul_u32_u24 v28, 256, v28
v_and_b32 v29, 1, v27
v_lshl_add_u32 v28, v29, 3, v28
v_lshrrev_b32 v29, 1, v27
v_lshl_add_u32 v29, v24, 1, v29
v_add_u32 v29, s24, v29
v_lshlrev_b32 v30, 2, v26
v_add_u32 v31, 0, v29
v_xor_b32 v31, v31, v30
v_lshl_add_u32 v12, v31, 4, v28
v_add_u32 v31, 4, v29
v_xor_b32 v31, v31, v30
v_lshl_add_u32 v13, v31, 4, v28
s_waitcnt lgkmcnt(0)
s_cmp_eq_u32 s43, 2
s_cbranch_scc1 L_h1v_90
s_barrier
s_mov_b32 s39, 0
s_mov_b32 s38, 0
s_lshl_b32 s26, s11, 12
s_add_u32 s26, s26, s39
s_add_u32 m0, s26, 16384
s_add_u32 s27, s37, 0
buffer_load_dwordx4 v5, s[20:23], s27 offen lds
s_lshl_b32 s26, s11, 12
s_add_u32 s26, s26, s39
s_add_u32 m0, s26, 17408
s_add_u32 s27, s37, 32768
buffer_load_dwordx4 v5, s[20:23], s27 offen lds
s_lshl_b32 s26, s11, 12
s_add_u32 s26, s26, s39
s_add_u32 m0, s26, 18432
s_add_u32 s27, s37, 65536
buffer_load_dwordx4 v5, s[20:23], s27 offen lds
s_lshl_b32 s26, s11, 12
s_add_u32 s26, s26, s39
s_add_u32 m0, s26, 19456
s_add_u32 s27, s37, 98304
buffer_load_dwordx4 v5, s[20:23], s27 offen lds
s_add_u32 s37, s37, 524288
s_lshl_b32 s76, s44, 7
s_add_u32 s76, s76, 77594624
s_cmp_lg_u32 s11, 0
s_cbranch_scc1 L_wd_92
s_mov_b32 s60, s76
s_mov_b32 s61, 0
L_wp_93:
buffer_load_dword v1, off, s[12:15], s60 sc1
s_waitcnt vmcnt(0)
v_readfirstlane_b32 s62, v1
s_nop 0
s_cmp_ge_u32 s62, 128
s_cbranch_scc1 L_wd_92
s_add_u32 s61, s61, 1
s_cmp_gt_u32 s61, 4000000
s_cbranch_scc1 L_abortw
s_sleep 1
s_branch L_wp_93
L_wd_92:
s_barrier
s_lshl_b32 s26, s11, 12
s_add_u32 s26, s26, s39
s_add_u32 m0, s26, 0
s_add_u32 s27, s36, 0
buffer_load_dwordx4 v2, s[16:19], s27 offen sc1 lds
s_lshl_b32 s26, s11, 12
s_add_u32 s26, s26, s39
s_add_u32 m0, s26, 1024
s_add_u32 s27, s36, 9216
buffer_load_dwordx4 v3, s[16:19], s27 offen sc1 lds
s_lshl_b32 s26, s11, 12
s_add_u32 s26, s26, s39
s_add_u32 m0, s26, 2048
s_add_u32 s27, s36, 18432
buffer_load_dwordx4 v2, s[16:19], s27 offen sc1 lds
s_lshl_b32 s26, s11, 12
s_add_u32 s26, s26, s39
s_add_u32 m0, s26, 3072
s_add_u32 s27, s36, 27648
buffer_load_dwordx4 v3, s[16:19], s27 offen sc1 lds
s_add_u32 s36, s36, 128
s_add_u32 s39, s39, 32768
s_cmp_eq_u32 s39, 98304
s_cselect_b32 s39, 0, s39
s_lshl_b32 s26, s11, 12
s_add_u32 s26, s26, s39
s_add_u32 m0, s26, 0
s_add_u32 s27, s36, 0
buffer_load_dwordx4 v2, s[16:19], s27 offen sc1 lds
s_lshl_b32 s26, s11, 12
s_add_u32 s26, s26, s39
s_add_u32 m0, s26, 1024
s_add_u32 s27, s36, 9216
buffer_load_dwordx4 v3, s[16:19], s27 offen sc1 lds
s_lshl_b32 s26, s11, 12
s_add_u32 s26, s26, s39
s_add_u32 m0, s26, 2048
s_add_u32 s27, s36, 18432
buffer_load_dwordx4 v2, s[16:19], s27 offen sc1 lds
s_lshl_b32 s26, s11, 12
s_add_u32 s26, s26, s39
s_add_u32 m0, s26, 3072
s_add_u32 s27, s36, 27648
buffer_load_dwordx4 v3, s[16:19], s27 offen sc1 lds
s_add_u32 s36, s36, 128
s_lshl_b32 s26, s11, 12
s_add_u32 s26, s26, s39
s_add_u32 m0, s26, 16384
s_add_u32 s27, s37, 0
buffer_load_dwordx4 v5, s[20:23], s27 offen lds
s_lshl_b32 s26, s11, 12
s_add_u32 s26, s26, s39
s_add_u32 m0, s26, 17408
s_add_u32 s27, s37, 32768
buffer_load_dwordx4 v5, s[20:23], s27 offen lds
s_lshl_b32 s26, s11, 12
s_add_u32 s26, s26, s39
s_add_u32 m0, s26, 18432
s_add_u32 s27, s37, 65536
buffer_load_dwordx4 v5, s[20:23], s27 offen lds
s_lshl_b32 s26, s11, 12
s_add_u32 s26, s26, s39
s_add_u32 m0, s26, 19456
s_add_u32 s27, s37, 98304
buffer_load_dwordx4 v5, s[20:23], s27 offen lds
s_add_u32 s37, s37, 524288
s_add_u32 s39, s39, 32768
s_cmp_eq_u32 s39, 98304
s_cselect_b32 s39, 0, s39
s_lshl_b32 s26, s11, 12
s_add_u32 s26, s26, s39
s_add_u32 m0, s26, 0
s_add_u32 s27, s36, 0
buffer_load_dwordx4 v2, s[16:19], s27 offen sc1 lds
s_lshl_b32 s26, s11, 12
s_add_u32 s26, s26, s39
s_add_u32 m0, s26, 1024
s_add_u32 s27, s36, 9216
buffer_load_dwordx4 v3, s[16:19], s27 offen sc1 lds
s_lshl_b32 s26, s11, 12
s_add_u32 s26, s26, s39
s_add_u32 m0, s26, 2048
s_add_u32 s27, s36, 18432
buffer_load_dwordx4 v2, s[16:19], s27 offen sc1 lds
s_lshl_b32 s26, s11, 12
s_add_u32 s26, s26, s39
s_add_u32 m0, s26, 3072
s_add_u32 s27, s36, 27648
buffer_load_dwordx4 v3, s[16:19], s27 offen sc1 lds
s_add_u32 s36, s36, 128
s_lshl_b32 s26, s11, 12
s_add_u32 s26, s26, s39
s_add_u32 m0, s26, 16384
s_add_u32 s27, s37, 0
buffer_load_dwordx4 v5, s[20:23], s27 offen lds
s_lshl_b32 s26, s11, 12
s_add_u32 s26, s26, s39
s_add_u32 m0, s26, 17408
s_add_u32 s27, s37, 32768
buffer_load_dwordx4 v5, s[20:23], s27 offen lds
s_lshl_b32 s26, s11, 12
s_add_u32 s26, s26, s39
s_add_u32 m0, s26, 18432
s_add_u32 s27, s37, 65536
buffer_load_dwordx4 v5, s[20:23], s27 offen lds
s_lshl_b32 s26, s11, 12
s_add_u32 s26, s26, s39
s_add_u32 m0, s26, 19456
s_add_u32 s27, s37, 98304
buffer_load_dwordx4 v5, s[20:23], s27 offen lds
s_add_u32 s37, s37, 524288
s_add_u32 s39, s39, 32768
s_cmp_eq_u32 s39, 98304
s_cselect_b32 s39, 0, s39
s_waitcnt vmcnt(16)
s_barrier
v_add_u32 v16, s38, v8
v_add_u32 v17, s38, v9
v_add_u32 v18, s38, v10
v_add_u32 v19, s38, v11
s_add_u32 s25, s38, 16384
v_add_u32 v20, s25, v12
v_add_u32 v21, s25, v13
ds_read_b128 v[32:35], v16 offset:0
ds_read_b128 v[36:39], v16 offset:4096
ds_read_b64_tr_b16 v[64:65], v20 offset:0
ds_read_b64_tr_b16 v[66:67], v20 offset:1024
ds_read_b64_tr_b16 v[68:69], v21 offset:0
ds_read_b64_tr_b16 v[70:71], v21 offset:1024
s_waitcnt lgkmcnt(0)
ds_read_b128 v[40:43], v17 offset:0
ds_read_b128 v[44:47], v17 offset:4096
ds_read_b64_tr_b16 v[72:73], v20 offset:4096
ds_read_b64_tr_b16 v[74:75], v20 offset:5120
ds_read_b64_tr_b16 v[76:77], v21 offset:4096
ds_read_b64_tr_b16 v[78:79], v21 offset:5120
v_mfma_f32_32x32x16_bf16 v[128:143], v[64:67], v[32:35], 0
v_mfma_f32_32x32x16_bf16 v[144:159], v[64:67], v[36:39], 0
v_mfma_f32_32x32x16_bf16 v[160:175], v[68:71], v[32:35], 0
v_mfma_f32_32x32x16_bf16 v[176:191], v[68:71], v[36:39], 0
s_waitcnt lgkmcnt(0)
ds_read_b128 v[32:35], v18 offset:0
ds_read_b128 v[36:39], v18 offset:4096
ds_read_b64_tr_b16 v[64:65], v20 offset:8192
ds_read_b64_tr_b16 v[66:67], v20 offset:9216
ds_read_b64_tr_b16 v[68:69], v21 offset:8192
ds_read_b64_tr_b16 v[70:71], v21 offset:9216
v_mfma_f32_32x32x16_bf16 v[128:143], v[72:75], v[40:43], v[128:143]
v_mfma_f32_32x32x16_bf16 v[144:159], v[72:75], v[44:47], v[144:159]
v_mfma_f32_32x32x16_bf16 v[160:175], v[76:79], v[40:43], v[160:175]
v_mfma_f32_32x32x16_bf16 v[176:191], v[76:79], v[44:47], v[176:191]
s_waitcnt lgkmcnt(0)
ds_read_b128 v[40:43], v19 offset:0
ds_read_b128 v[44:47], v19 offset:4096
ds_read_b64_tr_b16 v[72:73], v20 offset:12288
ds_read_b64_tr_b16 v[74:75], v20 offset:13312
ds_read_b64_tr_b16 v[76:77], v21 offset:12288
ds_read_b64_tr_b16 v[78:79], v21 offset:13312
v_mfma_f32_32x32x16_bf16 v[128:143], v[64:67], v[32:35], v[128:143]
v_mfma_f32_32x32x16_bf16 v[144:159], v[64:67], v[36:39], v[144:159]
v_mfma_f32_32x32x16_bf16 v[160:175], v[68:71], v[32:35], v[160:175]
v_mfma_f32_32x32x16_bf16 v[176:191], v[68:71], v[36:39], v[176:191]
s_waitcnt lgkmcnt(0)
s_waitcnt vmcnt(8)
s_barrier
s_add_u32 s38, s38, 32768
s_cmp_eq_u32 s38, 98304
s_cselect_b32 s38, 0, s38
v_add_u32 v16, s38, v8
v_add_u32 v17, s38, v9
v_add_u32 v18, s38, v10
v_add_u32 v19, s38, v11
s_add_u32 s25, s38, 16384
v_add_u32 v20, s25, v12
v_add_u32 v21, s25, v13
ds_read_b128 v[32:35], v16 offset:0
ds_read_b128 v[36:39], v16 offset:4096
ds_read_b64_tr_b16 v[64:65], v20 offset:0
ds_read_b64_tr_b16 v[66:67], v20 offset:1024
ds_read_b64_tr_b16 v[68:69], v21 offset:0
ds_read_b64_tr_b16 v[70:71], v21 offset:1024
v_mfma_f32_32x32x16_bf16 v[128:143], v[72:75], v[40:43], v[128:143]
v_mfma_f32_32x32x16_bf16 v[144:159], v[72:75], v[44:47], v[144:159]
v_mfma_f32_32x32x16_bf16 v[160:175], v[76:79], v[40:43], v[160:175]
v_mfma_f32_32x32x16_bf16 v[176:191], v[76:79], v[44:47], v[176:191]
s_mov_b32 s40, 1
L_gl_94:
s_waitcnt lgkmcnt(0)
ds_read_b128 v[40:43], v17 offset:0
ds_read_b128 v[44:47], v17 offset:4096
ds_read_b64_tr_b16 v[72:73], v20 offset:4096
ds_read_b64_tr_b16 v[74:75], v20 offset:5120
ds_read_b64_tr_b16 v[76:77], v21 offset:4096
ds_read_b64_tr_b16 v[78:79], v21 offset:5120
v_mfma_f32_32x32x16_bf16 v[128:143], v[64:67], v[32:35], v[128:143]
s_lshl_b32 s26, s11, 12
s_add_u32 s26, s26, s39
s_add_u32 m0, s26, 0
s_add_u32 s27, s36, 0
buffer_load_dwordx4 v2, s[16:19], s27 offen sc1 lds
v_mfma_f32_32x32x16_bf16 v[144:159], v[64:67], v[36:39], v[144:159]
s_lshl_b32 s26, s11, 12
s_add_u32 s26, s26, s39
s_add_u32 m0, s26, 1024
s_add_u32 s27, s36, 9216
buffer_load_dwordx4 v3, s[16:19], s27 offen sc1 lds
v_mfma_f32_32x32x16_bf16 v[160:175], v[68:71], v[32:35], v[160:175]
s_lshl_b32 s26, s11, 12
s_add_u32 s26, s26, s39
s_add_u32 m0, s26, 2048
s_add_u32 s27, s36, 18432
buffer_load_dwordx4 v2, s[16:19], s27 offen sc1 lds
v_mfma_f32_32x32x16_bf16 v[176:191], v[68:71], v[36:39], v[176:191]
s_waitcnt lgkmcnt(0)
ds_read_b128 v[32:35], v18 offset:0
ds_read_b128 v[36:39], v18 offset:4096
ds_read_b64_tr_b16 v[64:65], v20 offset:8192
ds_read_b64_tr_b16 v[66:67], v20 offset:9216
ds_read_b64_tr_b16 v[68:69], v21 offset:8192
ds_read_b64_tr_b16 v[70:71], v21 offset:9216
v_mfma_f32_32x32x16_bf16 v[128:143], v[72:75], v[40:43], v[128:143]
s_lshl_b32 s26, s11, 12
s_add_u32 s26, s26, s39
s_add_u32 m0, s26, 3072
s_add_u32 s27, s36, 27648
buffer_load_dwordx4 v3, s[16:19], s27 offen sc1 lds
v_mfma_f32_32x32x16_bf16 v[144:159], v[72:75], v[44:47], v[144:159]
s_add_u32 s36, s36, 128
s_lshl_b32 s26, s11, 12
s_add_u32 s26, s26, s39
s_add_u32 m0, s26, 16384
s_add_u32 s27, s37, 0
buffer_load_dwordx4 v5, s[20:23], s27 offen lds
v_mfma_f32_32x32x16_bf16 v[160:175], v[76:79], v[40:43], v[160:175]
s_lshl_b32 s26, s11, 12
s_add_u32 s26, s26, s39
s_add_u32 m0, s26, 17408
s_add_u32 s27, s37, 32768
buffer_load_dwordx4 v5, s[20:23], s27 offen lds
v_mfma_f32_32x32x16_bf16 v[176:191], v[76:79], v[44:47], v[176:191]
s_waitcnt lgkmcnt(0)
ds_read_b128 v[40:43], v19 offset:0
ds_read_b128 v[44:47], v19 offset:4096
ds_read_b64_tr_b16 v[72:73], v20 offset:12288
ds_read_b64_tr_b16 v[74:75], v20 offset:13312
ds_read_b64_tr_b16 v[76:77], v21 offset:12288
ds_read_b64_tr_b16 v[78:79], v21 offset:13312
v_mfma_f32_32x32x16_bf16 v[128:143], v[64:67], v[32:35], v[128:143]
s_lshl_b32 s26, s11, 12
s_add_u32 s26, s26, s39
s_add_u32 m0, s26, 18432
s_add_u32 s27, s37, 65536
buffer_load_dwordx4 v5, s[20:23], s27 offen lds
v_mfma_f32_32x32x16_bf16 v[144:159], v[64:67], v[36:39], v[144:159]
s_lshl_b32 s26, s11, 12
s_add_u32 s26, s26, s39
s_add_u32 m0, s26, 19456
s_add_u32 s27, s37, 98304
buffer_load_dwordx4 v5, s[20:23], s27 offen lds
s_add_u32 s37, s37, 524288
v_mfma_f32_32x32x16_bf16 v[160:175], v[68:71], v[32:35], v[160:175]
v_mfma_f32_32x32x16_bf16 v[176:191], v[68:71], v[36:39], v[176:191]
s_waitcnt lgkmcnt(0)
s_waitcnt vmcnt(8)
s_barrier
s_add_u32 s38, s38, 32768
s_cmp_eq_u32 s38, 98304
s_cselect_b32 s38, 0, s38
v_add_u32 v16, s38, v8
v_add_u32 v17, s38, v9
v_add_u32 v18, s38, v10
v_add_u32 v19, s38, v11
s_add_u32 s25, s38, 16384
v_add_u32 v20, s25, v12
v_add_u32 v21, s25, v13
ds_read_b128 v[32:35], v16 offset:0
ds_read_b128 v[36:39], v16 offset:4096
ds_read_b64_tr_b16 v[64:65], v20 offset:0
ds_read_b64_tr_b16 v[66:67], v20 offset:1024
ds_read_b64_tr_b16 v[68:69], v21 offset:0
ds_read_b64_tr_b16 v[70:71], v21 offset:1024
v_mfma_f32_32x32x16_bf16 v[128:143], v[72:75], v[40:43], v[128:143]
v_mfma_f32_32x32x16_bf16 v[144:159], v[72:75], v[44:47], v[144:159]
v_mfma_f32_32x32x16_bf16 v[160:175], v[76:79], v[40:43], v[160:175]
v_mfma_f32_32x32x16_bf16 v[176:191], v[76:79], v[44:47], v[176:191]
s_add_u32 s39, s39, 32768
s_cmp_eq_u32 s39, 98304
s_cselect_b32 s39, 0, s39
s_add_u32 s40, s40, 1
s_cmp_lt_u32 s40, 7
s_cbranch_scc1 L_gl_94
s_waitcnt lgkmcnt(0)
ds_read_b128 v[40:43], v17 offset:0
ds_read_b128 v[44:47], v17 offset:4096
ds_read_b64_tr_b16 v[72:73], v20 offset:4096
ds_read_b64_tr_b16 v[74:75], v20 offset:5120
ds_read_b64_tr_b16 v[76:77], v21 offset:4096
ds_read_b64_tr_b16 v[78:79], v21 offset:5120
v_mfma_f32_32x32x16_bf16 v[128:143], v[64:67], v[32:35], v[128:143]
v_mfma_f32_32x32x16_bf16 v[144:159], v[64:67], v[36:39], v[144:159]
v_mfma_f32_32x32x16_bf16 v[160:175], v[68:71], v[32:35], v[160:175]
v_mfma_f32_32x32x16_bf16 v[176:191], v[68:71], v[36:39], v[176:191]
s_waitcnt lgkmcnt(0)
ds_read_b128 v[32:35], v18 offset:0
ds_read_b128 v[36:39], v18 offset:4096
ds_read_b64_tr_b16 v[64:65], v20 offset:8192
ds_read_b64_tr_b16 v[66:67], v20 offset:9216
ds_read_b64_tr_b16 v[68:69], v21 offset:8192
ds_read_b64_tr_b16 v[70:71], v21 offset:9216
v_mfma_f32_32x32x16_bf16 v[128:143], v[72:75], v[40:43], v[128:143]
v_mfma_f32_32x32x16_bf16 v[144:159], v[72:75], v[44:47], v[144:159]
v_mfma_f32_32x32x16_bf16 v[160:175], v[76:79], v[40:43], v[160:175]
v_mfma_f32_32x32x16_bf16 v[176:191], v[76:79], v[44:47], v[176:191]
s_waitcnt lgkmcnt(0)
ds_read_b128 v[40:43], v19 offset:0
ds_read_b128 v[44:47], v19 offset:4096
ds_read_b64_tr_b16 v[72:73], v20 offset:12288
ds_read_b64_tr_b16 v[74:75], v20 offset:13312
ds_read_b64_tr_b16 v[76:77], v21 offset:12288
ds_read_b64_tr_b16 v[78:79], v21 offset:13312
v_mfma_f32_32x32x16_bf16 v[128:143], v[64:67], v[32:35], v[128:143]
v_mfma_f32_32x32x16_bf16 v[144:159], v[64:67], v[36:39], v[144:159]
v_mfma_f32_32x32x16_bf16 v[160:175], v[68:71], v[32:35], v[160:175]
v_mfma_f32_32x32x16_bf16 v[176:191], v[68:71], v[36:39], v[176:191]
s_waitcnt lgkmcnt(0)
s_waitcnt vmcnt(0)
s_barrier
s_add_u32 s38, s38, 32768
s_cmp_eq_u32 s38, 98304
s_cselect_b32 s38, 0, s38
v_add_u32 v16, s38, v8
v_add_u32 v17, s38, v9
v_add_u32 v18, s38, v10
v_add_u32 v19, s38, v11
s_add_u32 s25, s38, 16384
v_add_u32 v20, s25, v12
v_add_u32 v21, s25, v13
ds_read_b128 v[32:35], v16 offset:0
ds_read_b128 v[36:39], v16 offset:4096
ds_read_b64_tr_b16 v[64:65], v20 offset:0
ds_read_b64_tr_b16 v[66:67], v20 offset:1024
ds_read_b64_tr_b16 v[68:69], v21 offset:0
ds_read_b64_tr_b16 v[70:71], v21 offset:1024
v_mfma_f32_32x32x16_bf16 v[128:143], v[72:75], v[40:43], v[128:143]
v_mfma_f32_32x32x16_bf16 v[144:159], v[72:75], v[44:47], v[144:159]
v_mfma_f32_32x32x16_bf16 v[160:175], v[76:79], v[40:43], v[160:175]
v_mfma_f32_32x32x16_bf16 v[176:191], v[76:79], v[44:47], v[176:191]
s_waitcnt lgkmcnt(0)
ds_read_b128 v[40:43], v17 offset:0
ds_read_b128 v[44:47], v17 offset:4096
ds_read_b64_tr_b16 v[72:73], v20 offset:4096
ds_read_b64_tr_b16 v[74:75], v20 offset:5120
ds_read_b64_tr_b16 v[76:77], v21 offset:4096
ds_read_b64_tr_b16 v[78:79], v21 offset:5120
v_mfma_f32_32x32x16_bf16 v[128:143], v[64:67], v[32:35], v[128:143]
v_mfma_f32_32x32x16_bf16 v[144:159], v[64:67], v[36:39], v[144:159]
v_mfma_f32_32x32x16_bf16 v[160:175], v[68:71], v[32:35], v[160:175]
v_mfma_f32_32x32x16_bf16 v[176:191], v[68:71], v[36:39], v[176:191]
s_waitcnt lgkmcnt(0)
ds_read_b128 v[32:35], v18 offset:0
ds_read_b128 v[36:39], v18 offset:4096
ds_read_b64_tr_b16 v[64:65], v20 offset:8192
ds_read_b64_tr_b16 v[66:67], v20 offset:9216
ds_read_b64_tr_b16 v[68:69], v21 offset:8192
ds_read_b64_tr_b16 v[70:71], v21 offset:9216
v_mfma_f32_32x32x16_bf16 v[128:143], v[72:75], v[40:43], v[128:143]
v_mfma_f32_32x32x16_bf16 v[144:159], v[72:75], v[44:47], v[144:159]
v_mfma_f32_32x32x16_bf16 v[160:175], v[76:79], v[40:43], v[160:175]
v_mfma_f32_32x32x16_bf16 v[176:191], v[76:79], v[44:47], v[176:191]
s_waitcnt lgkmcnt(0)
ds_read_b128 v[40:43], v19 offset:0
ds_read_b128 v[44:47], v19 offset:4096
ds_read_b64_tr_b16 v[72:73], v20 offset:12288
ds_read_b64_tr_b16 v[74:75], v20 offset:13312
ds_read_b64_tr_b16 v[76:77], v21 offset:12288
ds_read_b64_tr_b16 v[78:79], v21 offset:13312
v_mfma_f32_32x32x16_bf16 v[128:143], v[64:67], v[32:35], v[128:143]
v_mfma_f32_32x32x16_bf16 v[144:159], v[64:67], v[36:39], v[144:159]
v_mfma_f32_32x32x16_bf16 v[160:175], v[68:71], v[32:35], v[160:175]
v_mfma_f32_32x32x16_bf16 v[176:191], v[68:71], v[36:39], v[176:191]
s_waitcnt lgkmcnt(0)
v_mfma_f32_32x32x16_bf16 v[128:143], v[72:75], v[40:43], v[128:143]
v_mfma_f32_32x32x16_bf16 v[144:159], v[72:75], v[44:47], v[144:159]
v_mfma_f32_32x32x16_bf16 v[160:175], v[76:79], v[40:43], v[160:175]
v_mfma_f32_32x32x16_bf16 v[176:191], v[76:79], v[44:47], v[176:191]
s_nop 15
s_cmp_eq_u32 s43, 0
s_mov_b32 s41, 16777216
s_cselect_b32 s41, 50331648, s41
s_and_b32 s24, s11, 1
s_lshl_b32 s24, s24, 1
s_lshl_b32 s25, s44, 2
s_add_u32 s24, s24, s25
s_lshl_b32 s24, s24, 18
s_add_u32 s41, s41, s24
s_lshl_b32 s24, s45, 13
s_add_u32 s41, s41, s24
s_lshr_b32 s25, s11, 1
s_lshl_b32 s25, s25, 12
s_add_u32 s41, s41, s25
v_and_b32 v24, 31, v0
v_lshlrev_b32 v24, 4, v24
v_lshrrev_b32 v25, 5, v0
v_lshl_add_u32 v24, v25, 9, v24
v_cvt_pk_bf16_f32 v32, v128, v129
v_cvt_pk_bf16_f32 v33, v130, v131
v_cvt_pk_bf16_f32 v34, v132, v133
v_cvt_pk_bf16_f32 v35, v134, v135
s_nop 0
v_permlane32_swap_b32 v32, v34
v_permlane32_swap_b32 v33, v35
s_add_u32 s24, s41, 0
buffer_store_dwordx4 v[32:35], v24, s[12:15], s24 offen sc1
v_cvt_pk_bf16_f32 v36, v136, v137
v_cvt_pk_bf16_f32 v37, v138, v139
v_cvt_pk_bf16_f32 v38, v140, v141
v_cvt_pk_bf16_f32 v39, v142, v143
s_nop 0
v_permlane32_swap_b32 v36, v38
v_permlane32_swap_b32 v37, v39
s_add_u32 s24, s41, 1024
buffer_store_dwordx4 v[36:39], v24, s[12:15], s24 offen sc1
v_cvt_pk_bf16_f32 v40, v160, v161
v_cvt_pk_bf16_f32 v41, v162, v163
v_cvt_pk_bf16_f32 v42, v164, v165
v_cvt_pk_bf16_f32 v43, v166, v167
s_nop 0
v_permlane32_swap_b32 v40, v42
v_permlane32_swap_b32 v41, v43
s_add_u32 s24, s41, 2048
buffer_store_dwordx4 v[40:43], v24, s[12:15], s24 offen sc1
v_cvt_pk_bf16_f32 v44, v168, v169
v_cvt_pk_bf16_f32 v45, v170, v171
v_cvt_pk_bf16_f32 v46, v172, v173
v_cvt_pk_bf16_f32 v47, v174, v175
s_nop 0
v_permlane32_swap_b32 v44, v46
v_permlane32_swap_b32 v45, v47
s_add_u32 s24, s41, 3072
buffer_store_dwordx4 v[44:47], v24, s[12:15], s24 offen sc1
v_cvt_pk_bf16_f32 v48, v144, v145
v_cvt_pk_bf16_f32 v49, v146, v147
v_cvt_pk_bf16_f32 v50, v148, v149
v_cvt_pk_bf16_f32 v51, v150, v151
s_nop 0
v_permlane32_swap_b32 v48, v50
v_permlane32_swap_b32 v49, v51
s_add_u32 s24, s41, 262144
buffer_store_dwordx4 v[48:51], v24, s[12:15], s24 offen sc1
v_cvt_pk_bf16_f32 v52, v152, v153
v_cvt_pk_bf16_f32 v53, v154, v155
v_cvt_pk_bf16_f32 v54, v156, v157
v_cvt_pk_bf16_f32 v55, v158, v159
s_nop 0
v_permlane32_swap_b32 v52, v54
v_permlane32_swap_b32 v53, v55
s_add_u32 s24, s41, 263168
buffer_store_dwordx4 v[52:55], v24, s[12:15], s24 offen sc1
v_cvt_pk_bf16_f32 v56, v176, v177
v_cvt_pk_bf16_f32 v57, v178, v179
v_cvt_pk_bf16_f32 v58, v180, v181
v_cvt_pk_bf16_f32 v59, v182, v183
s_nop 0
v_permlane32_swap_b32 v56, v58
v_permlane32_swap_b32 v57, v59
s_add_u32 s24, s41, 264192
buffer_store_dwordx4 v[56:59], v24, s[12:15], s24 offen sc1
v_cvt_pk_bf16_f32 v60, v184, v185
v_cvt_pk_bf16_f32 v61, v186, v187
v_cvt_pk_bf16_f32 v62, v188, v189
v_cvt_pk_bf16_f32 v63, v190, v191
s_nop 0
v_permlane32_swap_b32 v60, v62
v_permlane32_swap_b32 v61, v63
s_add_u32 s24, s41, 265216
buffer_store_dwordx4 v[60:63], v24, s[12:15], s24 offen sc1
s_branch L_h1e_91
L_h1v_90:
s_barrier
s_mov_b32 s39, 0
s_mov_b32 s38, 0
s_lshl_b32 s26, s11, 12
s_add_u32 s26, s26, s39
s_add_u32 m0, s26, 16384
s_add_u32 s27, s37, 0
buffer_load_dwordx4 v5, s[20:23], s27 offen lds
s_lshl_b32 s26, s11, 12
s_add_u32 s26, s26, s39
s_add_u32 m0, s26, 17408
s_add_u32 s27, s37, 32768
buffer_load_dwordx4 v5, s[20:23], s27 offen lds
s_lshl_b32 s26, s11, 12
s_add_u32 s26, s26, s39
s_add_u32 m0, s26, 18432
s_add_u32 s27, s37, 65536
buffer_load_dwordx4 v5, s[20:23], s27 offen lds
s_lshl_b32 s26, s11, 12
s_add_u32 s26, s26, s39
s_add_u32 m0, s26, 19456
s_add_u32 s27, s37, 98304
buffer_load_dwordx4 v5, s[20:23], s27 offen lds
s_add_u32 s37, s37, 524288
s_lshl_b32 s76, s44, 7
s_add_u32 s76, s76, 77594624
s_cmp_lg_u32 s11, 0
s_cbranch_scc1 L_wd_95
s_mov_b32 s60, s76
s_mov_b32 s61, 0
L_wp_96:
buffer_load_dword v1, off, s[12:15], s60 sc1
s_waitcnt vmcnt(0)
v_readfirstlane_b32 s62, v1
s_nop 0
s_cmp_ge_u32 s62, 128
s_cbranch_scc1 L_wd_95
s_add_u32 s61, s61, 1
s_cmp_gt_u32 s61, 4000000
s_cbranch_scc1 L_abortw
s_sleep 1
s_branch L_wp_96
L_wd_95:
s_barrier
s_lshl_b32 s26, s11, 12
s_add_u32 s26, s26, s39
s_add_u32 m0, s26, 0
s_add_u32 s27, s36, 0
buffer_load_dwordx4 v2, s[16:19], s27 offen sc1 lds
s_lshl_b32 s26, s11, 12
s_add_u32 s26, s26, s39
s_add_u32 m0, s26, 1024
s_add_u32 s27, s36, 9216
buffer_load_dwordx4 v3, s[16:19], s27 offen sc1 lds
s_lshl_b32 s26, s11, 12
s_add_u32 s26, s26, s39
s_add_u32 m0, s26, 2048
s_add_u32 s27, s36, 18432
buffer_load_dwordx4 v2, s[16:19], s27 offen sc1 lds
s_lshl_b32 s26, s11, 12
s_add_u32 s26, s26, s39
s_add_u32 m0, s26, 3072
s_add_u32 s27, s36, 27648
buffer_load_dwordx4 v3, s[16:19], s27 offen sc1 lds
s_add_u32 s36, s36, 128
s_add_u32 s39, s39, 32768
s_cmp_eq_u32 s39, 98304
s_cselect_b32 s39, 0, s39
s_lshl_b32 s26, s11, 12
s_add_u32 s26, s26, s39
s_add_u32 m0, s26, 0
s_add_u32 s27, s36, 0
buffer_load_dwordx4 v2, s[16:19], s27 offen sc1 lds
s_lshl_b32 s26, s11, 12
s_add_u32 s26, s26, s39
s_add_u32 m0, s26, 1024
s_add_u32 s27, s36, 9216
buffer_load_dwordx4 v3, s[16:19], s27 offen sc1 lds
s_lshl_b32 s26, s11, 12
s_add_u32 s26, s26, s39
s_add_u32 m0, s26, 2048
s_add_u32 s27, s36, 18432
buffer_load_dwordx4 v2, s[16:19], s27 offen sc1 lds
s_lshl_b32 s26, s11, 12
s_add_u32 s26, s26, s39
s_add_u32 m0, s26, 3072
s_add_u32 s27, s36, 27648
buffer_load_dwordx4 v3, s[16:19], s27 offen sc1 lds
s_add_u32 s36, s36, 128
s_lshl_b32 s26, s11, 12
s_add_u32 s26, s26, s39
s_add_u32 m0, s26, 16384
s_add_u32 s27, s37, 0
buffer_load_dwordx4 v5, s[20:23], s27 offen lds
s_lshl_b32 s26, s11, 12
s_add_u32 s26, s26, s39
s_add_u32 m0, s26, 17408
s_add_u32 s27, s37, 32768
buffer_load_dwordx4 v5, s[20:23], s27 offen lds
s_lshl_b32 s26, s11, 12
s_add_u32 s26, s26, s39
s_add_u32 m0, s26, 18432
s_add_u32 s27, s37, 65536
buffer_load_dwordx4 v5, s[20:23], s27 offen lds
s_lshl_b32 s26, s11, 12
s_add_u32 s26, s26, s39
s_add_u32 m0, s26, 19456
s_add_u32 s27, s37, 98304
buffer_load_dwordx4 v5, s[20:23], s27 offen lds
s_add_u32 s37, s37, 524288
s_add_u32 s39, s39, 32768
s_cmp_eq_u32 s39, 98304
s_cselect_b32 s39, 0, s39
s_lshl_b32 s26, s11, 12
s_add_u32 s26, s26, s39
s_add_u32 m0, s26, 0
s_add_u32 s27, s36, 0
buffer_load_dwordx4 v2, s[16:19], s27 offen sc1 lds
s_lshl_b32 s26, s11, 12
s_add_u32 s26, s26, s39
s_add_u32 m0, s26, 1024
s_add_u32 s27, s36, 9216
buffer_load_dwordx4 v3, s[16:19], s27 offen sc1 lds
s_lshl_b32 s26, s11, 12
s_add_u32 s26, s26, s39
s_add_u32 m0, s26, 2048
s_add_u32 s27, s36, 18432
buffer_load_dwordx4 v2, s[16:19], s27 offen sc1 lds
s_lshl_b32 s26, s11, 12
s_add_u32 s26, s26, s39
s_add_u32 m0, s26, 3072
s_add_u32 s27, s36, 27648
buffer_load_dwordx4 v3, s[16:19], s27 offen sc1 lds
s_add_u32 s36, s36, 128
s_lshl_b32 s26, s11, 12
s_add_u32 s26, s26, s39
s_add_u32 m0, s26, 16384
s_add_u32 s27, s37, 0
buffer_load_dwordx4 v5, s[20:23], s27 offen lds
s_lshl_b32 s26, s11, 12
s_add_u32 s26, s26, s39
s_add_u32 m0, s26, 17408
s_add_u32 s27, s37, 32768
buffer_load_dwordx4 v5, s[20:23], s27 offen lds
s_lshl_b32 s26, s11, 12
s_add_u32 s26, s26, s39
s_add_u32 m0, s26, 18432
s_add_u32 s27, s37, 65536
buffer_load_dwordx4 v5, s[20:23], s27 offen lds
s_lshl_b32 s26, s11, 12
s_add_u32 s26, s26, s39
s_add_u32 m0, s26, 19456
s_add_u32 s27, s37, 98304
buffer_load_dwordx4 v5, s[20:23], s27 offen lds
s_add_u32 s37, s37, 524288
s_add_u32 s39, s39, 32768
s_cmp_eq_u32 s39, 98304
s_cselect_b32 s39, 0, s39
s_waitcnt vmcnt(16)
s_barrier
v_add_u32 v16, s38, v8
v_add_u32 v17, s38, v9
v_add_u32 v18, s38, v10
v_add_u32 v19, s38, v11
s_add_u32 s25, s38, 16384
v_add_u32 v20, s25, v12
v_add_u32 v21, s25, v13
ds_read_b128 v[32:35], v16 offset:0
ds_read_b128 v[36:39], v16 offset:4096
ds_read_b64_tr_b16 v[64:65], v20 offset:0
ds_read_b64_tr_b16 v[66:67], v20 offset:1024
ds_read_b64_tr_b16 v[68:69], v21 offset:0
ds_read_b64_tr_b16 v[70:71], v21 offset:1024
s_waitcnt lgkmcnt(0)
ds_read_b128 v[40:43], v17 offset:0
ds_read_b128 v[44:47], v17 offset:4096
ds_read_b64_tr_b16 v[72:73], v20 offset:4096
ds_read_b64_tr_b16 v[74:75], v20 offset:5120
ds_read_b64_tr_b16 v[76:77], v21 offset:4096
ds_read_b64_tr_b16 v[78:79], v21 offset:5120
v_mfma_f32_32x32x16_bf16 v[128:143], v[32:35], v[64:67], 0
v_mfma_f32_32x32x16_bf16 v[144:159], v[36:39], v[64:67], 0
v_mfma_f32_32x32x16_bf16 v[160:175], v[32:35], v[68:71], 0
v_mfma_f32_32x32x16_bf16 v[176:191], v[36:39], v[68:71], 0
s_waitcnt lgkmcnt(0)
ds_read_b128 v[32:35], v18 offset:0
ds_read_b128 v[36:39], v18 offset:4096
ds_read_b64_tr_b16 v[64:65], v20 offset:8192
ds_read_b64_tr_b16 v[66:67], v20 offset:9216
ds_read_b64_tr_b16 v[68:69], v21 offset:8192
ds_read_b64_tr_b16 v[70:71], v21 offset:9216
v_mfma_f32_32x32x16_bf16 v[128:143], v[40:43], v[72:75], v[128:143]
v_mfma_f32_32x32x16_bf16 v[144:159], v[44:47], v[72:75], v[144:159]
v_mfma_f32_32x32x16_bf16 v[160:175], v[40:43], v[76:79], v[160:175]
v_mfma_f32_32x32x16_bf16 v[176:191], v[44:47], v[76:79], v[176:191]
s_waitcnt lgkmcnt(0)
ds_read_b128 v[40:43], v19 offset:0
ds_read_b128 v[44:47], v19 offset:4096
ds_read_b64_tr_b16 v[72:73], v20 offset:12288
ds_read_b64_tr_b16 v[74:75], v20 offset:13312
ds_read_b64_tr_b16 v[76:77], v21 offset:12288
ds_read_b64_tr_b16 v[78:79], v21 offset:13312
v_mfma_f32_32x32x16_bf16 v[128:143], v[32:35], v[64:67], v[128:143]
v_mfma_f32_32x32x16_bf16 v[144:159], v[36:39], v[64:67], v[144:159]
v_mfma_f32_32x32x16_bf16 v[160:175], v[32:35], v[68:71], v[160:175]
v_mfma_f32_32x32x16_bf16 v[176:191], v[36:39], v[68:71], v[176:191]
s_waitcnt lgkmcnt(0)
s_waitcnt vmcnt(8)
s_barrier
s_add_u32 s38, s38, 32768
s_cmp_eq_u32 s38, 98304
s_cselect_b32 s38, 0, s38
v_add_u32 v16, s38, v8
v_add_u32 v17, s38, v9
v_add_u32 v18, s38, v10
v_add_u32 v19, s38, v11
s_add_u32 s25, s38, 16384
v_add_u32 v20, s25, v12
v_add_u32 v21, s25, v13
ds_read_b128 v[32:35], v16 offset:0
ds_read_b128 v[36:39], v16 offset:4096
ds_read_b64_tr_b16 v[64:65], v20 offset:0
ds_read_b64_tr_b16 v[66:67], v20 offset:1024
ds_read_b64_tr_b16 v[68:69], v21 offset:0
ds_read_b64_tr_b16 v[70:71], v21 offset:1024
v_mfma_f32_32x32x16_bf16 v[128:143], v[40:43], v[72:75], v[128:143]
v_mfma_f32_32x32x16_bf16 v[144:159], v[44:47], v[72:75], v[144:159]
v_mfma_f32_32x32x16_bf16 v[160:175], v[40:43], v[76:79], v[160:175]
v_mfma_f32_32x32x16_bf16 v[176:191], v[44:47], v[76:79], v[176:191]
s_mov_b32 s40, 1
L_gl_97:
s_waitcnt lgkmcnt(0)
ds_read_b128 v[40:43], v17 offset:0
ds_read_b128 v[44:47], v17 offset:4096
ds_read_b64_tr_b16 v[72:73], v20 offset:4096
ds_read_b64_tr_b16 v[74:75], v20 offset:5120
ds_read_b64_tr_b16 v[76:77], v21 offset:4096
ds_read_b64_tr_b16 v[78:79], v21 offset:5120
v_mfma_f32_32x32x16_bf16 v[128:143], v[32:35], v[64:67], v[128:143]
s_lshl_b32 s26, s11, 12
s_add_u32 s26, s26, s39
s_add_u32 m0, s26, 0
s_add_u32 s27, s36, 0
buffer_load_dwordx4 v2, s[16:19], s27 offen sc1 lds
v_mfma_f32_32x32x16_bf16 v[144:159], v[36:39], v[64:67], v[144:159]
s_lshl_b32 s26, s11, 12
s_add_u32 s26, s26, s39
s_add_u32 m0, s26, 1024
s_add_u32 s27, s36, 9216
buffer_load_dwordx4 v3, s[16:19], s27 offen sc1 lds
v_mfma_f32_32x32x16_bf16 v[160:175], v[32:35], v[68:71], v[160:175]
s_lshl_b32 s26, s11, 12
s_add_u32 s26, s26, s39
s_add_u32 m0, s26, 2048
s_add_u32 s27, s36, 18432
buffer_load_dwordx4 v2, s[16:19], s27 offen sc1 lds
v_mfma_f32_32x32x16_bf16 v[176:191], v[36:39], v[68:71], v[176:191]
s_waitcnt lgkmcnt(0)
ds_read_b128 v[32:35], v18 offset:0
ds_read_b128 v[36:39], v18 offset:4096
ds_read_b64_tr_b16 v[64:65], v20 offset:8192
ds_read_b64_tr_b16 v[66:67], v20 offset:9216
ds_read_b64_tr_b16 v[68:69], v21 offset:8192
ds_read_b64_tr_b16 v[70:71], v21 offset:9216
v_mfma_f32_32x32x16_bf16 v[128:143], v[40:43], v[72:75], v[128:143]
s_lshl_b32 s26, s11, 12
s_add_u32 s26, s26, s39
s_add_u32 m0, s26, 3072
s_add_u32 s27, s36, 27648
buffer_load_dwordx4 v3, s[16:19], s27 offen sc1 lds
v_mfma_f32_32x32x16_bf16 v[144:159], v[44:47], v[72:75], v[144:159]
s_add_u32 s36, s36, 128
s_lshl_b32 s26, s11, 12
s_add_u32 s26, s26, s39
s_add_u32 m0, s26, 16384
s_add_u32 s27, s37, 0
buffer_load_dwordx4 v5, s[20:23], s27 offen lds
v_mfma_f32_32x32x16_bf16 v[160:175], v[40:43], v[76:79], v[160:175]
s_lshl_b32 s26, s11, 12
s_add_u32 s26, s26, s39
s_add_u32 m0, s26, 17408
s_add_u32 s27, s37, 32768
buffer_load_dwordx4 v5, s[20:23], s27 offen lds
v_mfma_f32_32x32x16_bf16 v[176:191], v[44:47], v[76:79], v[176:191]
s_waitcnt lgkmcnt(0)
ds_read_b128 v[40:43], v19 offset:0
ds_read_b128 v[44:47], v19 offset:4096
ds_read_b64_tr_b16 v[72:73], v20 offset:12288
ds_read_b64_tr_b16 v[74:75], v20 offset:13312
ds_read_b64_tr_b16 v[76:77], v21 offset:12288
ds_read_b64_tr_b16 v[78:79], v21 offset:13312
v_mfma_f32_32x32x16_bf16 v[128:143], v[32:35], v[64:67], v[128:143]
s_lshl_b32 s26, s11, 12
s_add_u32 s26, s26, s39
s_add_u32 m0, s26, 18432
s_add_u32 s27, s37, 65536
buffer_load_dwordx4 v5, s[20:23], s27 offen lds
v_mfma_f32_32x32x16_bf16 v[144:159], v[36:39], v[64:67], v[144:159]
s_lshl_b32 s26, s11, 12
s_add_u32 s26, s26, s39
s_add_u32 m0, s26, 19456
s_add_u32 s27, s37, 98304
buffer_load_dwordx4 v5, s[20:23], s27 offen lds
s_add_u32 s37, s37, 524288
v_mfma_f32_32x32x16_bf16 v[160:175], v[32:35], v[68:71], v[160:175]
v_mfma_f32_32x32x16_bf16 v[176:191], v[36:39], v[68:71], v[176:191]
s_waitcnt lgkmcnt(0)
s_waitcnt vmcnt(8)
s_barrier
s_add_u32 s38, s38, 32768
s_cmp_eq_u32 s38, 98304
s_cselect_b32 s38, 0, s38
v_add_u32 v16, s38, v8
v_add_u32 v17, s38, v9
v_add_u32 v18, s38, v10
v_add_u32 v19, s38, v11
s_add_u32 s25, s38, 16384
v_add_u32 v20, s25, v12
v_add_u32 v21, s25, v13
ds_read_b128 v[32:35], v16 offset:0
ds_read_b128 v[36:39], v16 offset:4096
ds_read_b64_tr_b16 v[64:65], v20 offset:0
ds_read_b64_tr_b16 v[66:67], v20 offset:1024
ds_read_b64_tr_b16 v[68:69], v21 offset:0
ds_read_b64_tr_b16 v[70:71], v21 offset:1024
v_mfma_f32_32x32x16_bf16 v[128:143], v[40:43], v[72:75], v[128:143]
v_mfma_f32_32x32x16_bf16 v[144:159], v[44:47], v[72:75], v[144:159]
v_mfma_f32_32x32x16_bf16 v[160:175], v[40:43], v[76:79], v[160:175]
v_mfma_f32_32x32x16_bf16 v[176:191], v[44:47], v[76:79], v[176:191]
s_add_u32 s39, s39, 32768
s_cmp_eq_u32 s39, 98304
s_cselect_b32 s39, 0, s39
s_add_u32 s40, s40, 1
s_cmp_lt_u32 s40, 7
s_cbranch_scc1 L_gl_97
s_waitcnt lgkmcnt(0)
ds_read_b128 v[40:43], v17 offset:0
ds_read_b128 v[44:47], v17 offset:4096
ds_read_b64_tr_b16 v[72:73], v20 offset:4096
ds_read_b64_tr_b16 v[74:75], v20 offset:5120
ds_read_b64_tr_b16 v[76:77], v21 offset:4096
ds_read_b64_tr_b16 v[78:79], v21 offset:5120
v_mfma_f32_32x32x16_bf16 v[128:143], v[32:35], v[64:67], v[128:143]
v_mfma_f32_32x32x16_bf16 v[144:159], v[36:39], v[64:67], v[144:159]
v_mfma_f32_32x32x16_bf16 v[160:175], v[32:35], v[68:71], v[160:175]
v_mfma_f32_32x32x16_bf16 v[176:191], v[36:39], v[68:71], v[176:191]
s_waitcnt lgkmcnt(0)
ds_read_b128 v[32:35], v18 offset:0
ds_read_b128 v[36:39], v18 offset:4096
ds_read_b64_tr_b16 v[64:65], v20 offset:8192
ds_read_b64_tr_b16 v[66:67], v20 offset:9216
ds_read_b64_tr_b16 v[68:69], v21 offset:8192
ds_read_b64_tr_b16 v[70:71], v21 offset:9216
v_mfma_f32_32x32x16_bf16 v[128:143], v[40:43], v[72:75], v[128:143]
v_mfma_f32_32x32x16_bf16 v[144:159], v[44:47], v[72:75], v[144:159]
v_mfma_f32_32x32x16_bf16 v[160:175], v[40:43], v[76:79], v[160:175]
v_mfma_f32_32x32x16_bf16 v[176:191], v[44:47], v[76:79], v[176:191]
s_waitcnt lgkmcnt(0)
ds_read_b128 v[40:43], v19 offset:0
ds_read_b128 v[44:47], v19 offset:4096
ds_read_b64_tr_b16 v[72:73], v20 offset:12288
ds_read_b64_tr_b16 v[74:75], v20 offset:13312
ds_read_b64_tr_b16 v[76:77], v21 offset:12288
ds_read_b64_tr_b16 v[78:79], v21 offset:13312
v_mfma_f32_32x32x16_bf16 v[128:143], v[32:35], v[64:67], v[128:143]
v_mfma_f32_32x32x16_bf16 v[144:159], v[36:39], v[64:67], v[144:159]
v_mfma_f32_32x32x16_bf16 v[160:175], v[32:35], v[68:71], v[160:175]
v_mfma_f32_32x32x16_bf16 v[176:191], v[36:39], v[68:71], v[176:191]
s_waitcnt lgkmcnt(0)
s_waitcnt vmcnt(0)
s_barrier
s_add_u32 s38, s38, 32768
s_cmp_eq_u32 s38, 98304
s_cselect_b32 s38, 0, s38
v_add_u32 v16, s38, v8
v_add_u32 v17, s38, v9
v_add_u32 v18, s38, v10
v_add_u32 v19, s38, v11
s_add_u32 s25, s38, 16384
v_add_u32 v20, s25, v12
v_add_u32 v21, s25, v13
ds_read_b128 v[32:35], v16 offset:0
ds_read_b128 v[36:39], v16 offset:4096
ds_read_b64_tr_b16 v[64:65], v20 offset:0
ds_read_b64_tr_b16 v[66:67], v20 offset:1024
ds_read_b64_tr_b16 v[68:69], v21 offset:0
ds_read_b64_tr_b16 v[70:71], v21 offset:1024
v_mfma_f32_32x32x16_bf16 v[128:143], v[40:43], v[72:75], v[128:143]
v_mfma_f32_32x32x16_bf16 v[144:159], v[44:47], v[72:75], v[144:159]
v_mfma_f32_32x32x16_bf16 v[160:175], v[40:43], v[76:79], v[160:175]
v_mfma_f32_32x32x16_bf16 v[176:191], v[44:47], v[76:79], v[176:191]
s_waitcnt lgkmcnt(0)
ds_read_b128 v[40:43], v17 offset:0
ds_read_b128 v[44:47], v17 offset:4096
ds_read_b64_tr_b16 v[72:73], v20 offset:4096
ds_read_b64_tr_b16 v[74:75], v20 offset:5120
ds_read_b64_tr_b16 v[76:77], v21 offset:4096
ds_read_b64_tr_b16 v[78:79], v21 offset:5120
v_mfma_f32_32x32x16_bf16 v[128:143], v[32:35], v[64:67], v[128:143]
v_mfma_f32_32x32x16_bf16 v[144:159], v[36:39], v[64:67], v[144:159]
v_mfma_f32_32x32x16_bf16 v[160:175], v[32:35], v[68:71], v[160:175]
v_mfma_f32_32x32x16_bf16 v[176:191], v[36:39], v[68:71], v[176:191]
s_waitcnt lgkmcnt(0)
ds_read_b128 v[32:35], v18 offset:0
ds_read_b128 v[36:39], v18 offset:4096
ds_read_b64_tr_b16 v[64:65], v20 offset:8192
ds_read_b64_tr_b16 v[66:67], v20 offset:9216
ds_read_b64_tr_b16 v[68:69], v21 offset:8192
ds_read_b64_tr_b16 v[70:71], v21 offset:9216
v_mfma_f32_32x32x16_bf16 v[128:143], v[40:43], v[72:75], v[128:143]
v_mfma_f32_32x32x16_bf16 v[144:159], v[44:47], v[72:75], v[144:159]
v_mfma_f32_32x32x16_bf16 v[160:175], v[40:43], v[76:79], v[160:175]
v_mfma_f32_32x32x16_bf16 v[176:191], v[44:47], v[76:79], v[176:191]
s_waitcnt lgkmcnt(0)
ds_read_b128 v[40:43], v19 offset:0
ds_read_b128 v[44:47], v19 offset:4096
ds_read_b64_tr_b16 v[72:73], v20 offset:12288
ds_read_b64_tr_b16 v[74:75], v20 offset:13312
ds_read_b64_tr_b16 v[76:77], v21 offset:12288
ds_read_b64_tr_b16 v[78:79], v21 offset:13312
v_mfma_f32_32x32x16_bf16 v[128:143], v[32:35], v[64:67], v[128:143]
v_mfma_f32_32x32x16_bf16 v[144:159], v[36:39], v[64:67], v[144:159]
v_mfma_f32_32x32x16_bf16 v[160:175], v[32:35], v[68:71], v[160:175]
v_mfma_f32_32x32x16_bf16 v[176:191], v[36:39], v[68:71], v[176:191]
s_waitcnt lgkmcnt(0)
v_mfma_f32_32x32x16_bf16 v[128:143], v[40:43], v[72:75], v[128:143]
v_mfma_f32_32x32x16_bf16 v[144:159], v[44:47], v[72:75], v[144:159]
v_mfma_f32_32x32x16_bf16 v[160:175], v[40:43], v[76:79], v[160:175]
v_mfma_f32_32x32x16_bf16 v[176:191], v[44:47], v[76:79], v[176:191]
s_nop 15
s_and_b32 s24, s11, 1
s_lshl_b32 s24, s24, 1
s_lshl_b32 s25, s44, 2
s_add_u32 s24, s24, s25
s_lshl_b32 s24, s24, 18
s_add_u32 s41, s24, 33554432
s_lshl_b32 s24, s45, 13
s_add_u32 s41, s41, s24
s_lshr_b32 s25, s11, 1
s_lshl_b32 s25, s25, 10
s_add_u32 s41, s41, s25
v_and_b32 v24, 31, v0
v_lshlrev_b32 v24, 4, v24
v_lshrrev_b32 v25, 5, v0
v_lshl_add_u32 v24, v25, 11, v24
v_cvt_pk_bf16_f32 v32, v128, v129
v_cvt_pk_bf16_f32 v33, v130, v131
v_cvt_pk_bf16_f32 v34, v136, v137
v_cvt_pk_bf16_f32 v35, v138, v139
s_add_u32 s24, s41, 0
buffer_store_dwordx4 v[32:35], v24, s[12:15], s24 offen sc1
v_cvt_pk_bf16_f32 v36, v132, v133
v_cvt_pk_bf16_f32 v37, v134, v135
v_cvt_pk_bf16_f32 v38, v140, v141
v_cvt_pk_bf16_f32 v39, v142, v143
s_add_u32 s24, s41, 4096
buffer_store_dwordx4 v[36:39], v24, s[12:15], s24 offen sc1
v_cvt_pk_bf16_f32 v40, v160, v161
v_cvt_pk_bf16_f32 v41, v162, v163
v_cvt_pk_bf16_f32 v42, v168, v169
v_cvt_pk_bf16_f32 v43, v170, v171
s_add_u32 s24, s41, 512
buffer_store_dwordx4 v[40:43], v24, s[12:15], s24 offen sc1
v_cvt_pk_bf16_f32 v44, v164, v165
v_cvt_pk_bf16_f32 v45, v166, v167
v_cvt_pk_bf16_f32 v46, v172, v173
v_cvt_pk_bf16_f32 v47, v174, v175
s_add_u32 s24, s41, 4608
buffer_store_dwordx4 v[44:47], v24, s[12:15], s24 offen sc1
v_cvt_pk_bf16_f32 v48, v144, v145
v_cvt_pk_bf16_f32 v49, v146, v147
v_cvt_pk_bf16_f32 v50, v152, v153
v_cvt_pk_bf16_f32 v51, v154, v155
s_add_u32 s24, s41, 262144
buffer_store_dwordx4 v[48:51], v24, s[12:15], s24 offen sc1
v_cvt_pk_bf16_f32 v52, v148, v149
v_cvt_pk_bf16_f32 v53, v150, v151
v_cvt_pk_bf16_f32 v54, v156, v157
v_cvt_pk_bf16_f32 v55, v158, v159
s_add_u32 s24, s41, 266240
buffer_store_dwordx4 v[52:55], v24, s[12:15], s24 offen sc1
v_cvt_pk_bf16_f32 v56, v176, v177
v_cvt_pk_bf16_f32 v57, v178, v179
v_cvt_pk_bf16_f32 v58, v184, v185
v_cvt_pk_bf16_f32 v59, v186, v187
s_add_u32 s24, s41, 262656
buffer_store_dwordx4 v[56:59], v24, s[12:15], s24 offen sc1
v_cvt_pk_bf16_f32 v60, v180, v181
v_cvt_pk_bf16_f32 v61, v182, v183
v_cvt_pk_bf16_f32 v62, v188, v189
v_cvt_pk_bf16_f32 v63, v190, v191
s_add_u32 s24, s41, 266752
buffer_store_dwordx4 v[60:63], v24, s[12:15], s24 offen sc1
L_h1e_91:
s_waitcnt vmcnt(0)
s_lshl_b32 s24, s44, 7
s_add_u32 s24, s24, 77596672
s_barrier
s_cmp_lg_u32 s11, 0
s_cbranch_scc1 L_sg_98
s_mov_b32 s60, s24
v_mov_b32 v1, 1
s_mov_b64 exec, 1
buffer_atomic_add v1, off, s[12:15], s60
s_mov_b64 exec, -1
L_sg_98:
s_branch L_next
L_t_g2:
s_sub_u32 s44, s42, 640
s_mul_i32 s43, s44, 1821
s_lshr_b32 s43, s43, 16
s_mul_i32 s24, s43, 36
s_sub_u32 s44, s44, s24
s_add_u32 s16, s12, 3145728
s_addc_u32 s17, s13, 0
s_mov_b32 s18, 2359296
s_load_dwordx2 s[20:21], s[0:1], 64
s_mov_b32 s22, 18874368
s_waitcnt lgkmcnt(0)
v_add_u32 v24, 0, v0
v_mul_u32_u24 v25, 2731, v24
v_lshrrev_b32 v25, 16, v25
v_mul_u32_u24 v26, 24, v25
v_sub_u32 v26, v24, v26
v_bfe_u32 v27, v25, 1, 1
v_lshlrev_b32 v27, 2, v27
v_xor_b32 v26, v26, v27
v_mul_u32_u24 v25, 1152, v25
v_lshl_add_u32 v2, v26, 4, v25
v_add_u32 v24, 64, v0
v_mul_u32_u24 v25, 2731, v24
v_lshrrev_b32 v25, 16, v25
v_mul_u32_u24 v26, 24, v25
v_sub_u32 v26, v24, v26
v_bfe_u32 v27, v25, 1, 1
v_lshlrev_b32 v27, 2, v27
v_xor_b32 v26, v26, v27
v_mul_u32_u24 v25, 1152, v25
v_lshl_add_u32 v3, v26, 4, v25
v_add_u32 v24, 128, v0
v_mul_u32_u24 v25, 2731, v24
v_lshrrev_b32 v25, 16, v25
v_mul_u32_u24 v26, 24, v25
v_sub_u32 v26, v24, v26
v_bfe_u32 v27, v25, 1, 1
v_lshlrev_b32 v27, 2, v27
v_xor_b32 v26, v26, v27
v_mul_u32_u24 v25, 1152, v25
v_lshl_add_u32 v4, v26, 4, v25
v_lshrrev_b32 v24, 4, v0
v_lshlrev_b32 v25, 2, v24
v_mul_u32_u24 v24, 9216, v24
v_and_b32 v26, 15, v0
v_xor_b32 v26, v26, v25
v_lshl_add_u32 v5, v26, 4, v24
s_mul_i32 s36, s11, 18432
s_mul_i32 s24, s43, 384
s_add_u32 s36, s36, s24
s_mul_i32 s37, s11, 147456
s_lshl_b32 s24, s44, 8
s_add_u32 s37, s37, s24
s_and_b32 s24, s11, 1
s_mul_i32 s24, s24, 12
v_bfe_u32 v24, v0, 4, 1
v_bfe_u32 v25, v0, 5, 1
v_bfe_u32 v26, v0, 2, 2
v_and_b32 v27, 3, v0
v_lshl_add_u32 v28, v25, 3, v26
v_mul_u32_u24 v28, 384, v28
v_and_b32 v29, 1, v27
v_lshl_add_u32 v28, v29, 3, v28
v_lshrrev_b32 v29, 1, v27
v_lshl_add_u32 v29, v24, 1, v29
v_add_u32 v29, s24, v29
v_lshrrev_b32 v30, 1, v26
v_lshlrev_b32 v30, 2, v30
v_add_u32 v31, 0, v29
v_xor_b32 v31, v31, v30
v_lshl_add_u32 v8, v31, 4, v28
v_add_u32 v31, 4, v29
v_xor_b32 v31, v31, v30
v_lshl_add_u32 v9, v31, 4, v28
v_add_u32 v31, 8, v29
v_xor_b32 v31, v31, v30
v_lshl_add_u32 v10, v31, 4, v28
s_lshr_b32 s24, s11, 1
s_lshl_b32 s24, s24, 3
v_bfe_u32 v24, v0, 4, 1
v_bfe_u32 v25, v0, 5, 1
v_bfe_u32 v26, v0, 2, 2
v_and_b32 v27, 3, v0
v_lshl_add_u32 v28, v25, 3, v26
v_mul_u32_u24 v28, 256, v28
v_and_b32 v29, 1, v27
v_lshl_add_u32 v28, v29, 3, v28
v_lshrrev_b32 v29, 1, v27
v_lshl_add_u32 v29, v24, 1, v29
v_add_u32 v29, s24, v29
v_lshlrev_b32 v30, 2, v26
v_add_u32 v31, 0, v29
v_xor_b32 v31, v31, v30
v_lshl_add_u32 v12, v31, 4, v28
v_add_u32 v31, 4, v29
v_xor_b32 v31, v31, v30
v_lshl_add_u32 v13, v31, 4, v28
s_barrier
s_mov_b32 s39, 0
s_mov_b32 s38, 0
s_lshl_b32 s26, s11, 12
s_add_u32 s26, s26, s39
s_add_u32 m0, s26, 24576
s_add_u32 s27, s37, 0
buffer_load_dwordx4 v5, s[20:23], s27 offen lds
s_lshl_b32 s26, s11, 12
s_add_u32 s26, s26, s39
s_add_u32 m0, s26, 25600
s_add_u32 s27, s37, 36864
buffer_load_dwordx4 v5, s[20:23], s27 offen lds
s_lshl_b32 s26, s11, 12
s_add_u32 s26, s26, s39
s_add_u32 m0, s26, 26624
s_add_u32 s27, s37, 73728
buffer_load_dwordx4 v5, s[20:23], s27 offen lds
s_lshl_b32 s26, s11, 12
s_add_u32 s26, s26, s39
s_add_u32 m0, s26, 27648
s_add_u32 s27, s37, 110592
buffer_load_dwordx4 v5, s[20:23], s27 offen lds
s_add_u32 s37, s37, 589824
s_cmp_lg_u32 s11, 0
s_cbranch_scc1 L_wd_99
s_mov_b32 s60, 77594624
s_mov_b32 s63, 128
s_mov_b32 s61, 0
v_min_u32 v1, 15, v0
v_lshlrev_b32 v1, 7, v1
L_wp_100:
buffer_load_dword v250, v1, s[12:15], s60 offen sc1
s_waitcnt vmcnt(0)
v_cmp_gt_u32 vcc, s63, v250
s_cbranch_vccz L_wd_99
s_add_u32 s61, s61, 1
s_cmp_gt_u32 s61, 4000000
s_cbranch_scc1 L_abortw
s_sleep 1
s_branch L_wp_100
L_wd_99:
s_barrier
s_mul_i32 s26, s11, 6144
s_add_u32 s26, s26, s39
s_add_u32 m0, s26, 0
s_add_u32 s27, s36, 0
buffer_load_dwordx4 v2, s[16:19], s27 offen sc1 lds
s_mul_i32 s26, s11, 6144
s_add_u32 s26, s26, s39
s_add_u32 m0, s26, 1024
s_add_u32 s27, s36, 0
buffer_load_dwordx4 v3, s[16:19], s27 offen sc1 lds
s_mul_i32 s26, s11, 6144
s_add_u32 s26, s26, s39
s_add_u32 m0, s26, 2048
s_add_u32 s27, s36, 0
buffer_load_dwordx4 v4, s[16:19], s27 offen sc1 lds
s_mul_i32 s26, s11, 6144
s_add_u32 s26, s26, s39
s_add_u32 m0, s26, 3072
s_add_u32 s27, s36, 9216
buffer_load_dwordx4 v2, s[16:19], s27 offen sc1 lds
s_mul_i32 s26, s11, 6144
s_add_u32 s26, s26, s39
s_add_u32 m0, s26, 4096
s_add_u32 s27, s36, 9216
buffer_load_dwordx4 v3, s[16:19], s27 offen sc1 lds
s_mul_i32 s26, s11, 6144
s_add_u32 s26, s26, s39
s_add_u32 m0, s26, 5120
s_add_u32 s27, s36, 9216
buffer_load_dwordx4 v4, s[16:19], s27 offen sc1 lds
s_add_u32 s36, s36, 73728
s_add_u32 s39, s39, 40960
s_cmp_eq_u32 s39, 122880
s_cselect_b32 s39, 0, s39
s_mul_i32 s26, s11, 6144
s_add_u32 s26, s26, s39
s_add_u32 m0, s26, 0
s_add_u32 s27, s36, 0
buffer_load_dwordx4 v2, s[16:19], s27 offen sc1 lds
s_mul_i32 s26, s11, 6144
s_add_u32 s26, s26, s39
s_add_u32 m0, s26, 1024
s_add_u32 s27, s36, 0
buffer_load_dwordx4 v3, s[16:19], s27 offen sc1 lds
s_mul_i32 s26, s11, 6144
s_add_u32 s26, s26, s39
s_add_u32 m0, s26, 2048
s_add_u32 s27, s36, 0
buffer_load_dwordx4 v4, s[16:19], s27 offen sc1 lds
s_mul_i32 s26, s11, 6144
s_add_u32 s26, s26, s39
s_add_u32 m0, s26, 3072
s_add_u32 s27, s36, 9216
buffer_load_dwordx4 v2, s[16:19], s27 offen sc1 lds
s_mul_i32 s26, s11, 6144
s_add_u32 s26, s26, s39
s_add_u32 m0, s26, 4096
s_add_u32 s27, s36, 9216
buffer_load_dwordx4 v3, s[16:19], s27 offen sc1 lds
s_mul_i32 s26, s11, 6144
s_add_u32 s26, s26, s39
s_add_u32 m0, s26, 5120
s_add_u32 s27, s36, 9216
buffer_load_dwordx4 v4, s[16:19], s27 offen sc1 lds
s_add_u32 s36, s36, 73728
s_lshl_b32 s26, s11, 12
s_add_u32 s26, s26, s39
s_add_u32 m0, s26, 24576
s_add_u32 s27, s37, 0
buffer_load_dwordx4 v5, s[20:23], s27 offen lds
s_lshl_b32 s26, s11, 12
s_add_u32 s26, s26, s39
s_add_u32 m0, s26, 25600
s_add_u32 s27, s37, 36864
buffer_load_dwordx4 v5, s[20:23], s27 offen lds
s_lshl_b32 s26, s11, 12
s_add_u32 s26, s26, s39
s_add_u32 m0, s26, 26624
s_add_u32 s27, s37, 73728
buffer_load_dwordx4 v5, s[20:23], s27 offen lds
s_lshl_b32 s26, s11, 12
s_add_u32 s26, s26, s39
s_add_u32 m0, s26, 27648
s_add_u32 s27, s37, 110592
buffer_load_dwordx4 v5, s[20:23], s27 offen lds
s_add_u32 s37, s37, 589824
s_add_u32 s39, s39, 40960
s_cmp_eq_u32 s39, 122880
s_cselect_b32 s39, 0, s39
s_mul_i32 s26, s11, 6144
s_add_u32 s26, s26, s39
s_add_u32 m0, s26, 0
s_add_u32 s27, s36, 0
buffer_load_dwordx4 v2, s[16:19], s27 offen sc1 lds
s_mul_i32 s26, s11, 6144
s_add_u32 s26, s26, s39
s_add_u32 m0, s26, 1024
s_add_u32 s27, s36, 0
buffer_load_dwordx4 v3, s[16:19], s27 offen sc1 lds
s_mul_i32 s26, s11, 6144
s_add_u32 s26, s26, s39
s_add_u32 m0, s26, 2048
s_add_u32 s27, s36, 0
buffer_load_dwordx4 v4, s[16:19], s27 offen sc1 lds
s_mul_i32 s26, s11, 6144
s_add_u32 s26, s26, s39
s_add_u32 m0, s26, 3072
s_add_u32 s27, s36, 9216
buffer_load_dwordx4 v2, s[16:19], s27 offen sc1 lds
s_mul_i32 s26, s11, 6144
s_add_u32 s26, s26, s39
s_add_u32 m0, s26, 4096
s_add_u32 s27, s36, 9216
buffer_load_dwordx4 v3, s[16:19], s27 offen sc1 lds
s_mul_i32 s26, s11, 6144
s_add_u32 s26, s26, s39
s_add_u32 m0, s26, 5120
s_add_u32 s27, s36, 9216
buffer_load_dwordx4 v4, s[16:19], s27 offen sc1 lds
s_add_u32 s36, s36, 73728
s_lshl_b32 s26, s11, 12
s_add_u32 s26, s26, s39
s_add_u32 m0, s26, 24576
s_add_u32 s27, s37, 0
buffer_load_dwordx4 v5, s[20:23], s27 offen lds
s_lshl_b32 s26, s11, 12
s_add_u32 s26, s26, s39
s_add_u32 m0, s26, 25600
s_add_u32 s27, s37, 36864
buffer_load_dwordx4 v5, s[20:23], s27 offen lds
s_lshl_b32 s26, s11, 12
s_add_u32 s26, s26, s39
s_add_u32 m0, s26, 26624
s_add_u32 s27, s37, 73728
buffer_load_dwordx4 v5, s[20:23], s27 offen lds
s_lshl_b32 s26, s11, 12
s_add_u32 s26, s26, s39
s_add_u32 m0, s26, 27648
s_add_u32 s27, s37, 110592
buffer_load_dwordx4 v5, s[20:23], s27 offen lds
s_add_u32 s37, s37, 589824
s_add_u32 s39, s39, 40960
s_cmp_eq_u32 s39, 122880
s_cselect_b32 s39, 0, s39
s_waitcnt vmcnt(20)
s_barrier
v_add_u32 v16, s38, v8
v_add_u32 v17, s38, v9
v_add_u32 v18, s38, v10
s_add_u32 s25, s38, 24576
v_add_u32 v20, s25, v12
v_add_u32 v21, s25, v13
ds_read_b64_tr_b16 v[32:33], v16 offset:0
ds_read_b64_tr_b16 v[34:35], v16 offset:1536
ds_read_b64_tr_b16 v[36:37], v17 offset:0
ds_read_b64_tr_b16 v[38:39], v17 offset:1536
ds_read_b64_tr_b16 v[40:41], v18 offset:0
ds_read_b64_tr_b16 v[42:43], v18 offset:1536
ds_read_b64_tr_b16 v[64:65], v20 offset:0
ds_read_b64_tr_b16 v[66:67], v20 offset:1024
ds_read_b64_tr_b16 v[68:69], v21 offset:0
ds_read_b64_tr_b16 v[70:71], v21 offset:1024
s_waitcnt lgkmcnt(0)
ds_read_b64_tr_b16 v[44:45], v16 offset:6144
ds_read_b64_tr_b16 v[46:47], v16 offset:7680
ds_read_b64_tr_b16 v[48:49], v17 offset:6144
ds_read_b64_tr_b16 v[50:51], v17 offset:7680
ds_read_b64_tr_b16 v[52:53], v18 offset:6144
ds_read_b64_tr_b16 v[54:55], v18 offset:7680
ds_read_b64_tr_b16 v[72:73], v20 offset:4096
ds_read_b64_tr_b16 v[74:75], v20 offset:5120
ds_read_b64_tr_b16 v[76:77], v21 offset:4096
ds_read_b64_tr_b16 v[78:79], v21 offset:5120
v_mfma_f32_32x32x16_bf16 v[128:143], v[64:67], v[32:35], 0
v_mfma_f32_32x32x16_bf16 v[144:159], v[64:67], v[36:39], 0
v_mfma_f32_32x32x16_bf16 v[160:175], v[64:67], v[40:43], 0
v_mfma_f32_32x32x16_bf16 v[176:191], v[68:71], v[32:35], 0
v_mfma_f32_32x32x16_bf16 v[192:207], v[68:71], v[36:39], 0
v_mfma_f32_32x32x16_bf16 v[208:223], v[68:71], v[40:43], 0
s_waitcnt lgkmcnt(0)
ds_read_b64_tr_b16 v[32:33], v16 offset:12288
ds_read_b64_tr_b16 v[34:35], v16 offset:13824
ds_read_b64_tr_b16 v[36:37], v17 offset:12288
ds_read_b64_tr_b16 v[38:39], v17 offset:13824
ds_read_b64_tr_b16 v[40:41], v18 offset:12288
ds_read_b64_tr_b16 v[42:43], v18 offset:13824
ds_read_b64_tr_b16 v[64:65], v20 offset:8192
ds_read_b64_tr_b16 v[66:67], v20 offset:9216
ds_read_b64_tr_b16 v[68:69], v21 offset:8192
ds_read_b64_tr_b16 v[70:71], v21 offset:9216
v_mfma_f32_32x32x16_bf16 v[128:143], v[72:75], v[44:47], v[128:143]
v_mfma_f32_32x32x16_bf16 v[144:159], v[72:75], v[48:51], v[144:159]
v_mfma_f32_32x32x16_bf16 v[160:175], v[72:75], v[52:55], v[160:175]
v_mfma_f32_32x32x16_bf16 v[176:191], v[76:79], v[44:47], v[176:191]
v_mfma_f32_32x32x16_bf16 v[192:207], v[76:79], v[48:51], v[192:207]
v_mfma_f32_32x32x16_bf16 v[208:223], v[76:79], v[52:55], v[208:223]
s_waitcnt lgkmcnt(0)
ds_read_b64_tr_b16 v[44:45], v16 offset:18432
ds_read_b64_tr_b16 v[46:47], v16 offset:19968
ds_read_b64_tr_b16 v[48:49], v17 offset:18432
ds_read_b64_tr_b16 v[50:51], v17 offset:19968
ds_read_b64_tr_b16 v[52:53], v18 offset:18432
ds_read_b64_tr_b16 v[54:55], v18 offset:19968
ds_read_b64_tr_b16 v[72:73], v20 offset:12288
ds_read_b64_tr_b16 v[74:75], v20 offset:13312
ds_read_b64_tr_b16 v[76:77], v21 offset:12288
ds_read_b64_tr_b16 v[78:79], v21 offset:13312
v_mfma_f32_32x32x16_bf16 v[128:143], v[64:67], v[32:35], v[128:143]
v_mfma_f32_32x32x16_bf16 v[144:159], v[64:67], v[36:39], v[144:159]
v_mfma_f32_32x32x16_bf16 v[160:175], v[64:67], v[40:43], v[160:175]
v_mfma_f32_32x32x16_bf16 v[176:191], v[68:71], v[32:35], v[176:191]
v_mfma_f32_32x32x16_bf16 v[192:207], v[68:71], v[36:39], v[192:207]
v_mfma_f32_32x32x16_bf16 v[208:223], v[68:71], v[40:43], v[208:223]
s_waitcnt lgkmcnt(0)
s_waitcnt vmcnt(10)
s_barrier
s_add_u32 s38, s38, 40960
s_cmp_eq_u32 s38, 122880
s_cselect_b32 s38, 0, s38
v_add_u32 v16, s38, v8
v_add_u32 v17, s38, v9
v_add_u32 v18, s38, v10
s_add_u32 s25, s38, 24576
v_add_u32 v20, s25, v12
v_add_u32 v21, s25, v13
ds_read_b64_tr_b16 v[32:33], v16 offset:0
ds_read_b64_tr_b16 v[34:35], v16 offset:1536
ds_read_b64_tr_b16 v[36:37], v17 offset:0
ds_read_b64_tr_b16 v[38:39], v17 offset:1536
ds_read_b64_tr_b16 v[40:41], v18 offset:0
ds_read_b64_tr_b16 v[42:43], v18 offset:1536
ds_read_b64_tr_b16 v[64:65], v20 offset:0
ds_read_b64_tr_b16 v[66:67], v20 offset:1024
ds_read_b64_tr_b16 v[68:69], v21 offset:0
ds_read_b64_tr_b16 v[70:71], v21 offset:1024
v_mfma_f32_32x32x16_bf16 v[128:143], v[72:75], v[44:47], v[128:143]
v_mfma_f32_32x32x16_bf16 v[144:159], v[72:75], v[48:51], v[144:159]
v_mfma_f32_32x32x16_bf16 v[160:175], v[72:75], v[52:55], v[160:175]
v_mfma_f32_32x32x16_bf16 v[176:191], v[76:79], v[44:47], v[176:191]
v_mfma_f32_32x32x16_bf16 v[192:207], v[76:79], v[48:51], v[192:207]
v_mfma_f32_32x32x16_bf16 v[208:223], v[76:79], v[52:55], v[208:223]
s_mov_b32 s40, 1
L_gl_101:
s_waitcnt lgkmcnt(0)
ds_read_b64_tr_b16 v[44:45], v16 offset:6144
ds_read_b64_tr_b16 v[46:47], v16 offset:7680
ds_read_b64_tr_b16 v[48:49], v17 offset:6144
ds_read_b64_tr_b16 v[50:51], v17 offset:7680
ds_read_b64_tr_b16 v[52:53], v18 offset:6144
ds_read_b64_tr_b16 v[54:55], v18 offset:7680
ds_read_b64_tr_b16 v[72:73], v20 offset:4096
ds_read_b64_tr_b16 v[74:75], v20 offset:5120
ds_read_b64_tr_b16 v[76:77], v21 offset:4096
ds_read_b64_tr_b16 v[78:79], v21 offset:5120
v_mfma_f32_32x32x16_bf16 v[128:143], v[64:67], v[32:35], v[128:143]
s_mul_i32 s26, s11, 6144
s_add_u32 s26, s26, s39
s_add_u32 m0, s26, 0
s_add_u32 s27, s36, 0
buffer_load_dwordx4 v2, s[16:19], s27 offen sc1 lds
v_mfma_f32_32x32x16_bf16 v[144:159], v[64:67], v[36:39], v[144:159]
s_mul_i32 s26, s11, 6144
s_add_u32 s26, s26, s39
s_add_u32 m0, s26, 1024
s_add_u32 s27, s36, 0
buffer_load_dwordx4 v3, s[16:19], s27 offen sc1 lds
v_mfma_f32_32x32x16_bf16 v[160:175], v[64:67], v[40:43], v[160:175]
s_mul_i32 s26, s11, 6144
s_add_u32 s26, s26, s39
s_add_u32 m0, s26, 2048
s_add_u32 s27, s36, 0
buffer_load_dwordx4 v4, s[16:19], s27 offen sc1 lds
v_mfma_f32_32x32x16_bf16 v[176:191], v[68:71], v[32:35], v[176:191]
s_mul_i32 s26, s11, 6144
s_add_u32 s26, s26, s39
s_add_u32 m0, s26, 3072
s_add_u32 s27, s36, 9216
buffer_load_dwordx4 v2, s[16:19], s27 offen sc1 lds
v_mfma_f32_32x32x16_bf16 v[192:207], v[68:71], v[36:39], v[192:207]
v_mfma_f32_32x32x16_bf16 v[208:223], v[68:71], v[40:43], v[208:223]
s_waitcnt lgkmcnt(0)
ds_read_b64_tr_b16 v[32:33], v16 offset:12288
ds_read_b64_tr_b16 v[34:35], v16 offset:13824
ds_read_b64_tr_b16 v[36:37], v17 offset:12288
ds_read_b64_tr_b16 v[38:39], v17 offset:13824
ds_read_b64_tr_b16 v[40:41], v18 offset:12288
ds_read_b64_tr_b16 v[42:43], v18 offset:13824
ds_read_b64_tr_b16 v[64:65], v20 offset:8192
ds_read_b64_tr_b16 v[66:67], v20 offset:9216
ds_read_b64_tr_b16 v[68:69], v21 offset:8192
ds_read_b64_tr_b16 v[70:71], v21 offset:9216
v_mfma_f32_32x32x16_bf16 v[128:143], v[72:75], v[44:47], v[128:143]
s_mul_i32 s26, s11, 6144
s_add_u32 s26, s26, s39
s_add_u32 m0, s26, 4096
s_add_u32 s27, s36, 9216
buffer_load_dwordx4 v3, s[16:19], s27 offen sc1 lds
v_mfma_f32_32x32x16_bf16 v[144:159], v[72:75], v[48:51], v[144:159]
s_mul_i32 s26, s11, 6144
s_add_u32 s26, s26, s39
s_add_u32 m0, s26, 5120
s_add_u32 s27, s36, 9216
buffer_load_dwordx4 v4, s[16:19], s27 offen sc1 lds
v_mfma_f32_32x32x16_bf16 v[160:175], v[72:75], v[52:55], v[160:175]
s_add_u32 s36, s36, 73728
s_lshl_b32 s26, s11, 12
s_add_u32 s26, s26, s39
s_add_u32 m0, s26, 24576
s_add_u32 s27, s37, 0
buffer_load_dwordx4 v5, s[20:23], s27 offen lds
v_mfma_f32_32x32x16_bf16 v[176:191], v[76:79], v[44:47], v[176:191]
s_lshl_b32 s26, s11, 12
s_add_u32 s26, s26, s39
s_add_u32 m0, s26, 25600
s_add_u32 s27, s37, 36864
buffer_load_dwordx4 v5, s[20:23], s27 offen lds
v_mfma_f32_32x32x16_bf16 v[192:207], v[76:79], v[48:51], v[192:207]
v_mfma_f32_32x32x16_bf16 v[208:223], v[76:79], v[52:55], v[208:223]
s_waitcnt lgkmcnt(0)
ds_read_b64_tr_b16 v[44:45], v16 offset:18432
ds_read_b64_tr_b16 v[46:47], v16 offset:19968
ds_read_b64_tr_b16 v[48:49], v17 offset:18432
ds_read_b64_tr_b16 v[50:51], v17 offset:19968
ds_read_b64_tr_b16 v[52:53], v18 offset:18432
ds_read_b64_tr_b16 v[54:55], v18 offset:19968
ds_read_b64_tr_b16 v[72:73], v20 offset:12288
ds_read_b64_tr_b16 v[74:75], v20 offset:13312
ds_read_b64_tr_b16 v[76:77], v21 offset:12288
ds_read_b64_tr_b16 v[78:79], v21 offset:13312
v_mfma_f32_32x32x16_bf16 v[128:143], v[64:67], v[32:35], v[128:143]
s_lshl_b32 s26, s11, 12
s_add_u32 s26, s26, s39
s_add_u32 m0, s26, 26624
s_add_u32 s27, s37, 73728
buffer_load_dwordx4 v5, s[20:23], s27 offen lds
v_mfma_f32_32x32x16_bf16 v[144:159], v[64:67], v[36:39], v[144:159]
s_lshl_b32 s26, s11, 12
s_add_u32 s26, s26, s39
s_add_u32 m0, s26, 27648
s_add_u32 s27, s37, 110592
buffer_load_dwordx4 v5, s[20:23], s27 offen lds
s_add_u32 s37, s37, 589824
v_mfma_f32_32x32x16_bf16 v[160:175], v[64:67], v[40:43], v[160:175]
v_mfma_f32_32x32x16_bf16 v[176:191], v[68:71], v[32:35], v[176:191]
v_mfma_f32_32x32x16_bf16 v[192:207], v[68:71], v[36:39], v[192:207]
v_mfma_f32_32x32x16_bf16 v[208:223], v[68:71], v[40:43], v[208:223]
s_waitcnt lgkmcnt(0)
s_waitcnt vmcnt(10)
s_barrier
s_add_u32 s38, s38, 40960
s_cmp_eq_u32 s38, 122880
s_cselect_b32 s38, 0, s38
v_add_u32 v16, s38, v8
v_add_u32 v17, s38, v9
v_add_u32 v18, s38, v10
s_add_u32 s25, s38, 24576
v_add_u32 v20, s25, v12
v_add_u32 v21, s25, v13
ds_read_b64_tr_b16 v[32:33], v16 offset:0
ds_read_b64_tr_b16 v[34:35], v16 offset:1536
ds_read_b64_tr_b16 v[36:37], v17 offset:0
ds_read_b64_tr_b16 v[38:39], v17 offset:1536
ds_read_b64_tr_b16 v[40:41], v18 offset:0
ds_read_b64_tr_b16 v[42:43], v18 offset:1536
ds_read_b64_tr_b16 v[64:65], v20 offset:0
ds_read_b64_tr_b16 v[66:67], v20 offset:1024
ds_read_b64_tr_b16 v[68:69], v21 offset:0
ds_read_b64_tr_b16 v[70:71], v21 offset:1024
v_mfma_f32_32x32x16_bf16 v[128:143], v[72:75], v[44:47], v[128:143]
v_mfma_f32_32x32x16_bf16 v[144:159], v[72:75], v[48:51], v[144:159]
v_mfma_f32_32x32x16_bf16 v[160:175], v[72:75], v[52:55], v[160:175]
v_mfma_f32_32x32x16_bf16 v[176:191], v[76:79], v[44:47], v[176:191]
v_mfma_f32_32x32x16_bf16 v[192:207], v[76:79], v[48:51], v[192:207]
v_mfma_f32_32x32x16_bf16 v[208:223], v[76:79], v[52:55], v[208:223]
s_add_u32 s39, s39, 40960
s_cmp_eq_u32 s39, 122880
s_cselect_b32 s39, 0, s39
s_add_u32 s40, s40, 1
s_cmp_lt_u32 s40, 30
s_cbranch_scc1 L_gl_101
s_waitcnt lgkmcnt(0)
ds_read_b64_tr_b16 v[44:45], v16 offset:6144
ds_read_b64_tr_b16 v[46:47], v16 offset:7680
ds_read_b64_tr_b16 v[48:49], v17 offset:6144
ds_read_b64_tr_b16 v[50:51], v17 offset:7680
ds_read_b64_tr_b16 v[52:53], v18 offset:6144
ds_read_b64_tr_b16 v[54:55], v18 offset:7680
ds_read_b64_tr_b16 v[72:73], v20 offset:4096
ds_read_b64_tr_b16 v[74:75], v20 offset:5120
ds_read_b64_tr_b16 v[76:77], v21 offset:4096
ds_read_b64_tr_b16 v[78:79], v21 offset:5120
v_mfma_f32_32x32x16_bf16 v[128:143], v[64:67], v[32:35], v[128:143]
v_mfma_f32_32x32x16_bf16 v[144:159], v[64:67], v[36:39], v[144:159]
v_mfma_f32_32x32x16_bf16 v[160:175], v[64:67], v[40:43], v[160:175]
v_mfma_f32_32x32x16_bf16 v[176:191], v[68:71], v[32:35], v[176:191]
v_mfma_f32_32x32x16_bf16 v[192:207], v[68:71], v[36:39], v[192:207]
v_mfma_f32_32x32x16_bf16 v[208:223], v[68:71], v[40:43], v[208:223]
s_waitcnt lgkmcnt(0)
ds_read_b64_tr_b16 v[32:33], v16 offset:12288
ds_read_b64_tr_b16 v[34:35], v16 offset:13824
ds_read_b64_tr_b16 v[36:37], v17 offset:12288
ds_read_b64_tr_b16 v[38:39], v17 offset:13824
ds_read_b64_tr_b16 v[40:41], v18 offset:12288
ds_read_b64_tr_b16 v[42:43], v18 offset:13824
ds_read_b64_tr_b16 v[64:65], v20 offset:8192
ds_read_b64_tr_b16 v[66:67], v20 offset:9216
ds_read_b64_tr_b16 v[68:69], v21 offset:8192
ds_read_b64_tr_b16 v[70:71], v21 offset:9216
v_mfma_f32_32x32x16_bf16 v[128:143], v[72:75], v[44:47], v[128:143]
v_mfma_f32_32x32x16_bf16 v[144:159], v[72:75], v[48:51], v[144:159]
v_mfma_f32_32x32x16_bf16 v[160:175], v[72:75], v[52:55], v[160:175]
v_mfma_f32_32x32x16_bf16 v[176:191], v[76:79], v[44:47], v[176:191]
v_mfma_f32_32x32x16_bf16 v[192:207], v[76:79], v[48:51], v[192:207]
v_mfma_f32_32x32x16_bf16 v[208:223], v[76:79], v[52:55], v[208:223]
s_waitcnt lgkmcnt(0)
ds_read_b64_tr_b16 v[44:45], v16 offset:18432
ds_read_b64_tr_b16 v[46:47], v16 offset:19968
ds_read_b64_tr_b16 v[48:49], v17 offset:18432
ds_read_b64_tr_b16 v[50:51], v17 offset:19968
ds_read_b64_tr_b16 v[52:53], v18 offset:18432
ds_read_b64_tr_b16 v[54:55], v18 offset:19968
ds_read_b64_tr_b16 v[72:73], v20 offset:12288
ds_read_b64_tr_b16 v[74:75], v20 offset:13312
ds_read_b64_tr_b16 v[76:77], v21 offset:12288
ds_read_b64_tr_b16 v[78:79], v21 offset:13312
v_mfma_f32_32x32x16_bf16 v[128:143], v[64:67], v[32:35], v[128:143]
v_mfma_f32_32x32x16_bf16 v[144:159], v[64:67], v[36:39], v[144:159]
v_mfma_f32_32x32x16_bf16 v[160:175], v[64:67], v[40:43], v[160:175]
v_mfma_f32_32x32x16_bf16 v[176:191], v[68:71], v[32:35], v[176:191]
v_mfma_f32_32x32x16_bf16 v[192:207], v[68:71], v[36:39], v[192:207]
v_mfma_f32_32x32x16_bf16 v[208:223], v[68:71], v[40:43], v[208:223]
s_waitcnt lgkmcnt(0)
s_waitcnt vmcnt(0)
s_barrier
s_add_u32 s38, s38, 40960
s_cmp_eq_u32 s38, 122880
s_cselect_b32 s38, 0, s38
v_add_u32 v16, s38, v8
v_add_u32 v17, s38, v9
v_add_u32 v18, s38, v10
s_add_u32 s25, s38, 24576
v_add_u32 v20, s25, v12
v_add_u32 v21, s25, v13
ds_read_b64_tr_b16 v[32:33], v16 offset:0
ds_read_b64_tr_b16 v[34:35], v16 offset:1536
ds_read_b64_tr_b16 v[36:37], v17 offset:0
ds_read_b64_tr_b16 v[38:39], v17 offset:1536
ds_read_b64_tr_b16 v[40:41], v18 offset:0
ds_read_b64_tr_b16 v[42:43], v18 offset:1536
ds_read_b64_tr_b16 v[64:65], v20 offset:0
ds_read_b64_tr_b16 v[66:67], v20 offset:1024
ds_read_b64_tr_b16 v[68:69], v21 offset:0
ds_read_b64_tr_b16 v[70:71], v21 offset:1024
v_mfma_f32_32x32x16_bf16 v[128:143], v[72:75], v[44:47], v[128:143]
v_mfma_f32_32x32x16_bf16 v[144:159], v[72:75], v[48:51], v[144:159]
v_mfma_f32_32x32x16_bf16 v[160:175], v[72:75], v[52:55], v[160:175]
v_mfma_f32_32x32x16_bf16 v[176:191], v[76:79], v[44:47], v[176:191]
v_mfma_f32_32x32x16_bf16 v[192:207], v[76:79], v[48:51], v[192:207]
v_mfma_f32_32x32x16_bf16 v[208:223], v[76:79], v[52:55], v[208:223]
s_waitcnt lgkmcnt(0)
ds_read_b64_tr_b16 v[44:45], v16 offset:6144
ds_read_b64_tr_b16 v[46:47], v16 offset:7680
ds_read_b64_tr_b16 v[48:49], v17 offset:6144
ds_read_b64_tr_b16 v[50:51], v17 offset:7680
ds_read_b64_tr_b16 v[52:53], v18 offset:6144
ds_read_b64_tr_b16 v[54:55], v18 offset:7680
ds_read_b64_tr_b16 v[72:73], v20 offset:4096
ds_read_b64_tr_b16 v[74:75], v20 offset:5120
ds_read_b64_tr_b16 v[76:77], v21 offset:4096
ds_read_b64_tr_b16 v[78:79], v21 offset:5120
v_mfma_f32_32x32x16_bf16 v[128:143], v[64:67], v[32:35], v[128:143]
v_mfma_f32_32x32x16_bf16 v[144:159], v[64:67], v[36:39], v[144:159]
v_mfma_f32_32x32x16_bf16 v[160:175], v[64:67], v[40:43], v[160:175]
v_mfma_f32_32x32x16_bf16 v[176:191], v[68:71], v[32:35], v[176:191]
v_mfma_f32_32x32x16_bf16 v[192:207], v[68:71], v[36:39], v[192:207]
v_mfma_f32_32x32x16_bf16 v[208:223], v[68:71], v[40:43], v[208:223]
s_waitcnt lgkmcnt(0)
ds_read_b64_tr_b16 v[32:33], v16 offset:12288
ds_read_b64_tr_b16 v[34:35], v16 offset:13824
ds_read_b64_tr_b16 v[36:37], v17 offset:12288
ds_read_b64_tr_b16 v[38:39], v17 offset:13824
ds_read_b64_tr_b16 v[40:41], v18 offset:12288
ds_read_b64_tr_b16 v[42:43], v18 offset:13824
ds_read_b64_tr_b16 v[64:65], v20 offset:8192
ds_read_b64_tr_b16 v[66:67], v20 offset:9216
ds_read_b64_tr_b16 v[68:69], v21 offset:8192
ds_read_b64_tr_b16 v[70:71], v21 offset:9216
v_mfma_f32_32x32x16_bf16 v[128:143], v[72:75], v[44:47], v[128:143]
v_mfma_f32_32x32x16_bf16 v[144:159], v[72:75], v[48:51], v[144:159]
v_mfma_f32_32x32x16_bf16 v[160:175], v[72:75], v[52:55], v[160:175]
v_mfma_f32_32x32x16_bf16 v[176:191], v[76:79], v[44:47], v[176:191]
v_mfma_f32_32x32x16_bf16 v[192:207], v[76:79], v[48:51], v[192:207]
v_mfma_f32_32x32x16_bf16 v[208:223], v[76:79], v[52:55], v[208:223]
s_waitcnt lgkmcnt(0)
ds_read_b64_tr_b16 v[44:45], v16 offset:18432
ds_read_b64_tr_b16 v[46:47], v16 offset:19968
ds_read_b64_tr_b16 v[48:49], v17 offset:18432
ds_read_b64_tr_b16 v[50:51], v17 offset:19968
ds_read_b64_tr_b16 v[52:53], v18 offset:18432
ds_read_b64_tr_b16 v[54:55], v18 offset:19968
ds_read_b64_tr_b16 v[72:73], v20 offset:12288
ds_read_b64_tr_b16 v[74:75], v20 offset:13312
ds_read_b64_tr_b16 v[76:77], v21 offset:12288
ds_read_b64_tr_b16 v[78:79], v21 offset:13312
v_mfma_f32_32x32x16_bf16 v[128:143], v[64:67], v[32:35], v[128:143]
v_mfma_f32_32x32x16_bf16 v[144:159], v[64:67], v[36:39], v[144:159]
v_mfma_f32_32x32x16_bf16 v[160:175], v[64:67], v[40:43], v[160:175]
v_mfma_f32_32x32x16_bf16 v[176:191], v[68:71], v[32:35], v[176:191]
v_mfma_f32_32x32x16_bf16 v[192:207], v[68:71], v[36:39], v[192:207]
v_mfma_f32_32x32x16_bf16 v[208:223], v[68:71], v[40:43], v[208:223]
s_waitcnt lgkmcnt(0)
v_mfma_f32_32x32x16_bf16 v[128:143], v[72:75], v[44:47], v[128:143]
v_mfma_f32_32x32x16_bf16 v[144:159], v[72:75], v[48:51], v[144:159]
v_mfma_f32_32x32x16_bf16 v[160:175], v[72:75], v[52:55], v[160:175]
v_mfma_f32_32x32x16_bf16 v[176:191], v[76:79], v[44:47], v[176:191]
v_mfma_f32_32x32x16_bf16 v[192:207], v[76:79], v[48:51], v[192:207]
v_mfma_f32_32x32x16_bf16 v[208:223], v[76:79], v[52:55], v[208:223]
s_nop 15
s_load_dwordx2 s[16:17], s[0:1], 72
s_mov_b32 s18, 9216
s_waitcnt lgkmcnt(0)
s_lshl_b32 s24, s44, 7
s_lshr_b32 s25, s11, 1
s_lshl_b32 s25, s25, 6
s_add_u32 s46, s24, s25
s_lshl_b32 s24, s46, 1
v_lshrrev_b32 v24, 5, v0
v_lshlrev_b32 v24, 3, v24
buffer_load_dwordx2 v[64:65], v24, s[16:19], s24 offen offset:0
buffer_load_dwordx2 v[66:67], v24, s[16:19], s24 offen offset:16
buffer_load_dwordx2 v[68:69], v24, s[16:19], s24 offen offset:32
buffer_load_dwordx2 v[70:71], v24, s[16:19], s24 offen offset:48
buffer_load_dwordx2 v[72:73], v24, s[16:19], s24 offen offset:64
buffer_load_dwordx2 v[74:75], v24, s[16:19], s24 offen offset:80
buffer_load_dwordx2 v[76:77], v24, s[16:19], s24 offen offset:96
buffer_load_dwordx2 v[78:79], v24, s[16:19], s24 offen offset:112
s_waitcnt vmcnt(0)
v_lshlrev_b32 v32, 16, v64
v_and_b32 v33, 0xffff0000, v64
v_lshlrev_b32 v34, 16, v65
v_and_b32 v35, 0xffff0000, v65
v_lshlrev_b32 v36, 16, v66
v_and_b32 v37, 0xffff0000, v66
v_lshlrev_b32 v38, 16, v67
v_and_b32 v39, 0xffff0000, v67
v_lshlrev_b32 v40, 16, v68
v_and_b32 v41, 0xffff0000, v68
v_lshlrev_b32 v42, 16, v69
v_and_b32 v43, 0xffff0000, v69
v_lshlrev_b32 v44, 16, v70
v_and_b32 v45, 0xffff0000, v70
v_lshlrev_b32 v46, 16, v71
v_and_b32 v47, 0xffff0000, v71
v_lshlrev_b32 v48, 16, v72
v_and_b32 v49, 0xffff0000, v72
v_lshlrev_b32 v50, 16, v73
v_and_b32 v51, 0xffff0000, v73
v_lshlrev_b32 v52, 16, v74
v_and_b32 v53, 0xffff0000, v74
v_lshlrev_b32 v54, 16, v75
v_and_b32 v55, 0xffff0000, v75
v_lshlrev_b32 v56, 16, v76
v_and_b32 v57, 0xffff0000, v76
v_lshlrev_b32 v58, 16, v77
v_and_b32 v59, 0xffff0000, v77
v_lshlrev_b32 v60, 16, v78
v_and_b32 v61, 0xffff0000, v78
v_lshlrev_b32 v62, 16, v79
v_and_b32 v63, 0xffff0000, v79
s_lshr_b32 s24, s46, 3
s_mul_i32 s41, s24, 9216
s_mul_i32 s24, s43, 3072
s_add_u32 s41, s41, s24
s_and_b32 s24, s11, 1
s_mul_i32 s24, s24, 1536
s_add_u32 s41, s41, s24
s_add_u32 s41, s41, 83886080
v_and_b32 v24, 31, v0
v_lshlrev_b32 v24, 4, v24
v_lshrrev_b32 v25, 5, v0
v_mul_u32_u24 v25, 9216, v25
v_add_u32 v24, v24, v25
s_mov_b32 s28, 0x3d372713
s_mov_b32 s29, 0xc0135761
v_add_f32 v128, v128, v32
v_mul_f32 v26, v128, v128
v_mul_f32 v26, s28, v26
v_fma_f32 v26, v26, v128, v128
v_mul_f32 v26, s29, v26
v_exp_f32 v26, v26
s_nop 0
v_add_f32 v26, 1.0, v26
v_rcp_f32 v26, v26
s_nop 0
v_mul_f32 v128, v128, v26
v_add_f32 v129, v129, v33
v_mul_f32 v26, v129, v129
v_mul_f32 v26, s28, v26
v_fma_f32 v26, v26, v129, v129
v_mul_f32 v26, s29, v26
v_exp_f32 v26, v26
s_nop 0
v_add_f32 v26, 1.0, v26
v_rcp_f32 v26, v26
s_nop 0
v_mul_f32 v129, v129, v26
v_add_f32 v130, v130, v34
v_mul_f32 v26, v130, v130
v_mul_f32 v26, s28, v26
v_fma_f32 v26, v26, v130, v130
v_mul_f32 v26, s29, v26
v_exp_f32 v26, v26
s_nop 0
v_add_f32 v26, 1.0, v26
v_rcp_f32 v26, v26
s_nop 0
v_mul_f32 v130, v130, v26
v_add_f32 v131, v131, v35
v_mul_f32 v26, v131, v131
v_mul_f32 v26, s28, v26
v_fma_f32 v26, v26, v131, v131
v_mul_f32 v26, s29, v26
v_exp_f32 v26, v26
s_nop 0
v_add_f32 v26, 1.0, v26
v_rcp_f32 v26, v26
s_nop 0
v_mul_f32 v131, v131, v26
v_add_f32 v132, v132, v36
v_mul_f32 v26, v132, v132
v_mul_f32 v26, s28, v26
v_fma_f32 v26, v26, v132, v132
v_mul_f32 v26, s29, v26
v_exp_f32 v26, v26
s_nop 0
v_add_f32 v26, 1.0, v26
v_rcp_f32 v26, v26
s_nop 0
v_mul_f32 v132, v132, v26
v_add_f32 v133, v133, v37
v_mul_f32 v26, v133, v133
v_mul_f32 v26, s28, v26
v_fma_f32 v26, v26, v133, v133
v_mul_f32 v26, s29, v26
v_exp_f32 v26, v26
s_nop 0
v_add_f32 v26, 1.0, v26
v_rcp_f32 v26, v26
s_nop 0
v_mul_f32 v133, v133, v26
v_add_f32 v134, v134, v38
v_mul_f32 v26, v134, v134
v_mul_f32 v26, s28, v26
v_fma_f32 v26, v26, v134, v134
v_mul_f32 v26, s29, v26
v_exp_f32 v26, v26
s_nop 0
v_add_f32 v26, 1.0, v26
v_rcp_f32 v26, v26
s_nop 0
v_mul_f32 v134, v134, v26
v_add_f32 v135, v135, v39
v_mul_f32 v26, v135, v135
v_mul_f32 v26, s28, v26
v_fma_f32 v26, v26, v135, v135
v_mul_f32 v26, s29, v26
v_exp_f32 v26, v26
s_nop 0
v_add_f32 v26, 1.0, v26
v_rcp_f32 v26, v26
s_nop 0
v_mul_f32 v135, v135, v26
v_add_f32 v136, v136, v40
v_mul_f32 v26, v136, v136
v_mul_f32 v26, s28, v26
v_fma_f32 v26, v26, v136, v136
v_mul_f32 v26, s29, v26
v_exp_f32 v26, v26
s_nop 0
v_add_f32 v26, 1.0, v26
v_rcp_f32 v26, v26
s_nop 0
v_mul_f32 v136, v136, v26
v_add_f32 v137, v137, v41
v_mul_f32 v26, v137, v137
v_mul_f32 v26, s28, v26
v_fma_f32 v26, v26, v137, v137
v_mul_f32 v26, s29, v26
v_exp_f32 v26, v26
s_nop 0
v_add_f32 v26, 1.0, v26
v_rcp_f32 v26, v26
s_nop 0
v_mul_f32 v137, v137, v26
v_add_f32 v138, v138, v42
v_mul_f32 v26, v138, v138
v_mul_f32 v26, s28, v26
v_fma_f32 v26, v26, v138, v138
v_mul_f32 v26, s29, v26
v_exp_f32 v26, v26
s_nop 0
v_add_f32 v26, 1.0, v26
v_rcp_f32 v26, v26
s_nop 0
v_mul_f32 v138, v138, v26
v_add_f32 v139, v139, v43
v_mul_f32 v26, v139, v139
v_mul_f32 v26, s28, v26
v_fma_f32 v26, v26, v139, v139
v_mul_f32 v26, s29, v26
v_exp_f32 v26, v26
s_nop 0
v_add_f32 v26, 1.0, v26
v_rcp_f32 v26, v26
s_nop 0
v_mul_f32 v139, v139, v26
v_add_f32 v140, v140, v44
v_mul_f32 v26, v140, v140
v_mul_f32 v26, s28, v26
v_fma_f32 v26, v26, v140, v140
v_mul_f32 v26, s29, v26
v_exp_f32 v26, v26
s_nop 0
v_add_f32 v26, 1.0, v26
v_rcp_f32 v26, v26
s_nop 0
v_mul_f32 v140, v140, v26
v_add_f32 v141, v141, v45
v_mul_f32 v26, v141, v141
v_mul_f32 v26, s28, v26
v_fma_f32 v26, v26, v141, v141
v_mul_f32 v26, s29, v26
v_exp_f32 v26, v26
s_nop 0
v_add_f32 v26, 1.0, v26
v_rcp_f32 v26, v26
s_nop 0
v_mul_f32 v141, v141, v26
v_add_f32 v142, v142, v46
v_mul_f32 v26, v142, v142
v_mul_f32 v26, s28, v26
v_fma_f32 v26, v26, v142, v142
v_mul_f32 v26, s29, v26
v_exp_f32 v26, v26
s_nop 0
v_add_f32 v26, 1.0, v26
v_rcp_f32 v26, v26
s_nop 0
v_mul_f32 v142, v142, v26
v_add_f32 v143, v143, v47
v_mul_f32 v26, v143, v143
v_mul_f32 v26, s28, v26
v_fma_f32 v26, v26, v143, v143
v_mul_f32 v26, s29, v26
v_exp_f32 v26, v26
s_nop 0
v_add_f32 v26, 1.0, v26
v_rcp_f32 v26, v26
s_nop 0
v_mul_f32 v143, v143, v26
v_cvt_pk_bf16_f32 v64, v128, v129
v_cvt_pk_bf16_f32 v65, v130, v131
v_cvt_pk_bf16_f32 v66, v132, v133
v_cvt_pk_bf16_f32 v67, v134, v135
s_nop 0
v_permlane32_swap_b32 v64, v66
v_permlane32_swap_b32 v65, v67
s_add_u32 s24, s41, 0
buffer_store_dwordx4 v[64:67], v24, s[12:15], s24 offen sc1
v_cvt_pk_bf16_f32 v68, v136, v137
v_cvt_pk_bf16_f32 v69, v138, v139
v_cvt_pk_bf16_f32 v70, v140, v141
v_cvt_pk_bf16_f32 v71, v142, v143
s_nop 0
v_permlane32_swap_b32 v68, v70
v_permlane32_swap_b32 v69, v71
s_add_u32 s24, s41, 18432
buffer_store_dwordx4 v[68:71], v24, s[12:15], s24 offen sc1
v_add_f32 v144, v144, v32
v_mul_f32 v26, v144, v144
v_mul_f32 v26, s28, v26
v_fma_f32 v26, v26, v144, v144
v_mul_f32 v26, s29, v26
v_exp_f32 v26, v26
s_nop 0
v_add_f32 v26, 1.0, v26
v_rcp_f32 v26, v26
s_nop 0
v_mul_f32 v144, v144, v26
v_add_f32 v145, v145, v33
v_mul_f32 v26, v145, v145
v_mul_f32 v26, s28, v26
v_fma_f32 v26, v26, v145, v145
v_mul_f32 v26, s29, v26
v_exp_f32 v26, v26
s_nop 0
v_add_f32 v26, 1.0, v26
v_rcp_f32 v26, v26
s_nop 0
v_mul_f32 v145, v145, v26
v_add_f32 v146, v146, v34
v_mul_f32 v26, v146, v146
v_mul_f32 v26, s28, v26
v_fma_f32 v26, v26, v146, v146
v_mul_f32 v26, s29, v26
v_exp_f32 v26, v26
s_nop 0
v_add_f32 v26, 1.0, v26
v_rcp_f32 v26, v26
s_nop 0
v_mul_f32 v146, v146, v26
v_add_f32 v147, v147, v35
v_mul_f32 v26, v147, v147
v_mul_f32 v26, s28, v26
v_fma_f32 v26, v26, v147, v147
v_mul_f32 v26, s29, v26
v_exp_f32 v26, v26
s_nop 0
v_add_f32 v26, 1.0, v26
v_rcp_f32 v26, v26
s_nop 0
v_mul_f32 v147, v147, v26
v_add_f32 v148, v148, v36
v_mul_f32 v26, v148, v148
v_mul_f32 v26, s28, v26
v_fma_f32 v26, v26, v148, v148
v_mul_f32 v26, s29, v26
v_exp_f32 v26, v26
s_nop 0
v_add_f32 v26, 1.0, v26
v_rcp_f32 v26, v26
s_nop 0
v_mul_f32 v148, v148, v26
v_add_f32 v149, v149, v37
v_mul_f32 v26, v149, v149
v_mul_f32 v26, s28, v26
v_fma_f32 v26, v26, v149, v149
v_mul_f32 v26, s29, v26
v_exp_f32 v26, v26
s_nop 0
v_add_f32 v26, 1.0, v26
v_rcp_f32 v26, v26
s_nop 0
v_mul_f32 v149, v149, v26
v_add_f32 v150, v150, v38
v_mul_f32 v26, v150, v150
v_mul_f32 v26, s28, v26
v_fma_f32 v26, v26, v150, v150
v_mul_f32 v26, s29, v26
v_exp_f32 v26, v26
s_nop 0
v_add_f32 v26, 1.0, v26
v_rcp_f32 v26, v26
s_nop 0
v_mul_f32 v150, v150, v26
v_add_f32 v151, v151, v39
v_mul_f32 v26, v151, v151
v_mul_f32 v26, s28, v26
v_fma_f32 v26, v26, v151, v151
v_mul_f32 v26, s29, v26
v_exp_f32 v26, v26
s_nop 0
v_add_f32 v26, 1.0, v26
v_rcp_f32 v26, v26
s_nop 0
v_mul_f32 v151, v151, v26
v_add_f32 v152, v152, v40
v_mul_f32 v26, v152, v152
v_mul_f32 v26, s28, v26
v_fma_f32 v26, v26, v152, v152
v_mul_f32 v26, s29, v26
v_exp_f32 v26, v26
s_nop 0
v_add_f32 v26, 1.0, v26
v_rcp_f32 v26, v26
s_nop 0
v_mul_f32 v152, v152, v26
v_add_f32 v153, v153, v41
v_mul_f32 v26, v153, v153
v_mul_f32 v26, s28, v26
v_fma_f32 v26, v26, v153, v153
v_mul_f32 v26, s29, v26
v_exp_f32 v26, v26
s_nop 0
v_add_f32 v26, 1.0, v26
v_rcp_f32 v26, v26
s_nop 0
v_mul_f32 v153, v153, v26
v_add_f32 v154, v154, v42
v_mul_f32 v26, v154, v154
v_mul_f32 v26, s28, v26
v_fma_f32 v26, v26, v154, v154
v_mul_f32 v26, s29, v26
v_exp_f32 v26, v26
s_nop 0
v_add_f32 v26, 1.0, v26
v_rcp_f32 v26, v26
s_nop 0
v_mul_f32 v154, v154, v26
v_add_f32 v155, v155, v43
v_mul_f32 v26, v155, v155
v_mul_f32 v26, s28, v26
v_fma_f32 v26, v26, v155, v155
v_mul_f32 v26, s29, v26
v_exp_f32 v26, v26
s_nop 0
v_add_f32 v26, 1.0, v26
v_rcp_f32 v26, v26
s_nop 0
v_mul_f32 v155, v155, v26
v_add_f32 v156, v156, v44
v_mul_f32 v26, v156, v156
v_mul_f32 v26, s28, v26
v_fma_f32 v26, v26, v156, v156
v_mul_f32 v26, s29, v26
v_exp_f32 v26, v26
s_nop 0
v_add_f32 v26, 1.0, v26
v_rcp_f32 v26, v26
s_nop 0
v_mul_f32 v156, v156, v26
v_add_f32 v157, v157, v45
v_mul_f32 v26, v157, v157
v_mul_f32 v26, s28, v26
v_fma_f32 v26, v26, v157, v157
v_mul_f32 v26, s29, v26
v_exp_f32 v26, v26
s_nop 0
v_add_f32 v26, 1.0, v26
v_rcp_f32 v26, v26
s_nop 0
v_mul_f32 v157, v157, v26
v_add_f32 v158, v158, v46
v_mul_f32 v26, v158, v158
v_mul_f32 v26, s28, v26
v_fma_f32 v26, v26, v158, v158
v_mul_f32 v26, s29, v26
v_exp_f32 v26, v26
s_nop 0
v_add_f32 v26, 1.0, v26
v_rcp_f32 v26, v26
s_nop 0
v_mul_f32 v158, v158, v26
v_add_f32 v159, v159, v47
v_mul_f32 v26, v159, v159
v_mul_f32 v26, s28, v26
v_fma_f32 v26, v26, v159, v159
v_mul_f32 v26, s29, v26
v_exp_f32 v26, v26
s_nop 0
v_add_f32 v26, 1.0, v26
v_rcp_f32 v26, v26
s_nop 0
v_mul_f32 v159, v159, v26
v_cvt_pk_bf16_f32 v72, v144, v145
v_cvt_pk_bf16_f32 v73, v146, v147
v_cvt_pk_bf16_f32 v74, v148, v149
v_cvt_pk_bf16_f32 v75, v150, v151
s_nop 0
v_permlane32_swap_b32 v72, v74
v_permlane32_swap_b32 v73, v75
s_add_u32 s24, s41, 512
buffer_store_dwordx4 v[72:75], v24, s[12:15], s24 offen sc1
v_cvt_pk_bf16_f32 v76, v152, v153
v_cvt_pk_bf16_f32 v77, v154, v155
v_cvt_pk_bf16_f32 v78, v156, v157
v_cvt_pk_bf16_f32 v79, v158, v159
s_nop 0
v_permlane32_swap_b32 v76, v78
v_permlane32_swap_b32 v77, v79
s_add_u32 s24, s41, 18944
buffer_store_dwordx4 v[76:79], v24, s[12:15], s24 offen sc1
v_add_f32 v160, v160, v32
v_mul_f32 v26, v160, v160
v_mul_f32 v26, s28, v26
v_fma_f32 v26, v26, v160, v160
v_mul_f32 v26, s29, v26
v_exp_f32 v26, v26
s_nop 0
v_add_f32 v26, 1.0, v26
v_rcp_f32 v26, v26
s_nop 0
v_mul_f32 v160, v160, v26
v_add_f32 v161, v161, v33
v_mul_f32 v26, v161, v161
v_mul_f32 v26, s28, v26
v_fma_f32 v26, v26, v161, v161
v_mul_f32 v26, s29, v26
v_exp_f32 v26, v26
s_nop 0
v_add_f32 v26, 1.0, v26
v_rcp_f32 v26, v26
s_nop 0
v_mul_f32 v161, v161, v26
v_add_f32 v162, v162, v34
v_mul_f32 v26, v162, v162
v_mul_f32 v26, s28, v26
v_fma_f32 v26, v26, v162, v162
v_mul_f32 v26, s29, v26
v_exp_f32 v26, v26
s_nop 0
v_add_f32 v26, 1.0, v26
v_rcp_f32 v26, v26
s_nop 0
v_mul_f32 v162, v162, v26
v_add_f32 v163, v163, v35
v_mul_f32 v26, v163, v163
v_mul_f32 v26, s28, v26
v_fma_f32 v26, v26, v163, v163
v_mul_f32 v26, s29, v26
v_exp_f32 v26, v26
s_nop 0
v_add_f32 v26, 1.0, v26
v_rcp_f32 v26, v26
s_nop 0
v_mul_f32 v163, v163, v26
v_add_f32 v164, v164, v36
v_mul_f32 v26, v164, v164
v_mul_f32 v26, s28, v26
v_fma_f32 v26, v26, v164, v164
v_mul_f32 v26, s29, v26
v_exp_f32 v26, v26
s_nop 0
v_add_f32 v26, 1.0, v26
v_rcp_f32 v26, v26
s_nop 0
v_mul_f32 v164, v164, v26
v_add_f32 v165, v165, v37
v_mul_f32 v26, v165, v165
v_mul_f32 v26, s28, v26
v_fma_f32 v26, v26, v165, v165
v_mul_f32 v26, s29, v26
v_exp_f32 v26, v26
s_nop 0
v_add_f32 v26, 1.0, v26
v_rcp_f32 v26, v26
s_nop 0
v_mul_f32 v165, v165, v26
v_add_f32 v166, v166, v38
v_mul_f32 v26, v166, v166
v_mul_f32 v26, s28, v26
v_fma_f32 v26, v26, v166, v166
v_mul_f32 v26, s29, v26
v_exp_f32 v26, v26
s_nop 0
v_add_f32 v26, 1.0, v26
v_rcp_f32 v26, v26
s_nop 0
v_mul_f32 v166, v166, v26
v_add_f32 v167, v167, v39
v_mul_f32 v26, v167, v167
v_mul_f32 v26, s28, v26
v_fma_f32 v26, v26, v167, v167
v_mul_f32 v26, s29, v26
v_exp_f32 v26, v26
s_nop 0
v_add_f32 v26, 1.0, v26
v_rcp_f32 v26, v26
s_nop 0
v_mul_f32 v167, v167, v26
v_add_f32 v168, v168, v40
v_mul_f32 v26, v168, v168
v_mul_f32 v26, s28, v26
v_fma_f32 v26, v26, v168, v168
v_mul_f32 v26, s29, v26
v_exp_f32 v26, v26
s_nop 0
v_add_f32 v26, 1.0, v26
v_rcp_f32 v26, v26
s_nop 0
v_mul_f32 v168, v168, v26
v_add_f32 v169, v169, v41
v_mul_f32 v26, v169, v169
v_mul_f32 v26, s28, v26
v_fma_f32 v26, v26, v169, v169
v_mul_f32 v26, s29, v26
v_exp_f32 v26, v26
s_nop 0
v_add_f32 v26, 1.0, v26
v_rcp_f32 v26, v26
s_nop 0
v_mul_f32 v169, v169, v26
v_add_f32 v170, v170, v42
v_mul_f32 v26, v170, v170
v_mul_f32 v26, s28, v26
v_fma_f32 v26, v26, v170, v170
v_mul_f32 v26, s29, v26
v_exp_f32 v26, v26
s_nop 0
v_add_f32 v26, 1.0, v26
v_rcp_f32 v26, v26
s_nop 0
v_mul_f32 v170, v170, v26
v_add_f32 v171, v171, v43
v_mul_f32 v26, v171, v171
v_mul_f32 v26, s28, v26
v_fma_f32 v26, v26, v171, v171
v_mul_f32 v26, s29, v26
v_exp_f32 v26, v26
s_nop 0
v_add_f32 v26, 1.0, v26
v_rcp_f32 v26, v26
s_nop 0
v_mul_f32 v171, v171, v26
v_add_f32 v172, v172, v44
v_mul_f32 v26, v172, v172
v_mul_f32 v26, s28, v26
v_fma_f32 v26, v26, v172, v172
v_mul_f32 v26, s29, v26
v_exp_f32 v26, v26
s_nop 0
v_add_f32 v26, 1.0, v26
v_rcp_f32 v26, v26
s_nop 0
v_mul_f32 v172, v172, v26
v_add_f32 v173, v173, v45
v_mul_f32 v26, v173, v173
v_mul_f32 v26, s28, v26
v_fma_f32 v26, v26, v173, v173
v_mul_f32 v26, s29, v26
v_exp_f32 v26, v26
s_nop 0
v_add_f32 v26, 1.0, v26
v_rcp_f32 v26, v26
s_nop 0
v_mul_f32 v173, v173, v26
v_add_f32 v174, v174, v46
v_mul_f32 v26, v174, v174
v_mul_f32 v26, s28, v26
v_fma_f32 v26, v26, v174, v174
v_mul_f32 v26, s29, v26
v_exp_f32 v26, v26
s_nop 0
v_add_f32 v26, 1.0, v26
v_rcp_f32 v26, v26
s_nop 0
v_mul_f32 v174, v174, v26
v_add_f32 v175, v175, v47
v_mul_f32 v26, v175, v175
v_mul_f32 v26, s28, v26
v_fma_f32 v26, v26, v175, v175
v_mul_f32 v26, s29, v26
v_exp_f32 v26, v26
s_nop 0
v_add_f32 v26, 1.0, v26
v_rcp_f32 v26, v26
s_nop 0
v_mul_f32 v175, v175, v26
v_cvt_pk_bf16_f32 v80, v160, v161
v_cvt_pk_bf16_f32 v81, v162, v163
v_cvt_pk_bf16_f32 v82, v164, v165
v_cvt_pk_bf16_f32 v83, v166, v167
s_nop 0
v_permlane32_swap_b32 v80, v82
v_permlane32_swap_b32 v81, v83
s_add_u32 s24, s41, 1024
buffer_store_dwordx4 v[80:83], v24, s[12:15], s24 offen sc1
v_cvt_pk_bf16_f32 v84, v168, v169
v_cvt_pk_bf16_f32 v85, v170, v171
v_cvt_pk_bf16_f32 v86, v172, v173
v_cvt_pk_bf16_f32 v87, v174, v175
s_nop 0
v_permlane32_swap_b32 v84, v86
v_permlane32_swap_b32 v85, v87
s_add_u32 s24, s41, 19456
buffer_store_dwordx4 v[84:87], v24, s[12:15], s24 offen sc1
v_add_f32 v176, v176, v48
v_mul_f32 v26, v176, v176
v_mul_f32 v26, s28, v26
v_fma_f32 v26, v26, v176, v176
v_mul_f32 v26, s29, v26
v_exp_f32 v26, v26
s_nop 0
v_add_f32 v26, 1.0, v26
v_rcp_f32 v26, v26
s_nop 0
v_mul_f32 v176, v176, v26
v_add_f32 v177, v177, v49
v_mul_f32 v26, v177, v177
v_mul_f32 v26, s28, v26
v_fma_f32 v26, v26, v177, v177
v_mul_f32 v26, s29, v26
v_exp_f32 v26, v26
s_nop 0
v_add_f32 v26, 1.0, v26
v_rcp_f32 v26, v26
s_nop 0
v_mul_f32 v177, v177, v26
v_add_f32 v178, v178, v50
v_mul_f32 v26, v178, v178
v_mul_f32 v26, s28, v26
v_fma_f32 v26, v26, v178, v178
v_mul_f32 v26, s29, v26
v_exp_f32 v26, v26
s_nop 0
v_add_f32 v26, 1.0, v26
v_rcp_f32 v26, v26
s_nop 0
v_mul_f32 v178, v178, v26
v_add_f32 v179, v179, v51
v_mul_f32 v26, v179, v179
v_mul_f32 v26, s28, v26
v_fma_f32 v26, v26, v179, v179
v_mul_f32 v26, s29, v26
v_exp_f32 v26, v26
s_nop 0
v_add_f32 v26, 1.0, v26
v_rcp_f32 v26, v26
s_nop 0
v_mul_f32 v179, v179, v26
v_add_f32 v180, v180, v52
v_mul_f32 v26, v180, v180
v_mul_f32 v26, s28, v26
v_fma_f32 v26, v26, v180, v180
v_mul_f32 v26, s29, v26
v_exp_f32 v26, v26
s_nop 0
v_add_f32 v26, 1.0, v26
v_rcp_f32 v26, v26
s_nop 0
v_mul_f32 v180, v180, v26
v_add_f32 v181, v181, v53
v_mul_f32 v26, v181, v181
v_mul_f32 v26, s28, v26
v_fma_f32 v26, v26, v181, v181
v_mul_f32 v26, s29, v26
v_exp_f32 v26, v26
s_nop 0
v_add_f32 v26, 1.0, v26
v_rcp_f32 v26, v26
s_nop 0
v_mul_f32 v181, v181, v26
v_add_f32 v182, v182, v54
v_mul_f32 v26, v182, v182
v_mul_f32 v26, s28, v26
v_fma_f32 v26, v26, v182, v182
v_mul_f32 v26, s29, v26
v_exp_f32 v26, v26
s_nop 0
v_add_f32 v26, 1.0, v26
v_rcp_f32 v26, v26
s_nop 0
v_mul_f32 v182, v182, v26
v_add_f32 v183, v183, v55
v_mul_f32 v26, v183, v183
v_mul_f32 v26, s28, v26
v_fma_f32 v26, v26, v183, v183
v_mul_f32 v26, s29, v26
v_exp_f32 v26, v26
s_nop 0
v_add_f32 v26, 1.0, v26
v_rcp_f32 v26, v26
s_nop 0
v_mul_f32 v183, v183, v26
v_add_f32 v184, v184, v56
v_mul_f32 v26, v184, v184
v_mul_f32 v26, s28, v26
v_fma_f32 v26, v26, v184, v184
v_mul_f32 v26, s29, v26
v_exp_f32 v26, v26
s_nop 0
v_add_f32 v26, 1.0, v26
v_rcp_f32 v26, v26
s_nop 0
v_mul_f32 v184, v184, v26
v_add_f32 v185, v185, v57
v_mul_f32 v26, v185, v185
v_mul_f32 v26, s28, v26
v_fma_f32 v26, v26, v185, v185
v_mul_f32 v26, s29, v26
v_exp_f32 v26, v26
s_nop 0
v_add_f32 v26, 1.0, v26
v_rcp_f32 v26, v26
s_nop 0
v_mul_f32 v185, v185, v26
v_add_f32 v186, v186, v58
v_mul_f32 v26, v186, v186
v_mul_f32 v26, s28, v26
v_fma_f32 v26, v26, v186, v186
v_mul_f32 v26, s29, v26
v_exp_f32 v26, v26
s_nop 0
v_add_f32 v26, 1.0, v26
v_rcp_f32 v26, v26
s_nop 0
v_mul_f32 v186, v186, v26
v_add_f32 v187, v187, v59
v_mul_f32 v26, v187, v187
v_mul_f32 v26, s28, v26
v_fma_f32 v26, v26, v187, v187
v_mul_f32 v26, s29, v26
v_exp_f32 v26, v26
s_nop 0
v_add_f32 v26, 1.0, v26
v_rcp_f32 v26, v26
s_nop 0
v_mul_f32 v187, v187, v26
v_add_f32 v188, v188, v60
v_mul_f32 v26, v188, v188
v_mul_f32 v26, s28, v26
v_fma_f32 v26, v26, v188, v188
v_mul_f32 v26, s29, v26
v_exp_f32 v26, v26
s_nop 0
v_add_f32 v26, 1.0, v26
v_rcp_f32 v26, v26
s_nop 0
v_mul_f32 v188, v188, v26
v_add_f32 v189, v189, v61
v_mul_f32 v26, v189, v189
v_mul_f32 v26, s28, v26
v_fma_f32 v26, v26, v189, v189
v_mul_f32 v26, s29, v26
v_exp_f32 v26, v26
s_nop 0
v_add_f32 v26, 1.0, v26
v_rcp_f32 v26, v26
s_nop 0
v_mul_f32 v189, v189, v26
v_add_f32 v190, v190, v62
v_mul_f32 v26, v190, v190
v_mul_f32 v26, s28, v26
v_fma_f32 v26, v26, v190, v190
v_mul_f32 v26, s29, v26
v_exp_f32 v26, v26
s_nop 0
v_add_f32 v26, 1.0, v26
v_rcp_f32 v26, v26
s_nop 0
v_mul_f32 v190, v190, v26
v_add_f32 v191, v191, v63
v_mul_f32 v26, v191, v191
v_mul_f32 v26, s28, v26
v_fma_f32 v26, v26, v191, v191
v_mul_f32 v26, s29, v26
v_exp_f32 v26, v26
s_nop 0
v_add_f32 v26, 1.0, v26
v_rcp_f32 v26, v26
s_nop 0
v_mul_f32 v191, v191, v26
v_cvt_pk_bf16_f32 v88, v176, v177
v_cvt_pk_bf16_f32 v89, v178, v179
v_cvt_pk_bf16_f32 v90, v180, v181
v_cvt_pk_bf16_f32 v91, v182, v183
s_nop 0
v_permlane32_swap_b32 v88, v90
v_permlane32_swap_b32 v89, v91
s_add_u32 s24, s41, 36864
buffer_store_dwordx4 v[88:91], v24, s[12:15], s24 offen sc1
v_cvt_pk_bf16_f32 v92, v184, v185
v_cvt_pk_bf16_f32 v93, v186, v187
v_cvt_pk_bf16_f32 v94, v188, v189
v_cvt_pk_bf16_f32 v95, v190, v191
s_nop 0
v_permlane32_swap_b32 v92, v94
v_permlane32_swap_b32 v93, v95
s_add_u32 s24, s41, 55296
buffer_store_dwordx4 v[92:95], v24, s[12:15], s24 offen sc1
v_add_f32 v192, v192, v48
v_mul_f32 v26, v192, v192
v_mul_f32 v26, s28, v26
v_fma_f32 v26, v26, v192, v192
v_mul_f32 v26, s29, v26
v_exp_f32 v26, v26
s_nop 0
v_add_f32 v26, 1.0, v26
v_rcp_f32 v26, v26
s_nop 0
v_mul_f32 v192, v192, v26
v_add_f32 v193, v193, v49
v_mul_f32 v26, v193, v193
v_mul_f32 v26, s28, v26
v_fma_f32 v26, v26, v193, v193
v_mul_f32 v26, s29, v26
v_exp_f32 v26, v26
s_nop 0
v_add_f32 v26, 1.0, v26
v_rcp_f32 v26, v26
s_nop 0
v_mul_f32 v193, v193, v26
v_add_f32 v194, v194, v50
v_mul_f32 v26, v194, v194
v_mul_f32 v26, s28, v26
v_fma_f32 v26, v26, v194, v194
v_mul_f32 v26, s29, v26
v_exp_f32 v26, v26
s_nop 0
v_add_f32 v26, 1.0, v26
v_rcp_f32 v26, v26
s_nop 0
v_mul_f32 v194, v194, v26
v_add_f32 v195, v195, v51
v_mul_f32 v26, v195, v195
v_mul_f32 v26, s28, v26
v_fma_f32 v26, v26, v195, v195
v_mul_f32 v26, s29, v26
v_exp_f32 v26, v26
s_nop 0
v_add_f32 v26, 1.0, v26
v_rcp_f32 v26, v26
s_nop 0
v_mul_f32 v195, v195, v26
v_add_f32 v196, v196, v52
v_mul_f32 v26, v196, v196
v_mul_f32 v26, s28, v26
v_fma_f32 v26, v26, v196, v196
v_mul_f32 v26, s29, v26
v_exp_f32 v26, v26
s_nop 0
v_add_f32 v26, 1.0, v26
v_rcp_f32 v26, v26
s_nop 0
v_mul_f32 v196, v196, v26
v_add_f32 v197, v197, v53
v_mul_f32 v26, v197, v197
v_mul_f32 v26, s28, v26
v_fma_f32 v26, v26, v197, v197
v_mul_f32 v26, s29, v26
v_exp_f32 v26, v26
s_nop 0
v_add_f32 v26, 1.0, v26
v_rcp_f32 v26, v26
s_nop 0
v_mul_f32 v197, v197, v26
v_add_f32 v198, v198, v54
v_mul_f32 v26, v198, v198
v_mul_f32 v26, s28, v26
v_fma_f32 v26, v26, v198, v198
v_mul_f32 v26, s29, v26
v_exp_f32 v26, v26
s_nop 0
v_add_f32 v26, 1.0, v26
v_rcp_f32 v26, v26
s_nop 0
v_mul_f32 v198, v198, v26
v_add_f32 v199, v199, v55
v_mul_f32 v26, v199, v199
v_mul_f32 v26, s28, v26
v_fma_f32 v26, v26, v199, v199
v_mul_f32 v26, s29, v26
v_exp_f32 v26, v26
s_nop 0
v_add_f32 v26, 1.0, v26
v_rcp_f32 v26, v26
s_nop 0
v_mul_f32 v199, v199, v26
v_add_f32 v200, v200, v56
v_mul_f32 v26, v200, v200
v_mul_f32 v26, s28, v26
v_fma_f32 v26, v26, v200, v200
v_mul_f32 v26, s29, v26
v_exp_f32 v26, v26
s_nop 0
v_add_f32 v26, 1.0, v26
v_rcp_f32 v26, v26
s_nop 0
v_mul_f32 v200, v200, v26
v_add_f32 v201, v201, v57
v_mul_f32 v26, v201, v201
v_mul_f32 v26, s28, v26
v_fma_f32 v26, v26, v201, v201
v_mul_f32 v26, s29, v26
v_exp_f32 v26, v26
s_nop 0
v_add_f32 v26, 1.0, v26
v_rcp_f32 v26, v26
s_nop 0
v_mul_f32 v201, v201, v26
v_add_f32 v202, v202, v58
v_mul_f32 v26, v202, v202
v_mul_f32 v26, s28, v26
v_fma_f32 v26, v26, v202, v202
v_mul_f32 v26, s29, v26
v_exp_f32 v26, v26
s_nop 0
v_add_f32 v26, 1.0, v26
v_rcp_f32 v26, v26
s_nop 0
v_mul_f32 v202, v202, v26
v_add_f32 v203, v203, v59
v_mul_f32 v26, v203, v203
v_mul_f32 v26, s28, v26
v_fma_f32 v26, v26, v203, v203
v_mul_f32 v26, s29, v26
v_exp_f32 v26, v26
s_nop 0
v_add_f32 v26, 1.0, v26
v_rcp_f32 v26, v26
s_nop 0
v_mul_f32 v203, v203, v26
v_add_f32 v204, v204, v60
v_mul_f32 v26, v204, v204
v_mul_f32 v26, s28, v26
v_fma_f32 v26, v26, v204, v204
v_mul_f32 v26, s29, v26
v_exp_f32 v26, v26
s_nop 0
v_add_f32 v26, 1.0, v26
v_rcp_f32 v26, v26
s_nop 0
v_mul_f32 v204, v204, v26
v_add_f32 v205, v205, v61
v_mul_f32 v26, v205, v205
v_mul_f32 v26, s28, v26
v_fma_f32 v26, v26, v205, v205
v_mul_f32 v26, s29, v26
v_exp_f32 v26, v26
s_nop 0
v_add_f32 v26, 1.0, v26
v_rcp_f32 v26, v26
s_nop 0
v_mul_f32 v205, v205, v26
v_add_f32 v206, v206, v62
v_mul_f32 v26, v206, v206
v_mul_f32 v26, s28, v26
v_fma_f32 v26, v26, v206, v206
v_mul_f32 v26, s29, v26
v_exp_f32 v26, v26
s_nop 0
v_add_f32 v26, 1.0, v26
v_rcp_f32 v26, v26
s_nop 0
v_mul_f32 v206, v206, v26
v_add_f32 v207, v207, v63
v_mul_f32 v26, v207, v207
v_mul_f32 v26, s28, v26
v_fma_f32 v26, v26, v207, v207
v_mul_f32 v26, s29, v26
v_exp_f32 v26, v26
s_nop 0
v_add_f32 v26, 1.0, v26
v_rcp_f32 v26, v26
s_nop 0
v_mul_f32 v207, v207, v26
v_cvt_pk_bf16_f32 v64, v192, v193
v_cvt_pk_bf16_f32 v65, v194, v195
v_cvt_pk_bf16_f32 v66, v196, v197
v_cvt_pk_bf16_f32 v67, v198, v199
s_nop 0
v_permlane32_swap_b32 v64, v66
v_permlane32_swap_b32 v65, v67
s_add_u32 s24, s41, 37376
buffer_store_dwordx4 v[64:67], v24, s[12:15], s24 offen sc1
v_cvt_pk_bf16_f32 v68, v200, v201
v_cvt_pk_bf16_f32 v69, v202, v203
v_cvt_pk_bf16_f32 v70, v204, v205
v_cvt_pk_bf16_f32 v71, v206, v207
s_nop 0
v_permlane32_swap_b32 v68, v70
v_permlane32_swap_b32 v69, v71
s_add_u32 s24, s41, 55808
buffer_store_dwordx4 v[68:71], v24, s[12:15], s24 offen sc1
v_add_f32 v208, v208, v48
v_mul_f32 v26, v208, v208
v_mul_f32 v26, s28, v26
v_fma_f32 v26, v26, v208, v208
v_mul_f32 v26, s29, v26
v_exp_f32 v26, v26
s_nop 0
v_add_f32 v26, 1.0, v26
v_rcp_f32 v26, v26
s_nop 0
v_mul_f32 v208, v208, v26
v_add_f32 v209, v209, v49
v_mul_f32 v26, v209, v209
v_mul_f32 v26, s28, v26
v_fma_f32 v26, v26, v209, v209
v_mul_f32 v26, s29, v26
v_exp_f32 v26, v26
s_nop 0
v_add_f32 v26, 1.0, v26
v_rcp_f32 v26, v26
s_nop 0
v_mul_f32 v209, v209, v26
v_add_f32 v210, v210, v50
v_mul_f32 v26, v210, v210
v_mul_f32 v26, s28, v26
v_fma_f32 v26, v26, v210, v210
v_mul_f32 v26, s29, v26
v_exp_f32 v26, v26
s_nop 0
v_add_f32 v26, 1.0, v26
v_rcp_f32 v26, v26
s_nop 0
v_mul_f32 v210, v210, v26
v_add_f32 v211, v211, v51
v_mul_f32 v26, v211, v211
v_mul_f32 v26, s28, v26
v_fma_f32 v26, v26, v211, v211
v_mul_f32 v26, s29, v26
v_exp_f32 v26, v26
s_nop 0
v_add_f32 v26, 1.0, v26
v_rcp_f32 v26, v26
s_nop 0
v_mul_f32 v211, v211, v26
v_add_f32 v212, v212, v52
v_mul_f32 v26, v212, v212
v_mul_f32 v26, s28, v26
v_fma_f32 v26, v26, v212, v212
v_mul_f32 v26, s29, v26
v_exp_f32 v26, v26
s_nop 0
v_add_f32 v26, 1.0, v26
v_rcp_f32 v26, v26
s_nop 0
v_mul_f32 v212, v212, v26
v_add_f32 v213, v213, v53
v_mul_f32 v26, v213, v213
v_mul_f32 v26, s28, v26
v_fma_f32 v26, v26, v213, v213
v_mul_f32 v26, s29, v26
v_exp_f32 v26, v26
s_nop 0
v_add_f32 v26, 1.0, v26
v_rcp_f32 v26, v26
s_nop 0
v_mul_f32 v213, v213, v26
v_add_f32 v214, v214, v54
v_mul_f32 v26, v214, v214
v_mul_f32 v26, s28, v26
v_fma_f32 v26, v26, v214, v214
v_mul_f32 v26, s29, v26
v_exp_f32 v26, v26
s_nop 0
v_add_f32 v26, 1.0, v26
v_rcp_f32 v26, v26
s_nop 0
v_mul_f32 v214, v214, v26
v_add_f32 v215, v215, v55
v_mul_f32 v26, v215, v215
v_mul_f32 v26, s28, v26
v_fma_f32 v26, v26, v215, v215
v_mul_f32 v26, s29, v26
v_exp_f32 v26, v26
s_nop 0
v_add_f32 v26, 1.0, v26
v_rcp_f32 v26, v26
s_nop 0
v_mul_f32 v215, v215, v26
v_add_f32 v216, v216, v56
v_mul_f32 v26, v216, v216
v_mul_f32 v26, s28, v26
v_fma_f32 v26, v26, v216, v216
v_mul_f32 v26, s29, v26
v_exp_f32 v26, v26
s_nop 0
v_add_f32 v26, 1.0, v26
v_rcp_f32 v26, v26
s_nop 0
v_mul_f32 v216, v216, v26
v_add_f32 v217, v217, v57
v_mul_f32 v26, v217, v217
v_mul_f32 v26, s28, v26
v_fma_f32 v26, v26, v217, v217
v_mul_f32 v26, s29, v26
v_exp_f32 v26, v26
s_nop 0
v_add_f32 v26, 1.0, v26
v_rcp_f32 v26, v26
s_nop 0
v_mul_f32 v217, v217, v26
v_add_f32 v218, v218, v58
v_mul_f32 v26, v218, v218
v_mul_f32 v26, s28, v26
v_fma_f32 v26, v26, v218, v218
v_mul_f32 v26, s29, v26
v_exp_f32 v26, v26
s_nop 0
v_add_f32 v26, 1.0, v26
v_rcp_f32 v26, v26
s_nop 0
v_mul_f32 v218, v218, v26
v_add_f32 v219, v219, v59
v_mul_f32 v26, v219, v219
v_mul_f32 v26, s28, v26
v_fma_f32 v26, v26, v219, v219
v_mul_f32 v26, s29, v26
v_exp_f32 v26, v26
s_nop 0
v_add_f32 v26, 1.0, v26
v_rcp_f32 v26, v26
s_nop 0
v_mul_f32 v219, v219, v26
v_add_f32 v220, v220, v60
v_mul_f32 v26, v220, v220
v_mul_f32 v26, s28, v26
v_fma_f32 v26, v26, v220, v220
v_mul_f32 v26, s29, v26
v_exp_f32 v26, v26
s_nop 0
v_add_f32 v26, 1.0, v26
v_rcp_f32 v26, v26
s_nop 0
v_mul_f32 v220, v220, v26
v_add_f32 v221, v221, v61
v_mul_f32 v26, v221, v221
v_mul_f32 v26, s28, v26
v_fma_f32 v26, v26, v221, v221
v_mul_f32 v26, s29, v26
v_exp_f32 v26, v26
s_nop 0
v_add_f32 v26, 1.0, v26
v_rcp_f32 v26, v26
s_nop 0
v_mul_f32 v221, v221, v26
v_add_f32 v222, v222, v62
v_mul_f32 v26, v222, v222
v_mul_f32 v26, s28, v26
v_fma_f32 v26, v26, v222, v222
v_mul_f32 v26, s29, v26
v_exp_f32 v26, v26
s_nop 0
v_add_f32 v26, 1.0, v26
v_rcp_f32 v26, v26
s_nop 0
v_mul_f32 v222, v222, v26
v_add_f32 v223, v223, v63
v_mul_f32 v26, v223, v223
v_mul_f32 v26, s28, v26
v_fma_f32 v26, v26, v223, v223
v_mul_f32 v26, s29, v26
v_exp_f32 v26, v26
s_nop 0
v_add_f32 v26, 1.0, v26
v_rcp_f32 v26, v26
s_nop 0
v_mul_f32 v223, v223, v26
v_cvt_pk_bf16_f32 v72, v208, v209
v_cvt_pk_bf16_f32 v73, v210, v211
v_cvt_pk_bf16_f32 v74, v212, v213
v_cvt_pk_bf16_f32 v75, v214, v215
s_nop 0
v_permlane32_swap_b32 v72, v74
v_permlane32_swap_b32 v73, v75
s_add_u32 s24, s41, 37888
buffer_store_dwordx4 v[72:75], v24, s[12:15], s24 offen sc1
v_cvt_pk_bf16_f32 v76, v216, v217
v_cvt_pk_bf16_f32 v77, v218, v219
v_cvt_pk_bf16_f32 v78, v220, v221
v_cvt_pk_bf16_f32 v79, v222, v223
s_nop 0
v_permlane32_swap_b32 v76, v78
v_permlane32_swap_b32 v77, v79
s_add_u32 s24, s41, 56320
buffer_store_dwordx4 v[76:79], v24, s[12:15], s24 offen sc1
s_waitcnt vmcnt(0)
s_mul_i32 s24, s44, 7282
s_lshr_b32 s24, s24, 16
s_lshl_b32 s25, s43, 2
s_add_u32 s24, s24, s25
s_lshl_b32 s24, s24, 7
s_add_u32 s24, s24, 77600768
s_barrier
s_cmp_lg_u32 s11, 0
s_cbranch_scc1 L_sg_102
s_mov_b32 s60, s24
v_mov_b32 v1, 1
s_mov_b64 exec, 1
buffer_atomic_add v1, off, s[12:15], s60
s_mov_b64 exec, -1
L_sg_102:
s_branch L_next
L_t_g3:
s_sub_u32 s24, s42, 1004
s_and_b32 s45, s24, 3
s_bfe_u32 s44, s24, 0x40002
s_lshr_b32 s43, s24, 6
s_add_u32 s16, s12, 83886080
s_addc_u32 s17, s13, 0
s_mov_b32 s18, 5308416
s_load_dwordx2 s[20:21], s[0:1], 80
s_mov_b32 s22, 18874368
s_waitcnt lgkmcnt(0)
v_lshrrev_b32 v24, 3, v0
v_lshlrev_b32 v24, 4, v24
v_and_b32 v25, 7, v0
v_lshrrev_b32 v26, 4, v0
v_xor_b32 v27, v25, v26
v_mul_u32_u24 v28, 9216, v27
v_add_u32 v2, v28, v24
v_xor_b32 v27, 4, v27
v_mul_u32_u24 v28, 9216, v27
v_add_u32 v3, v28, v24
v_lshrrev_b32 v24, 4, v0
v_lshlrev_b32 v25, 2, v24
v_lshlrev_b32 v24, 12, v24
v_and_b32 v26, 15, v0
v_xor_b32 v26, v26, v25
v_lshl_add_u32 v5, v26, 4, v24
s_mul_i32 s36, s45, 1327104
s_mul_i32 s24, s43, 3072
s_add_u32 s36, s36, s24
s_mul_i32 s24, s11, 768
s_add_u32 s36, s36, s24
s_mul_i32 s37, s45, 4718592
s_lshl_b32 s24, s11, 16
s_add_u32 s37, s37, s24
s_lshl_b32 s24, s44, 8
s_add_u32 s37, s37, s24
s_and_b32 s24, s11, 1
s_mul_i32 s24, s24, 96
v_and_b32 v24, 31, v0
v_add_u32 v24, s24, v24
v_lshrrev_b32 v25, 5, v0
v_bfe_u32 v26, v24, 1, 3
v_lshlrev_b32 v24, 7, v24
v_add_u32 v27, 0, v25
v_xor_b32 v27, v27, v26
v_lshl_add_u32 v8, v27, 4, v24
v_add_u32 v27, 2, v25
v_xor_b32 v27, v27, v26
v_lshl_add_u32 v9, v27, 4, v24
v_add_u32 v27, 4, v25
v_xor_b32 v27, v27, v26
v_lshl_add_u32 v10, v27, 4, v24
v_add_u32 v27, 6, v25
v_xor_b32 v27, v27, v26
v_lshl_add_u32 v11, v27, 4, v24
s_lshr_b32 s24, s11, 1
s_lshl_b32 s24, s24, 3
v_bfe_u32 v24, v0, 4, 1
v_bfe_u32 v25, v0, 5, 1
v_bfe_u32 v26, v0, 2, 2
v_and_b32 v27, 3, v0
v_lshl_add_u32 v28, v25, 3, v26
v_mul_u32_u24 v28, 256, v28
v_and_b32 v29, 1, v27
v_lshl_add_u32 v28, v29, 3, v28
v_lshrrev_b32 v29, 1, v27
v_lshl_add_u32 v29, v24, 1, v29
v_add_u32 v29, s24, v29
v_lshlrev_b32 v30, 2, v26
v_add_u32 v31, 0, v29
v_xor_b32 v31, v31, v30
v_lshl_add_u32 v12, v31, 4, v28
v_add_u32 v31, 4, v29
v_xor_b32 v31, v31, v30
v_lshl_add_u32 v13, v31, 4, v28
s_barrier
s_mov_b32 s39, 0
s_mov_b32 s38, 0
s_lshl_b32 s26, s11, 12
s_add_u32 s26, s26, s39
s_add_u32 m0, s26, 24576
s_add_u32 s27, s37, 0
buffer_load_dwordx4 v5, s[20:23], s27 offen lds
s_lshl_b32 s26, s11, 12
s_add_u32 s26, s26, s39
s_add_u32 m0, s26, 25600
s_add_u32 s27, s37, 16384
buffer_load_dwordx4 v5, s[20:23], s27 offen lds
s_lshl_b32 s26, s11, 12
s_add_u32 s26, s26, s39
s_add_u32 m0, s26, 26624
s_add_u32 s27, s37, 32768
buffer_load_dwordx4 v5, s[20:23], s27 offen lds
s_lshl_b32 s26, s11, 12
s_add_u32 s26, s26, s39
s_add_u32 m0, s26, 27648
s_add_u32 s27, s37, 49152
buffer_load_dwordx4 v5, s[20:23], s27 offen lds
s_add_u32 s37, s37, 262144
s_lshl_b32 s76, s43, 2
s_add_u32 s76, s76, s45
s_lshl_b32 s76, s76, 7
s_add_u32 s76, s76, 77600768
s_cmp_lg_u32 s11, 0
s_cbranch_scc1 L_wd_103
s_mov_b32 s60, s76
s_mov_b32 s61, 0
L_wp_104:
buffer_load_dword v1, off, s[12:15], s60 sc1
s_waitcnt vmcnt(0)
v_readfirstlane_b32 s62, v1
s_nop 0
s_cmp_ge_u32 s62, 9
s_cbranch_scc1 L_wd_103
s_add_u32 s61, s61, 1
s_cmp_gt_u32 s61, 4000000
s_cbranch_scc1 L_abortw
s_sleep 1
s_branch L_wp_104
L_wd_103:
s_barrier
s_mul_i32 s26, s11, 6144
s_add_u32 s26, s26, s39
s_add_u32 m0, s26, 0
s_add_u32 s27, s36, 0
buffer_load_dwordx4 v2, s[16:19], s27 offen sc1 lds
s_mul_i32 s26, s11, 6144
s_add_u32 s26, s26, s39
s_add_u32 m0, s26, 1024
s_add_u32 s27, s36, 128
buffer_load_dwordx4 v3, s[16:19], s27 offen sc1 lds
s_mul_i32 s26, s11, 6144
s_add_u32 s26, s26, s39
s_add_u32 m0, s26, 2048
s_add_u32 s27, s36, 256
buffer_load_dwordx4 v2, s[16:19], s27 offen sc1 lds
s_mul_i32 s26, s11, 6144
s_add_u32 s26, s26, s39
s_add_u32 m0, s26, 3072
s_add_u32 s27, s36, 384
buffer_load_dwordx4 v3, s[16:19], s27 offen sc1 lds
s_mul_i32 s26, s11, 6144
s_add_u32 s26, s26, s39
s_add_u32 m0, s26, 4096
s_add_u32 s27, s36, 512
buffer_load_dwordx4 v2, s[16:19], s27 offen sc1 lds
s_mul_i32 s26, s11, 6144
s_add_u32 s26, s26, s39
s_add_u32 m0, s26, 5120
s_add_u32 s27, s36, 640
buffer_load_dwordx4 v3, s[16:19], s27 offen sc1 lds
s_add_u32 s36, s36, 73728
s_add_u32 s39, s39, 40960
s_cmp_eq_u32 s39, 122880
s_cselect_b32 s39, 0, s39
s_mul_i32 s26, s11, 6144
s_add_u32 s26, s26, s39
s_add_u32 m0, s26, 0
s_add_u32 s27, s36, 0
buffer_load_dwordx4 v2, s[16:19], s27 offen sc1 lds
s_mul_i32 s26, s11, 6144
s_add_u32 s26, s26, s39
s_add_u32 m0, s26, 1024
s_add_u32 s27, s36, 128
buffer_load_dwordx4 v3, s[16:19], s27 offen sc1 lds
s_mul_i32 s26, s11, 6144
s_add_u32 s26, s26, s39
s_add_u32 m0, s26, 2048
s_add_u32 s27, s36, 256
buffer_load_dwordx4 v2, s[16:19], s27 offen sc1 lds
s_mul_i32 s26, s11, 6144
s_add_u32 s26, s26, s39
s_add_u32 m0, s26, 3072
s_add_u32 s27, s36, 384
buffer_load_dwordx4 v3, s[16:19], s27 offen sc1 lds
s_mul_i32 s26, s11, 6144
s_add_u32 s26, s26, s39
s_add_u32 m0, s26, 4096
s_add_u32 s27, s36, 512
buffer_load_dwordx4 v2, s[16:19], s27 offen sc1 lds
s_mul_i32 s26, s11, 6144
s_add_u32 s26, s26, s39
s_add_u32 m0, s26, 5120
s_add_u32 s27, s36, 640
buffer_load_dwordx4 v3, s[16:19], s27 offen sc1 lds
s_add_u32 s36, s36, 73728
s_lshl_b32 s26, s11, 12
s_add_u32 s26, s26, s39
s_add_u32 m0, s26, 24576
s_add_u32 s27, s37, 0
buffer_load_dwordx4 v5, s[20:23], s27 offen lds
s_lshl_b32 s26, s11, 12
s_add_u32 s26, s26, s39
s_add_u32 m0, s26, 25600
s_add_u32 s27, s37, 16384
buffer_load_dwordx4 v5, s[20:23], s27 offen lds
s_lshl_b32 s26, s11, 12
s_add_u32 s26, s26, s39
s_add_u32 m0, s26, 26624
s_add_u32 s27, s37, 32768
buffer_load_dwordx4 v5, s[20:23], s27 offen lds
s_lshl_b32 s26, s11, 12
s_add_u32 s26, s26, s39
s_add_u32 m0, s26, 27648
s_add_u32 s27, s37, 49152
buffer_load_dwordx4 v5, s[20:23], s27 offen lds
s_add_u32 s37, s37, 262144
s_add_u32 s39, s39, 40960
s_cmp_eq_u32 s39, 122880
s_cselect_b32 s39, 0, s39
s_mul_i32 s26, s11, 6144
s_add_u32 s26, s26, s39
s_add_u32 m0, s26, 0
s_add_u32 s27, s36, 0
buffer_load_dwordx4 v2, s[16:19], s27 offen sc1 lds
s_mul_i32 s26, s11, 6144
s_add_u32 s26, s26, s39
s_add_u32 m0, s26, 1024
s_add_u32 s27, s36, 128
buffer_load_dwordx4 v3, s[16:19], s27 offen sc1 lds
s_mul_i32 s26, s11, 6144
s_add_u32 s26, s26, s39
s_add_u32 m0, s26, 2048
s_add_u32 s27, s36, 256
buffer_load_dwordx4 v2, s[16:19], s27 offen sc1 lds
s_mul_i32 s26, s11, 6144
s_add_u32 s26, s26, s39
s_add_u32 m0, s26, 3072
s_add_u32 s27, s36, 384
buffer_load_dwordx4 v3, s[16:19], s27 offen sc1 lds
s_mul_i32 s26, s11, 6144
s_add_u32 s26, s26, s39
s_add_u32 m0, s26, 4096
s_add_u32 s27, s36, 512
buffer_load_dwordx4 v2, s[16:19], s27 offen sc1 lds
s_mul_i32 s26, s11, 6144
s_add_u32 s26, s26, s39
s_add_u32 m0, s26, 5120
s_add_u32 s27, s36, 640
buffer_load_dwordx4 v3, s[16:19], s27 offen sc1 lds
s_add_u32 s36, s36, 73728
s_lshl_b32 s26, s11, 12
s_add_u32 s26, s26, s39
s_add_u32 m0, s26, 24576
s_add_u32 s27, s37, 0
buffer_load_dwordx4 v5, s[20:23], s27 offen lds
s_lshl_b32 s26, s11, 12
s_add_u32 s26, s26, s39
s_add_u32 m0, s26, 25600
s_add_u32 s27, s37, 16384
buffer_load_dwordx4 v5, s[20:23], s27 offen lds
s_lshl_b32 s26, s11, 12
s_add_u32 s26, s26, s39
s_add_u32 m0, s26, 26624
s_add_u32 s27, s37, 32768
buffer_load_dwordx4 v5, s[20:23], s27 offen lds
s_lshl_b32 s26, s11, 12
s_add_u32 s26, s26, s39
s_add_u32 m0, s26, 27648
s_add_u32 s27, s37, 49152
buffer_load_dwordx4 v5, s[20:23], s27 offen lds
s_add_u32 s37, s37, 262144
s_add_u32 s39, s39, 40960
s_cmp_eq_u32 s39, 122880
s_cselect_b32 s39, 0, s39
s_waitcnt vmcnt(20)
s_barrier
v_add_u32 v16, s38, v8
v_add_u32 v17, s38, v9
v_add_u32 v18, s38, v10
v_add_u32 v19, s38, v11
s_add_u32 s25, s38, 24576
v_add_u32 v20, s25, v12
v_add_u32 v21, s25, v13
ds_read_b128 v[32:35], v16 offset:0
ds_read_b128 v[36:39], v16 offset:4096
ds_read_b128 v[40:43], v16 offset:8192
ds_read_b64_tr_b16 v[64:65], v20 offset:0
ds_read_b64_tr_b16 v[66:67], v20 offset:1024
ds_read_b64_tr_b16 v[68:69], v21 offset:0
ds_read_b64_tr_b16 v[70:71], v21 offset:1024
s_waitcnt lgkmcnt(0)
ds_read_b128 v[44:47], v17 offset:0
ds_read_b128 v[48:51], v17 offset:4096
ds_read_b128 v[52:55], v17 offset:8192
ds_read_b64_tr_b16 v[72:73], v20 offset:4096
ds_read_b64_tr_b16 v[74:75], v20 offset:5120
ds_read_b64_tr_b16 v[76:77], v21 offset:4096
ds_read_b64_tr_b16 v[78:79], v21 offset:5120
v_mfma_f32_32x32x16_bf16 v[128:143], v[32:35], v[64:67], 0
v_mfma_f32_32x32x16_bf16 v[144:159], v[36:39], v[64:67], 0
v_mfma_f32_32x32x16_bf16 v[160:175], v[40:43], v[64:67], 0
v_mfma_f32_32x32x16_bf16 v[176:191], v[32:35], v[68:71], 0
v_mfma_f32_32x32x16_bf16 v[192:207], v[36:39], v[68:71], 0
v_mfma_f32_32x32x16_bf16 v[208:223], v[40:43], v[68:71], 0
s_waitcnt lgkmcnt(0)
ds_read_b128 v[32:35], v18 offset:0
ds_read_b128 v[36:39], v18 offset:4096
ds_read_b128 v[40:43], v18 offset:8192
ds_read_b64_tr_b16 v[64:65], v20 offset:8192
ds_read_b64_tr_b16 v[66:67], v20 offset:9216
ds_read_b64_tr_b16 v[68:69], v21 offset:8192
ds_read_b64_tr_b16 v[70:71], v21 offset:9216
v_mfma_f32_32x32x16_bf16 v[128:143], v[44:47], v[72:75], v[128:143]
v_mfma_f32_32x32x16_bf16 v[144:159], v[48:51], v[72:75], v[144:159]
v_mfma_f32_32x32x16_bf16 v[160:175], v[52:55], v[72:75], v[160:175]
v_mfma_f32_32x32x16_bf16 v[176:191], v[44:47], v[76:79], v[176:191]
v_mfma_f32_32x32x16_bf16 v[192:207], v[48:51], v[76:79], v[192:207]
v_mfma_f32_32x32x16_bf16 v[208:223], v[52:55], v[76:79], v[208:223]
s_waitcnt lgkmcnt(0)
ds_read_b128 v[44:47], v19 offset:0
ds_read_b128 v[48:51], v19 offset:4096
ds_read_b128 v[52:55], v19 offset:8192
ds_read_b64_tr_b16 v[72:73], v20 offset:12288
ds_read_b64_tr_b16 v[74:75], v20 offset:13312
ds_read_b64_tr_b16 v[76:77], v21 offset:12288
ds_read_b64_tr_b16 v[78:79], v21 offset:13312
v_mfma_f32_32x32x16_bf16 v[128:143], v[32:35], v[64:67], v[128:143]
v_mfma_f32_32x32x16_bf16 v[144:159], v[36:39], v[64:67], v[144:159]
v_mfma_f32_32x32x16_bf16 v[160:175], v[40:43], v[64:67], v[160:175]
v_mfma_f32_32x32x16_bf16 v[176:191], v[32:35], v[68:71], v[176:191]
v_mfma_f32_32x32x16_bf16 v[192:207], v[36:39], v[68:71], v[192:207]
v_mfma_f32_32x32x16_bf16 v[208:223], v[40:43], v[68:71], v[208:223]
s_waitcnt lgkmcnt(0)
s_waitcnt vmcnt(10)
s_barrier
s_add_u32 s38, s38, 40960
s_cmp_eq_u32 s38, 122880
s_cselect_b32 s38, 0, s38
v_add_u32 v16, s38, v8
v_add_u32 v17, s38, v9
v_add_u32 v18, s38, v10
v_add_u32 v19, s38, v11
s_add_u32 s25, s38, 24576
v_add_u32 v20, s25, v12
v_add_u32 v21, s25, v13
ds_read_b128 v[32:35], v16 offset:0
ds_read_b128 v[36:39], v16 offset:4096
ds_read_b128 v[40:43], v16 offset:8192
ds_read_b64_tr_b16 v[64:65], v20 offset:0
ds_read_b64_tr_b16 v[66:67], v20 offset:1024
ds_read_b64_tr_b16 v[68:69], v21 offset:0
ds_read_b64_tr_b16 v[70:71], v21 offset:1024
v_mfma_f32_32x32x16_bf16 v[128:143], v[44:47], v[72:75], v[128:143]
v_mfma_f32_32x32x16_bf16 v[144:159], v[48:51], v[72:75], v[144:159]
v_mfma_f32_32x32x16_bf16 v[160:175], v[52:55], v[72:75], v[160:175]
v_mfma_f32_32x32x16_bf16 v[176:191], v[44:47], v[76:79], v[176:191]
v_mfma_f32_32x32x16_bf16 v[192:207], v[48:51], v[76:79], v[192:207]
v_mfma_f32_32x32x16_bf16 v[208:223], v[52:55], v[76:79], v[208:223]
s_mov_b32 s40, 1
L_gl_105:
s_waitcnt lgkmcnt(0)
ds_read_b128 v[44:47], v17 offset:0
ds_read_b128 v[48:51], v17 offset:4096
ds_read_b128 v[52:55], v17 offset:8192
ds_read_b64_tr_b16 v[72:73], v20 offset:4096
ds_read_b64_tr_b16 v[74:75], v20 offset:5120
ds_read_b64_tr_b16 v[76:77], v21 offset:4096
ds_read_b64_tr_b16 v[78:79], v21 offset:5120
v_mfma_f32_32x32x16_bf16 v[128:143], v[32:35], v[64:67], v[128:143]
s_mul_i32 s26, s11, 6144
s_add_u32 s26, s26, s39
s_add_u32 m0, s26, 0
s_add_u32 s27, s36, 0
buffer_load_dwordx4 v2, s[16:19], s27 offen sc1 lds
v_mfma_f32_32x32x16_bf16 v[144:159], v[36:39], v[64:67], v[144:159]
s_mul_i32 s26, s11, 6144
s_add_u32 s26, s26, s39
s_add_u32 m0, s26, 1024
s_add_u32 s27, s36, 128
buffer_load_dwordx4 v3, s[16:19], s27 offen sc1 lds
v_mfma_f32_32x32x16_bf16 v[160:175], v[40:43], v[64:67], v[160:175]
s_mul_i32 s26, s11, 6144
s_add_u32 s26, s26, s39
s_add_u32 m0, s26, 2048
s_add_u32 s27, s36, 256
buffer_load_dwordx4 v2, s[16:19], s27 offen sc1 lds
v_mfma_f32_32x32x16_bf16 v[176:191], v[32:35], v[68:71], v[176:191]
s_mul_i32 s26, s11, 6144
s_add_u32 s26, s26, s39
s_add_u32 m0, s26, 3072
s_add_u32 s27, s36, 384
buffer_load_dwordx4 v3, s[16:19], s27 offen sc1 lds
v_mfma_f32_32x32x16_bf16 v[192:207], v[36:39], v[68:71], v[192:207]
v_mfma_f32_32x32x16_bf16 v[208:223], v[40:43], v[68:71], v[208:223]
s_waitcnt lgkmcnt(0)
ds_read_b128 v[32:35], v18 offset:0
ds_read_b128 v[36:39], v18 offset:4096
ds_read_b128 v[40:43], v18 offset:8192
ds_read_b64_tr_b16 v[64:65], v20 offset:8192
ds_read_b64_tr_b16 v[66:67], v20 offset:9216
ds_read_b64_tr_b16 v[68:69], v21 offset:8192
ds_read_b64_tr_b16 v[70:71], v21 offset:9216
v_mfma_f32_32x32x16_bf16 v[128:143], v[44:47], v[72:75], v[128:143]
s_mul_i32 s26, s11, 6144
s_add_u32 s26, s26, s39
s_add_u32 m0, s26, 4096
s_add_u32 s27, s36, 512
buffer_load_dwordx4 v2, s[16:19], s27 offen sc1 lds
v_mfma_f32_32x32x16_bf16 v[144:159], v[48:51], v[72:75], v[144:159]
s_mul_i32 s26, s11, 6144
s_add_u32 s26, s26, s39
s_add_u32 m0, s26, 5120
s_add_u32 s27, s36, 640
buffer_load_dwordx4 v3, s[16:19], s27 offen sc1 lds
v_mfma_f32_32x32x16_bf16 v[160:175], v[52:55], v[72:75], v[160:175]
s_add_u32 s36, s36, 73728
s_lshl_b32 s26, s11, 12
s_add_u32 s26, s26, s39
s_add_u32 m0, s26, 24576
s_add_u32 s27, s37, 0
buffer_load_dwordx4 v5, s[20:23], s27 offen lds
v_mfma_f32_32x32x16_bf16 v[176:191], v[44:47], v[76:79], v[176:191]
s_lshl_b32 s26, s11, 12
s_add_u32 s26, s26, s39
s_add_u32 m0, s26, 25600
s_add_u32 s27, s37, 16384
buffer_load_dwordx4 v5, s[20:23], s27 offen lds
v_mfma_f32_32x32x16_bf16 v[192:207], v[48:51], v[76:79], v[192:207]
v_mfma_f32_32x32x16_bf16 v[208:223], v[52:55], v[76:79], v[208:223]
s_waitcnt lgkmcnt(0)
ds_read_b128 v[44:47], v19 offset:0
ds_read_b128 v[48:51], v19 offset:4096
ds_read_b128 v[52:55], v19 offset:8192
ds_read_b64_tr_b16 v[72:73], v20 offset:12288
ds_read_b64_tr_b16 v[74:75], v20 offset:13312
ds_read_b64_tr_b16 v[76:77], v21 offset:12288
ds_read_b64_tr_b16 v[78:79], v21 offset:13312
v_mfma_f32_32x32x16_bf16 v[128:143], v[32:35], v[64:67], v[128:143]
s_lshl_b32 s26, s11, 12
s_add_u32 s26, s26, s39
s_add_u32 m0, s26, 26624
s_add_u32 s27, s37, 32768
buffer_load_dwordx4 v5, s[20:23], s27 offen lds
v_mfma_f32_32x32x16_bf16 v[144:159], v[36:39], v[64:67], v[144:159]
s_lshl_b32 s26, s11, 12
s_add_u32 s26, s26, s39
s_add_u32 m0, s26, 27648
s_add_u32 s27, s37, 49152
buffer_load_dwordx4 v5, s[20:23], s27 offen lds
s_add_u32 s37, s37, 262144
v_mfma_f32_32x32x16_bf16 v[160:175], v[40:43], v[64:67], v[160:175]
v_mfma_f32_32x32x16_bf16 v[176:191], v[32:35], v[68:71], v[176:191]
v_mfma_f32_32x32x16_bf16 v[192:207], v[36:39], v[68:71], v[192:207]
v_mfma_f32_32x32x16_bf16 v[208:223], v[40:43], v[68:71], v[208:223]
s_waitcnt lgkmcnt(0)
s_waitcnt vmcnt(10)
s_barrier
s_add_u32 s38, s38, 40960
s_cmp_eq_u32 s38, 122880
s_cselect_b32 s38, 0, s38
v_add_u32 v16, s38, v8
v_add_u32 v17, s38, v9
v_add_u32 v18, s38, v10
v_add_u32 v19, s38, v11
s_add_u32 s25, s38, 24576
v_add_u32 v20, s25, v12
v_add_u32 v21, s25, v13
ds_read_b128 v[32:35], v16 offset:0
ds_read_b128 v[36:39], v16 offset:4096
ds_read_b128 v[40:43], v16 offset:8192
ds_read_b64_tr_b16 v[64:65], v20 offset:0
ds_read_b64_tr_b16 v[66:67], v20 offset:1024
ds_read_b64_tr_b16 v[68:69], v21 offset:0
ds_read_b64_tr_b16 v[70:71], v21 offset:1024
v_mfma_f32_32x32x16_bf16 v[128:143], v[44:47], v[72:75], v[128:143]
v_mfma_f32_32x32x16_bf16 v[144:159], v[48:51], v[72:75], v[144:159]
v_mfma_f32_32x32x16_bf16 v[160:175], v[52:55], v[72:75], v[160:175]
v_mfma_f32_32x32x16_bf16 v[176:191], v[44:47], v[76:79], v[176:191]
v_mfma_f32_32x32x16_bf16 v[192:207], v[48:51], v[76:79], v[192:207]
v_mfma_f32_32x32x16_bf16 v[208:223], v[52:55], v[76:79], v[208:223]
s_add_u32 s39, s39, 40960
s_cmp_eq_u32 s39, 122880
s_cselect_b32 s39, 0, s39
s_add_u32 s40, s40, 1
s_cmp_lt_u32 s40, 16
s_cbranch_scc1 L_gl_105
s_waitcnt lgkmcnt(0)
ds_read_b128 v[44:47], v17 offset:0
ds_read_b128 v[48:51], v17 offset:4096
ds_read_b128 v[52:55], v17 offset:8192
ds_read_b64_tr_b16 v[72:73], v20 offset:4096
ds_read_b64_tr_b16 v[74:75], v20 offset:5120
ds_read_b64_tr_b16 v[76:77], v21 offset:4096
ds_read_b64_tr_b16 v[78:79], v21 offset:5120
v_mfma_f32_32x32x16_bf16 v[128:143], v[32:35], v[64:67], v[128:143]
v_mfma_f32_32x32x16_bf16 v[144:159], v[36:39], v[64:67], v[144:159]
v_mfma_f32_32x32x16_bf16 v[160:175], v[40:43], v[64:67], v[160:175]
v_mfma_f32_32x32x16_bf16 v[176:191], v[32:35], v[68:71], v[176:191]
v_mfma_f32_32x32x16_bf16 v[192:207], v[36:39], v[68:71], v[192:207]
v_mfma_f32_32x32x16_bf16 v[208:223], v[40:43], v[68:71], v[208:223]
s_waitcnt lgkmcnt(0)
ds_read_b128 v[32:35], v18 offset:0
ds_read_b128 v[36:39], v18 offset:4096
ds_read_b128 v[40:43], v18 offset:8192
ds_read_b64_tr_b16 v[64:65], v20 offset:8192
ds_read_b64_tr_b16 v[66:67], v20 offset:9216
ds_read_b64_tr_b16 v[68:69], v21 offset:8192
ds_read_b64_tr_b16 v[70:71], v21 offset:9216
v_mfma_f32_32x32x16_bf16 v[128:143], v[44:47], v[72:75], v[128:143]
v_mfma_f32_32x32x16_bf16 v[144:159], v[48:51], v[72:75], v[144:159]
v_mfma_f32_32x32x16_bf16 v[160:175], v[52:55], v[72:75], v[160:175]
v_mfma_f32_32x32x16_bf16 v[176:191], v[44:47], v[76:79], v[176:191]
v_mfma_f32_32x32x16_bf16 v[192:207], v[48:51], v[76:79], v[192:207]
v_mfma_f32_32x32x16_bf16 v[208:223], v[52:55], v[76:79], v[208:223]
s_waitcnt lgkmcnt(0)
ds_read_b128 v[44:47], v19 offset:0
ds_read_b128 v[48:51], v19 offset:4096
ds_read_b128 v[52:55], v19 offset:8192
ds_read_b64_tr_b16 v[72:73], v20 offset:12288
ds_read_b64_tr_b16 v[74:75], v20 offset:13312
ds_read_b64_tr_b16 v[76:77], v21 offset:12288
ds_read_b64_tr_b16 v[78:79], v21 offset:13312
v_mfma_f32_32x32x16_bf16 v[128:143], v[32:35], v[64:67], v[128:143]
v_mfma_f32_32x32x16_bf16 v[144:159], v[36:39], v[64:67], v[144:159]
v_mfma_f32_32x32x16_bf16 v[160:175], v[40:43], v[64:67], v[160:175]
v_mfma_f32_32x32x16_bf16 v[176:191], v[32:35], v[68:71], v[176:191]
v_mfma_f32_32x32x16_bf16 v[192:207], v[36:39], v[68:71], v[192:207]
v_mfma_f32_32x32x16_bf16 v[208:223], v[40:43], v[68:71], v[208:223]
s_waitcnt lgkmcnt(0)
s_waitcnt vmcnt(0)
s_barrier
s_add_u32 s38, s38, 40960
s_cmp_eq_u32 s38, 122880
s_cselect_b32 s38, 0, s38
v_add_u32 v16, s38, v8
v_add_u32 v17, s38, v9
v_add_u32 v18, s38, v10
v_add_u32 v19, s38, v11
s_add_u32 s25, s38, 24576
v_add_u32 v20, s25, v12
v_add_u32 v21, s25, v13
ds_read_b128 v[32:35], v16 offset:0
ds_read_b128 v[36:39], v16 offset:4096
ds_read_b128 v[40:43], v16 offset:8192
ds_read_b64_tr_b16 v[64:65], v20 offset:0
ds_read_b64_tr_b16 v[66:67], v20 offset:1024
ds_read_b64_tr_b16 v[68:69], v21 offset:0
ds_read_b64_tr_b16 v[70:71], v21 offset:1024
v_mfma_f32_32x32x16_bf16 v[128:143], v[44:47], v[72:75], v[128:143]
v_mfma_f32_32x32x16_bf16 v[144:159], v[48:51], v[72:75], v[144:159]
v_mfma_f32_32x32x16_bf16 v[160:175], v[52:55], v[72:75], v[160:175]
v_mfma_f32_32x32x16_bf16 v[176:191], v[44:47], v[76:79], v[176:191]
v_mfma_f32_32x32x16_bf16 v[192:207], v[48:51], v[76:79], v[192:207]
v_mfma_f32_32x32x16_bf16 v[208:223], v[52:55], v[76:79], v[208:223]
s_waitcnt lgkmcnt(0)
ds_read_b128 v[44:47], v17 offset:0
ds_read_b128 v[48:51], v17 offset:4096
ds_read_b128 v[52:55], v17 offset:8192
ds_read_b64_tr_b16 v[72:73], v20 offset:4096
ds_read_b64_tr_b16 v[74:75], v20 offset:5120
ds_read_b64_tr_b16 v[76:77], v21 offset:4096
ds_read_b64_tr_b16 v[78:79], v21 offset:5120
v_mfma_f32_32x32x16_bf16 v[128:143], v[32:35], v[64:67], v[128:143]
v_mfma_f32_32x32x16_bf16 v[144:159], v[36:39], v[64:67], v[144:159]
v_mfma_f32_32x32x16_bf16 v[160:175], v[40:43], v[64:67], v[160:175]
v_mfma_f32_32x32x16_bf16 v[176:191], v[32:35], v[68:71], v[176:191]
v_mfma_f32_32x32x16_bf16 v[192:207], v[36:39], v[68:71], v[192:207]
v_mfma_f32_32x32x16_bf16 v[208:223], v[40:43], v[68:71], v[208:223]
s_waitcnt lgkmcnt(0)
ds_read_b128 v[32:35], v18 offset:0
ds_read_b128 v[36:39], v18 offset:4096
ds_read_b128 v[40:43], v18 offset:8192
ds_read_b64_tr_b16 v[64:65], v20 offset:8192
ds_read_b64_tr_b16 v[66:67], v20 offset:9216
ds_read_b64_tr_b16 v[68:69], v21 offset:8192
ds_read_b64_tr_b16 v[70:71], v21 offset:9216
v_mfma_f32_32x32x16_bf16 v[128:143], v[44:47], v[72:75], v[128:143]
v_mfma_f32_32x32x16_bf16 v[144:159], v[48:51], v[72:75], v[144:159]
v_mfma_f32_32x32x16_bf16 v[160:175], v[52:55], v[72:75], v[160:175]
v_mfma_f32_32x32x16_bf16 v[176:191], v[44:47], v[76:79], v[176:191]
v_mfma_f32_32x32x16_bf16 v[192:207], v[48:51], v[76:79], v[192:207]
v_mfma_f32_32x32x16_bf16 v[208:223], v[52:55], v[76:79], v[208:223]
s_waitcnt lgkmcnt(0)
ds_read_b128 v[44:47], v19 offset:0
ds_read_b128 v[48:51], v19 offset:4096
ds_read_b128 v[52:55], v19 offset:8192
ds_read_b64_tr_b16 v[72:73], v20 offset:12288
ds_read_b64_tr_b16 v[74:75], v20 offset:13312
ds_read_b64_tr_b16 v[76:77], v21 offset:12288
ds_read_b64_tr_b16 v[78:79], v21 offset:13312
v_mfma_f32_32x32x16_bf16 v[128:143], v[32:35], v[64:67], v[128:143]
v_mfma_f32_32x32x16_bf16 v[144:159], v[36:39], v[64:67], v[144:159]
v_mfma_f32_32x32x16_bf16 v[160:175], v[40:43], v[64:67], v[160:175]
v_mfma_f32_32x32x16_bf16 v[176:191], v[32:35], v[68:71], v[176:191]
v_mfma_f32_32x32x16_bf16 v[192:207], v[36:39], v[68:71], v[192:207]
v_mfma_f32_32x32x16_bf16 v[208:223], v[40:43], v[68:71], v[208:223]
s_waitcnt lgkmcnt(0)
v_mfma_f32_32x32x16_bf16 v[128:143], v[44:47], v[72:75], v[128:143]
v_mfma_f32_32x32x16_bf16 v[144:159], v[48:51], v[72:75], v[144:159]
v_mfma_f32_32x32x16_bf16 v[160:175], v[52:55], v[72:75], v[160:175]
v_mfma_f32_32x32x16_bf16 v[176:191], v[44:47], v[76:79], v[176:191]
v_mfma_f32_32x32x16_bf16 v[192:207], v[48:51], v[76:79], v[192:207]
v_mfma_f32_32x32x16_bf16 v[208:223], v[52:55], v[76:79], v[208:223]
s_nop 15
s_load_dwordx2 s[16:17], s[0:1], 88
s_mov_b32 s18, 4096
s_waitcnt lgkmcnt(0)
s_lshl_b32 s24, s44, 7
s_lshr_b32 s25, s11, 1
s_lshl_b32 s25, s25, 6
s_add_u32 s46, s24, s25
s_lshl_b32 s24, s46, 1
v_and_b32 v24, 31, v0
v_lshlrev_b32 v24, 1, v24
buffer_load_ushort v28, v24, s[16:19], s24 offen
buffer_load_ushort v29, v24, s[16:19], s24 offen offset:64
s_lshr_b32 s24, s46, 4
s_mul_i32 s41, s24, 36864
s_mul_i32 s24, s43, 12288
s_add_u32 s41, s41, s24
s_and_b32 s24, s11, 1
s_mul_i32 s24, s24, 6144
s_add_u32 s41, s41, s24
s_add_u32 s24, s45, 8
s_mul_i32 s24, s24, 4718592
s_add_u32 s41, s41, s24
s_add_u32 s41, s41, 100663296
v_and_b32 v24, 15, v0
v_lshlrev_b32 v24, 4, v24
v_lshrrev_b32 v25, 5, v0
v_lshl_add_u32 v24, v25, 8, v24
v_bfe_u32 v25, v0, 4, 1
v_mul_u32_u24 v25, 36864, v25
v_add_u32 v24, v24, v25
s_cmp_eq_u32 s45, 0
s_cselect_b32 s30, -1, 0
s_waitcnt vmcnt(0)
v_lshlrev_b32 v28, 16, v28
v_lshlrev_b32 v29, 16, v29
v_and_b32 v28, s30, v28
v_and_b32 v29, s30, v29
v_add_f32 v128, v128, v28
v_add_f32 v129, v129, v28
v_add_f32 v130, v130, v28
v_add_f32 v131, v131, v28
v_add_f32 v132, v132, v28
v_add_f32 v133, v133, v28
v_add_f32 v134, v134, v28
v_add_f32 v135, v135, v28
v_add_f32 v136, v136, v28
v_add_f32 v137, v137, v28
v_add_f32 v138, v138, v28
v_add_f32 v139, v139, v28
v_add_f32 v140, v140, v28
v_add_f32 v141, v141, v28
v_add_f32 v142, v142, v28
v_add_f32 v143, v143, v28
s_add_u32 s24, s41, 0
buffer_store_dwordx4 v[128:131], v24, s[12:15], s24 offen sc1
s_add_u32 s24, s41, 512
buffer_store_dwordx4 v[132:135], v24, s[12:15], s24 offen sc1
s_add_u32 s24, s41, 1024
buffer_store_dwordx4 v[136:139], v24, s[12:15], s24 offen sc1
s_add_u32 s24, s41, 1536
buffer_store_dwordx4 v[140:143], v24, s[12:15], s24 offen sc1
v_add_f32 v144, v144, v28
v_add_f32 v145, v145, v28
v_add_f32 v146, v146, v28
v_add_f32 v147, v147, v28
v_add_f32 v148, v148, v28
v_add_f32 v149, v149, v28
v_add_f32 v150, v150, v28
v_add_f32 v151, v151, v28
v_add_f32 v152, v152, v28
v_add_f32 v153, v153, v28
v_add_f32 v154, v154, v28
v_add_f32 v155, v155, v28
v_add_f32 v156, v156, v28
v_add_f32 v157, v157, v28
v_add_f32 v158, v158, v28
v_add_f32 v159, v159, v28
s_add_u32 s24, s41, 2048
buffer_store_dwordx4 v[144:147], v24, s[12:15], s24 offen sc1
s_add_u32 s24, s41, 2560
buffer_store_dwordx4 v[148:151], v24, s[12:15], s24 offen sc1
s_add_u32 s24, s41, 3072
buffer_store_dwordx4 v[152:155], v24, s[12:15], s24 offen sc1
s_add_u32 s24, s41, 3584
buffer_store_dwordx4 v[156:159], v24, s[12:15], s24 offen sc1
v_add_f32 v160, v160, v28
v_add_f32 v161, v161, v28
v_add_f32 v162, v162, v28
v_add_f32 v163, v163, v28
v_add_f32 v164, v164, v28
v_add_f32 v165, v165, v28
v_add_f32 v166, v166, v28
v_add_f32 v167, v167, v28
v_add_f32 v168, v168, v28
v_add_f32 v169, v169, v28
v_add_f32 v170, v170, v28
v_add_f32 v171, v171, v28
v_add_f32 v172, v172, v28
v_add_f32 v173, v173, v28
v_add_f32 v174, v174, v28
v_add_f32 v175, v175, v28
s_add_u32 s24, s41, 4096
buffer_store_dwordx4 v[160:163], v24, s[12:15], s24 offen sc1
s_add_u32 s24, s41, 4608
buffer_store_dwordx4 v[164:167], v24, s[12:15], s24 offen sc1
s_add_u32 s24, s41, 5120
buffer_store_dwordx4 v[168:171], v24, s[12:15], s24 offen sc1
s_add_u32 s24, s41, 5632
buffer_store_dwordx4 v[172:175], v24, s[12:15], s24 offen sc1
v_add_f32 v176, v176, v29
v_add_f32 v177, v177, v29
v_add_f32 v178, v178, v29
v_add_f32 v179, v179, v29
v_add_f32 v180, v180, v29
v_add_f32 v181, v181, v29
v_add_f32 v182, v182, v29
v_add_f32 v183, v183, v29
v_add_f32 v184, v184, v29
v_add_f32 v185, v185, v29
v_add_f32 v186, v186, v29
v_add_f32 v187, v187, v29
v_add_f32 v188, v188, v29
v_add_f32 v189, v189, v29
v_add_f32 v190, v190, v29
v_add_f32 v191, v191, v29
s_add_u32 s24, s41, 73728
buffer_store_dwordx4 v[176:179], v24, s[12:15], s24 offen sc1
s_add_u32 s24, s41, 74240
buffer_store_dwordx4 v[180:183], v24, s[12:15], s24 offen sc1
s_add_u32 s24, s41, 74752
buffer_store_dwordx4 v[184:187], v24, s[12:15], s24 offen sc1
s_add_u32 s24, s41, 75264
buffer_store_dwordx4 v[188:191], v24, s[12:15], s24 offen sc1
v_add_f32 v192, v192, v29
v_add_f32 v193, v193, v29
v_add_f32 v194, v194, v29
v_add_f32 v195, v195, v29
v_add_f32 v196, v196, v29
v_add_f32 v197, v197, v29
v_add_f32 v198, v198, v29
v_add_f32 v199, v199, v29
v_add_f32 v200, v200, v29
v_add_f32 v201, v201, v29
v_add_f32 v202, v202, v29
v_add_f32 v203, v203, v29
v_add_f32 v204, v204, v29
v_add_f32 v205, v205, v29
v_add_f32 v206, v206, v29
v_add_f32 v207, v207, v29
s_add_u32 s24, s41, 75776
buffer_store_dwordx4 v[192:195], v24, s[12:15], s24 offen sc1
s_add_u32 s24, s41, 76288
buffer_store_dwordx4 v[196:199], v24, s[12:15], s24 offen sc1
s_add_u32 s24, s41, 76800
buffer_store_dwordx4 v[200:203], v24, s[12:15], s24 offen sc1
s_add_u32 s24, s41, 77312
buffer_store_dwordx4 v[204:207], v24, s[12:15], s24 offen sc1
v_add_f32 v208, v208, v29
v_add_f32 v209, v209, v29
v_add_f32 v210, v210, v29
v_add_f32 v211, v211, v29
v_add_f32 v212, v212, v29
v_add_f32 v213, v213, v29
v_add_f32 v214, v214, v29
v_add_f32 v215, v215, v29
v_add_f32 v216, v216, v29
v_add_f32 v217, v217, v29
v_add_f32 v218, v218, v29
v_add_f32 v219, v219, v29
v_add_f32 v220, v220, v29
v_add_f32 v221, v221, v29
v_add_f32 v222, v222, v29
v_add_f32 v223, v223, v29
s_add_u32 s24, s41, 77824
buffer_store_dwordx4 v[208:211], v24, s[12:15], s24 offen sc1
s_add_u32 s24, s41, 78336
buffer_store_dwordx4 v[212:215], v24, s[12:15], s24 offen sc1
s_add_u32 s24, s41, 78848
buffer_store_dwordx4 v[216:219], v24, s[12:15], s24 offen sc1
s_add_u32 s24, s41, 79360
buffer_store_dwordx4 v[220:223], v24, s[12:15], s24 offen sc1
s_waitcnt vmcnt(0)
s_lshl_b32 s24, s44, 7
s_add_u32 s24, s24, 77602304
s_barrier
s_cmp_lg_u32 s11, 0
s_cbranch_scc1 L_sg_106
s_mov_b32 s60, s24
v_mov_b32 v1, 1
s_mov_b64 exec, 1
buffer_atomic_add v1, off, s[12:15], s60
s_mov_b64 exec, -1
L_sg_106:
s_branch L_next
L_p4:
s_and_b32 s43, s10, 7
s_bfe_u32 s44, s10, 0x20003
s_lshr_b32 s48, s10, 5
s_mov_b32 s47, -1
s_load_dwordx2 s[20:21], s[0:1], 40
s_mov_b32 s22, 4718592
s_waitcnt lgkmcnt(0)
s_barrier
s_mul_i32 s24, s43, 589824
s_mul_i32 s25, s44, 288
s_add_u32 s37, s24, s25
s_mul_i32 s28, s11, 2304
s_add_u32 s26, s28, 0
v_add_u32 v8, s26, v0
v_mul_u32_u24 v9, 58255, v8
v_lshrrev_b32 v9, 20, v9
v_mul_u32_u24 v10, 18, v9
v_sub_u32 v10, v8, v10
v_mul_u32_u24 v9, 1152, v9
v_lshl_add_u32 v11, v10, 4, v9
s_lshl_b32 m0, s26, 4
s_nop 0
buffer_load_dwordx4 v11, s[20:23], s37 offen lds
s_add_u32 s26, s28, 64
v_add_u32 v8, s26, v0
v_mul_u32_u24 v9, 58255, v8
v_lshrrev_b32 v9, 20, v9
v_mul_u32_u24 v10, 18, v9
v_sub_u32 v10, v8, v10
v_mul_u32_u24 v9, 1152, v9
v_lshl_add_u32 v11, v10, 4, v9
s_lshl_b32 m0, s26, 4
s_nop 0
buffer_load_dwordx4 v11, s[20:23], s37 offen lds
s_add_u32 s26, s28, 128
v_add_u32 v8, s26, v0
v_mul_u32_u24 v9, 58255, v8
v_lshrrev_b32 v9, 20, v9
v_mul_u32_u24 v10, 18, v9
v_sub_u32 v10, v8, v10
v_mul_u32_u24 v9, 1152, v9
v_lshl_add_u32 v11, v10, 4, v9
s_lshl_b32 m0, s26, 4
s_nop 0
buffer_load_dwordx4 v11, s[20:23], s37 offen lds
s_add_u32 s26, s28, 192
v_add_u32 v8, s26, v0
v_mul_u32_u24 v9, 58255, v8
v_lshrrev_b32 v9, 20, v9
v_mul_u32_u24 v10, 18, v9
v_sub_u32 v10, v8, v10
v_mul_u32_u24 v9, 1152, v9
v_lshl_add_u32 v11, v10, 4, v9
s_lshl_b32 m0, s26, 4
s_nop 0
buffer_load_dwordx4 v11, s[20:23], s37 offen lds
s_add_u32 s26, s28, 256
v_add_u32 v8, s26, v0
v_mul_u32_u24 v9, 58255, v8
v_lshrrev_b32 v9, 20, v9
v_mul_u32_u24 v10, 18, v9
v_sub_u32 v10, v8, v10
v_mul_u32_u24 v9, 1152, v9
v_lshl_add_u32 v11, v10, 4, v9
s_lshl_b32 m0, s26, 4
s_nop 0
buffer_load_dwordx4 v11, s[20:23], s37 offen lds
s_add_u32 s26, s28, 320
v_add_u32 v8, s26, v0
v_mul_u32_u24 v9, 58255, v8
v_lshrrev_b32 v9, 20, v9
v_mul_u32_u24 v10, 18, v9
v_sub_u32 v10, v8, v10
v_mul_u32_u24 v9, 1152, v9
v_lshl_add_u32 v11, v10, 4, v9
s_lshl_b32 m0, s26, 4
s_nop 0
buffer_load_dwordx4 v11, s[20:23], s37 offen lds
s_add_u32 s26, s28, 384
v_add_u32 v8, s26, v0
v_mul_u32_u24 v9, 58255, v8
v_lshrrev_b32 v9, 20, v9
v_mul_u32_u24 v10, 18, v9
v_sub_u32 v10, v8, v10
v_mul_u32_u24 v9, 1152, v9
v_lshl_add_u32 v11, v10, 4, v9
s_lshl_b32 m0, s26, 4
s_nop 0
buffer_load_dwordx4 v11, s[20:23], s37 offen lds
s_add_u32 s26, s28, 448
v_add_u32 v8, s26, v0
v_mul_u32_u24 v9, 58255, v8
v_lshrrev_b32 v9, 20, v9
v_mul_u32_u24 v10, 18, v9
v_sub_u32 v10, v8, v10
v_mul_u32_u24 v9, 1152, v9
v_lshl_add_u32 v11, v10, 4, v9
s_lshl_b32 m0, s26, 4
s_nop 0
buffer_load_dwordx4 v11, s[20:23], s37 offen lds
s_add_u32 s26, s28, 512
v_add_u32 v8, s26, v0
v_mul_u32_u24 v9, 58255, v8
v_lshrrev_b32 v9, 20, v9
v_mul_u32_u24 v10, 18, v9
v_sub_u32 v10, v8, v10
v_mul_u32_u24 v9, 1152, v9
v_lshl_add_u32 v11, v10, 4, v9
s_lshl_b32 m0, s26, 4
s_nop 0
buffer_load_dwordx4 v11, s[20:23], s37 offen lds
s_add_u32 s26, s28, 576
v_add_u32 v8, s26, v0
v_mul_u32_u24 v9, 58255, v8
v_lshrrev_b32 v9, 20, v9
v_mul_u32_u24 v10, 18, v9
v_sub_u32 v10, v8, v10
v_mul_u32_u24 v9, 1152, v9
v_lshl_add_u32 v11, v10, 4, v9
s_lshl_b32 m0, s26, 4
s_nop 0
buffer_load_dwordx4 v11, s[20:23], s37 offen lds
s_add_u32 s26, s28, 640
v_add_u32 v8, s26, v0
v_mul_u32_u24 v9, 58255, v8
v_lshrrev_b32 v9, 20, v9
v_mul_u32_u24 v10, 18, v9
v_sub_u32 v10, v8, v10
v_mul_u32_u24 v9, 1152, v9
v_lshl_add_u32 v11, v10, 4, v9
s_lshl_b32 m0, s26, 4
s_nop 0
buffer_load_dwordx4 v11, s[20:23], s37 offen lds
s_add_u32 s26, s28, 704
v_add_u32 v8, s26, v0
v_mul_u32_u24 v9, 58255, v8
v_lshrrev_b32 v9, 20, v9
v_mul_u32_u24 v10, 18, v9
v_sub_u32 v10, v8, v10
v_mul_u32_u24 v9, 1152, v9
v_lshl_add_u32 v11, v10, 4, v9
s_lshl_b32 m0, s26, 4
s_nop 0
buffer_load_dwordx4 v11, s[20:23], s37 offen lds
s_add_u32 s26, s28, 768
v_add_u32 v8, s26, v0
v_mul_u32_u24 v9, 58255, v8
v_lshrrev_b32 v9, 20, v9
v_mul_u32_u24 v10, 18, v9
v_sub_u32 v10, v8, v10
v_mul_u32_u24 v9, 1152, v9
v_lshl_add_u32 v11, v10, 4, v9
s_lshl_b32 m0, s26, 4
s_nop 0
buffer_load_dwordx4 v11, s[20:23], s37 offen lds
s_add_u32 s26, s28, 832
v_add_u32 v8, s26, v0
v_mul_u32_u24 v9, 58255, v8
v_lshrrev_b32 v9, 20, v9
v_mul_u32_u24 v10, 18, v9
v_sub_u32 v10, v8, v10
v_mul_u32_u24 v9, 1152, v9
v_lshl_add_u32 v11, v10, 4, v9
s_lshl_b32 m0, s26, 4
s_nop 0
buffer_load_dwordx4 v11, s[20:23], s37 offen lds
s_add_u32 s26, s28, 896
v_add_u32 v8, s26, v0
v_mul_u32_u24 v9, 58255, v8
v_lshrrev_b32 v9, 20, v9
v_mul_u32_u24 v10, 18, v9
v_sub_u32 v10, v8, v10
v_mul_u32_u24 v9, 1152, v9
v_lshl_add_u32 v11, v10, 4, v9
s_lshl_b32 m0, s26, 4
s_nop 0
buffer_load_dwordx4 v11, s[20:23], s37 offen lds
s_add_u32 s26, s28, 960
v_add_u32 v8, s26, v0
v_mul_u32_u24 v9, 58255, v8
v_lshrrev_b32 v9, 20, v9
v_mul_u32_u24 v10, 18, v9
v_sub_u32 v10, v8, v10
v_mul_u32_u24 v9, 1152, v9
v_lshl_add_u32 v11, v10, 4, v9
s_lshl_b32 m0, s26, 4
s_nop 0
buffer_load_dwordx4 v11, s[20:23], s37 offen lds
s_add_u32 s26, s28, 1024
v_add_u32 v8, s26, v0
v_mul_u32_u24 v9, 58255, v8
v_lshrrev_b32 v9, 20, v9
v_mul_u32_u24 v10, 18, v9
v_sub_u32 v10, v8, v10
v_mul_u32_u24 v9, 1152, v9
v_lshl_add_u32 v11, v10, 4, v9
s_lshl_b32 m0, s26, 4
s_nop 0
buffer_load_dwordx4 v11, s[20:23], s37 offen lds
s_add_u32 s26, s28, 1088
v_add_u32 v8, s26, v0
v_mul_u32_u24 v9, 58255, v8
v_lshrrev_b32 v9, 20, v9
v_mul_u32_u24 v10, 18, v9
v_sub_u32 v10, v8, v10
v_mul_u32_u24 v9, 1152, v9
v_lshl_add_u32 v11, v10, 4, v9
s_lshl_b32 m0, s26, 4
s_nop 0
buffer_load_dwordx4 v11, s[20:23], s37 offen lds
s_add_u32 s26, s28, 1152
v_add_u32 v8, s26, v0
v_mul_u32_u24 v9, 58255, v8
v_lshrrev_b32 v9, 20, v9
v_mul_u32_u24 v10, 18, v9
v_sub_u32 v10, v8, v10
v_mul_u32_u24 v9, 1152, v9
v_lshl_add_u32 v11, v10, 4, v9
s_lshl_b32 m0, s26, 4
s_nop 0
buffer_load_dwordx4 v11, s[20:23], s37 offen lds
s_add_u32 s26, s28, 1216
v_add_u32 v8, s26, v0
v_mul_u32_u24 v9, 58255, v8
v_lshrrev_b32 v9, 20, v9
v_mul_u32_u24 v10, 18, v9
v_sub_u32 v10, v8, v10
v_mul_u32_u24 v9, 1152, v9
v_lshl_add_u32 v11, v10, 4, v9
s_lshl_b32 m0, s26, 4
s_nop 0
buffer_load_dwordx4 v11, s[20:23], s37 offen lds
s_add_u32 s26, s28, 1280
v_add_u32 v8, s26, v0
v_mul_u32_u24 v9, 58255, v8
v_lshrrev_b32 v9, 20, v9
v_mul_u32_u24 v10, 18, v9
v_sub_u32 v10, v8, v10
v_mul_u32_u24 v9, 1152, v9
v_lshl_add_u32 v11, v10, 4, v9
s_lshl_b32 m0, s26, 4
s_nop 0
buffer_load_dwordx4 v11, s[20:23], s37 offen lds
s_add_u32 s26, s28, 1344
v_add_u32 v8, s26, v0
v_mul_u32_u24 v9, 58255, v8
v_lshrrev_b32 v9, 20, v9
v_mul_u32_u24 v10, 18, v9
v_sub_u32 v10, v8, v10
v_mul_u32_u24 v9, 1152, v9
v_lshl_add_u32 v11, v10, 4, v9
s_lshl_b32 m0, s26, 4
s_nop 0
buffer_load_dwordx4 v11, s[20:23], s37 offen lds
s_add_u32 s26, s28, 1408
v_add_u32 v8, s26, v0
v_mul_u32_u24 v9, 58255, v8
v_lshrrev_b32 v9, 20, v9
v_mul_u32_u24 v10, 18, v9
v_sub_u32 v10, v8, v10
v_mul_u32_u24 v9, 1152, v9
v_lshl_add_u32 v11, v10, 4, v9
s_lshl_b32 m0, s26, 4
s_nop 0
buffer_load_dwordx4 v11, s[20:23], s37 offen lds
s_add_u32 s26, s28, 1472
v_add_u32 v8, s26, v0
v_mul_u32_u24 v9, 58255, v8
v_lshrrev_b32 v9, 20, v9
v_mul_u32_u24 v10, 18, v9
v_sub_u32 v10, v8, v10
v_mul_u32_u24 v9, 1152, v9
v_lshl_add_u32 v11, v10, 4, v9
s_lshl_b32 m0, s26, 4
s_nop 0
buffer_load_dwordx4 v11, s[20:23], s37 offen lds
s_add_u32 s26, s28, 1536
v_add_u32 v8, s26, v0
v_mul_u32_u24 v9, 58255, v8
v_lshrrev_b32 v9, 20, v9
v_mul_u32_u24 v10, 18, v9
v_sub_u32 v10, v8, v10
v_mul_u32_u24 v9, 1152, v9
v_lshl_add_u32 v11, v10, 4, v9
s_lshl_b32 m0, s26, 4
s_nop 0
buffer_load_dwordx4 v11, s[20:23], s37 offen lds
s_add_u32 s26, s28, 1600
v_add_u32 v8, s26, v0
v_mul_u32_u24 v9, 58255, v8
v_lshrrev_b32 v9, 20, v9
v_mul_u32_u24 v10, 18, v9
v_sub_u32 v10, v8, v10
v_mul_u32_u24 v9, 1152, v9
v_lshl_add_u32 v11, v10, 4, v9
s_lshl_b32 m0, s26, 4
s_nop 0
buffer_load_dwordx4 v11, s[20:23], s37 offen lds
s_add_u32 s26, s28, 1664
v_add_u32 v8, s26, v0
v_mul_u32_u24 v9, 58255, v8
v_lshrrev_b32 v9, 20, v9
v_mul_u32_u24 v10, 18, v9
v_sub_u32 v10, v8, v10
v_mul_u32_u24 v9, 1152, v9
v_lshl_add_u32 v11, v10, 4, v9
s_lshl_b32 m0, s26, 4
s_nop 0
buffer_load_dwordx4 v11, s[20:23], s37 offen lds
s_add_u32 s26, s28, 1728
v_add_u32 v8, s26, v0
v_mul_u32_u24 v9, 58255, v8
v_lshrrev_b32 v9, 20, v9
v_mul_u32_u24 v10, 18, v9
v_sub_u32 v10, v8, v10
v_mul_u32_u24 v9, 1152, v9
v_lshl_add_u32 v11, v10, 4, v9
s_lshl_b32 m0, s26, 4
s_nop 0
buffer_load_dwordx4 v11, s[20:23], s37 offen lds
s_add_u32 s26, s28, 1792
v_add_u32 v8, s26, v0
v_mul_u32_u24 v9, 58255, v8
v_lshrrev_b32 v9, 20, v9
v_mul_u32_u24 v10, 18, v9
v_sub_u32 v10, v8, v10
v_mul_u32_u24 v9, 1152, v9
v_lshl_add_u32 v11, v10, 4, v9
s_lshl_b32 m0, s26, 4
s_nop 0
buffer_load_dwordx4 v11, s[20:23], s37 offen lds
s_add_u32 s26, s28, 1856
v_add_u32 v8, s26, v0
v_mul_u32_u24 v9, 58255, v8
v_lshrrev_b32 v9, 20, v9
v_mul_u32_u24 v10, 18, v9
v_sub_u32 v10, v8, v10
v_mul_u32_u24 v9, 1152, v9
v_lshl_add_u32 v11, v10, 4, v9
s_lshl_b32 m0, s26, 4
s_nop 0
buffer_load_dwordx4 v11, s[20:23], s37 offen lds
s_add_u32 s26, s28, 1920
v_add_u32 v8, s26, v0
v_mul_u32_u24 v9, 58255, v8
v_lshrrev_b32 v9, 20, v9
v_mul_u32_u24 v10, 18, v9
v_sub_u32 v10, v8, v10
v_mul_u32_u24 v9, 1152, v9
v_lshl_add_u32 v11, v10, 4, v9
s_lshl_b32 m0, s26, 4
s_nop 0
buffer_load_dwordx4 v11, s[20:23], s37 offen lds
s_add_u32 s26, s28, 1984
v_add_u32 v8, s26, v0
v_mul_u32_u24 v9, 58255, v8
v_lshrrev_b32 v9, 20, v9
v_mul_u32_u24 v10, 18, v9
v_sub_u32 v10, v8, v10
v_mul_u32_u24 v9, 1152, v9
v_lshl_add_u32 v11, v10, 4, v9
s_lshl_b32 m0, s26, 4
s_nop 0
buffer_load_dwordx4 v11, s[20:23], s37 offen lds
s_add_u32 s26, s28, 2048
v_add_u32 v8, s26, v0
v_mul_u32_u24 v9, 58255, v8
v_lshrrev_b32 v9, 20, v9
v_mul_u32_u24 v10, 18, v9
v_sub_u32 v10, v8, v10
v_mul_u32_u24 v9, 1152, v9
v_lshl_add_u32 v11, v10, 4, v9
s_lshl_b32 m0, s26, 4
s_nop 0
buffer_load_dwordx4 v11, s[20:23], s37 offen lds
s_add_u32 s26, s28, 2112
v_add_u32 v8, s26, v0
v_mul_u32_u24 v9, 58255, v8
v_lshrrev_b32 v9, 20, v9
v_mul_u32_u24 v10, 18, v9
v_sub_u32 v10, v8, v10
v_mul_u32_u24 v9, 1152, v9
v_lshl_add_u32 v11, v10, 4, v9
s_lshl_b32 m0, s26, 4
s_nop 0
buffer_load_dwordx4 v11, s[20:23], s37 offen lds
s_add_u32 s26, s28, 2176
v_add_u32 v8, s26, v0
v_mul_u32_u24 v9, 58255, v8
v_lshrrev_b32 v9, 20, v9
v_mul_u32_u24 v10, 18, v9
v_sub_u32 v10, v8, v10
v_mul_u32_u24 v9, 1152, v9
v_lshl_add_u32 v11, v10, 4, v9
s_lshl_b32 m0, s26, 4
s_nop 0
buffer_load_dwordx4 v11, s[20:23], s37 offen lds
s_add_u32 s26, s28, 2240
v_add_u32 v8, s26, v0
v_mul_u32_u24 v9, 58255, v8
v_lshrrev_b32 v9, 20, v9
v_mul_u32_u24 v10, 18, v9
v_sub_u32 v10, v8, v10
v_mul_u32_u24 v9, 1152, v9
v_lshl_add_u32 v11, v10, 4, v9
s_lshl_b32 m0, s26, 4
s_nop 0
buffer_load_dwordx4 v11, s[20:23], s37 offen lds
s_waitcnt vmcnt(0)
s_barrier
v_lshrrev_b32 v8, 4, v0
v_lshlrev_b32 v8, 2, v8
v_bfe_u32 v9, v0, 2, 2
v_add_u32 v8, v8, v9
v_mul_u32_u24 v8, 288, v8
v_and_b32 v9, 3, v0
v_lshl_add_u32 v8, v9, 3, v8
v_add_u32 v9, 65536, v8
v_add_u32 v10, 131072, v8
s_cmp_lg_u32 s11, 0
s_cbranch_scc1 L_wo_107
ds_read_b64_tr_b16 a[0:1], v8 offset:0
ds_read_b64_tr_b16 a[2:3], v8 offset:4608
ds_read_b64_tr_b16 a[4:5], v8 offset:9216
ds_read_b64_tr_b16 a[6:7], v8 offset:13824
ds_read_b64_tr_b16 a[8:9], v8 offset:18432
ds_read_b64_tr_b16 a[10:11], v8 offset:23040
ds_read_b64_tr_b16 a[12:13], v8 offset:27648
ds_read_b64_tr_b16 a[14:15], v8 offset:32256
ds_read_b64_tr_b16 a[16:17], v8 offset:36864
ds_read_b64_tr_b16 a[18:19], v8 offset:41472
ds_read_b64_tr_b16 a[20:21], v8 offset:46080
ds_read_b64_tr_b16 a[22:23], v8 offset:50688
s_waitcnt lgkmcnt(0)
ds_read_b64_tr_b16 a[24:25], v8 offset:55296
ds_read_b64_tr_b16 a[26:27], v8 offset:59904
ds_read_b64_tr_b16 a[28:29], v8 offset:64512
ds_read_b64_tr_b16 a[30:31], v9 offset:3584
ds_read_b64_tr_b16 a[32:33], v9 offset:8192
ds_read_b64_tr_b16 a[34:35], v9 offset:12800
ds_read_b64_tr_b16 a[36:37], v9 offset:17408
ds_read_b64_tr_b16 a[38:39], v9 offset:22016
ds_read_b64_tr_b16 a[40:41], v9 offset:26624
ds_read_b64_tr_b16 a[42:43], v9 offset:31232
ds_read_b64_tr_b16 a[44:45], v9 offset:35840
ds_read_b64_tr_b16 a[46:47], v9 offset:40448
s_waitcnt lgkmcnt(0)
ds_read_b64_tr_b16 a[48:49], v9 offset:45056
ds_read_b64_tr_b16 a[50:51], v9 offset:49664
ds_read_b64_tr_b16 a[52:53], v9 offset:54272
ds_read_b64_tr_b16 a[54:55], v9 offset:58880
ds_read_b64_tr_b16 a[56:57], v9 offset:63488
ds_read_b64_tr_b16 a[58:59], v10 offset:2560
ds_read_b64_tr_b16 a[60:61], v10 offset:7168
ds_read_b64_tr_b16 a[62:63], v10 offset:11776
ds_read_b64_tr_b16 a[64:65], v8 offset:32
ds_read_b64_tr_b16 a[66:67], v8 offset:4640
ds_read_b64_tr_b16 a[68:69], v8 offset:9248
ds_read_b64_tr_b16 a[70:71], v8 offset:13856
s_waitcnt lgkmcnt(0)
ds_read_b64_tr_b16 a[72:73], v8 offset:18464
ds_read_b64_tr_b16 a[74:75], v8 offset:23072
ds_read_b64_tr_b16 a[76:77], v8 offset:27680
ds_read_b64_tr_b16 a[78:79], v8 offset:32288
ds_read_b64_tr_b16 a[80:81], v8 offset:36896
ds_read_b64_tr_b16 a[82:83], v8 offset:41504
ds_read_b64_tr_b16 a[84:85], v8 offset:46112
ds_read_b64_tr_b16 a[86:87], v8 offset:50720
ds_read_b64_tr_b16 a[88:89], v8 offset:55328
ds_read_b64_tr_b16 a[90:91], v8 offset:59936
ds_read_b64_tr_b16 a[92:93], v8 offset:64544
ds_read_b64_tr_b16 a[94:95], v9 offset:3616
s_waitcnt lgkmcnt(0)
ds_read_b64_tr_b16 a[96:97], v9 offset:8224
ds_read_b64_tr_b16 a[98:99], v9 offset:12832
ds_read_b64_tr_b16 a[100:101], v9 offset:17440
ds_read_b64_tr_b16 a[102:103], v9 offset:22048
ds_read_b64_tr_b16 a[104:105], v9 offset:26656
ds_read_b64_tr_b16 a[106:107], v9 offset:31264
ds_read_b64_tr_b16 a[108:109], v9 offset:35872
ds_read_b64_tr_b16 a[110:111], v9 offset:40480
ds_read_b64_tr_b16 a[112:113], v9 offset:45088
ds_read_b64_tr_b16 a[114:115], v9 offset:49696
ds_read_b64_tr_b16 a[116:117], v9 offset:54304
ds_read_b64_tr_b16 a[118:119], v9 offset:58912
s_waitcnt lgkmcnt(0)
ds_read_b64_tr_b16 a[120:121], v9 offset:63520
ds_read_b64_tr_b16 a[122:123], v10 offset:2592
ds_read_b64_tr_b16 a[124:125], v10 offset:7200
ds_read_b64_tr_b16 a[126:127], v10 offset:11808
ds_read_b64_tr_b16 a[128:129], v8 offset:256
ds_read_b64_tr_b16 a[130:131], v8 offset:4864
ds_read_b64_tr_b16 a[132:133], v8 offset:9472
ds_read_b64_tr_b16 a[134:135], v8 offset:14080
ds_read_b64_tr_b16 a[136:137], v8 offset:18688
ds_read_b64_tr_b16 a[138:139], v8 offset:23296
ds_read_b64_tr_b16 a[140:141], v8 offset:27904
ds_read_b64_tr_b16 a[142:143], v8 offset:32512
s_waitcnt lgkmcnt(0)
ds_read_b64_tr_b16 a[144:145], v8 offset:37120
ds_read_b64_tr_b16 a[146:147], v8 offset:41728
ds_read_b64_tr_b16 a[148:149], v8 offset:46336
ds_read_b64_tr_b16 a[150:151], v8 offset:50944
ds_read_b64_tr_b16 a[152:153], v8 offset:55552
ds_read_b64_tr_b16 a[154:155], v8 offset:60160
ds_read_b64_tr_b16 a[156:157], v8 offset:64768
ds_read_b64_tr_b16 a[158:159], v9 offset:3840
ds_read_b64_tr_b16 a[160:161], v9 offset:8448
ds_read_b64_tr_b16 a[162:163], v9 offset:13056
ds_read_b64_tr_b16 a[164:165], v9 offset:17664
ds_read_b64_tr_b16 a[166:167], v9 offset:22272
s_waitcnt lgkmcnt(0)
ds_read_b64_tr_b16 a[168:169], v9 offset:26880
ds_read_b64_tr_b16 a[170:171], v9 offset:31488
ds_read_b64_tr_b16 a[172:173], v9 offset:36096
ds_read_b64_tr_b16 a[174:175], v9 offset:40704
ds_read_b64_tr_b16 a[176:177], v9 offset:45312
ds_read_b64_tr_b16 a[178:179], v9 offset:49920
ds_read_b64_tr_b16 a[180:181], v9 offset:54528
ds_read_b64_tr_b16 a[182:183], v9 offset:59136
ds_read_b64_tr_b16 a[184:185], v9 offset:63744
ds_read_b64_tr_b16 a[186:187], v10 offset:2816
ds_read_b64_tr_b16 a[188:189], v10 offset:7424
ds_read_b64_tr_b16 a[190:191], v10 offset:12032
s_waitcnt lgkmcnt(0)
s_waitcnt lgkmcnt(0)
s_branch L_woe_111
L_wo_107:
s_cmp_lg_u32 s11, 1
s_cbranch_scc1 L_wo_108
ds_read_b64_tr_b16 a[0:1], v8 offset:64
ds_read_b64_tr_b16 a[2:3], v8 offset:4672
ds_read_b64_tr_b16 a[4:5], v8 offset:9280
ds_read_b64_tr_b16 a[6:7], v8 offset:13888
ds_read_b64_tr_b16 a[8:9], v8 offset:18496
ds_read_b64_tr_b16 a[10:11], v8 offset:23104
ds_read_b64_tr_b16 a[12:13], v8 offset:27712
ds_read_b64_tr_b16 a[14:15], v8 offset:32320
ds_read_b64_tr_b16 a[16:17], v8 offset:36928
ds_read_b64_tr_b16 a[18:19], v8 offset:41536
ds_read_b64_tr_b16 a[20:21], v8 offset:46144
ds_read_b64_tr_b16 a[22:23], v8 offset:50752
s_waitcnt lgkmcnt(0)
ds_read_b64_tr_b16 a[24:25], v8 offset:55360
ds_read_b64_tr_b16 a[26:27], v8 offset:59968
ds_read_b64_tr_b16 a[28:29], v8 offset:64576
ds_read_b64_tr_b16 a[30:31], v9 offset:3648
ds_read_b64_tr_b16 a[32:33], v9 offset:8256
ds_read_b64_tr_b16 a[34:35], v9 offset:12864
ds_read_b64_tr_b16 a[36:37], v9 offset:17472
ds_read_b64_tr_b16 a[38:39], v9 offset:22080
ds_read_b64_tr_b16 a[40:41], v9 offset:26688
ds_read_b64_tr_b16 a[42:43], v9 offset:31296
ds_read_b64_tr_b16 a[44:45], v9 offset:35904
ds_read_b64_tr_b16 a[46:47], v9 offset:40512
s_waitcnt lgkmcnt(0)
ds_read_b64_tr_b16 a[48:49], v9 offset:45120
ds_read_b64_tr_b16 a[50:51], v9 offset:49728
ds_read_b64_tr_b16 a[52:53], v9 offset:54336
ds_read_b64_tr_b16 a[54:55], v9 offset:58944
ds_read_b64_tr_b16 a[56:57], v9 offset:63552
ds_read_b64_tr_b16 a[58:59], v10 offset:2624
ds_read_b64_tr_b16 a[60:61], v10 offset:7232
ds_read_b64_tr_b16 a[62:63], v10 offset:11840
ds_read_b64_tr_b16 a[64:65], v8 offset:96
ds_read_b64_tr_b16 a[66:67], v8 offset:4704
ds_read_b64_tr_b16 a[68:69], v8 offset:9312
ds_read_b64_tr_b16 a[70:71], v8 offset:13920
s_waitcnt lgkmcnt(0)
ds_read_b64_tr_b16 a[72:73], v8 offset:18528
ds_read_b64_tr_b16 a[74:75], v8 offset:23136
ds_read_b64_tr_b16 a[76:77], v8 offset:27744
ds_read_b64_tr_b16 a[78:79], v8 offset:32352
ds_read_b64_tr_b16 a[80:81], v8 offset:36960
ds_read_b64_tr_b16 a[82:83], v8 offset:41568
ds_read_b64_tr_b16 a[84:85], v8 offset:46176
ds_read_b64_tr_b16 a[86:87], v8 offset:50784
ds_read_b64_tr_b16 a[88:89], v8 offset:55392
ds_read_b64_tr_b16 a[90:91], v8 offset:60000
ds_read_b64_tr_b16 a[92:93], v8 offset:64608
ds_read_b64_tr_b16 a[94:95], v9 offset:3680
s_waitcnt lgkmcnt(0)
ds_read_b64_tr_b16 a[96:97], v9 offset:8288
ds_read_b64_tr_b16 a[98:99], v9 offset:12896
ds_read_b64_tr_b16 a[100:101], v9 offset:17504
ds_read_b64_tr_b16 a[102:103], v9 offset:22112
ds_read_b64_tr_b16 a[104:105], v9 offset:26720
ds_read_b64_tr_b16 a[106:107], v9 offset:31328
ds_read_b64_tr_b16 a[108:109], v9 offset:35936
ds_read_b64_tr_b16 a[110:111], v9 offset:40544
ds_read_b64_tr_b16 a[112:113], v9 offset:45152
ds_read_b64_tr_b16 a[114:115], v9 offset:49760
ds_read_b64_tr_b16 a[116:117], v9 offset:54368
ds_read_b64_tr_b16 a[118:119], v9 offset:58976
s_waitcnt lgkmcnt(0)
ds_read_b64_tr_b16 a[120:121], v9 offset:63584
ds_read_b64_tr_b16 a[122:123], v10 offset:2656
ds_read_b64_tr_b16 a[124:125], v10 offset:7264
ds_read_b64_tr_b16 a[126:127], v10 offset:11872
ds_read_b64_tr_b16 a[128:129], v8 offset:256
ds_read_b64_tr_b16 a[130:131], v8 offset:4864
ds_read_b64_tr_b16 a[132:133], v8 offset:9472
ds_read_b64_tr_b16 a[134:135], v8 offset:14080
ds_read_b64_tr_b16 a[136:137], v8 offset:18688
ds_read_b64_tr_b16 a[138:139], v8 offset:23296
ds_read_b64_tr_b16 a[140:141], v8 offset:27904
ds_read_b64_tr_b16 a[142:143], v8 offset:32512
s_waitcnt lgkmcnt(0)
ds_read_b64_tr_b16 a[144:145], v8 offset:37120
ds_read_b64_tr_b16 a[146:147], v8 offset:41728
ds_read_b64_tr_b16 a[148:149], v8 offset:46336
ds_read_b64_tr_b16 a[150:151], v8 offset:50944
ds_read_b64_tr_b16 a[152:153], v8 offset:55552
ds_read_b64_tr_b16 a[154:155], v8 offset:60160
ds_read_b64_tr_b16 a[156:157], v8 offset:64768
ds_read_b64_tr_b16 a[158:159], v9 offset:3840
ds_read_b64_tr_b16 a[160:161], v9 offset:8448
ds_read_b64_tr_b16 a[162:163], v9 offset:13056
ds_read_b64_tr_b16 a[164:165], v9 offset:17664
ds_read_b64_tr_b16 a[166:167], v9 offset:22272
s_waitcnt lgkmcnt(0)
ds_read_b64_tr_b16 a[168:169], v9 offset:26880
ds_read_b64_tr_b16 a[170:171], v9 offset:31488
ds_read_b64_tr_b16 a[172:173], v9 offset:36096
ds_read_b64_tr_b16 a[174:175], v9 offset:40704
ds_read_b64_tr_b16 a[176:177], v9 offset:45312
ds_read_b64_tr_b16 a[178:179], v9 offset:49920
ds_read_b64_tr_b16 a[180:181], v9 offset:54528
ds_read_b64_tr_b16 a[182:183], v9 offset:59136
ds_read_b64_tr_b16 a[184:185], v9 offset:63744
ds_read_b64_tr_b16 a[186:187], v10 offset:2816
ds_read_b64_tr_b16 a[188:189], v10 offset:7424
ds_read_b64_tr_b16 a[190:191], v10 offset:12032
s_waitcnt lgkmcnt(0)
s_waitcnt lgkmcnt(0)
s_branch L_woe_111
L_wo_108:
s_cmp_lg_u32 s11, 2
s_cbranch_scc1 L_wo_109
ds_read_b64_tr_b16 a[0:1], v8 offset:128
ds_read_b64_tr_b16 a[2:3], v8 offset:4736
ds_read_b64_tr_b16 a[4:5], v8 offset:9344
ds_read_b64_tr_b16 a[6:7], v8 offset:13952
ds_read_b64_tr_b16 a[8:9], v8 offset:18560
ds_read_b64_tr_b16 a[10:11], v8 offset:23168
ds_read_b64_tr_b16 a[12:13], v8 offset:27776
ds_read_b64_tr_b16 a[14:15], v8 offset:32384
ds_read_b64_tr_b16 a[16:17], v8 offset:36992
ds_read_b64_tr_b16 a[18:19], v8 offset:41600
ds_read_b64_tr_b16 a[20:21], v8 offset:46208
ds_read_b64_tr_b16 a[22:23], v8 offset:50816
s_waitcnt lgkmcnt(0)
ds_read_b64_tr_b16 a[24:25], v8 offset:55424
ds_read_b64_tr_b16 a[26:27], v8 offset:60032
ds_read_b64_tr_b16 a[28:29], v8 offset:64640
ds_read_b64_tr_b16 a[30:31], v9 offset:3712
ds_read_b64_tr_b16 a[32:33], v9 offset:8320
ds_read_b64_tr_b16 a[34:35], v9 offset:12928
ds_read_b64_tr_b16 a[36:37], v9 offset:17536
ds_read_b64_tr_b16 a[38:39], v9 offset:22144
ds_read_b64_tr_b16 a[40:41], v9 offset:26752
ds_read_b64_tr_b16 a[42:43], v9 offset:31360
ds_read_b64_tr_b16 a[44:45], v9 offset:35968
ds_read_b64_tr_b16 a[46:47], v9 offset:40576
s_waitcnt lgkmcnt(0)
ds_read_b64_tr_b16 a[48:49], v9 offset:45184
ds_read_b64_tr_b16 a[50:51], v9 offset:49792
ds_read_b64_tr_b16 a[52:53], v9 offset:54400
ds_read_b64_tr_b16 a[54:55], v9 offset:59008
ds_read_b64_tr_b16 a[56:57], v9 offset:63616
ds_read_b64_tr_b16 a[58:59], v10 offset:2688
ds_read_b64_tr_b16 a[60:61], v10 offset:7296
ds_read_b64_tr_b16 a[62:63], v10 offset:11904
ds_read_b64_tr_b16 a[64:65], v8 offset:160
ds_read_b64_tr_b16 a[66:67], v8 offset:4768
ds_read_b64_tr_b16 a[68:69], v8 offset:9376
ds_read_b64_tr_b16 a[70:71], v8 offset:13984
s_waitcnt lgkmcnt(0)
ds_read_b64_tr_b16 a[72:73], v8 offset:18592
ds_read_b64_tr_b16 a[74:75], v8 offset:23200
ds_read_b64_tr_b16 a[76:77], v8 offset:27808
ds_read_b64_tr_b16 a[78:79], v8 offset:32416
ds_read_b64_tr_b16 a[80:81], v8 offset:37024
ds_read_b64_tr_b16 a[82:83], v8 offset:41632
ds_read_b64_tr_b16 a[84:85], v8 offset:46240
ds_read_b64_tr_b16 a[86:87], v8 offset:50848
ds_read_b64_tr_b16 a[88:89], v8 offset:55456
ds_read_b64_tr_b16 a[90:91], v8 offset:60064
ds_read_b64_tr_b16 a[92:93], v8 offset:64672
ds_read_b64_tr_b16 a[94:95], v9 offset:3744
s_waitcnt lgkmcnt(0)
ds_read_b64_tr_b16 a[96:97], v9 offset:8352
ds_read_b64_tr_b16 a[98:99], v9 offset:12960
ds_read_b64_tr_b16 a[100:101], v9 offset:17568
ds_read_b64_tr_b16 a[102:103], v9 offset:22176
ds_read_b64_tr_b16 a[104:105], v9 offset:26784
ds_read_b64_tr_b16 a[106:107], v9 offset:31392
ds_read_b64_tr_b16 a[108:109], v9 offset:36000
ds_read_b64_tr_b16 a[110:111], v9 offset:40608
ds_read_b64_tr_b16 a[112:113], v9 offset:45216
ds_read_b64_tr_b16 a[114:115], v9 offset:49824
ds_read_b64_tr_b16 a[116:117], v9 offset:54432
ds_read_b64_tr_b16 a[118:119], v9 offset:59040
s_waitcnt lgkmcnt(0)
ds_read_b64_tr_b16 a[120:121], v9 offset:63648
ds_read_b64_tr_b16 a[122:123], v10 offset:2720
ds_read_b64_tr_b16 a[124:125], v10 offset:7328
ds_read_b64_tr_b16 a[126:127], v10 offset:11936
s_waitcnt lgkmcnt(0)
s_branch L_woe_111
L_wo_109:
ds_read_b64_tr_b16 a[0:1], v8 offset:192
ds_read_b64_tr_b16 a[2:3], v8 offset:4800
ds_read_b64_tr_b16 a[4:5], v8 offset:9408
ds_read_b64_tr_b16 a[6:7], v8 offset:14016
ds_read_b64_tr_b16 a[8:9], v8 offset:18624
ds_read_b64_tr_b16 a[10:11], v8 offset:23232
ds_read_b64_tr_b16 a[12:13], v8 offset:27840
ds_read_b64_tr_b16 a[14:15], v8 offset:32448
ds_read_b64_tr_b16 a[16:17], v8 offset:37056
ds_read_b64_tr_b16 a[18:19], v8 offset:41664
ds_read_b64_tr_b16 a[20:21], v8 offset:46272
ds_read_b64_tr_b16 a[22:23], v8 offset:50880
s_waitcnt lgkmcnt(0)
ds_read_b64_tr_b16 a[24:25], v8 offset:55488
ds_read_b64_tr_b16 a[26:27], v8 offset:60096
ds_read_b64_tr_b16 a[28:29], v8 offset:64704
ds_read_b64_tr_b16 a[30:31], v9 offset:3776
ds_read_b64_tr_b16 a[32:33], v9 offset:8384
ds_read_b64_tr_b16 a[34:35], v9 offset:12992
ds_read_b64_tr_b16 a[36:37], v9 offset:17600
ds_read_b64_tr_b16 a[38:39], v9 offset:22208
ds_read_b64_tr_b16 a[40:41], v9 offset:26816
ds_read_b64_tr_b16 a[42:43], v9 offset:31424
ds_read_b64_tr_b16 a[44:45], v9 offset:36032
ds_read_b64_tr_b16 a[46:47], v9 offset:40640
s_waitcnt lgkmcnt(0)
ds_read_b64_tr_b16 a[48:49], v9 offset:45248
ds_read_b64_tr_b16 a[50:51], v9 offset:49856
ds_read_b64_tr_b16 a[52:53], v9 offset:54464
ds_read_b64_tr_b16 a[54:55], v9 offset:59072
ds_read_b64_tr_b16 a[56:57], v9 offset:63680
ds_read_b64_tr_b16 a[58:59], v10 offset:2752
ds_read_b64_tr_b16 a[60:61], v10 offset:7360
ds_read_b64_tr_b16 a[62:63], v10 offset:11968
ds_read_b64_tr_b16 a[64:65], v8 offset:224
ds_read_b64_tr_b16 a[66:67], v8 offset:4832
ds_read_b64_tr_b16 a[68:69], v8 offset:9440
ds_read_b64_tr_b16 a[70:71], v8 offset:14048
s_waitcnt lgkmcnt(0)
ds_read_b64_tr_b16 a[72:73], v8 offset:18656
ds_read_b64_tr_b16 a[74:75], v8 offset:23264
ds_read_b64_tr_b16 a[76:77], v8 offset:27872
ds_read_b64_tr_b16 a[78:79], v8 offset:32480
ds_read_b64_tr_b16 a[80:81], v8 offset:37088
ds_read_b64_tr_b16 a[82:83], v8 offset:41696
ds_read_b64_tr_b16 a[84:85], v8 offset:46304
ds_read_b64_tr_b16 a[86:87], v8 offset:50912
ds_read_b64_tr_b16 a[88:89], v8 offset:55520
ds_read_b64_tr_b16 a[90:91], v8 offset:60128
ds_read_b64_tr_b16 a[92:93], v8 offset:64736
ds_read_b64_tr_b16 a[94:95], v9 offset:3808
s_waitcnt lgkmcnt(0)
ds_read_b64_tr_b16 a[96:97], v9 offset:8416
ds_read_b64_tr_b16 a[98:99], v9 offset:13024
ds_read_b64_tr_b16 a[100:101], v9 offset:17632
ds_read_b64_tr_b16 a[102:103], v9 offset:22240
ds_read_b64_tr_b16 a[104:105], v9 offset:26848
ds_read_b64_tr_b16 a[106:107], v9 offset:31456
ds_read_b64_tr_b16 a[108:109], v9 offset:36064
ds_read_b64_tr_b16 a[110:111], v9 offset:40672
ds_read_b64_tr_b16 a[112:113], v9 offset:45280
ds_read_b64_tr_b16 a[114:115], v9 offset:49888
ds_read_b64_tr_b16 a[116:117], v9 offset:54496
ds_read_b64_tr_b16 a[118:119], v9 offset:59104
s_waitcnt lgkmcnt(0)
ds_read_b64_tr_b16 a[120:121], v9 offset:63712
ds_read_b64_tr_b16 a[122:123], v10 offset:2784
ds_read_b64_tr_b16 a[124:125], v10 offset:7392
ds_read_b64_tr_b16 a[126:127], v10 offset:12000
s_waitcnt lgkmcnt(0)
L_woe_111:
s_barrier
v_and_b32 v8, 15, v0
v_lshrrev_b32 v9, 4, v0
v_lshlrev_b32 v2, 4, v8
v_lshl_add_u32 v2, v9, 9, v2
v_and_b32 v10, 7, v0
v_lshlrev_b32 v3, 8, v10
v_lshl_add_u32 v3, v9, 4, v3
v_lshlrev_b32 v4, 4, v8
v_lshl_add_u32 v4, v9, 11, v4
v_lshlrev_b32 v5, 4, v8
v_and_b32 v10, 1, v9
v_lshl_add_u32 v5, v10, 3, v5
v_lshlrev_b32 v6, 4, v0
v_lshlrev_b32 v10, 2, v9
v_add_u32 v11, 0, v10
v_cmp_le_u32 s[50:51], v11, v8
v_add_u32 v11, 1, v10
v_cmp_le_u32 s[52:53], v11, v8
v_add_u32 v11, 2, v10
v_cmp_le_u32 s[54:55], v11, v8
v_add_u32 v11, 3, v10
v_cmp_le_u32 s[56:57], v11, v8
s_mov_b32 s58, -1
s_mov_b32 s59, 0
s_load_dwordx2 s[16:17], s[0:1], 0
s_mov_b32 s18, 2359296
s_waitcnt lgkmcnt(0)
s_load_dwordx2 s[20:21], s[0:1], 96
s_mov_b32 s22, 2359296
s_waitcnt lgkmcnt(0)
s_cmp_lg_u32 s11, 0
s_cbranch_scc1 L_wd_112
s_mov_b32 s60, 77598720
s_mov_b32 s63, 16
s_mov_b32 s61, 0
v_min_u32 v1, 15, v0
v_lshlrev_b32 v1, 7, v1
L_wp_113:
buffer_load_dword v250, v1, s[12:15], s60 offen sc1
s_waitcnt vmcnt(0)
v_cmp_gt_u32 vcc, s63, v250
s_cbranch_vccz L_wd_112
s_add_u32 s61, s61, 1
s_cmp_gt_u32 s61, 4000000
s_cbranch_scc1 L_abortw
s_sleep 1
s_branch L_wp_113
L_wd_112:
s_barrier
s_cmp_lg_u32 s11, 0
s_cbranch_scc1 L_wd_114
s_mov_b32 s60, 77596672
s_mov_b32 s63, 64
s_mov_b32 s61, 0
v_min_u32 v1, 15, v0
v_lshlrev_b32 v1, 7, v1
L_wp_115:
buffer_load_dword v250, v1, s[12:15], s60 offen sc1
s_waitcnt vmcnt(0)
v_cmp_gt_u32 vcc, s63, v250
s_cbranch_vccz L_wd_114
s_add_u32 s61, s61, 1
s_cmp_gt_u32 s61, 4000000
s_cbranch_scc1 L_abortw
s_sleep 1
s_branch L_wp_115
L_wd_114:
s_barrier
s_cmp_lg_u32 s11, 0
s_cbranch_scc1 L_wd_116
s_mov_b32 s60, 77602304
s_mov_b32 s63, 12
s_mov_b32 s61, 0
v_min_u32 v1, 15, v0
v_lshlrev_b32 v1, 7, v1
L_wp_117:
buffer_load_dword v250, v1, s[12:15], s60 offen sc1
s_waitcnt vmcnt(0)
v_cmp_gt_u32 vcc, s63, v250
s_cbranch_vccz L_wd_116
s_add_u32 s61, s61, 1
s_cmp_gt_u32 s61, 4000000
s_cbranch_scc1 L_abortw
s_sleep 1
s_branch L_wp_117
L_wd_116:
s_barrier
L_p4loop:
s_cmp_lt_i32 s47, 0
s_cbranch_scc1 L_cs_118
s_lshl_b32 s24, s47, 7
s_add_u32 s24, s24, 77604864
s_cmp_lg_u32 s11, 0
s_cbranch_scc1 L_wd_119
s_mov_b32 s60, s24
s_mov_b32 s61, 0
L_wp_120:
buffer_load_dword v1, off, s[12:15], s60 sc1
s_waitcnt vmcnt(0)
v_readfirstlane_b32 s62, v1
s_nop 0
s_cmp_ge_u32 s62, 32
s_cbranch_scc1 L_wd_119
s_add_u32 s61, s61, 1
s_cmp_gt_u32 s61, 4000000
s_cbranch_scc1 L_abortw
s_sleep 1
s_branch L_wp_120
L_wd_119:
s_barrier
s_lshl_b32 s32, s43, 2
s_add_u32 s32, s32, s11
s_cmp_ge_u32 s32, 18
s_cbranch_scc1 L_cs_118
s_cmp_ge_u32 s32, 9
s_cselect_b32 s33, 1, 0
s_mul_i32 s34, s33, 9
s_sub_u32 s32, s32, s34
s_lshl_b32 s45, s47, 1
s_add_u32 s45, s45, s33
s_mul_i32 s46, s44, 9
s_add_u32 s46, s46, s32
s_mul_i32 s24, s45, 36864
s_lshl_b32 s25, s46, 10
s_add_u32 s24, s24, s25
s_add_u32 s24, s24, 100663296
v_lshlrev_b32 v8, 4, v0
buffer_load_dwordx4 v[32:35], v8, s[12:15], s24 offen sc1
s_add_u32 s24, s24, 4718592
buffer_load_dwordx4 v[36:39], v8, s[12:15], s24 offen sc1
s_add_u32 s24, s24, 4718592
buffer_load_dwordx4 v[40:43], v8, s[12:15], s24 offen sc1
s_add_u32 s24, s24, 4718592
buffer_load_dwordx4 v[44:47], v8, s[12:15], s24 offen sc1
s_add_u32 s24, s24, 4718592
buffer_load_dwordx4 v[48:51], v8, s[12:15], s24 offen sc1
s_add_u32 s24, s24, 4718592
buffer_load_dwordx4 v[52:55], v8, s[12:15], s24 offen sc1
s_add_u32 s24, s24, 4718592
buffer_load_dwordx4 v[56:59], v8, s[12:15], s24 offen sc1
s_add_u32 s24, s24, 4718592
buffer_load_dwordx4 v[60:63], v8, s[12:15], s24 offen sc1
s_add_u32 s24, s24, 4718592
buffer_load_dwordx4 v[64:67], v8, s[12:15], s24 offen sc1
s_add_u32 s24, s24, 4718592
buffer_load_dwordx4 v[68:71], v8, s[12:15], s24 offen sc1
s_add_u32 s24, s24, 4718592
buffer_load_dwordx4 v[72:75], v8, s[12:15], s24 offen sc1
s_add_u32 s24, s24, 4718592
buffer_load_dwordx4 v[76:79], v8, s[12:15], s24 offen sc1
s_add_u32 s24, s24, 4718592
v_and_b32 v9, 15, v0
v_mul_u32_u24 v9, 1152, v9
v_lshrrev_b32 v10, 4, v0
v_lshl_add_u32 v9, v10, 3, v9
s_mul_i32 s24, s45, 18432
s_lshl_b32 s25, s46, 5
s_add_u32 s24, s24, s25
buffer_load_dwordx2 v[12:13], v9, s[16:19], s24 offen
s_waitcnt vmcnt(0)
v_add_f32 v32, v32, v36
v_add_f32 v33, v33, v37
v_add_f32 v34, v34, v38
v_add_f32 v35, v35, v39
v_add_f32 v32, v32, v40
v_add_f32 v33, v33, v41
v_add_f32 v34, v34, v42
v_add_f32 v35, v35, v43
v_add_f32 v32, v32, v44
v_add_f32 v33, v33, v45
v_add_f32 v34, v34, v46
v_add_f32 v35, v35, v47
v_add_f32 v32, v32, v48
v_add_f32 v33, v33, v49
v_add_f32 v34, v34, v50
v_add_f32 v35, v35, v51
v_add_f32 v32, v32, v52
v_add_f32 v33, v33, v53
v_add_f32 v34, v34, v54
v_add_f32 v35, v35, v55
v_add_f32 v32, v32, v56
v_add_f32 v33, v33, v57
v_add_f32 v34, v34, v58
v_add_f32 v35, v35, v59
v_add_f32 v32, v32, v60
v_add_f32 v33, v33, v61
v_add_f32 v34, v34, v62
v_add_f32 v35, v35, v63
v_add_f32 v32, v32, v64
v_add_f32 v33, v33, v65
v_add_f32 v34, v34, v66
v_add_f32 v35, v35, v67
v_add_f32 v32, v32, v68
v_add_f32 v33, v33, v69
v_add_f32 v34, v34, v70
v_add_f32 v35, v35, v71
v_add_f32 v32, v32, v72
v_add_f32 v33, v33, v73
v_add_f32 v34, v34, v74
v_add_f32 v35, v35, v75
v_add_f32 v32, v32, v76
v_add_f32 v33, v33, v77
v_add_f32 v34, v34, v78
v_add_f32 v35, v35, v79
v_lshlrev_b32 v14, 16, v12
v_and_b32 v15, 0xffff0000, v12
v_lshlrev_b32 v16, 16, v13
v_and_b32 v17, 0xffff0000, v13
v_add_f32 v32, v32, v14
v_add_f32 v33, v33, v15
v_add_f32 v34, v34, v16
v_add_f32 v35, v35, v17
v_cvt_pk_bf16_f32 v12, v32, v33
v_cvt_pk_bf16_f32 v13, v34, v35
buffer_store_dwordx2 v[12:13], v9, s[20:23], s24 offen
L_cs_118:
s_mov_b32 s45, s48
s_lshl_b32 s24, s43, 2
s_add_u32 s24, s24, s11
s_lshl_b32 s25, s45, 5
s_add_u32 s24, s24, s25
s_lshl_b32 s25, s24, 13
s_add_u32 s26, s25, 50331648
s_add_u32 s27, s25, 16777216
s_add_u32 s28, s25, 33554432
s_lshl_b32 s25, s24, 11
s_add_u32 s29, s25, 67108864
s_add_u32 s30, s25, 71303168
s_add_u32 s31, s26, 0
s_add_u32 s32, s27, 0
buffer_load_dwordx4 v[32:35], v2, s[12:15], s31 offen offset:0 sc1
buffer_load_dwordx4 v[64:67], v2, s[12:15], s32 offen offset:0 sc1
buffer_load_dwordx4 v[48:51], v2, s[12:15], s31 offen offset:256 sc1
buffer_load_dwordx4 v[80:83], v2, s[12:15], s32 offen offset:256 sc1
s_add_u32 s31, s26, 2048
s_add_u32 s32, s27, 2048
buffer_load_dwordx4 v[36:39], v2, s[12:15], s31 offen offset:0 sc1
buffer_load_dwordx4 v[68:71], v2, s[12:15], s32 offen offset:0 sc1
buffer_load_dwordx4 v[52:55], v2, s[12:15], s31 offen offset:256 sc1
buffer_load_dwordx4 v[84:87], v2, s[12:15], s32 offen offset:256 sc1
s_add_u32 s31, s26, 4096
s_add_u32 s32, s27, 4096
buffer_load_dwordx4 v[40:43], v2, s[12:15], s31 offen offset:0 sc1
buffer_load_dwordx4 v[72:75], v2, s[12:15], s32 offen offset:0 sc1
buffer_load_dwordx4 v[56:59], v2, s[12:15], s31 offen offset:256 sc1
buffer_load_dwordx4 v[88:91], v2, s[12:15], s32 offen offset:256 sc1
s_add_u32 s31, s26, 6144
s_add_u32 s32, s27, 6144
buffer_load_dwordx4 v[44:47], v2, s[12:15], s31 offen offset:0 sc1
buffer_load_dwordx4 v[76:79], v2, s[12:15], s32 offen offset:0 sc1
buffer_load_dwordx4 v[60:63], v2, s[12:15], s31 offen offset:256 sc1
buffer_load_dwordx4 v[92:95], v2, s[12:15], s32 offen offset:256 sc1
buffer_load_dwordx4 v[112:115], v4, s[12:15], s28 offen offset:0 sc1
buffer_load_dwordx4 v[116:119], v4, s[12:15], s28 offen offset:256 sc1
buffer_load_dwordx4 v[120:123], v4, s[12:15], s28 offen offset:512 sc1
buffer_load_dwordx4 v[124:127], v4, s[12:15], s28 offen offset:768 sc1
buffer_load_dwordx4 v[128:131], v4, s[12:15], s28 offen offset:1024 sc1
buffer_load_dwordx4 v[132:135], v4, s[12:15], s28 offen offset:1280 sc1
buffer_load_dwordx4 v[136:139], v4, s[12:15], s28 offen offset:1536 sc1
buffer_load_dwordx4 v[140:143], v4, s[12:15], s28 offen offset:1792 sc1
s_lshl_b32 s68, s43, 9
s_add_u32 s68, s68, 77613056
s_add_u32 s69, s48, 1
s_cmp_lg_u32 s11, 0
s_cbranch_scc1 L_wd_121
s_mov_b32 s60, s68
s_mov_b32 s63, s69
s_mov_b32 s61, 0
v_min_u32 v1, 3, v0
v_lshlrev_b32 v1, 7, v1
L_wp_122:
buffer_load_dword v250, v1, s[12:15], s60 offen sc1
s_waitcnt vmcnt(0)
v_cmp_gt_u32 vcc, s63, v250
s_cbranch_vccz L_wd_121
s_add_u32 s61, s61, 1
s_cmp_gt_u32 s61, 4000000
s_cbranch_scc1 L_abortw
s_sleep 1
s_branch L_wp_122
L_wd_121:
s_barrier
buffer_load_dwordx4 v[96:99], v3, s[12:15], s29 offen offset:0 sc1
buffer_load_dwordx4 v[100:103], v3, s[12:15], s29 offen offset:64 sc1
buffer_load_dwordx4 v[104:107], v3, s[12:15], s29 offen offset:128 sc1
buffer_load_dwordx4 v[108:111], v3, s[12:15], s29 offen offset:192 sc1
buffer_load_dwordx2 v[144:145], v5, s[12:15], s30 offen offset:0 sc1
buffer_load_dwordx2 v[146:147], v5, s[12:15], s30 offen offset:256 sc1
buffer_load_dwordx2 v[148:149], v5, s[12:15], s30 offen offset:512 sc1
buffer_load_dwordx2 v[150:151], v5, s[12:15], s30 offen offset:768 sc1
buffer_load_dwordx2 v[152:153], v5, s[12:15], s30 offen offset:1024 sc1
buffer_load_dwordx2 v[154:155], v5, s[12:15], s30 offen offset:1280 sc1
buffer_load_dwordx2 v[156:157], v5, s[12:15], s30 offen offset:1536 sc1
buffer_load_dwordx2 v[158:159], v5, s[12:15], s30 offen offset:1792 sc1
s_waitcnt vmcnt(8)
v_mfma_f32_16x16x32_bf16 v[160:163], v[96:99], v[32:35], 0
v_mfma_f32_16x16x32_bf16 v[164:167], v[64:67], v[32:35], 0
v_mfma_f32_16x16x32_bf16 v[160:163], v[100:103], v[36:39], v[160:163]
v_mfma_f32_16x16x32_bf16 v[164:167], v[68:71], v[36:39], v[164:167]
v_mfma_f32_16x16x32_bf16 v[160:163], v[104:107], v[40:43], v[160:163]
v_mfma_f32_16x16x32_bf16 v[164:167], v[72:75], v[40:43], v[164:167]
v_mfma_f32_16x16x32_bf16 v[160:163], v[108:111], v[44:47], v[160:163]
v_mfma_f32_16x16x32_bf16 v[164:167], v[76:79], v[44:47], v[164:167]
v_mfma_f32_16x16x32_bf16 v[172:175], v[96:99], v[48:51], 0
v_mfma_f32_16x16x32_bf16 v[176:179], v[64:67], v[48:51], 0
v_mfma_f32_16x16x32_bf16 v[180:183], v[80:83], v[48:51], 0
v_mfma_f32_16x16x32_bf16 v[172:175], v[100:103], v[52:55], v[172:175]
v_mfma_f32_16x16x32_bf16 v[176:179], v[68:71], v[52:55], v[176:179]
v_mfma_f32_16x16x32_bf16 v[180:183], v[84:87], v[52:55], v[180:183]
v_mfma_f32_16x16x32_bf16 v[172:175], v[104:107], v[56:59], v[172:175]
v_mfma_f32_16x16x32_bf16 v[176:179], v[72:75], v[56:59], v[176:179]
v_mfma_f32_16x16x32_bf16 v[180:183], v[88:91], v[56:59], v[180:183]
v_mfma_f32_16x16x32_bf16 v[172:175], v[108:111], v[60:63], v[172:175]
v_mfma_f32_16x16x32_bf16 v[176:179], v[76:79], v[60:63], v[176:179]
v_mfma_f32_16x16x32_bf16 v[180:183], v[92:95], v[60:63], v[180:183]
s_mov_b32 s31, 0x3e0293ee
v_mov_b32 v15, 0xff800000
v_cndmask_b32 v160, v15, v160, s[58:59]
v_cndmask_b32 v164, v15, v164, s[50:51]
v_cndmask_b32 v161, v15, v161, s[58:59]
v_cndmask_b32 v165, v15, v165, s[52:53]
v_cndmask_b32 v162, v15, v162, s[58:59]
v_cndmask_b32 v166, v15, v166, s[54:55]
v_cndmask_b32 v163, v15, v163, s[58:59]
v_cndmask_b32 v167, v15, v167, s[56:57]
v_max3_f32 v8, v160, v161, v162
v_max3_f32 v9, v163, v164, v165
v_max3_f32 v8, v8, v166, v167
v_max_f32 v8, v8, v9
v_mov_b32 v9, v8
s_nop 1
v_permlane32_swap_b32 v8, v9
v_max_f32 v8, v8, v9
v_mov_b32 v9, v8
s_nop 1
v_permlane16_swap_b32 v8, v9
v_max_f32 v8, v8, v9
v_mul_f32 v9, s31, v8
v_fma_f32 v160, v160, s31, -v9
v_fma_f32 v161, v161, s31, -v9
v_fma_f32 v162, v162, s31, -v9
v_fma_f32 v163, v163, s31, -v9
v_fma_f32 v164, v164, s31, -v9
v_fma_f32 v165, v165, s31, -v9
v_fma_f32 v166, v166, s31, -v9
v_fma_f32 v167, v167, s31, -v9
v_exp_f32 v160, v160
v_exp_f32 v161, v161
v_exp_f32 v162, v162
v_exp_f32 v163, v163
v_exp_f32 v164, v164
v_exp_f32 v165, v165
v_exp_f32 v166, v166
v_exp_f32 v167, v167
v_add_f32 v12, v160, v161
v_add_f32 v12, v12, v162
v_add_f32 v12, v12, v163
v_add_f32 v12, v12, v164
v_add_f32 v12, v12, v165
v_add_f32 v12, v12, v166
v_add_f32 v12, v12, v167
v_mov_b32 v10, v12
s_nop 1
v_permlane32_swap_b32 v12, v10
v_add_f32 v12, v12, v10
v_mov_b32 v10, v12
s_nop 1
v_permlane16_swap_b32 v12, v10
v_add_f32 v12, v12, v10
v_rcp_f32 v12, v12
v_cvt_pk_bf16_f32 v16, v164, v165
v_cvt_pk_bf16_f32 v17, v166, v167
v_mov_b32 v18, 0
v_mov_b32 v19, 0
v_cvt_pk_bf16_f32 v20, v160, v161
v_cvt_pk_bf16_f32 v21, v162, v163
v_cndmask_b32 v172, v15, v172, s[58:59]
v_cndmask_b32 v180, v15, v180, s[50:51]
v_cndmask_b32 v173, v15, v173, s[58:59]
v_cndmask_b32 v181, v15, v181, s[52:53]
v_cndmask_b32 v174, v15, v174, s[58:59]
v_cndmask_b32 v182, v15, v182, s[54:55]
v_cndmask_b32 v175, v15, v175, s[58:59]
v_cndmask_b32 v183, v15, v183, s[56:57]
v_max3_f32 v8, v172, v173, v174
v_max3_f32 v9, v175, v176, v177
v_max3_f32 v8, v8, v178, v179
v_max3_f32 v9, v9, v180, v181
v_max3_f32 v8, v8, v182, v183
v_max_f32 v8, v8, v9
v_mov_b32 v9, v8
s_nop 1
v_permlane32_swap_b32 v8, v9
v_max_f32 v8, v8, v9
v_mov_b32 v9, v8
s_nop 1
v_permlane16_swap_b32 v8, v9
v_max_f32 v8, v8, v9
v_mul_f32 v9, s31, v8
v_fma_f32 v172, v172, s31, -v9
v_fma_f32 v173, v173, s31, -v9
v_fma_f32 v174, v174, s31, -v9
v_fma_f32 v175, v175, s31, -v9
v_fma_f32 v176, v176, s31, -v9
v_fma_f32 v177, v177, s31, -v9
v_fma_f32 v178, v178, s31, -v9
v_fma_f32 v179, v179, s31, -v9
v_fma_f32 v180, v180, s31, -v9
v_fma_f32 v181, v181, s31, -v9
v_fma_f32 v182, v182, s31, -v9
v_fma_f32 v183, v183, s31, -v9
v_exp_f32 v172, v172
v_exp_f32 v173, v173
v_exp_f32 v174, v174
v_exp_f32 v175, v175
v_exp_f32 v176, v176
v_exp_f32 v177, v177
v_exp_f32 v178, v178
v_exp_f32 v179, v179
v_exp_f32 v180, v180
v_exp_f32 v181, v181
v_exp_f32 v182, v182
v_exp_f32 v183, v183
v_add_f32 v13, v172, v173
v_add_f32 v13, v13, v174
v_add_f32 v13, v13, v175
v_add_f32 v13, v13, v176
v_add_f32 v13, v13, v177
v_add_f32 v13, v13, v178
v_add_f32 v13, v13, v179
v_add_f32 v13, v13, v180
v_add_f32 v13, v13, v181
v_add_f32 v13, v13, v182
v_add_f32 v13, v13, v183
v_mov_b32 v10, v13
s_nop 1
v_permlane32_swap_b32 v13, v10
v_add_f32 v13, v13, v10
v_mov_b32 v10, v13
s_nop 1
v_permlane16_swap_b32 v13, v10
v_add_f32 v13, v13, v10
v_rcp_f32 v13, v13
v_cvt_pk_bf16_f32 v24, v176, v177
v_cvt_pk_bf16_f32 v25, v178, v179
v_cvt_pk_bf16_f32 v26, v180, v181
v_cvt_pk_bf16_f32 v27, v182, v183
v_cvt_pk_bf16_f32 v28, v172, v173
v_cvt_pk_bf16_f32 v29, v174, v175
s_waitcnt vmcnt(0)
v_mfma_f32_16x16x32_bf16 v[184:187], v[112:115], v[16:19], 0
v_mfma_f32_16x16x32_bf16 v[188:191], v[112:115], v[24:27], 0
v_mfma_f32_16x16x32_bf16 v[192:195], v[116:119], v[16:19], 0
v_mfma_f32_16x16x32_bf16 v[196:199], v[116:119], v[24:27], 0
v_mfma_f32_16x16x32_bf16 v[200:203], v[120:123], v[16:19], 0
v_mfma_f32_16x16x32_bf16 v[204:207], v[120:123], v[24:27], 0
v_mfma_f32_16x16x32_bf16 v[208:211], v[124:127], v[16:19], 0
v_mfma_f32_16x16x32_bf16 v[212:215], v[124:127], v[24:27], 0
v_mfma_f32_16x16x32_bf16 v[216:219], v[128:131], v[16:19], 0
v_mfma_f32_16x16x32_bf16 v[220:223], v[128:131], v[24:27], 0
v_mfma_f32_16x16x32_bf16 v[224:227], v[132:135], v[16:19], 0
v_mfma_f32_16x16x32_bf16 v[228:231], v[132:135], v[24:27], 0
v_mfma_f32_16x16x32_bf16 v[232:235], v[136:139], v[16:19], 0
v_mfma_f32_16x16x32_bf16 v[236:239], v[136:139], v[24:27], 0
v_mfma_f32_16x16x32_bf16 v[240:243], v[140:143], v[16:19], 0
v_mfma_f32_16x16x32_bf16 v[244:247], v[140:143], v[24:27], 0
v_mfma_f32_16x16x16_bf16 v[184:187], v[144:145], v[20:21], v[184:187]
v_mfma_f32_16x16x16_bf16 v[188:191], v[144:145], v[28:29], v[188:191]
v_mfma_f32_16x16x16_bf16 v[192:195], v[146:147], v[20:21], v[192:195]
v_mfma_f32_16x16x16_bf16 v[196:199], v[146:147], v[28:29], v[196:199]
v_mfma_f32_16x16x16_bf16 v[200:203], v[148:149], v[20:21], v[200:203]
v_mfma_f32_16x16x16_bf16 v[204:207], v[148:149], v[28:29], v[204:207]
v_mfma_f32_16x16x16_bf16 v[208:211], v[150:151], v[20:21], v[208:211]
v_mfma_f32_16x16x16_bf16 v[212:215], v[150:151], v[28:29], v[212:215]
v_mfma_f32_16x16x16_bf16 v[216:219], v[152:153], v[20:21], v[216:219]
v_mfma_f32_16x16x16_bf16 v[220:223], v[152:153], v[28:29], v[220:223]
v_mfma_f32_16x16x16_bf16 v[224:227], v[154:155], v[20:21], v[224:227]
v_mfma_f32_16x16x16_bf16 v[228:231], v[154:155], v[28:29], v[228:231]
v_mfma_f32_16x16x16_bf16 v[232:235], v[156:157], v[20:21], v[232:235]
v_mfma_f32_16x16x16_bf16 v[236:239], v[156:157], v[28:29], v[236:239]
v_mfma_f32_16x16x16_bf16 v[240:243], v[158:159], v[20:21], v[240:243]
v_mfma_f32_16x16x16_bf16 v[244:247], v[158:159], v[28:29], v[244:247]
s_lshl_b32 s24, s11, 13
v_add_u32 v14, s24, v6
v_mul_f32 v184, v184, v12
v_mul_f32 v192, v192, v12
v_mul_f32 v185, v185, v12
v_mul_f32 v193, v193, v12
v_mul_f32 v186, v186, v12
v_mul_f32 v194, v194, v12
v_mul_f32 v187, v187, v12
v_mul_f32 v195, v195, v12
v_cvt_pk_bf16_f32 v32, v184, v185
v_cvt_pk_bf16_f32 v33, v186, v187
v_cvt_pk_bf16_f32 v34, v192, v193
v_cvt_pk_bf16_f32 v35, v194, v195
ds_write_b128 v14, v[32:35] offset:0
v_mul_f32 v188, v188, v13
v_mul_f32 v196, v196, v13
v_mul_f32 v189, v189, v13
v_mul_f32 v197, v197, v13
v_mul_f32 v190, v190, v13
v_mul_f32 v198, v198, v13
v_mul_f32 v191, v191, v13
v_mul_f32 v199, v199, v13
v_cvt_pk_bf16_f32 v36, v188, v189
v_cvt_pk_bf16_f32 v37, v190, v191
v_cvt_pk_bf16_f32 v38, v196, v197
v_cvt_pk_bf16_f32 v39, v198, v199
ds_write_b128 v14, v[36:39] offset:1024
v_mul_f32 v200, v200, v12
v_mul_f32 v208, v208, v12
v_mul_f32 v201, v201, v12
v_mul_f32 v209, v209, v12
v_mul_f32 v202, v202, v12
v_mul_f32 v210, v210, v12
v_mul_f32 v203, v203, v12
v_mul_f32 v211, v211, v12
v_cvt_pk_bf16_f32 v40, v200, v201
v_cvt_pk_bf16_f32 v41, v202, v203
v_cvt_pk_bf16_f32 v42, v208, v209
v_cvt_pk_bf16_f32 v43, v210, v211
ds_write_b128 v14, v[40:43] offset:2048
v_mul_f32 v204, v204, v13
v_mul_f32 v212, v212, v13
v_mul_f32 v205, v205, v13
v_mul_f32 v213, v213, v13
v_mul_f32 v206, v206, v13
v_mul_f32 v214, v214, v13
v_mul_f32 v207, v207, v13
v_mul_f32 v215, v215, v13
v_cvt_pk_bf16_f32 v44, v204, v205
v_cvt_pk_bf16_f32 v45, v206, v207
v_cvt_pk_bf16_f32 v46, v212, v213
v_cvt_pk_bf16_f32 v47, v214, v215
ds_write_b128 v14, v[44:47] offset:3072
v_mul_f32 v216, v216, v12
v_mul_f32 v224, v224, v12
v_mul_f32 v217, v217, v12
v_mul_f32 v225, v225, v12
v_mul_f32 v218, v218, v12
v_mul_f32 v226, v226, v12
v_mul_f32 v219, v219, v12
v_mul_f32 v227, v227, v12
v_cvt_pk_bf16_f32 v48, v216, v217
v_cvt_pk_bf16_f32 v49, v218, v219
v_cvt_pk_bf16_f32 v50, v224, v225
v_cvt_pk_bf16_f32 v51, v226, v227
ds_write_b128 v14, v[48:51] offset:4096
v_mul_f32 v220, v220, v13
v_mul_f32 v228, v228, v13
v_mul_f32 v221, v221, v13
v_mul_f32 v229, v229, v13
v_mul_f32 v222, v222, v13
v_mul_f32 v230, v230, v13
v_mul_f32 v223, v223, v13
v_mul_f32 v231, v231, v13
v_cvt_pk_bf16_f32 v52, v220, v221
v_cvt_pk_bf16_f32 v53, v222, v223
v_cvt_pk_bf16_f32 v54, v228, v229
v_cvt_pk_bf16_f32 v55, v230, v231
ds_write_b128 v14, v[52:55] offset:5120
v_mul_f32 v232, v232, v12
v_mul_f32 v240, v240, v12
v_mul_f32 v233, v233, v12
v_mul_f32 v241, v241, v12
v_mul_f32 v234, v234, v12
v_mul_f32 v242, v242, v12
v_mul_f32 v235, v235, v12
v_mul_f32 v243, v243, v12
v_cvt_pk_bf16_f32 v56, v232, v233
v_cvt_pk_bf16_f32 v57, v234, v235
v_cvt_pk_bf16_f32 v58, v240, v241
v_cvt_pk_bf16_f32 v59, v242, v243
ds_write_b128 v14, v[56:59] offset:6144
v_mul_f32 v236, v236, v13
v_mul_f32 v244, v244, v13
v_mul_f32 v237, v237, v13
v_mul_f32 v245, v245, v13
v_mul_f32 v238, v238, v13
v_mul_f32 v246, v246, v13
v_mul_f32 v239, v239, v13
v_mul_f32 v247, v247, v13
v_cvt_pk_bf16_f32 v60, v236, v237
v_cvt_pk_bf16_f32 v61, v238, v239
v_cvt_pk_bf16_f32 v62, v244, v245
v_cvt_pk_bf16_f32 v63, v246, v247
ds_write_b128 v14, v[60:63] offset:7168
s_waitcnt lgkmcnt(0)
s_barrier
s_mul_i32 s41, s43, 4718592
s_mul_i32 s24, s45, 73728
s_add_u32 s41, s41, s24
s_mul_i32 s24, s44, 9216
s_add_u32 s41, s41, s24
s_add_u32 s41, s41, 100663296
s_cmp_lg_u32 s11, 0
s_cbranch_scc1 L_op_123
ds_read_b128 v[64:67], v6 offset:0
ds_read_b128 v[68:71], v6 offset:1024
ds_read_b128 v[72:75], v6 offset:2048
ds_read_b128 v[76:79], v6 offset:3072
ds_read_b128 v[80:83], v6 offset:4096
ds_read_b128 v[84:87], v6 offset:5120
ds_read_b128 v[88:91], v6 offset:6144
ds_read_b128 v[92:95], v6 offset:7168
s_waitcnt lgkmcnt(6)
v_mfma_f32_16x16x32_bf16 v[160:163], a[0:3], v[64:67], 0
v_mfma_f32_16x16x32_bf16 v[164:167], a[0:3], v[68:71], 0
v_mfma_f32_16x16x32_bf16 v[168:171], a[64:67], v[64:67], 0
v_mfma_f32_16x16x32_bf16 v[172:175], a[64:67], v[68:71], 0
v_mfma_f32_16x16x32_bf16 v[176:179], a[128:131], v[64:67], 0
ds_read_b128 v[64:67], v6 offset:8192
ds_read_b128 v[68:71], v6 offset:9216
s_waitcnt lgkmcnt(6)
v_mfma_f32_16x16x32_bf16 v[160:163], a[4:7], v[72:75], v[160:163]
v_mfma_f32_16x16x32_bf16 v[164:167], a[4:7], v[76:79], v[164:167]
v_mfma_f32_16x16x32_bf16 v[168:171], a[68:71], v[72:75], v[168:171]
v_mfma_f32_16x16x32_bf16 v[172:175], a[68:71], v[76:79], v[172:175]
v_mfma_f32_16x16x32_bf16 v[176:179], a[132:135], v[72:75], v[176:179]
ds_read_b128 v[72:75], v6 offset:10240
ds_read_b128 v[76:79], v6 offset:11264
s_waitcnt lgkmcnt(6)
v_mfma_f32_16x16x32_bf16 v[160:163], a[8:11], v[80:83], v[160:163]
v_mfma_f32_16x16x32_bf16 v[164:167], a[8:11], v[84:87], v[164:167]
v_mfma_f32_16x16x32_bf16 v[168:171], a[72:75], v[80:83], v[168:171]
v_mfma_f32_16x16x32_bf16 v[172:175], a[72:75], v[84:87], v[172:175]
v_mfma_f32_16x16x32_bf16 v[176:179], a[136:139], v[80:83], v[176:179]
ds_read_b128 v[80:83], v6 offset:12288
ds_read_b128 v[84:87], v6 offset:13312
s_waitcnt lgkmcnt(6)
v_mfma_f32_16x16x32_bf16 v[160:163], a[12:15], v[88:91], v[160:163]
v_mfma_f32_16x16x32_bf16 v[164:167], a[12:15], v[92:95], v[164:167]
v_mfma_f32_16x16x32_bf16 v[168:171], a[76:79], v[88:91], v[168:171]
v_mfma_f32_16x16x32_bf16 v[172:175], a[76:79], v[92:95], v[172:175]
v_mfma_f32_16x16x32_bf16 v[176:179], a[140:143], v[88:91], v[176:179]
ds_read_b128 v[88:91], v6 offset:14336
ds_read_b128 v[92:95], v6 offset:15360
s_waitcnt lgkmcnt(6)
v_mfma_f32_16x16x32_bf16 v[160:163], a[16:19], v[64:67], v[160:163]
v_mfma_f32_16x16x32_bf16 v[164:167], a[16:19], v[68:71], v[164:167]
v_mfma_f32_16x16x32_bf16 v[168:171], a[80:83], v[64:67], v[168:171]
v_mfma_f32_16x16x32_bf16 v[172:175], a[80:83], v[68:71], v[172:175]
v_mfma_f32_16x16x32_bf16 v[176:179], a[144:147], v[64:67], v[176:179]
ds_read_b128 v[64:67], v6 offset:16384
ds_read_b128 v[68:71], v6 offset:17408
s_waitcnt lgkmcnt(6)
v_mfma_f32_16x16x32_bf16 v[160:163], a[20:23], v[72:75], v[160:163]
v_mfma_f32_16x16x32_bf16 v[164:167], a[20:23], v[76:79], v[164:167]
v_mfma_f32_16x16x32_bf16 v[168:171], a[84:87], v[72:75], v[168:171]
v_mfma_f32_16x16x32_bf16 v[172:175], a[84:87], v[76:79], v[172:175]
v_mfma_f32_16x16x32_bf16 v[176:179], a[148:151], v[72:75], v[176:179]
ds_read_b128 v[72:75], v6 offset:18432
ds_read_b128 v[76:79], v6 offset:19456
s_waitcnt lgkmcnt(6)
v_mfma_f32_16x16x32_bf16 v[160:163], a[24:27], v[80:83], v[160:163]
v_mfma_f32_16x16x32_bf16 v[164:167], a[24:27], v[84:87], v[164:167]
v_mfma_f32_16x16x32_bf16 v[168:171], a[88:91], v[80:83], v[168:171]
v_mfma_f32_16x16x32_bf16 v[172:175], a[88:91], v[84:87], v[172:175]
v_mfma_f32_16x16x32_bf16 v[176:179], a[152:155], v[80:83], v[176:179]
ds_read_b128 v[80:83], v6 offset:20480
ds_read_b128 v[84:87], v6 offset:21504
s_waitcnt lgkmcnt(6)
v_mfma_f32_16x16x32_bf16 v[160:163], a[28:31], v[88:91], v[160:163]
v_mfma_f32_16x16x32_bf16 v[164:167], a[28:31], v[92:95], v[164:167]
v_mfma_f32_16x16x32_bf16 v[168:171], a[92:95], v[88:91], v[168:171]
v_mfma_f32_16x16x32_bf16 v[172:175], a[92:95], v[92:95], v[172:175]
v_mfma_f32_16x16x32_bf16 v[176:179], a[156:159], v[88:91], v[176:179]
ds_read_b128 v[88:91], v6 offset:22528
ds_read_b128 v[92:95], v6 offset:23552
s_waitcnt lgkmcnt(6)
v_mfma_f32_16x16x32_bf16 v[160:163], a[32:35], v[64:67], v[160:163]
v_mfma_f32_16x16x32_bf16 v[164:167], a[32:35], v[68:71], v[164:167]
v_mfma_f32_16x16x32_bf16 v[168:171], a[96:99], v[64:67], v[168:171]
v_mfma_f32_16x16x32_bf16 v[172:175], a[96:99], v[68:71], v[172:175]
v_mfma_f32_16x16x32_bf16 v[176:179], a[160:163], v[64:67], v[176:179]
ds_read_b128 v[64:67], v6 offset:24576
ds_read_b128 v[68:71], v6 offset:25600
s_waitcnt lgkmcnt(6)
v_mfma_f32_16x16x32_bf16 v[160:163], a[36:39], v[72:75], v[160:163]
v_mfma_f32_16x16x32_bf16 v[164:167], a[36:39], v[76:79], v[164:167]
v_mfma_f32_16x16x32_bf16 v[168:171], a[100:103], v[72:75], v[168:171]
v_mfma_f32_16x16x32_bf16 v[172:175], a[100:103], v[76:79], v[172:175]
v_mfma_f32_16x16x32_bf16 v[176:179], a[164:167], v[72:75], v[176:179]
ds_read_b128 v[72:75], v6 offset:26624
ds_read_b128 v[76:79], v6 offset:27648
s_waitcnt lgkmcnt(6)
v_mfma_f32_16x16x32_bf16 v[160:163], a[40:43], v[80:83], v[160:163]
v_mfma_f32_16x16x32_bf16 v[164:167], a[40:43], v[84:87], v[164:167]
v_mfma_f32_16x16x32_bf16 v[168:171], a[104:107], v[80:83], v[168:171]
v_mfma_f32_16x16x32_bf16 v[172:175], a[104:107], v[84:87], v[172:175]
v_mfma_f32_16x16x32_bf16 v[176:179], a[168:171], v[80:83], v[176:179]
ds_read_b128 v[80:83], v6 offset:28672
ds_read_b128 v[84:87], v6 offset:29696
s_waitcnt lgkmcnt(6)
v_mfma_f32_16x16x32_bf16 v[160:163], a[44:47], v[88:91], v[160:163]
v_mfma_f32_16x16x32_bf16 v[164:167], a[44:47], v[92:95], v[164:167]
v_mfma_f32_16x16x32_bf16 v[168:171], a[108:111], v[88:91], v[168:171]
v_mfma_f32_16x16x32_bf16 v[172:175], a[108:111], v[92:95], v[172:175]
v_mfma_f32_16x16x32_bf16 v[176:179], a[172:175], v[88:91], v[176:179]
ds_read_b128 v[88:91], v6 offset:30720
ds_read_b128 v[92:95], v6 offset:31744
s_waitcnt lgkmcnt(6)
v_mfma_f32_16x16x32_bf16 v[160:163], a[48:51], v[64:67], v[160:163]
v_mfma_f32_16x16x32_bf16 v[164:167], a[48:51], v[68:71], v[164:167]
v_mfma_f32_16x16x32_bf16 v[168:171], a[112:115], v[64:67], v[168:171]
v_mfma_f32_16x16x32_bf16 v[172:175], a[112:115], v[68:71], v[172:175]
v_mfma_f32_16x16x32_bf16 v[176:179], a[176:179], v[64:67], v[176:179]
s_waitcnt lgkmcnt(4)
v_mfma_f32_16x16x32_bf16 v[160:163], a[52:55], v[72:75], v[160:163]
v_mfma_f32_16x16x32_bf16 v[164:167], a[52:55], v[76:79], v[164:167]
v_mfma_f32_16x16x32_bf16 v[168:171], a[116:119], v[72:75], v[168:171]
v_mfma_f32_16x16x32_bf16 v[172:175], a[116:119], v[76:79], v[172:175]
v_mfma_f32_16x16x32_bf16 v[176:179], a[180:183], v[72:75], v[176:179]
s_waitcnt lgkmcnt(2)
v_mfma_f32_16x16x32_bf16 v[160:163], a[56:59], v[80:83], v[160:163]
v_mfma_f32_16x16x32_bf16 v[164:167], a[56:59], v[84:87], v[164:167]
v_mfma_f32_16x16x32_bf16 v[168:171], a[120:123], v[80:83], v[168:171]
v_mfma_f32_16x16x32_bf16 v[172:175], a[120:123], v[84:87], v[172:175]
v_mfma_f32_16x16x32_bf16 v[176:179], a[184:187], v[80:83], v[176:179]
s_waitcnt lgkmcnt(0)
v_mfma_f32_16x16x32_bf16 v[160:163], a[60:63], v[88:91], v[160:163]
v_mfma_f32_16x16x32_bf16 v[164:167], a[60:63], v[92:95], v[164:167]
v_mfma_f32_16x16x32_bf16 v[168:171], a[124:127], v[88:91], v[168:171]
v_mfma_f32_16x16x32_bf16 v[172:175], a[124:127], v[92:95], v[172:175]
v_mfma_f32_16x16x32_bf16 v[176:179], a[188:191], v[88:91], v[176:179]
s_add_u32 s24, s41, 0
buffer_store_dwordx4 v[160:163], v6, s[12:15], s24 offen sc1
s_add_u32 s24, s41, 36864
buffer_store_dwordx4 v[164:167], v6, s[12:15], s24 offen sc1
s_add_u32 s24, s41, 1024
buffer_store_dwordx4 v[168:171], v6, s[12:15], s24 offen sc1
s_add_u32 s24, s41, 37888
buffer_store_dwordx4 v[172:175], v6, s[12:15], s24 offen sc1
s_add_u32 s24, s41, 8192
buffer_store_dwordx4 v[176:179], v6, s[12:15], s24 offen sc1
s_branch L_ope_127
L_op_123:
s_cmp_lg_u32 s11, 1
s_cbranch_scc1 L_op_124
ds_read_b128 v[64:67], v6 offset:0
ds_read_b128 v[68:71], v6 offset:1024
ds_read_b128 v[72:75], v6 offset:2048
ds_read_b128 v[76:79], v6 offset:3072
ds_read_b128 v[80:83], v6 offset:4096
ds_read_b128 v[84:87], v6 offset:5120
ds_read_b128 v[88:91], v6 offset:6144
ds_read_b128 v[92:95], v6 offset:7168
s_waitcnt lgkmcnt(6)
v_mfma_f32_16x16x32_bf16 v[160:163], a[0:3], v[64:67], 0
v_mfma_f32_16x16x32_bf16 v[164:167], a[0:3], v[68:71], 0
v_mfma_f32_16x16x32_bf16 v[168:171], a[64:67], v[64:67], 0
v_mfma_f32_16x16x32_bf16 v[172:175], a[64:67], v[68:71], 0
v_mfma_f32_16x16x32_bf16 v[176:179], a[128:131], v[68:71], 0
ds_read_b128 v[64:67], v6 offset:8192
ds_read_b128 v[68:71], v6 offset:9216
s_waitcnt lgkmcnt(6)
v_mfma_f32_16x16x32_bf16 v[160:163], a[4:7], v[72:75], v[160:163]
v_mfma_f32_16x16x32_bf16 v[164:167], a[4:7], v[76:79], v[164:167]
v_mfma_f32_16x16x32_bf16 v[168:171], a[68:71], v[72:75], v[168:171]
v_mfma_f32_16x16x32_bf16 v[172:175], a[68:71], v[76:79], v[172:175]
v_mfma_f32_16x16x32_bf16 v[176:179], a[132:135], v[76:79], v[176:179]
ds_read_b128 v[72:75], v6 offset:10240
ds_read_b128 v[76:79], v6 offset:11264
s_waitcnt lgkmcnt(6)
v_mfma_f32_16x16x32_bf16 v[160:163], a[8:11], v[80:83], v[160:163]
v_mfma_f32_16x16x32_bf16 v[164:167], a[8:11], v[84:87], v[164:167]
v_mfma_f32_16x16x32_bf16 v[168:171], a[72:75], v[80:83], v[168:171]
v_mfma_f32_16x16x32_bf16 v[172:175], a[72:75], v[84:87], v[172:175]
v_mfma_f32_16x16x32_bf16 v[176:179], a[136:139], v[84:87], v[176:179]
ds_read_b128 v[80:83], v6 offset:12288
ds_read_b128 v[84:87], v6 offset:13312
s_waitcnt lgkmcnt(6)
v_mfma_f32_16x16x32_bf16 v[160:163], a[12:15], v[88:91], v[160:163]
v_mfma_f32_16x16x32_bf16 v[164:167], a[12:15], v[92:95], v[164:167]
v_mfma_f32_16x16x32_bf16 v[168:171], a[76:79], v[88:91], v[168:171]
v_mfma_f32_16x16x32_bf16 v[172:175], a[76:79], v[92:95], v[172:175]
v_mfma_f32_16x16x32_bf16 v[176:179], a[140:143], v[92:95], v[176:179]
ds_read_b128 v[88:91], v6 offset:14336
ds_read_b128 v[92:95], v6 offset:15360
s_waitcnt lgkmcnt(6)
v_mfma_f32_16x16x32_bf16 v[160:163], a[16:19], v[64:67], v[160:163]
v_mfma_f32_16x16x32_bf16 v[164:167], a[16:19], v[68:71], v[164:167]
v_mfma_f32_16x16x32_bf16 v[168:171], a[80:83], v[64:67], v[168:171]
v_mfma_f32_16x16x32_bf16 v[172:175], a[80:83], v[68:71], v[172:175]
v_mfma_f32_16x16x32_bf16 v[176:179], a[144:147], v[68:71], v[176:179]
ds_read_b128 v[64:67], v6 offset:16384
ds_read_b128 v[68:71], v6 offset:17408
s_waitcnt lgkmcnt(6)
v_mfma_f32_16x16x32_bf16 v[160:163], a[20:23], v[72:75], v[160:163]
v_mfma_f32_16x16x32_bf16 v[164:167], a[20:23], v[76:79], v[164:167]
v_mfma_f32_16x16x32_bf16 v[168:171], a[84:87], v[72:75], v[168:171]
v_mfma_f32_16x16x32_bf16 v[172:175], a[84:87], v[76:79], v[172:175]
v_mfma_f32_16x16x32_bf16 v[176:179], a[148:151], v[76:79], v[176:179]
ds_read_b128 v[72:75], v6 offset:18432
ds_read_b128 v[76:79], v6 offset:19456
s_waitcnt lgkmcnt(6)
v_mfma_f32_16x16x32_bf16 v[160:163], a[24:27], v[80:83], v[160:163]
v_mfma_f32_16x16x32_bf16 v[164:167], a[24:27], v[84:87], v[164:167]
v_mfma_f32_16x16x32_bf16 v[168:171], a[88:91], v[80:83], v[168:171]
v_mfma_f32_16x16x32_bf16 v[172:175], a[88:91], v[84:87], v[172:175]
v_mfma_f32_16x16x32_bf16 v[176:179], a[152:155], v[84:87], v[176:179]
ds_read_b128 v[80:83], v6 offset:20480
ds_read_b128 v[84:87], v6 offset:21504
s_waitcnt lgkmcnt(6)
v_mfma_f32_16x16x32_bf16 v[160:163], a[28:31], v[88:91], v[160:163]
v_mfma_f32_16x16x32_bf16 v[164:167], a[28:31], v[92:95], v[164:167]
v_mfma_f32_16x16x32_bf16 v[168:171], a[92:95], v[88:91], v[168:171]
v_mfma_f32_16x16x32_bf16 v[172:175], a[92:95], v[92:95], v[172:175]
v_mfma_f32_16x16x32_bf16 v[176:179], a[156:159], v[92:95], v[176:179]
ds_read_b128 v[88:91], v6 offset:22528
ds_read_b128 v[92:95], v6 offset:23552
s_waitcnt lgkmcnt(6)
v_mfma_f32_16x16x32_bf16 v[160:163], a[32:35], v[64:67], v[160:163]
v_mfma_f32_16x16x32_bf16 v[164:167], a[32:35], v[68:71], v[164:167]
v_mfma_f32_16x16x32_bf16 v[168:171], a[96:99], v[64:67], v[168:171]
v_mfma_f32_16x16x32_bf16 v[172:175], a[96:99], v[68:71], v[172:175]
v_mfma_f32_16x16x32_bf16 v[176:179], a[160:163], v[68:71], v[176:179]
ds_read_b128 v[64:67], v6 offset:24576
ds_read_b128 v[68:71], v6 offset:25600
s_waitcnt lgkmcnt(6)
v_mfma_f32_16x16x32_bf16 v[160:163], a[36:39], v[72:75], v[160:163]
v_mfma_f32_16x16x32_bf16 v[164:167], a[36:39], v[76:79], v[164:167]
v_mfma_f32_16x16x32_bf16 v[168:171], a[100:103], v[72:75], v[168:171]
v_mfma_f32_16x16x32_bf16 v[172:175], a[100:103], v[76:79], v[172:175]
v_mfma_f32_16x16x32_bf16 v[176:179], a[164:167], v[76:79], v[176:179]
ds_read_b128 v[72:75], v6 offset:26624
ds_read_b128 v[76:79], v6 offset:27648
s_waitcnt lgkmcnt(6)
v_mfma_f32_16x16x32_bf16 v[160:163], a[40:43], v[80:83], v[160:163]
v_mfma_f32_16x16x32_bf16 v[164:167], a[40:43], v[84:87], v[164:167]
v_mfma_f32_16x16x32_bf16 v[168:171], a[104:107], v[80:83], v[168:171]
v_mfma_f32_16x16x32_bf16 v[172:175], a[104:107], v[84:87], v[172:175]
v_mfma_f32_16x16x32_bf16 v[176:179], a[168:171], v[84:87], v[176:179]
ds_read_b128 v[80:83], v6 offset:28672
ds_read_b128 v[84:87], v6 offset:29696
s_waitcnt lgkmcnt(6)
v_mfma_f32_16x16x32_bf16 v[160:163], a[44:47], v[88:91], v[160:163]
v_mfma_f32_16x16x32_bf16 v[164:167], a[44:47], v[92:95], v[164:167]
v_mfma_f32_16x16x32_bf16 v[168:171], a[108:111], v[88:91], v[168:171]
v_mfma_f32_16x16x32_bf16 v[172:175], a[108:111], v[92:95], v[172:175]
v_mfma_f32_16x16x32_bf16 v[176:179], a[172:175], v[92:95], v[176:179]
ds_read_b128 v[88:91], v6 offset:30720
ds_read_b128 v[92:95], v6 offset:31744
s_waitcnt lgkmcnt(6)
v_mfma_f32_16x16x32_bf16 v[160:163], a[48:51], v[64:67], v[160:163]
v_mfma_f32_16x16x32_bf16 v[164:167], a[48:51], v[68:71], v[164:167]
v_mfma_f32_16x16x32_bf16 v[168:171], a[112:115], v[64:67], v[168:171]
v_mfma_f32_16x16x32_bf16 v[172:175], a[112:115], v[68:71], v[172:175]
v_mfma_f32_16x16x32_bf16 v[176:179], a[176:179], v[68:71], v[176:179]
s_waitcnt lgkmcnt(4)
v_mfma_f32_16x16x32_bf16 v[160:163], a[52:55], v[72:75], v[160:163]
v_mfma_f32_16x16x32_bf16 v[164:167], a[52:55], v[76:79], v[164:167]
v_mfma_f32_16x16x32_bf16 v[168:171], a[116:119], v[72:75], v[168:171]
v_mfma_f32_16x16x32_bf16 v[172:175], a[116:119], v[76:79], v[172:175]
v_mfma_f32_16x16x32_bf16 v[176:179], a[180:183], v[76:79], v[176:179]
s_waitcnt lgkmcnt(2)
v_mfma_f32_16x16x32_bf16 v[160:163], a[56:59], v[80:83], v[160:163]
v_mfma_f32_16x16x32_bf16 v[164:167], a[56:59], v[84:87], v[164:167]
v_mfma_f32_16x16x32_bf16 v[168:171], a[120:123], v[80:83], v[168:171]
v_mfma_f32_16x16x32_bf16 v[172:175], a[120:123], v[84:87], v[172:175]
v_mfma_f32_16x16x32_bf16 v[176:179], a[184:187], v[84:87], v[176:179]
s_waitcnt lgkmcnt(0)
v_mfma_f32_16x16x32_bf16 v[160:163], a[60:63], v[88:91], v[160:163]
v_mfma_f32_16x16x32_bf16 v[164:167], a[60:63], v[92:95], v[164:167]
v_mfma_f32_16x16x32_bf16 v[168:171], a[124:127], v[88:91], v[168:171]
v_mfma_f32_16x16x32_bf16 v[172:175], a[124:127], v[92:95], v[172:175]
v_mfma_f32_16x16x32_bf16 v[176:179], a[188:191], v[92:95], v[176:179]
s_add_u32 s24, s41, 2048
buffer_store_dwordx4 v[160:163], v6, s[12:15], s24 offen sc1
s_add_u32 s24, s41, 38912
buffer_store_dwordx4 v[164:167], v6, s[12:15], s24 offen sc1
s_add_u32 s24, s41, 3072
buffer_store_dwordx4 v[168:171], v6, s[12:15], s24 offen sc1
s_add_u32 s24, s41, 39936
buffer_store_dwordx4 v[172:175], v6, s[12:15], s24 offen sc1
s_add_u32 s24, s41, 45056
buffer_store_dwordx4 v[176:179], v6, s[12:15], s24 offen sc1
s_branch L_ope_127
L_op_124:
s_cmp_lg_u32 s11, 2
s_cbranch_scc1 L_op_125
ds_read_b128 v[64:67], v6 offset:0
ds_read_b128 v[68:71], v6 offset:1024
ds_read_b128 v[72:75], v6 offset:2048
ds_read_b128 v[76:79], v6 offset:3072
ds_read_b128 v[80:83], v6 offset:4096
ds_read_b128 v[84:87], v6 offset:5120
ds_read_b128 v[88:91], v6 offset:6144
ds_read_b128 v[92:95], v6 offset:7168
s_waitcnt lgkmcnt(6)
v_mfma_f32_16x16x32_bf16 v[160:163], a[0:3], v[64:67], 0
v_mfma_f32_16x16x32_bf16 v[164:167], a[0:3], v[68:71], 0
v_mfma_f32_16x16x32_bf16 v[168:171], a[64:67], v[64:67], 0
v_mfma_f32_16x16x32_bf16 v[172:175], a[64:67], v[68:71], 0
ds_read_b128 v[64:67], v6 offset:8192
ds_read_b128 v[68:71], v6 offset:9216
s_waitcnt lgkmcnt(6)
v_mfma_f32_16x16x32_bf16 v[160:163], a[4:7], v[72:75], v[160:163]
v_mfma_f32_16x16x32_bf16 v[164:167], a[4:7], v[76:79], v[164:167]
v_mfma_f32_16x16x32_bf16 v[168:171], a[68:71], v[72:75], v[168:171]
v_mfma_f32_16x16x32_bf16 v[172:175], a[68:71], v[76:79], v[172:175]
ds_read_b128 v[72:75], v6 offset:10240
ds_read_b128 v[76:79], v6 offset:11264
s_waitcnt lgkmcnt(6)
v_mfma_f32_16x16x32_bf16 v[160:163], a[8:11], v[80:83], v[160:163]
v_mfma_f32_16x16x32_bf16 v[164:167], a[8:11], v[84:87], v[164:167]
v_mfma_f32_16x16x32_bf16 v[168:171], a[72:75], v[80:83], v[168:171]
v_mfma_f32_16x16x32_bf16 v[172:175], a[72:75], v[84:87], v[172:175]
ds_read_b128 v[80:83], v6 offset:12288
ds_read_b128 v[84:87], v6 offset:13312
s_waitcnt lgkmcnt(6)
v_mfma_f32_16x16x32_bf16 v[160:163], a[12:15], v[88:91], v[160:163]
v_mfma_f32_16x16x32_bf16 v[164:167], a[12:15], v[92:95], v[164:167]
v_mfma_f32_16x16x32_bf16 v[168:171], a[76:79], v[88:91], v[168:171]
v_mfma_f32_16x16x32_bf16 v[172:175], a[76:79], v[92:95], v[172:175]
ds_read_b128 v[88:91], v6 offset:14336
ds_read_b128 v[92:95], v6 offset:15360
s_waitcnt lgkmcnt(6)
v_mfma_f32_16x16x32_bf16 v[160:163], a[16:19], v[64:67], v[160:163]
v_mfma_f32_16x16x32_bf16 v[164:167], a[16:19], v[68:71], v[164:167]
v_mfma_f32_16x16x32_bf16 v[168:171], a[80:83], v[64:67], v[168:171]
v_mfma_f32_16x16x32_bf16 v[172:175], a[80:83], v[68:71], v[172:175]
ds_read_b128 v[64:67], v6 offset:16384
ds_read_b128 v[68:71], v6 offset:17408
s_waitcnt lgkmcnt(6)
v_mfma_f32_16x16x32_bf16 v[160:163], a[20:23], v[72:75], v[160:163]
v_mfma_f32_16x16x32_bf16 v[164:167], a[20:23], v[76:79], v[164:167]
v_mfma_f32_16x16x32_bf16 v[168:171], a[84:87], v[72:75], v[168:171]
v_mfma_f32_16x16x32_bf16 v[172:175], a[84:87], v[76:79], v[172:175]
ds_read_b128 v[72:75], v6 offset:18432
ds_read_b128 v[76:79], v6 offset:19456
s_waitcnt lgkmcnt(6)
v_mfma_f32_16x16x32_bf16 v[160:163], a[24:27], v[80:83], v[160:163]
v_mfma_f32_16x16x32_bf16 v[164:167], a[24:27], v[84:87], v[164:167]
v_mfma_f32_16x16x32_bf16 v[168:171], a[88:91], v[80:83], v[168:171]
v_mfma_f32_16x16x32_bf16 v[172:175], a[88:91], v[84:87], v[172:175]
ds_read_b128 v[80:83], v6 offset:20480
ds_read_b128 v[84:87], v6 offset:21504
s_waitcnt lgkmcnt(6)
v_mfma_f32_16x16x32_bf16 v[160:163], a[28:31], v[88:91], v[160:163]
v_mfma_f32_16x16x32_bf16 v[164:167], a[28:31], v[92:95], v[164:167]
v_mfma_f32_16x16x32_bf16 v[168:171], a[92:95], v[88:91], v[168:171]
v_mfma_f32_16x16x32_bf16 v[172:175], a[92:95], v[92:95], v[172:175]
ds_read_b128 v[88:91], v6 offset:22528
ds_read_b128 v[92:95], v6 offset:23552
s_waitcnt lgkmcnt(6)
v_mfma_f32_16x16x32_bf16 v[160:163], a[32:35], v[64:67], v[160:163]
v_mfma_f32_16x16x32_bf16 v[164:167], a[32:35], v[68:71], v[164:167]
v_mfma_f32_16x16x32_bf16 v[168:171], a[96:99], v[64:67], v[168:171]
v_mfma_f32_16x16x32_bf16 v[172:175], a[96:99], v[68:71], v[172:175]
ds_read_b128 v[64:67], v6 offset:24576
ds_read_b128 v[68:71], v6 offset:25600
s_waitcnt lgkmcnt(6)
v_mfma_f32_16x16x32_bf16 v[160:163], a[36:39], v[72:75], v[160:163]
v_mfma_f32_16x16x32_bf16 v[164:167], a[36:39], v[76:79], v[164:167]
v_mfma_f32_16x16x32_bf16 v[168:171], a[100:103], v[72:75], v[168:171]
v_mfma_f32_16x16x32_bf16 v[172:175], a[100:103], v[76:79], v[172:175]
ds_read_b128 v[72:75], v6 offset:26624
ds_read_b128 v[76:79], v6 offset:27648
s_waitcnt lgkmcnt(6)
v_mfma_f32_16x16x32_bf16 v[160:163], a[40:43], v[80:83], v[160:163]
v_mfma_f32_16x16x32_bf16 v[164:167], a[40:43], v[84:87], v[164:167]
v_mfma_f32_16x16x32_bf16 v[168:171], a[104:107], v[80:83], v[168:171]
v_mfma_f32_16x16x32_bf16 v[172:175], a[104:107], v[84:87], v[172:175]
ds_read_b128 v[80:83], v6 offset:28672
ds_read_b128 v[84:87], v6 offset:29696
s_waitcnt lgkmcnt(6)
v_mfma_f32_16x16x32_bf16 v[160:163], a[44:47], v[88:91], v[160:163]
v_mfma_f32_16x16x32_bf16 v[164:167], a[44:47], v[92:95], v[164:167]
v_mfma_f32_16x16x32_bf16 v[168:171], a[108:111], v[88:91], v[168:171]
v_mfma_f32_16x16x32_bf16 v[172:175], a[108:111], v[92:95], v[172:175]
ds_read_b128 v[88:91], v6 offset:30720
ds_read_b128 v[92:95], v6 offset:31744
s_waitcnt lgkmcnt(6)
v_mfma_f32_16x16x32_bf16 v[160:163], a[48:51], v[64:67], v[160:163]
v_mfma_f32_16x16x32_bf16 v[164:167], a[48:51], v[68:71], v[164:167]
v_mfma_f32_16x16x32_bf16 v[168:171], a[112:115], v[64:67], v[168:171]
v_mfma_f32_16x16x32_bf16 v[172:175], a[112:115], v[68:71], v[172:175]
s_waitcnt lgkmcnt(4)
v_mfma_f32_16x16x32_bf16 v[160:163], a[52:55], v[72:75], v[160:163]
v_mfma_f32_16x16x32_bf16 v[164:167], a[52:55], v[76:79], v[164:167]
v_mfma_f32_16x16x32_bf16 v[168:171], a[116:119], v[72:75], v[168:171]
v_mfma_f32_16x16x32_bf16 v[172:175], a[116:119], v[76:79], v[172:175]
s_waitcnt lgkmcnt(2)
v_mfma_f32_16x16x32_bf16 v[160:163], a[56:59], v[80:83], v[160:163]
v_mfma_f32_16x16x32_bf16 v[164:167], a[56:59], v[84:87], v[164:167]
v_mfma_f32_16x16x32_bf16 v[168:171], a[120:123], v[80:83], v[168:171]
v_mfma_f32_16x16x32_bf16 v[172:175], a[120:123], v[84:87], v[172:175]
s_waitcnt lgkmcnt(0)
v_mfma_f32_16x16x32_bf16 v[160:163], a[60:63], v[88:91], v[160:163]
v_mfma_f32_16x16x32_bf16 v[164:167], a[60:63], v[92:95], v[164:167]
v_mfma_f32_16x16x32_bf16 v[168:171], a[124:127], v[88:91], v[168:171]
v_mfma_f32_16x16x32_bf16 v[172:175], a[124:127], v[92:95], v[172:175]
s_add_u32 s24, s41, 4096
buffer_store_dwordx4 v[160:163], v6, s[12:15], s24 offen sc1
s_add_u32 s24, s41, 40960
buffer_store_dwordx4 v[164:167], v6, s[12:15], s24 offen sc1
s_add_u32 s24, s41, 5120
buffer_store_dwordx4 v[168:171], v6, s[12:15], s24 offen sc1
s_add_u32 s24, s41, 41984
s_nop 0
buffer_store_dwordx4 v[172:175], v6, s[12:15], s24 offen sc1
s_branch L_ope_127
L_op_125:
ds_read_b128 v[64:67], v6 offset:0
ds_read_b128 v[68:71], v6 offset:1024
ds_read_b128 v[72:75], v6 offset:2048
ds_read_b128 v[76:79], v6 offset:3072
ds_read_b128 v[80:83], v6 offset:4096
ds_read_b128 v[84:87], v6 offset:5120
ds_read_b128 v[88:91], v6 offset:6144
ds_read_b128 v[92:95], v6 offset:7168
s_waitcnt lgkmcnt(6)
v_mfma_f32_16x16x32_bf16 v[160:163], a[0:3], v[64:67], 0
v_mfma_f32_16x16x32_bf16 v[164:167], a[0:3], v[68:71], 0
v_mfma_f32_16x16x32_bf16 v[168:171], a[64:67], v[64:67], 0
v_mfma_f32_16x16x32_bf16 v[172:175], a[64:67], v[68:71], 0
ds_read_b128 v[64:67], v6 offset:8192
ds_read_b128 v[68:71], v6 offset:9216
s_waitcnt lgkmcnt(6)
v_mfma_f32_16x16x32_bf16 v[160:163], a[4:7], v[72:75], v[160:163]
v_mfma_f32_16x16x32_bf16 v[164:167], a[4:7], v[76:79], v[164:167]
v_mfma_f32_16x16x32_bf16 v[168:171], a[68:71], v[72:75], v[168:171]
v_mfma_f32_16x16x32_bf16 v[172:175], a[68:71], v[76:79], v[172:175]
ds_read_b128 v[72:75], v6 offset:10240
ds_read_b128 v[76:79], v6 offset:11264
s_waitcnt lgkmcnt(6)
v_mfma_f32_16x16x32_bf16 v[160:163], a[8:11], v[80:83], v[160:163]
v_mfma_f32_16x16x32_bf16 v[164:167], a[8:11], v[84:87], v[164:167]
v_mfma_f32_16x16x32_bf16 v[168:171], a[72:75], v[80:83], v[168:171]
v_mfma_f32_16x16x32_bf16 v[172:175], a[72:75], v[84:87], v[172:175]
ds_read_b128 v[80:83], v6 offset:12288
ds_read_b128 v[84:87], v6 offset:13312
s_waitcnt lgkmcnt(6)
v_mfma_f32_16x16x32_bf16 v[160:163], a[12:15], v[88:91], v[160:163]
v_mfma_f32_16x16x32_bf16 v[164:167], a[12:15], v[92:95], v[164:167]
v_mfma_f32_16x16x32_bf16 v[168:171], a[76:79], v[88:91], v[168:171]
v_mfma_f32_16x16x32_bf16 v[172:175], a[76:79], v[92:95], v[172:175]
ds_read_b128 v[88:91], v6 offset:14336
ds_read_b128 v[92:95], v6 offset:15360
s_waitcnt lgkmcnt(6)
v_mfma_f32_16x16x32_bf16 v[160:163], a[16:19], v[64:67], v[160:163]
v_mfma_f32_16x16x32_bf16 v[164:167], a[16:19], v[68:71], v[164:167]
v_mfma_f32_16x16x32_bf16 v[168:171], a[80:83], v[64:67], v[168:171]
v_mfma_f32_16x16x32_bf16 v[172:175], a[80:83], v[68:71], v[172:175]
ds_read_b128 v[64:67], v6 offset:16384
ds_read_b128 v[68:71], v6 offset:17408
s_waitcnt lgkmcnt(6)
v_mfma_f32_16x16x32_bf16 v[160:163], a[20:23], v[72:75], v[160:163]
v_mfma_f32_16x16x32_bf16 v[164:167], a[20:23], v[76:79], v[164:167]
v_mfma_f32_16x16x32_bf16 v[168:171], a[84:87], v[72:75], v[168:171]
v_mfma_f32_16x16x32_bf16 v[172:175], a[84:87], v[76:79], v[172:175]
ds_read_b128 v[72:75], v6 offset:18432
ds_read_b128 v[76:79], v6 offset:19456
s_waitcnt lgkmcnt(6)
v_mfma_f32_16x16x32_bf16 v[160:163], a[24:27], v[80:83], v[160:163]
v_mfma_f32_16x16x32_bf16 v[164:167], a[24:27], v[84:87], v[164:167]
v_mfma_f32_16x16x32_bf16 v[168:171], a[88:91], v[80:83], v[168:171]
v_mfma_f32_16x16x32_bf16 v[172:175], a[88:91], v[84:87], v[172:175]
ds_read_b128 v[80:83], v6 offset:20480
ds_read_b128 v[84:87], v6 offset:21504
s_waitcnt lgkmcnt(6)
v_mfma_f32_16x16x32_bf16 v[160:163], a[28:31], v[88:91], v[160:163]
v_mfma_f32_16x16x32_bf16 v[164:167], a[28:31], v[92:95], v[164:167]
v_mfma_f32_16x16x32_bf16 v[168:171], a[92:95], v[88:91], v[168:171]
v_mfma_f32_16x16x32_bf16 v[172:175], a[92:95], v[92:95], v[172:175]
ds_read_b128 v[88:91], v6 offset:22528
ds_read_b128 v[92:95], v6 offset:23552
s_waitcnt lgkmcnt(6)
v_mfma_f32_16x16x32_bf16 v[160:163], a[32:35], v[64:67], v[160:163]
v_mfma_f32_16x16x32_bf16 v[164:167], a[32:35], v[68:71], v[164:167]
v_mfma_f32_16x16x32_bf16 v[168:171], a[96:99], v[64:67], v[168:171]
v_mfma_f32_16x16x32_bf16 v[172:175], a[96:99], v[68:71], v[172:175]
ds_read_b128 v[64:67], v6 offset:24576
ds_read_b128 v[68:71], v6 offset:25600
s_waitcnt lgkmcnt(6)
v_mfma_f32_16x16x32_bf16 v[160:163], a[36:39], v[72:75], v[160:163]
v_mfma_f32_16x16x32_bf16 v[164:167], a[36:39], v[76:79], v[164:167]
v_mfma_f32_16x16x32_bf16 v[168:171], a[100:103], v[72:75], v[168:171]
v_mfma_f32_16x16x32_bf16 v[172:175], a[100:103], v[76:79], v[172:175]
ds_read_b128 v[72:75], v6 offset:26624
ds_read_b128 v[76:79], v6 offset:27648
s_waitcnt lgkmcnt(6)
v_mfma_f32_16x16x32_bf16 v[160:163], a[40:43], v[80:83], v[160:163]
v_mfma_f32_16x16x32_bf16 v[164:167], a[40:43], v[84:87], v[164:167]
v_mfma_f32_16x16x32_bf16 v[168:171], a[104:107], v[80:83], v[168:171]
v_mfma_f32_16x16x32_bf16 v[172:175], a[104:107], v[84:87], v[172:175]
ds_read_b128 v[80:83], v6 offset:28672
ds_read_b128 v[84:87], v6 offset:29696
s_waitcnt lgkmcnt(6)
v_mfma_f32_16x16x32_bf16 v[160:163], a[44:47], v[88:91], v[160:163]
v_mfma_f32_16x16x32_bf16 v[164:167], a[44:47], v[92:95], v[164:167]
v_mfma_f32_16x16x32_bf16 v[168:171], a[108:111], v[88:91], v[168:171]
v_mfma_f32_16x16x32_bf16 v[172:175], a[108:111], v[92:95], v[172:175]
ds_read_b128 v[88:91], v6 offset:30720
ds_read_b128 v[92:95], v6 offset:31744
s_waitcnt lgkmcnt(6)
v_mfma_f32_16x16x32_bf16 v[160:163], a[48:51], v[64:67], v[160:163]
v_mfma_f32_16x16x32_bf16 v[164:167], a[48:51], v[68:71], v[164:167]
v_mfma_f32_16x16x32_bf16 v[168:171], a[112:115], v[64:67], v[168:171]
v_mfma_f32_16x16x32_bf16 v[172:175], a[112:115], v[68:71], v[172:175]
s_waitcnt lgkmcnt(4)
v_mfma_f32_16x16x32_bf16 v[160:163], a[52:55], v[72:75], v[160:163]
v_mfma_f32_16x16x32_bf16 v[164:167], a[52:55], v[76:79], v[164:167]
v_mfma_f32_16x16x32_bf16 v[168:171], a[116:119], v[72:75], v[168:171]
v_mfma_f32_16x16x32_bf16 v[172:175], a[116:119], v[76:79], v[172:175]
s_waitcnt lgkmcnt(2)
v_mfma_f32_16x16x32_bf16 v[160:163], a[56:59], v[80:83], v[160:163]
v_mfma_f32_16x16x32_bf16 v[164:167], a[56:59], v[84:87], v[164:167]
v_mfma_f32_16x16x32_bf16 v[168:171], a[120:123], v[80:83], v[168:171]
v_mfma_f32_16x16x32_bf16 v[172:175], a[120:123], v[84:87], v[172:175]
s_waitcnt lgkmcnt(0)
v_mfma_f32_16x16x32_bf16 v[160:163], a[60:63], v[88:91], v[160:163]
v_mfma_f32_16x16x32_bf16 v[164:167], a[60:63], v[92:95], v[164:167]
v_mfma_f32_16x16x32_bf16 v[168:171], a[124:127], v[88:91], v[168:171]
v_mfma_f32_16x16x32_bf16 v[172:175], a[124:127], v[92:95], v[172:175]
s_add_u32 s24, s41, 6144
buffer_store_dwordx4 v[160:163], v6, s[12:15], s24 offen sc1
s_add_u32 s24, s41, 43008
buffer_store_dwordx4 v[164:167], v6, s[12:15], s24 offen sc1
s_add_u32 s24, s41, 7168
buffer_store_dwordx4 v[168:171], v6, s[12:15], s24 offen sc1
s_add_u32 s24, s41, 44032
s_nop 0
buffer_store_dwordx4 v[172:175], v6, s[12:15], s24 offen sc1
L_ope_127:
s_waitcnt vmcnt(0)
s_lshl_b32 s24, s48, 7
s_add_u32 s24, s24, 77604864
s_barrier
s_cmp_lg_u32 s11, 0
s_cbranch_scc1 L_sg_128
s_mov_b32 s60, s24
v_mov_b32 v1, 1
s_mov_b64 exec, 1
buffer_atomic_add v1, off, s[12:15], s60
s_mov_b64 exec, -1
L_sg_128:
s_mov_b32 s47, s48
s_add_u32 s48, s48, 7
s_cmp_lt_u32 s48, 64
s_nop 7
s_cbranch_scc1 L_p4loop
s_cmp_lt_i32 s47, 0
s_cbranch_scc1 L_cs_129
s_lshl_b32 s24, s47, 7
s_add_u32 s24, s24, 77604864
s_cmp_lg_u32 s11, 0
s_cbranch_scc1 L_wd_130
s_mov_b32 s60, s24
s_mov_b32 s61, 0
L_wp_131:
buffer_load_dword v1, off, s[12:15], s60 sc1
s_waitcnt vmcnt(0)
v_readfirstlane_b32 s62, v1
s_nop 0
s_cmp_ge_u32 s62, 32
s_cbranch_scc1 L_wd_130
s_add_u32 s61, s61, 1
s_cmp_gt_u32 s61, 4000000
s_cbranch_scc1 L_abortw
s_sleep 1
s_branch L_wp_131
L_wd_130:
s_barrier
s_lshl_b32 s32, s43, 2
s_add_u32 s32, s32, s11
s_cmp_ge_u32 s32, 18
s_cbranch_scc1 L_cs_129
s_cmp_ge_u32 s32, 9
s_cselect_b32 s33, 1, 0
s_mul_i32 s34, s33, 9
s_sub_u32 s32, s32, s34
s_lshl_b32 s45, s47, 1
s_add_u32 s45, s45, s33
s_mul_i32 s46, s44, 9
s_add_u32 s46, s46, s32
s_mul_i32 s24, s45, 36864
s_lshl_b32 s25, s46, 10
s_add_u32 s24, s24, s25
s_add_u32 s24, s24, 100663296
v_lshlrev_b32 v8, 4, v0
buffer_load_dwordx4 v[32:35], v8, s[12:15], s24 offen sc1
s_add_u32 s24, s24, 4718592
buffer_load_dwordx4 v[36:39], v8, s[12:15], s24 offen sc1
s_add_u32 s24, s24, 4718592
buffer_load_dwordx4 v[40:43], v8, s[12:15], s24 offen sc1
s_add_u32 s24, s24, 4718592
buffer_load_dwordx4 v[44:47], v8, s[12:15], s24 offen sc1
s_add_u32 s24, s24, 4718592
buffer_load_dwordx4 v[48:51], v8, s[12:15], s24 offen sc1
s_add_u32 s24, s24, 4718592
buffer_load_dwordx4 v[52:55], v8, s[12:15], s24 offen sc1
s_add_u32 s24, s24, 4718592
buffer_load_dwordx4 v[56:59], v8, s[12:15], s24 offen sc1
s_add_u32 s24, s24, 4718592
buffer_load_dwordx4 v[60:63], v8, s[12:15], s24 offen sc1
s_add_u32 s24, s24, 4718592
buffer_load_dwordx4 v[64:67], v8, s[12:15], s24 offen sc1
s_add_u32 s24, s24, 4718592
buffer_load_dwordx4 v[68:71], v8, s[12:15], s24 offen sc1
s_add_u32 s24, s24, 4718592
buffer_load_dwordx4 v[72:75], v8, s[12:15], s24 offen sc1
s_add_u32 s24, s24, 4718592
buffer_load_dwordx4 v[76:79], v8, s[12:15], s24 offen sc1
s_add_u32 s24, s24, 4718592
v_and_b32 v9, 15, v0
v_mul_u32_u24 v9, 1152, v9
v_lshrrev_b32 v10, 4, v0
v_lshl_add_u32 v9, v10, 3, v9
s_mul_i32 s24, s45, 18432
s_lshl_b32 s25, s46, 5
s_add_u32 s24, s24, s25
buffer_load_dwordx2 v[12:13], v9, s[16:19], s24 offen
s_waitcnt vmcnt(0)
v_add_f32 v32, v32, v36
v_add_f32 v33, v33, v37
v_add_f32 v34, v34, v38
v_add_f32 v35, v35, v39
v_add_f32 v32, v32, v40
v_add_f32 v33, v33, v41
v_add_f32 v34, v34, v42
v_add_f32 v35, v35, v43
v_add_f32 v32, v32, v44
v_add_f32 v33, v33, v45
v_add_f32 v34, v34, v46
v_add_f32 v35, v35, v47
v_add_f32 v32, v32, v48
v_add_f32 v33, v33, v49
v_add_f32 v34, v34, v50
v_add_f32 v35, v35, v51
v_add_f32 v32, v32, v52
v_add_f32 v33, v33, v53
v_add_f32 v34, v34, v54
v_add_f32 v35, v35, v55
v_add_f32 v32, v32, v56
v_add_f32 v33, v33, v57
v_add_f32 v34, v34, v58
v_add_f32 v35, v35, v59
v_add_f32 v32, v32, v60
v_add_f32 v33, v33, v61
v_add_f32 v34, v34, v62
v_add_f32 v35, v35, v63
v_add_f32 v32, v32, v64
v_add_f32 v33, v33, v65
v_add_f32 v34, v34, v66
v_add_f32 v35, v35, v67
v_add_f32 v32, v32, v68
v_add_f32 v33, v33, v69
v_add_f32 v34, v34, v70
v_add_f32 v35, v35, v71
v_add_f32 v32, v32, v72
v_add_f32 v33, v33, v73
v_add_f32 v34, v34, v74
v_add_f32 v35, v35, v75
v_add_f32 v32, v32, v76
v_add_f32 v33, v33, v77
v_add_f32 v34, v34, v78
v_add_f32 v35, v35, v79
v_lshlrev_b32 v14, 16, v12
v_and_b32 v15, 0xffff0000, v12
v_lshlrev_b32 v16, 16, v13
v_and_b32 v17, 0xffff0000, v13
v_add_f32 v32, v32, v14
v_add_f32 v33, v33, v15
v_add_f32 v34, v34, v16
v_add_f32 v35, v35, v17
v_cvt_pk_bf16_f32 v12, v32, v33
v_cvt_pk_bf16_f32 v13, v34, v35
buffer_store_dwordx2 v[12:13], v9, s[20:23], s24 offen
L_cs_129:
L_abortw:
s_waitcnt vmcnt(0)
L_exit:
s_endpgm
.section .rodata,"a"
.p2align 6
.amdhsa_kernel parallel_sum__memory_aug_recurrent_mem_tr__mixer_token_mlp__prompt_kernel
  .amdhsa_next_free_vgpr 512
  .amdhsa_next_free_sgpr 102
  .amdhsa_accum_offset 256
  .amdhsa_group_segment_fixed_size 0
  .amdhsa_kernarg_size 120
  .amdhsa_user_sgpr_count 2
  .amdhsa_user_sgpr_kernarg_segment_ptr 1
  .amdhsa_system_sgpr_workgroup_id_x 1
.end_amdhsa_kernel
```
